```python
import torch

def _softmax(x, axis=-1):
    return torch.softmax(x, dim=axis)
def _gelu(x):
    return torch.nn.functional.gelu(x, approximate="tanh")
def _silu(x):
    return torch.nn.functional.silu(x)
def _sigmoid(x):
    return torch.sigmoid(x)
def _layernorm(x, axis=-1, eps=1e-5):
    m = x.mean(dim=axis, keepdim=True)
    v = x.var(dim=axis, keepdim=True, unbiased=False)
    return (x - m) / torch.sqrt(v + eps)
def _scatter_add(tgt, idx, src, axis=0):
    return tgt.clone().index_add_(axis, idx, src)
def _segment_sum(src, seg, n):
    out = torch.zeros((n,) + src.shape[1:], dtype=src.dtype)
    return out.index_add_(0, seg, src)
def _pad(x, pw):
    flat = tuple(v for pair in reversed(pw) for v in pair)
    return torch.nn.functional.pad(x, flat)

kernel_name = 'recurrent_scan__ssm_conv_s5__glu_gated_bilinear__prompt'

def setup_inputs():

    _w = (lambda a: (lambda t: t.to(torch.bfloat16) if t.is_floating_point() else t)(torch.as_tensor(a)))
    def _A_setup():
        B, S, D = 1, 2048, 576
        P = D
        Lambda_re = -0.5 * (lambda _x: torch.exp(torch.as_tensor(_x)))((lambda *s: torch.randn(*s, dtype=torch.bfloat16) * 0.8)(P))
        Lambda_im = (lambda *s: torch.randn(*s, dtype=torch.bfloat16) * 0.8)(P) * 1.0
        B_re = (lambda *s: torch.randn(*s, dtype=torch.bfloat16) * 1.6)(P, D) * (D ** -0.5)
        B_im = (lambda *s: torch.randn(*s, dtype=torch.bfloat16) * 1.6)(P, D) * (D ** -0.5)
        C_re = (lambda *s: torch.randn(*s, dtype=torch.bfloat16) * 1.6)(D, P) * (P ** -0.5)
        C_im = (lambda *s: torch.randn(*s, dtype=torch.bfloat16) * 1.6)(D, P) * (P ** -0.5)
        log_dt = (lambda *s: torch.randn(*s, dtype=torch.bfloat16) * 0.8)(P) * 0.3 - 2.0
        Dskip = (lambda *s: torch.randn(*s, dtype=torch.bfloat16) * 0.8)(D)
        return {
            "x": _w((lambda *s: torch.randn(*s, dtype=torch.bfloat16) * 0.05)(B, S, D)),
            "Lambda_re": _w(Lambda_re),
            "Lambda_im": _w(Lambda_im),
            "B_re": _w(B_re),
            "B_im": _w(B_im),
            "C_re": _w(C_re),
            "C_im": _w(C_im),
            "log_dt": _w(log_dt),
            "Dskip": _w(Dskip),
        }
    _A_in = _A_setup()

    def _B_setup():
        B, S, D, F = 1, 2048, 576, 4608
        return {
            "x": _w((lambda *s: torch.randn(*s, dtype=torch.bfloat16) * 0.05)(B, S, D)),
            "w_gate": _w((lambda *s: torch.randn(*s, dtype=torch.bfloat16) * 0.2)(D, F) * (D ** -0.5)),
            "w_up": _w((lambda *s: torch.randn(*s, dtype=torch.bfloat16) * 0.2)(D, F) * (D ** -0.5)),
            "w_down": _w((lambda *s: torch.randn(*s, dtype=torch.bfloat16) * 0.2)(F, D) * (F ** -0.5)),
        }
    _B_in = _B_setup()

    return {
        "A_x": _A_in["x"],
        "A_Lambda_re": _A_in["Lambda_re"],
        "A_Lambda_im": _A_in["Lambda_im"],
        "A_B_re": _A_in["B_re"],
        "A_B_im": _A_in["B_im"],
        "A_C_re": _A_in["C_re"],
        "A_C_im": _A_in["C_im"],
        "A_log_dt": _A_in["log_dt"],
        "A_Dskip": _A_in["Dskip"],
        "B_x": _B_in["x"],
        "B_w_gate": _B_in["w_gate"],
        "B_w_up": _B_in["w_up"],
        "B_w_down": _B_in["w_down"],
    }

def reference(A_x, A_Lambda_re, A_Lambda_im, A_B_re, A_B_im, A_C_re, A_C_im, A_log_dt, A_Dskip, B_x, B_w_gate, B_w_up, B_w_down):
    def _A_ref(x, Lambda_re, Lambda_im, B_re, B_im, C_re, C_im, log_dt, Dskip):
        Bsz, L, H = x.shape
        Lam = Lambda_re + 1j * Lambda_im
        Bmat = B_re + 1j * B_im
        Cmat = C_re + 1j * C_im
        dt = torch.exp(log_dt)
        Lam_bar = torch.exp(dt * Lam)
        B_bar = ((Lam_bar - 1.0) / Lam)[:, None] * Bmat
        Bu = torch.einsum("bld,pd->blp", x + 0j, B_bar)
        h = torch.zeros_like(Bu[:, 0, :])
        hs = []
        for t in range(L):
            h = Lam_bar[None, :] * h + Bu[:, t, :]
            hs.append(h)
        hseq = torch.stack(hs, 1)
        y = 2.0 * torch.einsum("blp,dp->bld", hseq, Cmat).real + x * Dskip[None, None, :]
        return y

    def _B_ref(x, w_gate, w_up, w_down):
        g = torch.einsum("bsd,df->bsf", x, w_gate)
        u = torch.einsum("bsd,df->bsf", x, w_up)
        h = g * u
        return torch.einsum("bsf,fd->bsd", h, w_down)

    x = A_x
    xn = _layernorm(x, axis=-1)
    s = _A_ref(xn, A_Lambda_re, A_Lambda_im, A_B_re, A_B_im, A_C_re, A_C_im, A_log_dt, A_Dskip)
    g = _silu(_B_ref(xn, B_w_gate, B_w_up, B_w_down))
    return x + s * g
```

```asm
; @launch grid=(256,1,1) block=(256,1,1) lds=163840
.amdgcn_target "amdgcn-amd-amdhsa--gfx950"
.text
.globl recurrent_scan__ssm_conv_s5__glu_gated_bilinear__prompt_kernel
.p2align 12
.p2align 8
.type recurrent_scan__ssm_conv_s5__glu_gated_bilinear__prompt_kernel,@function
recurrent_scan__ssm_conv_s5__glu_gated_bilinear__prompt_kernel:
s_cmp_lt_u32 s2, 256
s_cbranch_scc1 L_go
s_endpgm
L_go:
s_getpc_b64 s[6:7]
L_pc:
s_lshl_b32 s38, s2, 12
s_and_b32 s38, s38, 0x38000
v_lshl_add_u32 v1, v0, 7, s38
v_min_u32 v1, L_end-L_pc, v1
global_load_dword v60, v1, s[6:7]
s_load_dwordx2 s[52:53], s[0:1], 0
s_load_dwordx2 s[4:5], s[0:1], 120
s_load_dwordx4 s[64:67], s[0:1], 80
s_load_dwordx4 s[8:11], s[0:1], 24
s_load_dwordx4 s[56:59], s[0:1], 8
s_load_dwordx2 s[60:61], s[0:1], 56
s_load_dwordx4 s[68:71], s[0:1], 40
s_load_dwordx2 s[72:73], s[0:1], 96
v_lshrrev_b32 v177, 6, v0
v_and_b32 v176, 63, v0
v_readfirstlane_b32 s3, v177
v_lshlrev_b32 v200, 4, v176
s_and_b32 s12, s2, 7
s_lshr_b32 s13, s2, 3
s_and_b32 s14, s13, 7
s_lshr_b32 s18, s13, 3
s_lshl_b32 s15, s12, 2
s_add_u32 s15, s15, s18
s_and_b32 s16, s3, 1
s_lshr_b32 s17, s3, 1
s_lshl_b32 s51, s14, 5
s_add_u32 s51, s51, s15
s_lshl_b32 s51, s51, 2
s_add_u32 s51, s51, s3
s_lshl_b32 s18, s51, 1
v_lshrrev_b32 v177, 5, v176
v_add_u32 v178, s18, v177
v_and_b32 v179, 31, v176
v_mul_u32_u24 v180, 1152, v178
v_lshl_add_u32 v9, v179, 2, v180
v_lshl_add_u32 v180, v179, 4, v180
s_waitcnt lgkmcnt(0)
s_mov_b32 s24, s52
s_mov_b32 s25, s53
s_mov_b32 s26, 2359296
s_mov_b32 s27, 0x20000
buffer_load_dwordx4 v[0:3], v180, s[24:27], 0 offen
buffer_load_dwordx4 v[4:7], v180, s[24:27], 0 offen offset:512
buffer_load_dword v8, v9, s[24:27], 0 offen offset:1024
s_add_u32 s6, s4, 4587520
s_addc_u32 s7, s5, 0
s_load_dword s96, s[6:7], 0
s_mov_b32 s20, s4
s_mov_b32 s21, s5
s_mov_b32 s22, 48758784
s_mov_b32 s23, 0x20000
s_mul_i32 s35, s16, 3
s_mov_b32 s42, 6554
s_add_u32 s36, s35, 0
s_lshl_b32 s36, s36, 6
v_add_u32 v181, s36, v176
v_mul_lo_u32 v182, v181, s42
v_lshrrev_b32 v182, 16, v182
v_mul_u32_u24 v183, 10, v182
v_sub_u32 v183, v181, v183
v_bfe_u32 v184, v182, 2, 2
v_lshlrev_b32 v184, 3, v184
v_lshrrev_b32 v181, 4, v182
v_lshl_add_u32 v184, v181, 2, v184
v_and_b32 v181, 3, v182
v_add_u32 v184, v184, v181
v_mul_u32_u24 v184, 9216, v184
v_lshl_add_u32 v204, v183, 4, v184
s_add_u32 s36, s35, 1
s_lshl_b32 s36, s36, 6
v_add_u32 v181, s36, v176
v_mul_lo_u32 v182, v181, s42
v_lshrrev_b32 v182, 16, v182
v_mul_u32_u24 v183, 10, v182
v_sub_u32 v183, v181, v183
v_bfe_u32 v184, v182, 2, 2
v_lshlrev_b32 v184, 3, v184
v_lshrrev_b32 v181, 4, v182
v_lshl_add_u32 v184, v181, 2, v184
v_and_b32 v181, 3, v182
v_add_u32 v184, v184, v181
v_mul_u32_u24 v184, 9216, v184
v_lshl_add_u32 v205, v183, 4, v184
v_subrev_u32 v205, 1024, v205
s_add_u32 s36, s35, 2
s_lshl_b32 s36, s36, 6
v_add_u32 v181, s36, v176
v_mul_lo_u32 v182, v181, s42
v_lshrrev_b32 v182, 16, v182
v_mul_u32_u24 v183, 10, v182
v_sub_u32 v183, v181, v183
v_bfe_u32 v184, v182, 2, 2
v_lshlrev_b32 v184, 3, v184
v_lshrrev_b32 v181, 4, v182
v_lshl_add_u32 v184, v181, 2, v184
v_and_b32 v181, 3, v182
v_add_u32 v184, v184, v181
v_mul_u32_u24 v184, 9216, v184
v_lshl_add_u32 v206, v183, 4, v184
v_lshrrev_b32 v181, 2, v176
v_lshrrev_b32 v182, 4, v176
v_sub_u32 v182, 4, v182
v_xor_b32 v182, v182, v176
v_and_b32 v182, 3, v182
v_mul_u32_u24 v181, 1152, v181
v_lshl_add_u32 v181, v182, 4, v181
s_cmp_eq_u32 s16, 1
s_cselect_b64 vcc, -1, 0
v_cndmask_b32 v206, v206, v181, vcc
s_cmp_eq_u32 s17, 1
s_cselect_b32 s24, s66, s64
s_cselect_b32 s25, s67, s65
s_mov_b32 s26, 5308416
s_mov_b32 s27, 0x20000
s_cselect_b32 s32, s10, s8
s_cselect_b32 s33, s11, s9
s_cmp_eq_u32 s16, 1
s_cselect_b32 s28, s32, s24
s_cselect_b32 s29, s33, s25
s_cselect_b32 s30, 663552, s26
s_mov_b32 s31, 0x20000
s_cselect_b32 s41, 64, 294912
s_mul_i32 s39, s12, 1152
s_and_b32 s36, s15, 3
s_mul_i32 s36, s36, 160
s_add_u32 s39, s39, s36
s_mul_i32 s40, s15, 18432
s_cmp_eq_u32 s16, 1
s_cselect_b32 s40, s40, s39
s_mul_i32 s44, s3, 3072
s_add_u32 m0, s44, 131072
s_nop 0
buffer_load_dwordx4 v204, s[24:27], s39 offen lds
buffer_load_dwordx4 v205, s[24:27], s39 offen offset:1024 lds
s_add_u32 s39, s39, 294912
s_add_u32 m0, s44, 133120
s_nop 0
buffer_load_dwordx4 v206, s[28:31], s40 offen lds
s_add_u32 s40, s40, s41
s_lshl_b32 s6, s13, 1
s_add_u32 s6, s6, s16
s_mul_i32 s7, s12, 1152
s_mul_i32 s19, s6, 27648
s_add_u32 s19, s19, s7
s_add_u32 s19, s19, 294912
v_min_u32 v186, 14, v176
v_mul_u32_u24 v187, 52, v186
v_lshrrev_b32 v187, 8, v187
v_mul_u32_u24 v187, 8576, v187
v_lshl_add_u32 v186, v186, 7, v187
buffer_load_dword a255, v186, s[24:27], s19 offen
s_lshl_b32 s19, s12, 5
s_add_u32 s19, s19, s13
s_mul_i32 s19, s19, 2304
s_cmp_eq_u32 s16, 1
s_cselect_b32 s19, s19, 1073741824
v_min_u32 v186, 17, v176
v_lshlrev_b32 v186, 7, v186
buffer_load_dword a255, v186, s[28:31], s19 offen
s_mov_b32 s76, s56
s_mov_b32 s77, s57
s_mov_b32 s78, 1152
s_mov_b32 s79, 0x20000
s_mov_b32 s80, s58
s_mov_b32 s81, s59
s_mov_b32 s82, 1152
s_mov_b32 s83, 0x20000
s_mov_b32 s84, s60
s_mov_b32 s85, s61
s_mov_b32 s86, 1152
s_mov_b32 s87, 0x20000
s_mov_b32 s62, s15
v_and_b32 v181, 15, v176
s_lshl_b32 s18, s62, 4
v_add_lshl_u32 v195, v181, s18, 1
buffer_load_ushort v192, v195, s[76:79], 0 offen
buffer_load_ushort v193, v195, s[80:83], 0 offen
buffer_load_ushort v194, v195, s[84:87], 0 offen
v_bfe_u32 v181, v178, 5, 2
v_sub_u32 v182, 4, v181
v_xor_b32 v182, v182, v179
v_and_b32 v182, 3, v182
v_and_b32 v183, 3, v178
v_lshl_add_u32 v181, v181, 2, v183
v_lshl_add_u32 v181, v181, 2, v182
v_lshlrev_b32 v181, 4, v181
v_bfe_u32 v182, v178, 7, 1
v_bfe_u32 v183, v178, 2, 3
v_lshl_add_u32 v182, v182, 3, v183
v_lshl_add_u32 v181, v182, 10, v181
v_lshrrev_b32 v182, 2, v179
v_xor_b32 v10, v182, v179
v_and_b32 v10, 3, v10
v_lshlrev_b32 v10, 4, v10
v_xor_b32 v10, v10, v181
v_lshrrev_b32 v11, 4, v179
v_lshl_add_u32 v10, v11, 14, v10
v_and_b32 v11, 3, v179
v_lshl_add_u32 v10, v11, 2, v10
v_lshrrev_b32 v182, 2, v179
v_lshl_add_u32 v181, v182, 14, v181
s_mul_i32 s18, s14, 294912
s_lshl_b32 s43, s3, 12
s_add_u32 s38, s18, s43
s_waitcnt vmcnt(8)
v_lshlrev_b32 v16, 16, v0
v_and_b32 v17, 0xffff0000, v0
v_lshlrev_b32 v18, 16, v1
v_and_b32 v19, 0xffff0000, v1
v_pk_add_f32 v[40:41], v[16:17], v[18:19]
v_lshlrev_b32 v20, 16, v2
v_and_b32 v21, 0xffff0000, v2
v_lshlrev_b32 v22, 16, v3
v_and_b32 v23, 0xffff0000, v3
v_pk_add_f32 v[42:43], v[20:21], v[22:23]
v_lshlrev_b32 v24, 16, v4
v_and_b32 v25, 0xffff0000, v4
v_lshlrev_b32 v26, 16, v5
v_and_b32 v27, 0xffff0000, v5
v_pk_add_f32 v[42:43], v[42:43], v[24:25]
v_lshlrev_b32 v28, 16, v6
v_and_b32 v29, 0xffff0000, v6
v_pk_add_f32 v[40:41], v[40:41], v[26:27]
v_lshlrev_b32 v30, 16, v7
v_and_b32 v31, 0xffff0000, v7
v_pk_add_f32 v[42:43], v[42:43], v[28:29]
v_lshlrev_b32 v32, 16, v8
v_and_b32 v33, 0xffff0000, v8
v_pk_add_f32 v[40:41], v[40:41], v[30:31]
v_pk_add_f32 v[42:43], v[42:43], v[32:33]
v_pk_add_f32 v[40:41], v[40:41], v[42:43]
v_add_f32 v40, v40, v41
s_nop 1
v_add_f32_dpp v40, v40, v40 row_ror:8 row_mask:0xf bank_mask:0xf
s_nop 1
v_add_f32_dpp v40, v40, v40 row_ror:4 row_mask:0xf bank_mask:0xf
s_nop 1
v_add_f32_dpp v40, v40, v40 row_ror:2 row_mask:0xf bank_mask:0xf
s_nop 1
v_add_f32_dpp v40, v40, v40 row_ror:1 row_mask:0xf bank_mask:0xf
v_mov_b32 v41, v40
s_nop 1
v_permlane16_swap_b32 v40, v41
v_add_f32 v40, v40, v41
v_mul_f32 v40, 3135475257, v40
v_pk_add_f32 v[64:65], v[16:17], v[40:41] op_sel_hi:[1,0]
v_pk_add_f32 v[66:67], v[18:19], v[40:41] op_sel_hi:[1,0]
v_pk_add_f32 v[68:69], v[20:21], v[40:41] op_sel_hi:[1,0]
v_pk_add_f32 v[70:71], v[22:23], v[40:41] op_sel_hi:[1,0]
v_pk_add_f32 v[72:73], v[24:25], v[40:41] op_sel_hi:[1,0]
v_pk_add_f32 v[74:75], v[26:27], v[40:41] op_sel_hi:[1,0]
v_pk_add_f32 v[76:77], v[28:29], v[40:41] op_sel_hi:[1,0]
v_pk_add_f32 v[78:79], v[30:31], v[40:41] op_sel_hi:[1,0]
v_pk_add_f32 v[80:81], v[32:33], v[40:41] op_sel_hi:[1,0]
v_pk_mul_f32 v[42:43], v[64:65], v[64:65]
v_pk_mul_f32 v[44:45], v[66:67], v[66:67]
v_pk_fma_f32 v[42:43], v[68:69], v[68:69], v[42:43]
v_pk_fma_f32 v[44:45], v[70:71], v[70:71], v[44:45]
v_pk_fma_f32 v[42:43], v[72:73], v[72:73], v[42:43]
v_pk_fma_f32 v[44:45], v[74:75], v[74:75], v[44:45]
v_pk_fma_f32 v[42:43], v[76:77], v[76:77], v[42:43]
v_pk_fma_f32 v[44:45], v[78:79], v[78:79], v[44:45]
v_pk_fma_f32 v[42:43], v[80:81], v[80:81], v[42:43]
v_cvt_pk_bf16_f32 v40, 0, v40
v_pk_add_f32 v[42:43], v[42:43], v[44:45]
v_add_f32 v42, v42, v43
v_pk_add_f32 v[16:17], v[16:17], v[40:41] op_sel_hi:[1,0]
v_pk_add_f32 v[18:19], v[18:19], v[40:41] op_sel_hi:[1,0]
v_add_f32_dpp v42, v42, v42 row_ror:8 row_mask:0xf bank_mask:0xf
v_pk_add_f32 v[20:21], v[20:21], v[40:41] op_sel_hi:[1,0]
v_pk_add_f32 v[22:23], v[22:23], v[40:41] op_sel_hi:[1,0]
v_add_f32_dpp v42, v42, v42 row_ror:4 row_mask:0xf bank_mask:0xf
v_pk_add_f32 v[24:25], v[24:25], v[40:41] op_sel_hi:[1,0]
v_pk_add_f32 v[26:27], v[26:27], v[40:41] op_sel_hi:[1,0]
v_add_f32_dpp v42, v42, v42 row_ror:2 row_mask:0xf bank_mask:0xf
v_pk_add_f32 v[28:29], v[28:29], v[40:41] op_sel_hi:[1,0]
v_pk_add_f32 v[30:31], v[30:31], v[40:41] op_sel_hi:[1,0]
v_add_f32_dpp v42, v42, v42 row_ror:1 row_mask:0xf bank_mask:0xf
v_mov_b32 v43, v42
v_pk_add_f32 v[32:33], v[32:33], v[40:41] op_sel_hi:[1,0]
v_cvt_pk_bf16_f32 v16, 0, v16
v_permlane16_swap_b32 v42, v43
v_cvt_pk_bf16_f32 v17, 0, v17
v_cvt_pk_bf16_f32 v18, 0, v18
v_add_f32 v42, v42, v43
v_cvt_pk_bf16_f32 v19, 0, v19
v_cvt_pk_bf16_f32 v20, 0, v20
v_mul_f32 v42, 987991609, v42
v_cvt_pk_bf16_f32 v21, 0, v21
v_cvt_pk_bf16_f32 v22, 0, v22
v_cvt_pk_bf16_f32 v42, 0, v42
v_cvt_pk_bf16_f32 v23, 0, v23
v_cvt_pk_bf16_f32 v24, 0, v24
v_add_f32 v42, 925353388, v42
v_cvt_pk_bf16_f32 v25, 0, v25
v_cvt_pk_bf16_f32 v26, 0, v26
v_cvt_pk_bf16_f32 v42, 0, v42
v_cvt_pk_bf16_f32 v27, 0, v27
v_cvt_pk_bf16_f32 v28, 0, v28
v_sqrt_f32 v42, v42
v_cvt_pk_bf16_f32 v29, 0, v29
v_cvt_pk_bf16_f32 v30, 0, v30
v_cvt_pk_bf16_f32 v42, 0, v42
v_cvt_pk_bf16_f32 v31, 0, v31
v_cvt_pk_bf16_f32 v32, 0, v32
v_rcp_f32 v42, v42
v_cvt_pk_bf16_f32 v33, 0, v33
v_pk_mul_f32 v[16:17], v[16:17], v[42:43] op_sel_hi:[1,0]
v_pk_mul_f32 v[18:19], v[18:19], v[42:43] op_sel_hi:[1,0]
v_pk_mul_f32 v[20:21], v[20:21], v[42:43] op_sel_hi:[1,0]
v_pk_mul_f32 v[22:23], v[22:23], v[42:43] op_sel_hi:[1,0]
v_cvt_pk_bf16_f32 v0, v16, v17
v_cvt_pk_bf16_f32 v1, v18, v19
v_cvt_pk_bf16_f32 v2, v20, v21
v_cvt_pk_bf16_f32 v3, v22, v23
buffer_store_dwordx4 v[0:3], v181, s[20:23], s18 offen sc1
s_add_u32 s18, s18, 131072
v_pk_mul_f32 v[24:25], v[24:25], v[42:43] op_sel_hi:[1,0]
v_pk_mul_f32 v[26:27], v[26:27], v[42:43] op_sel_hi:[1,0]
v_pk_mul_f32 v[28:29], v[28:29], v[42:43] op_sel_hi:[1,0]
v_pk_mul_f32 v[30:31], v[30:31], v[42:43] op_sel_hi:[1,0]
v_cvt_pk_bf16_f32 v4, v24, v25
v_cvt_pk_bf16_f32 v5, v26, v27
v_cvt_pk_bf16_f32 v6, v28, v29
v_cvt_pk_bf16_f32 v7, v30, v31
buffer_store_dwordx4 v[4:7], v181, s[20:23], s18 offen sc1
s_add_u32 s18, s18, 131072
v_pk_mul_f32 v[32:33], v[32:33], v[42:43] op_sel_hi:[1,0]
v_cvt_pk_bf16_f32 v8, v32, v33
buffer_store_dword v8, v10, s[20:23], s18 offen sc1
s_add_u32 s18, s18, 131072
v_and_b32 v185, 15, v176
v_lshrrev_b32 v182, 2, v185
v_sub_u32 v182, 4, v182
v_lshrrev_b32 v183, 4, v176
v_xor_b32 v182, v182, v183
v_and_b32 v182, 3, v182
v_lshl_add_u32 v185, v185, 2, v182
v_lshlrev_b32 v185, 4, v185
s_lshl_b32 s36, s17, 13
s_add_u32 s36, s36, 114688
v_add_u32 v201, s36, v185
v_lshrrev_b32 v181, 2, v176
v_mul_u32_u24 v181, 160, v181
v_and_b32 v182, 3, v176
v_lshl_add_u32 v181, v182, 3, v181
s_lshl_b32 s36, s16, 6
s_add_u32 s36, s36, 131072
v_add_u32 v202, s36, v181
v_add_u32 v203, 131200, v181
v_add_u32 v181, 136192, v185
s_cmp_eq_u32 s16, 1
s_cselect_b64 vcc, -1, 0
v_cndmask_b32 v203, v203, v181, vcc
s_lshl_b32 s45, s51, 5
s_add_u32 s18, s45, 4456448
s_add_u32 s45, s45, 4489216
s_waitcnt vmcnt(0) lgkmcnt(0)
s_mul_i32 s96, s96, 1664525
s_add_u32 s96, s96, 1013904223
v_mov_b32 v181, 0
v_mov_b32 v182, s96
s_mov_b64 exec, 1
buffer_store_dword v182, v181, s[20:23], s18 offen sc1
s_mov_b64 exec, -1
s_add_u32 m0, s44, 16384
s_nop 0
buffer_load_dwordx4 v204, s[24:27], s39 offen lds
buffer_load_dwordx4 v205, s[24:27], s39 offen offset:1024 lds
s_add_u32 s39, s39, 294912
s_add_u32 m0, s44, 18432
s_nop 0
buffer_load_dwordx4 v206, s[28:31], s40 offen lds
s_add_u32 s40, s40, s41
s_add_u32 m0, s44, 45056
s_nop 0
buffer_load_dwordx4 v204, s[24:27], s39 offen lds
buffer_load_dwordx4 v205, s[24:27], s39 offen offset:1024 lds
s_add_u32 s39, s39, 294912
s_add_u32 m0, s44, 47104
s_nop 0
buffer_load_dwordx4 v206, s[28:31], s40 offen lds
s_add_u32 s40, s40, s41
s_add_u32 m0, s44, 73728
s_nop 0
buffer_load_dwordx4 v204, s[24:27], s39 offen lds
buffer_load_dwordx4 v205, s[24:27], s39 offen offset:1024 lds
s_add_u32 s39, s39, 294912
s_add_u32 m0, s44, 75776
s_nop 0
buffer_load_dwordx4 v206, s[28:31], s40 offen lds
s_add_u32 s40, s40, s41
s_lshl_b32 s6, s13, 1
s_add_u32 s6, s6, s16
s_mul_i32 s7, s12, 1152
s_mul_i32 s19, s6, 27648
s_add_u32 s19, s19, s7
s_add_u32 s19, s19, 2064384
v_min_u32 v186, 14, v176
v_mul_u32_u24 v187, 52, v186
v_lshrrev_b32 v187, 8, v187
v_mul_u32_u24 v187, 8576, v187
v_lshl_add_u32 v186, v186, 7, v187
buffer_load_dword a255, v186, s[24:27], s19 offen
s_mul_i32 s19, s13, 2304
s_add_u32 s19, s19, 589824
s_cmp_eq_u32 s16, 1
s_cselect_b32 s19, s19, 1073741824
v_min_u32 v186, 17, v176
v_lshlrev_b32 v186, 7, v186
buffer_load_dword a255, v186, s[28:31], s19 offen
s_mov_b32 s19, 2731
s_cmp_ge_u32 s13, 24
s_cselect_b64 vcc, -1, 0
v_add_u32 v181, 0, v176
v_mul_lo_u32 v182, v181, s19
v_lshrrev_b32 v182, 16, v182
v_mul_u32_u24 v183, 24, v182
v_sub_u32 v181, v181, v183
v_and_b32 v183, 6, v182
v_xor_b32 v181, v181, v183
v_mul_u32_u24 v182, 1152, v182
v_lshl_add_u32 v181, v181, 4, v182
v_subrev_u32 v181, 0, v181
v_cndmask_b32 v219, v181, v200, vcc
v_add_u32 v181, 64, v176
v_mul_lo_u32 v182, v181, s19
v_lshrrev_b32 v182, 16, v182
v_mul_u32_u24 v183, 24, v182
v_sub_u32 v181, v181, v183
v_and_b32 v183, 6, v182
v_xor_b32 v181, v181, v183
v_mul_u32_u24 v182, 1152, v182
v_lshl_add_u32 v181, v181, 4, v182
v_subrev_u32 v181, 1024, v181
v_cndmask_b32 v220, v181, v200, vcc
v_add_u32 v181, 128, v176
v_mul_lo_u32 v182, v181, s19
v_lshrrev_b32 v182, 16, v182
v_mul_u32_u24 v183, 24, v182
v_sub_u32 v181, v181, v183
v_and_b32 v183, 6, v182
v_xor_b32 v181, v181, v183
v_mul_u32_u24 v182, 1152, v182
v_lshl_add_u32 v181, v181, 4, v182
v_subrev_u32 v181, 2048, v181
v_cndmask_b32 v221, v181, v200, vcc
s_mov_b32 s19, 48758784
s_cselect_b32 s76, s4, s72
s_cselect_b32 s77, s5, s73
s_cselect_b32 s78, s19, 5308416
s_mov_b32 s79, 0x20000
s_mov_b32 s80, s68
s_mov_b32 s81, s69
s_mov_b32 s82, 663552
s_mov_b32 s83, 0x20000
s_mov_b32 s84, s70
s_mov_b32 s85, s71
s_mov_b32 s86, 663552
s_mov_b32 s87, 0x20000
s_lshl_b32 s36, s16, 4
v_lshrrev_b32 v182, 3, v176
v_add_u32 v182, s36, v182
v_and_b32 v183, 6, v182
v_xor_b32 v183, v183, v176
v_and_b32 v183, 7, v183
v_bfe_u32 v184, v182, 2, 2
v_lshlrev_b32 v184, 3, v184
v_lshrrev_b32 v181, 4, v182
v_lshl_add_u32 v184, v181, 2, v184
v_and_b32 v181, 3, v182
v_add_u32 v184, v184, v181
v_mul_u32_u24 v184, 9216, v184
v_lshl_add_u32 v207, v183, 4, v184
v_add_u32 v208, 146432, v207
s_lshl_b32 s36, s16, 1
v_bfe_u32 v181, v176, 3, 2
v_xor_b32 v181, s36, v181
v_lshrrev_b32 v182, 2, v176
v_lshl_add_u32 v181, v182, 2, v181
v_and_b32 v182, 3, v176
v_lshl_add_u32 v181, v181, 2, v182
v_lshlrev_b32 v199, 3, v181
s_mul_i32 s46, s12, 1152
s_and_b32 s36, s15, 3
s_lshl_b32 s36, s36, 7
s_add_u32 s46, s46, s36
s_add_u32 s46, s46, 5014144
s_cmp_eq_u32 s16, 0
s_cbranch_scc1 P0_r0
v_lshlrev_b32 v192, 16, v192
v_lshlrev_b32 v193, 16, v193
v_lshlrev_b32 v194, 16, v194
v_mul_f32 v194, 1069066811, v194
v_exp_f32 v194, v194
s_nop 0
v_cvt_pk_bf16_f32 v194, v194, v194
v_lshlrev_b32 v194, 16, v194
v_mul_f32 v181, v194, v192
v_mul_f32 v182, v194, v193
v_mul_f32 v181, 1069066811, v181
v_exp_f32 v181, v181
v_mul_f32 v182, 0.15915494, v182
v_rndne_f32 v183, v182
v_sub_f32 v182, v182, v183
v_cos_f32 v183, v182
v_sin_f32 v184, v182
v_mul_f32 v209, v181, v183
v_mul_f32 v210, v181, v184
v_mul_f32 v181, v192, v192
v_fmac_f32 v181, v193, v193
v_rcp_f32 v181, v181
v_add_f32 v182, -1.0, v209
v_add_f32 v181, v181, v181
v_mul_f32 v183, v182, v192
v_fmac_f32 v183, v210, v193
v_mul_f32 v211, v183, v181
v_mul_f32 v183, v210, v192
v_fma_f32 v183, -v182, v193, v183
v_mul_f32 v212, v183, v181
v_mov_b32 v181, v209
v_sub_f32 v182, 0, v210
v_mul_f32 v183, v182, v182
v_mul_f32 v184, v181, v182
v_fma_f32 v181, v181, v181, -v183
v_add_f32 v182, v184, v184
v_mul_f32 v183, v182, v182
v_mul_f32 v184, v181, v182
v_fma_f32 v181, v181, v181, -v183
v_add_f32 v182, v184, v184
v_mul_f32 v183, v182, v182
v_mul_f32 v184, v181, v182
v_fma_f32 v181, v181, v181, -v183
v_add_f32 v182, v184, v184
v_mul_f32 v183, v182, v182
v_mul_f32 v184, v181, v182
v_fma_f32 v181, v181, v181, -v183
v_add_f32 v182, v184, v184
v_mul_f32 v183, v182, v182
v_mul_f32 v184, v181, v182
v_fma_f32 v181, v181, v181, -v183
v_add_f32 v182, v184, v184
v_mov_b32 v213, v181
v_mov_b32 v214, v182
v_mul_f32 v183, v182, v182
v_mul_f32 v184, v181, v182
v_fma_f32 v181, v181, v181, -v183
v_add_f32 v182, v184, v184
v_mul_f32 v183, v182, v182
v_mul_f32 v184, v181, v182
v_fma_f32 v181, v181, v181, -v183
v_add_f32 v182, v184, v184
v_mov_b32 v215, v181
v_mov_b32 v216, v182
v_mul_f32 v183, v182, v182
v_mul_f32 v184, v181, v182
v_fma_f32 v181, v181, v181, -v183
v_add_f32 v182, v184, v184
v_mul_f32 v183, v182, v182
v_mul_f32 v184, v181, v182
v_fma_f32 v181, v181, v181, -v183
v_add_f32 v182, v184, v184
v_mov_b32 v217, v181
v_mov_b32 v218, v182
s_branch P0_rj
P0_r0:
s_lshr_b32 s18, s51, 1
s_add_u32 s18, s18, 0
s_mul_i32 s19, s18, 1821
s_lshr_b32 s19, s19, 16
s_mul_i32 s6, s19, 36
s_sub_u32 s7, s18, s6
s_mul_i32 s32, s7, 43
s_lshr_b32 s32, s32, 7
s_mul_i32 s33, s32, 3
s_sub_u32 s33, s7, s33
s_lshl_b32 s33, s33, 2
s_lshr_b32 s7, s32, 2
s_mul_i32 s7, s7, 12
s_add_u32 s7, s7, s33
s_bfe_u32 s33, s32, 0x10001
s_add_u32 s7, s7, s33
s_and_b32 s32, s32, 1
s_lshl_b32 s32, s32, 1
s_add_u32 s7, s7, s32
s_mul_i32 s35, s7, 18432
s_lshl_b32 s19, s19, 6
s_add_u32 s35, s35, s19
s_add_u32 s6, s6, s18
s_lshl_b32 s6, s6, 10
s_add_u32 s37, s6, 2621440
s_lshr_b32 s18, s51, 1
s_add_u32 s18, s18, 512
s_mul_i32 s19, s18, 1821
s_lshr_b32 s19, s19, 16
s_mul_i32 s6, s19, 36
s_sub_u32 s7, s18, s6
s_mul_i32 s32, s7, 43
s_lshr_b32 s32, s32, 7
s_mul_i32 s33, s32, 3
s_sub_u32 s33, s7, s33
s_lshl_b32 s33, s33, 2
s_lshr_b32 s7, s32, 2
s_mul_i32 s7, s7, 12
s_add_u32 s7, s7, s33
s_bfe_u32 s33, s32, 0x10001
s_add_u32 s7, s7, s33
s_and_b32 s32, s32, 1
s_lshl_b32 s32, s32, 1
s_add_u32 s7, s7, s32
s_mul_i32 s36, s7, 18432
s_lshl_b32 s19, s19, 6
s_add_u32 s36, s36, s19
s_add_u32 s6, s6, s18
s_lshl_b32 s6, s6, 10
s_add_u32 s42, s6, 2621440
s_cmp_ge_u32 s18, 648
s_cselect_b32 s36, 1073741824, s36
s_cselect_b32 s42, 1073741824, s42
v_and_b32 v181, 15, v176
v_mul_u32_u24 v209, 1152, v181
v_and_b32 v182, 48, v176
v_add_u32 v209, v209, v182
v_lshrrev_b32 v182, 5, v176
v_mul_u32_u24 v210, 36864, v182
v_lshl_add_u32 v210, v181, 4, v210
v_bfe_u32 v183, v176, 4, 1
v_lshl_add_u32 v210, v183, 9, v210
v_mul_u32_u24 v211, 183808, v182
v_add_u32 v211, v211, v200
s_mov_b32 s47, 0x05040100
s_mov_b32 s48, 0x07060302
v_lshlrev_b32 v217, 22, v200
v_mov_b32 v218, s96
v_and_b32 v215, 7, v176
v_lshlrev_b32 v215, 7, v215
P0_rj:
s_lshl_b32 s18, s14, 1
s_add_u32 s55, s18, s17
s_mul_i32 s88, s55, 1474560
s_add_u32 s88, s88, 10485760
s_lshr_b32 s18, s15, 3
s_mul_i32 s18, s18, 36
s_and_b32 s19, s15, 7
s_lshl_b32 s6, s18, 1
s_add_u32 s6, s6, s19
s_lshl_b32 s6, s6, 9
s_add_u32 s95, s6, s88
s_add_u32 s18, s18, s19
s_lshl_b32 s19, s16, 3
s_add_u32 s19, s19, s18
s_add_u32 s19, s19, 4
s_lshl_b32 s19, s19, 10
s_add_u32 s89, s19, s88
s_add_u32 s94, s89, 16384
s_lshl_b32 s90, s2, 7
s_lshl_b32 s18, s3, 5
s_add_u32 s90, s90, s18
s_add_u32 s90, s90, 4554752
s_mul_i32 s93, s3, 3072
s_lshl_b32 s63, s3, 11
s_cmp_ge_u32 s13, 24
s_cbranch_scc1 P0_t1
s_mul_i32 s64, s13, 43
s_lshr_b32 s64, s64, 7
s_mul_i32 s65, s64, 3
s_sub_u32 s65, s13, s65
s_lshr_b32 s18, s12, 2
s_lshl_b32 s18, s18, 3
s_add_u32 s64, s64, s18
s_and_b32 s66, s12, 3
s_mul_i32 s54, s66, 1327104
s_mul_i32 s18, s65, 384
s_add_u32 s54, s54, s18
s_mul_i32 s18, s16, 92160
s_mul_i32 s19, s17, 9216
s_add_u32 s18, s18, s19
s_add_u32 s18, s18, 73728
s_add_u32 s54, s54, s18
s_mul_i32 s91, s3, 9216
s_sub_u32 s91, s91, s18
s_sub_u32 s91, s91, 847872
s_mov_b32 s92, 184320
s_mov_b32 s70, 479232
s_mov_b32 s71, 92160
s_mul_i32 s69, s66, 36864
s_branch P0_tj
P0_t1:
s_sub_u32 s18, s13, 24
s_cmp_ge_u32 s18, 3
s_cselect_b32 s19, 1, 0
s_mul_i32 s65, s19, 3
s_sub_u32 s65, s18, s65
s_lshl_b32 s64, s12, 1
s_add_u32 s64, s64, s19
s_mul_i32 s54, s65, 12288
s_add_u32 s54, s54, 2621440
s_add_u32 s54, s54, s93
s_mov_b32 s92, 36864
s_mov_b32 s70, s92
s_mov_b32 s71, s92
s_mov_b32 s91, s92
s_mov_b32 s66, 0
s_mov_b32 s69, 147456
P0_tj:
s_and_b32 s19, s66, 1
s_xor_b32 s6, s3, s19
s_lshl_b32 s18, s64, 2
s_add_u32 s7, s18, s6
s_mul_i32 s7, s7, 368640
s_add_u32 s69, s69, 10485760
s_add_u32 s69, s69, s7
s_cmp_ge_u32 s13, 24
s_cselect_b32 s67, 1073741824, s69
s_mov_b32 s33, 1024
s_mov_b32 s51, 183296
s_cmp_lt_u32 s13, 30
s_cbranch_scc1 P0_l
v_lshrrev_b32 v181, 2, v176
v_lshrrev_b32 v182, 4, v176
v_sub_u32 v182, 4, v182
v_xor_b32 v182, v182, v176
v_and_b32 v182, 3, v182
v_mul_u32_u24 v181, 1152, v181
v_lshl_add_u32 v181, v182, 4, v181
s_add_u32 s18, s3, 32
s_mul_i32 s18, s18, 18432
v_add_u32 v219, s18, v181
v_subrev_u32 v220, 960, v219
v_subrev_u32 v221, 1920, v219
s_mov_b32 s76, s8
s_mov_b32 s77, s9
s_mov_b32 s78, 663552
s_mov_b32 s79, 0x20000
s_mov_b32 s54, 0
s_mov_b32 s92, 192
s_mov_b32 s70, s92
s_mov_b32 s71, s92
s_mov_b32 s91, s92
s_mov_b32 s33, 16384
s_mov_b32 s51, 0
s_sub_u32 s18, s13, 30
s_lshl_b32 s18, s18, 13
s_mul_i32 s67, s12, 294912
s_add_u32 s67, s67, s18
s_add_u32 s67, s67, s63
P0_l:
s_lshl_b32 s50, s17, 1
s_add_u32 s50, s50, s19
s_lshl_b32 s50, s50, 1
s_lshr_b32 s18, s64, 1
s_lshl_b32 s18, s18, 2
s_add_u32 s18, s18, s66
s_lshl_b32 s18, s18, 10
s_and_b32 s19, s64, 1
s_lshl_b32 s19, s19, 6
s_add_u32 s68, s18, s19
s_add_u32 s68, s68, 4489216
v_bfe_u32 v181, v176, 3, 2
v_and_b32 v182, 7, v176
v_lshl_add_u32 v181, v181, 4, v182
v_lshlrev_b32 v181, 5, v181
s_lshl_b32 s18, s14, 12
s_lshl_b32 s19, s17, 11
s_add_u32 s18, s18, s19
s_lshl_b32 s19, s16, 8
s_add_u32 s18, s18, s19
s_add_u32 s18, s18, 4456448
s_mov_b64 exec, 0
s_cmp_eq_u32 s3, 0
s_cbranch_scc1 T_a_4
s_cmp_eq_u32 s3, 1
s_cbranch_scc1 T_a_5
s_cmp_eq_u32 s3, 2
s_cbranch_scc1 T_a_6
s_branch T_a_7
T_a_q:
s_mov_b64 exec, -1
s_mov_b32 s97, 0
poll_1:
buffer_load_dword v182, v181, s[20:23], s18 offen offset:0 sc1
s_waitcnt vmcnt(0)
v_cmp_ne_u32 vcc, s96, v182
s_add_u32 s97, s97, 1
s_cmp_ge_u32 s97, 32768
s_cbranch_scc1 poll_1_x
s_cbranch_vccnz poll_1
poll_1_x:
s_add_u32 m0, s43, 114688
s_nop 0
buffer_load_dwordx4 v200, s[20:23], s38 offen offset:0 sc1 lds
buffer_load_dwordx4 v200, s[20:23], s38 offen offset:1024 sc1 lds
buffer_load_dwordx4 v200, s[20:23], s38 offen offset:2048 sc1 lds
buffer_load_dwordx4 v200, s[20:23], s38 offen offset:3072 sc1 lds
s_add_u32 s38, s38, 16384
s_add_u32 m0, s43, 0
s_nop 0
buffer_load_dwordx4 v200, s[20:23], s38 offen offset:0 sc1 lds
buffer_load_dwordx4 v200, s[20:23], s38 offen offset:1024 sc1 lds
buffer_load_dwordx4 v200, s[20:23], s38 offen offset:2048 sc1 lds
buffer_load_dwordx4 v200, s[20:23], s38 offen offset:3072 sc1 lds
s_add_u32 s38, s38, 16384
s_add_u32 m0, s43, 28672
s_nop 0
buffer_load_dwordx4 v200, s[20:23], s38 offen offset:0 sc1 lds
buffer_load_dwordx4 v200, s[20:23], s38 offen offset:1024 sc1 lds
buffer_load_dwordx4 v200, s[20:23], s38 offen offset:2048 sc1 lds
buffer_load_dwordx4 v200, s[20:23], s38 offen offset:3072 sc1 lds
s_add_u32 s38, s38, 16384
s_add_u32 m0, s43, 57344
s_nop 0
buffer_load_dwordx4 v200, s[20:23], s38 offen offset:0 sc1 lds
buffer_load_dwordx4 v200, s[20:23], s38 offen offset:1024 sc1 lds
buffer_load_dwordx4 v200, s[20:23], s38 offen offset:2048 sc1 lds
buffer_load_dwordx4 v200, s[20:23], s38 offen offset:3072 sc1 lds
s_add_u32 s38, s38, 16384
s_mov_b64 exec, 0
s_cmp_eq_u32 s3, 0
s_cbranch_scc1 T_a_0
s_cmp_eq_u32 s3, 1
s_cbranch_scc1 T_a_1
s_cmp_eq_u32 s3, 2
s_cbranch_scc1 T_a_2
s_branch T_a_3
.p2align 12
T_a_r:
s_mov_b64 exec, -1
s_waitcnt vmcnt(12)
s_barrier
ds_read_b128 a[160:163], v201 offset:0
ds_read_b128 a[164:167], v201 offset:1024
ds_read_b128 a[168:171], v201 offset:2048
ds_read_b128 a[172:175], v201 offset:3072
ds_read_b128 a[176:179], v201 offset:4096
ds_read_b128 a[180:183], v201 offset:5120
ds_read_b128 a[184:187], v201 offset:6144
ds_read_b128 a[188:191], v201 offset:7168
s_cmp_eq_u32 s16, 1
s_cbranch_scc1 P1_role1
P1_role0:
ds_read_b64_tr_b16 a[224:225], v203 offset:0
ds_read_b64_tr_b16 a[226:227], v203 offset:2560
ds_read_b64_tr_b16 a[228:229], v203 offset:6144
ds_read_b64_tr_b16 a[230:231], v203 offset:8704
ds_read_b64_tr_b16 a[232:233], v202 offset:0
ds_read_b64_tr_b16 a[234:235], v202 offset:2560
ds_read_b64_tr_b16 a[236:237], v202 offset:6144
ds_read_b64_tr_b16 a[238:239], v202 offset:8704
ds_read_b64_tr_b16 a[240:241], v202 offset:32
ds_read_b64_tr_b16 a[242:243], v202 offset:2592
ds_read_b64_tr_b16 a[244:245], v202 offset:6176
ds_read_b64_tr_b16 a[246:247], v202 offset:8736
s_waitcnt lgkmcnt(10)
v_mfma_f32_16x16x32_bf16 v[128:131], a[224:227], a[160:163], 0
v_mfma_f32_16x16x32_bf16 v[132:135], a[224:227], a[164:167], 0
v_add_u32 v201, 4294852608, v201
v_mfma_f32_16x16x32_bf16 v[136:139], a[224:227], a[168:171], 0
s_add_u32 m0, s44, 102400
v_mfma_f32_16x16x32_bf16 v[140:143], a[224:227], a[172:175], 0
v_add_u32 v202, 4294852608, v202
v_mfma_f32_16x16x32_bf16 v[144:147], a[224:227], a[176:179], 0
buffer_load_dwordx4 v204, s[24:27], s39 offen lds
v_mfma_f32_16x16x32_bf16 v[148:151], a[224:227], a[180:183], 0
v_add_u32 v203, 4294852608, v203
v_mfma_f32_16x16x32_bf16 v[152:155], a[224:227], a[184:187], 0
buffer_load_dwordx4 v205, s[24:27], s39 offen offset:1024 lds
v_mfma_f32_16x16x32_bf16 v[156:159], a[224:227], a[188:191], 0
s_waitcnt lgkmcnt(5)
s_add_u32 s39, s39, 294912
s_waitcnt vmcnt(10) lgkmcnt(0)
v_mfma_f32_16x16x32_bf16 a[128:131], a[228:231], a[160:163], 0
s_barrier
ds_read_b64_tr_b16 a[224:225], v203 offset:0
ds_read_b64_tr_b16 a[226:227], v203 offset:2560
v_mfma_f32_16x16x32_bf16 a[132:135], a[228:231], a[164:167], 0
s_add_u32 m0, s44, 104448
v_mfma_f32_16x16x32_bf16 a[136:139], a[228:231], a[168:171], 0
buffer_load_dwordx4 v206, s[28:31], s40 offen lds
v_mfma_f32_16x16x32_bf16 a[140:143], a[228:231], a[172:175], 0
s_add_u32 s40, s40, s41
ds_read_b128 a[192:195], v201 offset:0
s_add_u32 m0, s43, 86016
v_mfma_f32_16x16x32_bf16 a[144:147], a[228:231], a[176:179], 0
buffer_load_dwordx4 v200, s[20:23], s38 offen offset:0 sc1 lds
v_mfma_f32_16x16x32_bf16 a[148:151], a[228:231], a[180:183], 0
v_mfma_f32_16x16x32_bf16 a[152:155], a[228:231], a[184:187], 0
v_mfma_f32_16x16x32_bf16 a[156:159], a[228:231], a[188:191], 0
ds_read_b64_tr_b16 a[228:229], v203 offset:6144
ds_read_b128 a[196:199], v201 offset:1024
v_mfma_f32_16x16x32_bf16 v[0:3], a[232:235], a[160:163], 0
buffer_load_dwordx4 v200, s[20:23], s38 offen offset:1024 sc1 lds
v_mfma_f32_16x16x32_bf16 v[4:7], a[232:235], a[164:167], 0
ds_read_b64_tr_b16 a[230:231], v203 offset:8704
v_mfma_f32_16x16x32_bf16 v[8:11], a[232:235], a[168:171], 0
buffer_load_dwordx4 v200, s[20:23], s38 offen offset:2048 sc1 lds
v_mfma_f32_16x16x32_bf16 v[12:15], a[232:235], a[172:175], 0
v_mfma_f32_16x16x32_bf16 v[16:19], a[232:235], a[176:179], 0
ds_read_b128 a[200:203], v201 offset:2048
v_mfma_f32_16x16x32_bf16 v[20:23], a[232:235], a[180:183], 0
buffer_load_dwordx4 v200, s[20:23], s38 offen offset:3072 sc1 lds
v_mfma_f32_16x16x32_bf16 v[24:27], a[232:235], a[184:187], 0
s_add_u32 s38, s38, 16384
v_mfma_f32_16x16x32_bf16 v[28:31], a[232:235], a[188:191], 0
s_add_u32 m0, s44, 131072
ds_read_b64_tr_b16 a[232:233], v202 offset:0
v_mfma_f32_16x16x32_bf16 a[0:3], a[236:239], a[160:163], 0
ds_read_b64_tr_b16 a[234:235], v202 offset:2560
v_mfma_f32_16x16x32_bf16 a[4:7], a[236:239], a[164:167], 0
buffer_load_dwordx4 v204, s[24:27], s39 offen lds
v_mfma_f32_16x16x32_bf16 a[8:11], a[236:239], a[168:171], 0
ds_read_b128 a[204:207], v201 offset:3072
v_mfma_f32_16x16x32_bf16 a[12:15], a[236:239], a[172:175], 0
buffer_load_dwordx4 v205, s[24:27], s39 offen offset:1024 lds
v_mfma_f32_16x16x32_bf16 a[16:19], a[236:239], a[176:179], 0
s_add_u32 s39, s39, 294912
v_mfma_f32_16x16x32_bf16 a[20:23], a[236:239], a[180:183], 0
s_add_u32 m0, s44, 133120
v_mfma_f32_16x16x32_bf16 a[24:27], a[236:239], a[184:187], 0
ds_read_b128 a[208:211], v201 offset:4096
v_mfma_f32_16x16x32_bf16 a[28:31], a[236:239], a[188:191], 0
buffer_load_dwordx4 v206, s[28:31], s40 offen lds
v_mfma_f32_16x16x32_bf16 v[32:35], a[240:243], a[160:163], 0
s_add_u32 s40, s40, s41
ds_read_b64_tr_b16 a[236:237], v202 offset:6144
ds_read_b64_tr_b16 a[238:239], v202 offset:8704
v_mfma_f32_16x16x32_bf16 v[36:39], a[240:243], a[164:167], 0
s_add_u32 m0, s43, 114688
v_mfma_f32_16x16x32_bf16 v[40:43], a[240:243], a[168:171], 0
buffer_load_dwordx4 v200, s[20:23], s38 offen offset:0 sc1 lds
v_mfma_f32_16x16x32_bf16 v[44:47], a[240:243], a[172:175], 0
ds_read_b128 a[212:215], v201 offset:5120
v_mfma_f32_16x16x32_bf16 v[48:51], a[240:243], a[176:179], 0
buffer_load_dwordx4 v200, s[20:23], s38 offen offset:1024 sc1 lds
v_mfma_f32_16x16x32_bf16 v[52:55], a[240:243], a[180:183], 0
v_mfma_f32_16x16x32_bf16 v[56:59], a[240:243], a[184:187], 0
v_mfma_f32_16x16x32_bf16 v[60:63], a[240:243], a[188:191], 0
ds_read_b64_tr_b16 a[240:241], v202 offset:32
v_mfma_f32_16x16x32_bf16 a[32:35], a[244:247], a[160:163], 0
buffer_load_dwordx4 v200, s[20:23], s38 offen offset:2048 sc1 lds
v_mfma_f32_16x16x32_bf16 a[36:39], a[244:247], a[164:167], 0
ds_read_b64_tr_b16 a[242:243], v202 offset:2592
ds_read_b128 a[216:219], v201 offset:6144
v_mfma_f32_16x16x32_bf16 a[40:43], a[244:247], a[168:171], 0
buffer_load_dwordx4 v200, s[20:23], s38 offen offset:3072 sc1 lds
v_mfma_f32_16x16x32_bf16 a[44:47], a[244:247], a[172:175], 0
s_add_u32 s38, s38, 16384
v_mfma_f32_16x16x32_bf16 a[48:51], a[244:247], a[176:179], 0
v_mfma_f32_16x16x32_bf16 a[52:55], a[244:247], a[180:183], 0
ds_read_b128 a[220:223], v201 offset:7168
v_mfma_f32_16x16x32_bf16 a[56:59], a[244:247], a[184:187], 0
v_mfma_f32_16x16x32_bf16 a[60:63], a[244:247], a[188:191], 0
s_waitcnt lgkmcnt(4)
ds_read_b64_tr_b16 a[244:245], v202 offset:6176
ds_read_b64_tr_b16 a[246:247], v202 offset:8736
v_mfma_f32_16x16x32_bf16 v[128:131], a[224:227], a[192:195], v[128:131]
v_mfma_f32_16x16x32_bf16 v[132:135], a[224:227], a[196:199], v[132:135]
v_mfma_f32_16x16x32_bf16 v[136:139], a[224:227], a[200:203], v[136:139]
v_mfma_f32_16x16x32_bf16 v[140:143], a[224:227], a[204:207], v[140:143]
v_mfma_f32_16x16x32_bf16 v[144:147], a[224:227], a[208:211], v[144:147]
v_mfma_f32_16x16x32_bf16 v[148:151], a[224:227], a[212:215], v[148:151]
s_waitcnt lgkmcnt(3)
v_mfma_f32_16x16x32_bf16 v[152:155], a[224:227], a[216:219], v[152:155]
s_waitcnt lgkmcnt(2)
v_mfma_f32_16x16x32_bf16 v[156:159], a[224:227], a[220:223], v[156:159]
s_waitcnt vmcnt(18) lgkmcnt(0)
s_barrier
ds_read_b64_tr_b16 a[224:225], v203 offset:28672
v_mfma_f32_16x16x32_bf16 a[128:131], a[228:231], a[192:195], a[128:131]
ds_read_b64_tr_b16 a[226:227], v203 offset:31232
v_mfma_f32_16x16x32_bf16 a[132:135], a[228:231], a[196:199], a[132:135]
s_add_u32 m0, s44, 16384
v_mfma_f32_16x16x32_bf16 a[136:139], a[228:231], a[200:203], a[136:139]
ds_read_b128 a[160:163], v201 offset:28672
v_mfma_f32_16x16x32_bf16 a[140:143], a[228:231], a[204:207], a[140:143]
buffer_load_dwordx4 v204, s[24:27], s39 offen lds
v_mfma_f32_16x16x32_bf16 a[144:147], a[228:231], a[208:211], a[144:147]
v_mfma_f32_16x16x32_bf16 a[148:151], a[228:231], a[212:215], a[148:151]
v_mfma_f32_16x16x32_bf16 a[152:155], a[228:231], a[216:219], a[152:155]
v_mfma_f32_16x16x32_bf16 a[156:159], a[228:231], a[220:223], a[156:159]
ds_read_b64_tr_b16 a[228:229], v203 offset:34816
ds_read_b128 a[164:167], v201 offset:29696
v_mfma_f32_16x16x32_bf16 v[0:3], a[232:235], a[192:195], v[0:3]
buffer_load_dwordx4 v205, s[24:27], s39 offen offset:1024 lds
v_mfma_f32_16x16x32_bf16 v[4:7], a[232:235], a[196:199], v[4:7]
s_add_u32 s39, s39, 294912
ds_read_b64_tr_b16 a[230:231], v203 offset:37376
v_mfma_f32_16x16x32_bf16 v[8:11], a[232:235], a[200:203], v[8:11]
v_mfma_f32_16x16x32_bf16 v[12:15], a[232:235], a[204:207], v[12:15]
s_add_u32 m0, s44, 18432
v_mfma_f32_16x16x32_bf16 v[16:19], a[232:235], a[208:211], v[16:19]
ds_read_b128 a[168:171], v201 offset:30720
v_mfma_f32_16x16x32_bf16 v[20:23], a[232:235], a[212:215], v[20:23]
buffer_load_dwordx4 v206, s[28:31], s40 offen lds
v_mfma_f32_16x16x32_bf16 v[24:27], a[232:235], a[216:219], v[24:27]
s_add_u32 s40, s40, s41
v_mfma_f32_16x16x32_bf16 v[28:31], a[232:235], a[220:223], v[28:31]
ds_read_b64_tr_b16 a[232:233], v202 offset:28672
v_mfma_f32_16x16x32_bf16 a[0:3], a[236:239], a[192:195], a[0:3]
ds_read_b64_tr_b16 a[234:235], v202 offset:31232
v_mfma_f32_16x16x32_bf16 a[4:7], a[236:239], a[196:199], a[4:7]
s_add_u32 m0, s43, 0
ds_read_b128 a[172:175], v201 offset:31744
v_mfma_f32_16x16x32_bf16 a[8:11], a[236:239], a[200:203], a[8:11]
buffer_load_dwordx4 v200, s[20:23], s38 offen offset:0 sc1 lds
v_mfma_f32_16x16x32_bf16 a[12:15], a[236:239], a[204:207], a[12:15]
buffer_load_dwordx4 v[224:227], v209, s[80:83], s35 offen
v_mfma_f32_16x16x32_bf16 a[16:19], a[236:239], a[208:211], a[16:19]
v_mfma_f32_16x16x32_bf16 a[20:23], a[236:239], a[212:215], a[20:23]
v_mfma_f32_16x16x32_bf16 a[24:27], a[236:239], a[216:219], a[24:27]
ds_read_b128 a[176:179], v201 offset:32768
v_mfma_f32_16x16x32_bf16 a[28:31], a[236:239], a[220:223], a[28:31]
buffer_load_dwordx4 v[228:231], v209, s[84:87], s35 offen
v_mfma_f32_16x16x32_bf16 v[32:35], a[240:243], a[192:195], v[32:35]
ds_read_b64_tr_b16 a[236:237], v202 offset:34816
v_mfma_f32_16x16x32_bf16 v[36:39], a[240:243], a[196:199], v[36:39]
buffer_load_dwordx4 v200, s[20:23], s38 offen offset:1024 sc1 lds
v_mfma_f32_16x16x32_bf16 v[40:43], a[240:243], a[200:203], v[40:43]
ds_read_b64_tr_b16 a[238:239], v202 offset:37376
v_mfma_f32_16x16x32_bf16 v[44:47], a[240:243], a[204:207], v[44:47]
buffer_load_dwordx4 v[240:243], v209, s[80:83], s36 offen
v_mfma_f32_16x16x32_bf16 v[48:51], a[240:243], a[208:211], v[48:51]
ds_read_b128 a[180:183], v201 offset:33792
v_mfma_f32_16x16x32_bf16 v[52:55], a[240:243], a[212:215], v[52:55]
buffer_load_dwordx4 v[244:247], v209, s[84:87], s36 offen
v_mfma_f32_16x16x32_bf16 v[56:59], a[240:243], a[216:219], v[56:59]
buffer_load_dwordx4 v200, s[20:23], s38 offen offset:2048 sc1 lds
v_mfma_f32_16x16x32_bf16 v[60:63], a[240:243], a[220:223], v[60:63]
ds_read_b64_tr_b16 a[240:241], v202 offset:28704
v_mfma_f32_16x16x32_bf16 a[32:35], a[244:247], a[192:195], a[32:35]
ds_read_b64_tr_b16 a[242:243], v202 offset:31264
ds_read_b128 a[184:187], v201 offset:34816
v_mfma_f32_16x16x32_bf16 a[36:39], a[244:247], a[196:199], a[36:39]
v_mfma_f32_16x16x32_bf16 a[40:43], a[244:247], a[200:203], a[40:43]
buffer_load_dwordx4 v200, s[20:23], s38 offen offset:3072 sc1 lds
v_mfma_f32_16x16x32_bf16 a[44:47], a[244:247], a[204:207], a[44:47]
s_add_u32 s38, s38, 16384
v_mfma_f32_16x16x32_bf16 a[48:51], a[244:247], a[208:211], a[48:51]
v_mfma_f32_16x16x32_bf16 a[52:55], a[244:247], a[212:215], a[52:55]
ds_read_b128 a[188:191], v201 offset:35840
v_mfma_f32_16x16x32_bf16 a[56:59], a[244:247], a[216:219], a[56:59]
v_mfma_f32_16x16x32_bf16 a[60:63], a[244:247], a[220:223], a[60:63]
s_waitcnt lgkmcnt(5)
ds_read_b64_tr_b16 a[244:245], v202 offset:34848
ds_read_b64_tr_b16 a[246:247], v202 offset:37408
v_mfma_f32_16x16x32_bf16 v[128:131], a[224:227], a[160:163], v[128:131]
v_mfma_f32_16x16x32_bf16 v[132:135], a[224:227], a[164:167], v[132:135]
v_add_u32 v201, 57344, v201
v_mfma_f32_16x16x32_bf16 v[136:139], a[224:227], a[168:171], v[136:139]
v_mfma_f32_16x16x32_bf16 v[140:143], a[224:227], a[172:175], v[140:143]
v_add_u32 v202, 57344, v202
v_mfma_f32_16x16x32_bf16 v[144:147], a[224:227], a[176:179], v[144:147]
s_waitcnt lgkmcnt(3)
v_mfma_f32_16x16x32_bf16 v[148:151], a[224:227], a[180:183], v[148:151]
v_add_u32 v203, 57344, v203
v_mfma_f32_16x16x32_bf16 v[152:155], a[224:227], a[184:187], v[152:155]
s_waitcnt lgkmcnt(2)
v_mfma_f32_16x16x32_bf16 v[156:159], a[224:227], a[188:191], v[156:159]
s_waitcnt vmcnt(25) lgkmcnt(0)
s_barrier
ds_read_b64_tr_b16 a[224:225], v203 offset:0
v_mfma_f32_16x16x32_bf16 a[128:131], a[228:231], a[160:163], a[128:131]
ds_read_b64_tr_b16 a[226:227], v203 offset:2560
v_mfma_f32_16x16x32_bf16 a[132:135], a[228:231], a[164:167], a[132:135]
s_add_u32 m0, s44, 45056
v_mfma_f32_16x16x32_bf16 a[136:139], a[228:231], a[168:171], a[136:139]
ds_read_b128 a[192:195], v201 offset:0
v_mfma_f32_16x16x32_bf16 a[140:143], a[228:231], a[172:175], a[140:143]
buffer_load_dwordx4 v204, s[24:27], s39 offen lds
v_mfma_f32_16x16x32_bf16 a[144:147], a[228:231], a[176:179], a[144:147]
s_lshl_b32 s6, s13, 1
s_add_u32 s6, s6, s16
v_mfma_f32_16x16x32_bf16 a[148:151], a[228:231], a[180:183], a[148:151]
s_mul_i32 s6, s6, 18432
s_mul_i32 s7, s12, 1152
v_mfma_f32_16x16x32_bf16 a[152:155], a[228:231], a[184:187], a[152:155]
v_mfma_f32_16x16x32_bf16 a[156:159], a[228:231], a[188:191], a[156:159]
ds_read_b64_tr_b16 a[228:229], v203 offset:6144
ds_read_b128 a[196:199], v201 offset:1024
v_mfma_f32_16x16x32_bf16 v[0:3], a[232:235], a[160:163], v[0:3]
buffer_load_dwordx4 v205, s[24:27], s39 offen offset:1024 lds
v_mfma_f32_16x16x32_bf16 v[4:7], a[232:235], a[164:167], v[4:7]
s_add_u32 s39, s39, 294912
s_add_u32 s6, s6, s7
v_min_u32 v197, 144, v200
v_mfma_f32_16x16x32_bf16 v[8:11], a[232:235], a[168:171], v[8:11]
ds_read_b64_tr_b16 a[230:231], v203 offset:8704
v_mul_u32_u24 v198, 52, v197
v_mfma_f32_16x16x32_bf16 v[12:15], a[232:235], a[172:175], v[12:15]
v_lshrrev_b32 v198, 12, v198
s_add_u32 m0, s44, 47104
v_mfma_f32_16x16x32_bf16 v[16:19], a[232:235], a[176:179], v[16:19]
s_add_u32 s97, s6, 3833856
v_mul_u32_u24 v198, 8576, v198
ds_read_b128 a[200:203], v201 offset:2048
v_mfma_f32_16x16x32_bf16 v[20:23], a[232:235], a[180:183], v[20:23]
buffer_load_dwordx4 v206, s[28:31], s40 offen lds
v_mfma_f32_16x16x32_bf16 v[24:27], a[232:235], a[184:187], v[24:27]
s_add_u32 s40, s40, s41
v_lshl_add_u32 v197, v197, 3, v198
v_mfma_f32_16x16x32_bf16 v[28:31], a[232:235], a[188:191], v[28:31]
ds_read_b64_tr_b16 a[232:233], v202 offset:0
v_mfma_f32_16x16x32_bf16 a[0:3], a[236:239], a[160:163], a[0:3]
buffer_load_dword a255, v197, s[24:27], s97 offen
v_mfma_f32_16x16x32_bf16 a[4:7], a[236:239], a[164:167], a[4:7]
s_add_u32 m0, s43, 28672
ds_read_b64_tr_b16 a[234:235], v202 offset:2560
ds_read_b128 a[204:207], v201 offset:3072
v_mfma_f32_16x16x32_bf16 a[8:11], a[236:239], a[168:171], a[8:11]
buffer_load_dwordx4 v200, s[20:23], s38 offen offset:0 sc1 lds
v_mfma_f32_16x16x32_bf16 a[12:15], a[236:239], a[172:175], a[12:15]
v_mfma_f32_16x16x32_bf16 a[16:19], a[236:239], a[176:179], a[16:19]
v_mfma_f32_16x16x32_bf16 a[20:23], a[236:239], a[180:183], a[20:23]
v_mfma_f32_16x16x32_bf16 a[24:27], a[236:239], a[184:187], a[24:27]
ds_read_b128 a[208:211], v201 offset:4096
v_mfma_f32_16x16x32_bf16 a[28:31], a[236:239], a[188:191], a[28:31]
ds_read_b64_tr_b16 a[236:237], v202 offset:6144
v_mfma_f32_16x16x32_bf16 v[32:35], a[240:243], a[160:163], v[32:35]
buffer_load_dwordx4 v200, s[20:23], s38 offen offset:1024 sc1 lds
v_mfma_f32_16x16x32_bf16 v[36:39], a[240:243], a[164:167], v[36:39]
ds_read_b64_tr_b16 a[238:239], v202 offset:8704
v_mfma_f32_16x16x32_bf16 v[40:43], a[240:243], a[168:171], v[40:43]
v_mfma_f32_16x16x32_bf16 v[44:47], a[240:243], a[172:175], v[44:47]
ds_read_b128 a[212:215], v201 offset:5120
v_mfma_f32_16x16x32_bf16 v[48:51], a[240:243], a[176:179], v[48:51]
v_mfma_f32_16x16x32_bf16 v[52:55], a[240:243], a[180:183], v[52:55]
buffer_load_dwordx4 v200, s[20:23], s38 offen offset:2048 sc1 lds
v_mfma_f32_16x16x32_bf16 v[56:59], a[240:243], a[184:187], v[56:59]
v_mfma_f32_16x16x32_bf16 v[60:63], a[240:243], a[188:191], v[60:63]
ds_read_b64_tr_b16 a[240:241], v202 offset:32
v_mfma_f32_16x16x32_bf16 a[32:35], a[244:247], a[160:163], a[32:35]
ds_read_b64_tr_b16 a[242:243], v202 offset:2592
ds_read_b128 a[216:219], v201 offset:6144
v_mfma_f32_16x16x32_bf16 a[36:39], a[244:247], a[164:167], a[36:39]
v_mfma_f32_16x16x32_bf16 a[40:43], a[244:247], a[168:171], a[40:43]
buffer_load_dwordx4 v200, s[20:23], s38 offen offset:3072 sc1 lds
v_mfma_f32_16x16x32_bf16 a[44:47], a[244:247], a[172:175], a[44:47]
s_add_u32 s38, s38, 16384
v_mfma_f32_16x16x32_bf16 a[48:51], a[244:247], a[176:179], a[48:51]
v_mfma_f32_16x16x32_bf16 a[52:55], a[244:247], a[180:183], a[52:55]
ds_read_b128 a[220:223], v201 offset:7168
v_mfma_f32_16x16x32_bf16 a[56:59], a[244:247], a[184:187], a[56:59]
v_mfma_f32_16x16x32_bf16 a[60:63], a[244:247], a[188:191], a[60:63]
s_waitcnt lgkmcnt(5)
ds_read_b64_tr_b16 a[244:245], v202 offset:6176
ds_read_b64_tr_b16 a[246:247], v202 offset:8736
v_mfma_f32_16x16x32_bf16 v[128:131], a[224:227], a[192:195], v[128:131]
v_mfma_f32_16x16x32_bf16 v[132:135], a[224:227], a[196:199], v[132:135]
v_mfma_f32_16x16x32_bf16 v[136:139], a[224:227], a[200:203], v[136:139]
v_mfma_f32_16x16x32_bf16 v[140:143], a[224:227], a[204:207], v[140:143]
v_mfma_f32_16x16x32_bf16 v[144:147], a[224:227], a[208:211], v[144:147]
s_waitcnt lgkmcnt(5)
v_mfma_f32_16x16x32_bf16 v[148:151], a[224:227], a[212:215], v[148:151]
s_waitcnt lgkmcnt(3)
v_mfma_f32_16x16x32_bf16 v[152:155], a[224:227], a[216:219], v[152:155]
s_waitcnt lgkmcnt(2)
v_mfma_f32_16x16x32_bf16 v[156:159], a[224:227], a[220:223], v[156:159]
s_waitcnt vmcnt(26) lgkmcnt(0)
s_barrier
ds_read_b64_tr_b16 a[224:225], v203 offset:28672
v_mfma_f32_16x16x32_bf16 a[128:131], a[228:231], a[192:195], a[128:131]
ds_read_b64_tr_b16 a[226:227], v203 offset:31232
v_mfma_f32_16x16x32_bf16 a[132:135], a[228:231], a[196:199], a[132:135]
s_add_u32 m0, s44, 73728
v_mfma_f32_16x16x32_bf16 a[136:139], a[228:231], a[200:203], a[136:139]
ds_read_b128 a[160:163], v201 offset:28672
v_mfma_f32_16x16x32_bf16 a[140:143], a[228:231], a[204:207], a[140:143]
buffer_load_dwordx4 v204, s[24:27], s39 offen lds
v_mfma_f32_16x16x32_bf16 a[144:147], a[228:231], a[208:211], a[144:147]
v_mfma_f32_16x16x32_bf16 a[148:151], a[228:231], a[212:215], a[148:151]
v_mfma_f32_16x16x32_bf16 a[152:155], a[228:231], a[216:219], a[152:155]
v_mfma_f32_16x16x32_bf16 a[156:159], a[228:231], a[220:223], a[156:159]
ds_read_b64_tr_b16 a[228:229], v203 offset:34816
ds_read_b128 a[164:167], v201 offset:29696
v_mfma_f32_16x16x32_bf16 v[0:3], a[232:235], a[192:195], v[0:3]
buffer_load_dwordx4 v205, s[24:27], s39 offen offset:1024 lds
v_mfma_f32_16x16x32_bf16 v[4:7], a[232:235], a[196:199], v[4:7]
s_add_u32 s39, s39, 294912
ds_read_b64_tr_b16 a[230:231], v203 offset:37376
v_mfma_f32_16x16x32_bf16 v[8:11], a[232:235], a[200:203], v[8:11]
v_mfma_f32_16x16x32_bf16 v[12:15], a[232:235], a[204:207], v[12:15]
s_add_u32 m0, s44, 75776
v_mfma_f32_16x16x32_bf16 v[16:19], a[232:235], a[208:211], v[16:19]
ds_read_b128 a[168:171], v201 offset:30720
v_mfma_f32_16x16x32_bf16 v[20:23], a[232:235], a[212:215], v[20:23]
buffer_load_dwordx4 v206, s[28:31], s40 offen lds
v_mfma_f32_16x16x32_bf16 v[24:27], a[232:235], a[216:219], v[24:27]
s_add_u32 s40, s40, s41
v_mfma_f32_16x16x32_bf16 v[28:31], a[232:235], a[220:223], v[28:31]
ds_read_b64_tr_b16 a[232:233], v202 offset:28672
v_mfma_f32_16x16x32_bf16 a[0:3], a[236:239], a[192:195], a[0:3]
ds_read_b64_tr_b16 a[234:235], v202 offset:31232
v_mfma_f32_16x16x32_bf16 a[4:7], a[236:239], a[196:199], a[4:7]
s_add_u32 m0, s43, 57344
ds_read_b128 a[172:175], v201 offset:31744
v_mfma_f32_16x16x32_bf16 a[8:11], a[236:239], a[200:203], a[8:11]
buffer_load_dwordx4 v200, s[20:23], s38 offen offset:0 sc1 lds
v_mfma_f32_16x16x32_bf16 a[12:15], a[236:239], a[204:207], a[12:15]
v_mfma_f32_16x16x32_bf16 a[16:19], a[236:239], a[208:211], a[16:19]
v_mfma_f32_16x16x32_bf16 a[20:23], a[236:239], a[212:215], a[20:23]
v_mfma_f32_16x16x32_bf16 a[24:27], a[236:239], a[216:219], a[24:27]
ds_read_b128 a[176:179], v201 offset:32768
v_mfma_f32_16x16x32_bf16 a[28:31], a[236:239], a[220:223], a[28:31]
ds_read_b64_tr_b16 a[236:237], v202 offset:34816
v_mfma_f32_16x16x32_bf16 v[32:35], a[240:243], a[192:195], v[32:35]
buffer_load_dwordx4 v200, s[20:23], s38 offen offset:1024 sc1 lds
v_mfma_f32_16x16x32_bf16 v[36:39], a[240:243], a[196:199], v[36:39]
ds_read_b64_tr_b16 a[238:239], v202 offset:37376
v_mfma_f32_16x16x32_bf16 v[40:43], a[240:243], a[200:203], v[40:43]
v_mfma_f32_16x16x32_bf16 v[44:47], a[240:243], a[204:207], v[44:47]
ds_read_b128 a[180:183], v201 offset:33792
v_mfma_f32_16x16x32_bf16 v[48:51], a[240:243], a[208:211], v[48:51]
v_mfma_f32_16x16x32_bf16 v[52:55], a[240:243], a[212:215], v[52:55]
buffer_load_dwordx4 v200, s[20:23], s38 offen offset:2048 sc1 lds
v_mfma_f32_16x16x32_bf16 v[56:59], a[240:243], a[216:219], v[56:59]
v_mfma_f32_16x16x32_bf16 v[60:63], a[240:243], a[220:223], v[60:63]
ds_read_b64_tr_b16 a[240:241], v202 offset:28704
v_mfma_f32_16x16x32_bf16 a[32:35], a[244:247], a[192:195], a[32:35]
ds_read_b64_tr_b16 a[242:243], v202 offset:31264
ds_read_b128 a[184:187], v201 offset:34816
v_mfma_f32_16x16x32_bf16 a[36:39], a[244:247], a[196:199], a[36:39]
v_mfma_f32_16x16x32_bf16 a[40:43], a[244:247], a[200:203], a[40:43]
buffer_load_dwordx4 v200, s[20:23], s38 offen offset:3072 sc1 lds
v_mfma_f32_16x16x32_bf16 a[44:47], a[244:247], a[204:207], a[44:47]
s_add_u32 s38, s38, 16384
v_mfma_f32_16x16x32_bf16 a[48:51], a[244:247], a[208:211], a[48:51]
v_mfma_f32_16x16x32_bf16 a[52:55], a[244:247], a[212:215], a[52:55]
ds_read_b128 a[188:191], v201 offset:35840
v_mfma_f32_16x16x32_bf16 a[56:59], a[244:247], a[216:219], a[56:59]
v_mfma_f32_16x16x32_bf16 a[60:63], a[244:247], a[220:223], a[60:63]
s_waitcnt lgkmcnt(5)
ds_read_b64_tr_b16 a[244:245], v202 offset:34848
ds_read_b64_tr_b16 a[246:247], v202 offset:37408
v_mfma_f32_16x16x32_bf16 v[128:131], a[224:227], a[160:163], v[128:131]
v_mfma_f32_16x16x32_bf16 v[132:135], a[224:227], a[164:167], v[132:135]
v_add_u32 v201, 57344, v201
v_mfma_f32_16x16x32_bf16 v[136:139], a[224:227], a[168:171], v[136:139]
v_mfma_f32_16x16x32_bf16 v[140:143], a[224:227], a[172:175], v[140:143]
v_add_u32 v202, 57344, v202
v_mfma_f32_16x16x32_bf16 v[144:147], a[224:227], a[176:179], v[144:147]
s_waitcnt lgkmcnt(3)
v_mfma_f32_16x16x32_bf16 v[148:151], a[224:227], a[180:183], v[148:151]
v_add_u32 v203, 57344, v203
v_mfma_f32_16x16x32_bf16 v[152:155], a[224:227], a[184:187], v[152:155]
s_waitcnt lgkmcnt(2)
v_mfma_f32_16x16x32_bf16 v[156:159], a[224:227], a[188:191], v[156:159]
s_waitcnt vmcnt(26) lgkmcnt(0)
s_barrier
ds_read_b64_tr_b16 a[224:225], v203 offset:0
v_mfma_f32_16x16x32_bf16 a[128:131], a[228:231], a[160:163], a[128:131]
ds_read_b64_tr_b16 a[226:227], v203 offset:2560
v_mfma_f32_16x16x32_bf16 a[132:135], a[228:231], a[164:167], a[132:135]
s_add_u32 m0, s44, 102400
v_mfma_f32_16x16x32_bf16 a[136:139], a[228:231], a[168:171], a[136:139]
ds_read_b128 a[192:195], v201 offset:0
v_mfma_f32_16x16x32_bf16 a[140:143], a[228:231], a[172:175], a[140:143]
buffer_load_dwordx4 v204, s[24:27], s39 offen lds
v_mfma_f32_16x16x32_bf16 a[144:147], a[228:231], a[176:179], a[144:147]
v_mfma_f32_16x16x32_bf16 a[148:151], a[228:231], a[180:183], a[148:151]
v_mfma_f32_16x16x32_bf16 a[152:155], a[228:231], a[184:187], a[152:155]
v_mfma_f32_16x16x32_bf16 a[156:159], a[228:231], a[188:191], a[156:159]
ds_read_b64_tr_b16 a[228:229], v203 offset:6144
ds_read_b128 a[196:199], v201 offset:1024
v_mfma_f32_16x16x32_bf16 v[0:3], a[232:235], a[160:163], v[0:3]
buffer_load_dwordx4 v205, s[24:27], s39 offen offset:1024 lds
v_mfma_f32_16x16x32_bf16 v[4:7], a[232:235], a[164:167], v[4:7]
s_add_u32 s39, s39, 294912
ds_read_b64_tr_b16 a[230:231], v203 offset:8704
v_mfma_f32_16x16x32_bf16 v[8:11], a[232:235], a[168:171], v[8:11]
v_mfma_f32_16x16x32_bf16 v[12:15], a[232:235], a[172:175], v[12:15]
s_add_u32 m0, s44, 104448
v_mfma_f32_16x16x32_bf16 v[16:19], a[232:235], a[176:179], v[16:19]
ds_read_b128 a[200:203], v201 offset:2048
v_mfma_f32_16x16x32_bf16 v[20:23], a[232:235], a[180:183], v[20:23]
buffer_load_dwordx4 v206, s[28:31], s40 offen lds
v_mfma_f32_16x16x32_bf16 v[24:27], a[232:235], a[184:187], v[24:27]
s_add_u32 s40, s40, s41
v_mfma_f32_16x16x32_bf16 v[28:31], a[232:235], a[188:191], v[28:31]
ds_read_b64_tr_b16 a[232:233], v202 offset:0
v_mfma_f32_16x16x32_bf16 a[0:3], a[236:239], a[160:163], a[0:3]
ds_read_b64_tr_b16 a[234:235], v202 offset:2560
v_mfma_f32_16x16x32_bf16 a[4:7], a[236:239], a[164:167], a[4:7]
s_add_u32 m0, s43, 86016
ds_read_b128 a[204:207], v201 offset:3072
v_mfma_f32_16x16x32_bf16 a[8:11], a[236:239], a[168:171], a[8:11]
buffer_load_dwordx4 v200, s[20:23], s38 offen offset:0 sc1 lds
v_mfma_f32_16x16x32_bf16 a[12:15], a[236:239], a[172:175], a[12:15]
v_mfma_f32_16x16x32_bf16 a[16:19], a[236:239], a[176:179], a[16:19]
v_mfma_f32_16x16x32_bf16 a[20:23], a[236:239], a[180:183], a[20:23]
v_mfma_f32_16x16x32_bf16 a[24:27], a[236:239], a[184:187], a[24:27]
ds_read_b128 a[208:211], v201 offset:4096
v_mfma_f32_16x16x32_bf16 a[28:31], a[236:239], a[188:191], a[28:31]
ds_read_b64_tr_b16 a[236:237], v202 offset:6144
v_mfma_f32_16x16x32_bf16 v[32:35], a[240:243], a[160:163], v[32:35]
buffer_load_dwordx4 v200, s[20:23], s38 offen offset:1024 sc1 lds
v_mfma_f32_16x16x32_bf16 v[36:39], a[240:243], a[164:167], v[36:39]
ds_read_b64_tr_b16 a[238:239], v202 offset:8704
v_mfma_f32_16x16x32_bf16 v[40:43], a[240:243], a[168:171], v[40:43]
v_mfma_f32_16x16x32_bf16 v[44:47], a[240:243], a[172:175], v[44:47]
ds_read_b128 a[212:215], v201 offset:5120
v_mfma_f32_16x16x32_bf16 v[48:51], a[240:243], a[176:179], v[48:51]
v_mfma_f32_16x16x32_bf16 v[52:55], a[240:243], a[180:183], v[52:55]
buffer_load_dwordx4 v200, s[20:23], s38 offen offset:2048 sc1 lds
v_mfma_f32_16x16x32_bf16 v[56:59], a[240:243], a[184:187], v[56:59]
v_mfma_f32_16x16x32_bf16 v[60:63], a[240:243], a[188:191], v[60:63]
ds_read_b64_tr_b16 a[240:241], v202 offset:32
v_mfma_f32_16x16x32_bf16 a[32:35], a[244:247], a[160:163], a[32:35]
ds_read_b64_tr_b16 a[242:243], v202 offset:2592
ds_read_b128 a[216:219], v201 offset:6144
v_mfma_f32_16x16x32_bf16 a[36:39], a[244:247], a[164:167], a[36:39]
v_mfma_f32_16x16x32_bf16 a[40:43], a[244:247], a[168:171], a[40:43]
buffer_load_dwordx4 v200, s[20:23], s38 offen offset:3072 sc1 lds
v_mfma_f32_16x16x32_bf16 a[44:47], a[244:247], a[172:175], a[44:47]
s_add_u32 s38, s38, 16384
v_mfma_f32_16x16x32_bf16 a[48:51], a[244:247], a[176:179], a[48:51]
v_mfma_f32_16x16x32_bf16 a[52:55], a[244:247], a[180:183], a[52:55]
ds_read_b128 a[220:223], v201 offset:7168
v_mfma_f32_16x16x32_bf16 a[56:59], a[244:247], a[184:187], a[56:59]
v_mfma_f32_16x16x32_bf16 a[60:63], a[244:247], a[188:191], a[60:63]
s_waitcnt lgkmcnt(5)
ds_read_b64_tr_b16 a[244:245], v202 offset:6176
ds_read_b64_tr_b16 a[246:247], v202 offset:8736
v_mfma_f32_16x16x32_bf16 v[128:131], a[224:227], a[192:195], v[128:131]
v_mfma_f32_16x16x32_bf16 v[132:135], a[224:227], a[196:199], v[132:135]
v_add_u32 v201, 4294852608, v201
v_mfma_f32_16x16x32_bf16 v[136:139], a[224:227], a[200:203], v[136:139]
v_mfma_f32_16x16x32_bf16 v[140:143], a[224:227], a[204:207], v[140:143]
v_add_u32 v202, 4294852608, v202
v_mfma_f32_16x16x32_bf16 v[144:147], a[224:227], a[208:211], v[144:147]
s_waitcnt lgkmcnt(3)
v_mfma_f32_16x16x32_bf16 v[148:151], a[224:227], a[212:215], v[148:151]
v_add_u32 v203, 4294852608, v203
v_mfma_f32_16x16x32_bf16 v[152:155], a[224:227], a[216:219], v[152:155]
s_waitcnt lgkmcnt(2)
v_mfma_f32_16x16x32_bf16 v[156:159], a[224:227], a[220:223], v[156:159]
s_waitcnt vmcnt(22) lgkmcnt(0)
s_barrier
ds_read_b64_tr_b16 a[224:225], v203 offset:0
v_mfma_f32_16x16x32_bf16 a[128:131], a[228:231], a[192:195], a[128:131]
ds_read_b64_tr_b16 a[226:227], v203 offset:2560
v_mfma_f32_16x16x32_bf16 a[132:135], a[228:231], a[196:199], a[132:135]
s_add_u32 m0, s44, 131072
v_mfma_f32_16x16x32_bf16 a[136:139], a[228:231], a[200:203], a[136:139]
ds_read_b128 a[160:163], v201 offset:0
v_mfma_f32_16x16x32_bf16 a[140:143], a[228:231], a[204:207], a[140:143]
buffer_load_dwordx4 v204, s[24:27], s39 offen lds
v_mfma_f32_16x16x32_bf16 a[144:147], a[228:231], a[208:211], a[144:147]
v_perm_b32 v232, v228, v224, s47
v_mfma_f32_16x16x32_bf16 a[148:151], a[228:231], a[212:215], a[148:151]
v_perm_b32 v233, v228, v224, s48
v_mfma_f32_16x16x32_bf16 a[152:155], a[228:231], a[216:219], a[152:155]
v_perm_b32 v234, v229, v225, s47
v_mfma_f32_16x16x32_bf16 a[156:159], a[228:231], a[220:223], a[156:159]
ds_read_b64_tr_b16 a[228:229], v203 offset:6144
ds_read_b128 a[164:167], v201 offset:1024
v_mfma_f32_16x16x32_bf16 v[0:3], a[232:235], a[192:195], v[0:3]
buffer_load_dwordx4 v205, s[24:27], s39 offen offset:1024 lds
v_mfma_f32_16x16x32_bf16 v[4:7], a[232:235], a[196:199], v[4:7]
s_add_u32 s39, s39, 294912
v_perm_b32 v235, v229, v225, s48
ds_read_b64_tr_b16 a[230:231], v203 offset:8704
v_mfma_f32_16x16x32_bf16 v[8:11], a[232:235], a[200:203], v[8:11]
v_perm_b32 v236, v230, v226, s47
v_perm_b32 v237, v230, v226, s48
T_a_0:
s_cbranch_execz T_a_8
v_mfma_f32_16x16x32_bf16 v[12:15], a[232:235], a[204:207], v[12:15]
v_perm_b32 v238, v231, v227, s47
s_add_u32 m0, s44, 133120
v_mfma_f32_16x16x32_bf16 v[16:19], a[232:235], a[208:211], v[16:19]
v_perm_b32 v239, v231, v227, s48
ds_read_b128 a[168:171], v201 offset:2048
v_mfma_f32_16x16x32_bf16 v[20:23], a[232:235], a[212:215], v[20:23]
buffer_load_dwordx4 v206, s[28:31], s40 offen lds
v_mfma_f32_16x16x32_bf16 v[24:27], a[232:235], a[216:219], v[24:27]
s_add_u32 s40, s40, s41
v_mfma_f32_16x16x32_bf16 v[28:31], a[232:235], a[220:223], v[28:31]
ds_read_b64_tr_b16 a[232:233], v202 offset:0
buffer_store_dwordx4 v[232:235], v210, s[20:23], s37 offen offset:0 sc1
v_mfma_f32_16x16x32_bf16 a[0:3], a[236:239], a[192:195], a[0:3]
ds_read_b64_tr_b16 a[234:235], v202 offset:2560
v_mfma_f32_16x16x32_bf16 a[4:7], a[236:239], a[196:199], a[4:7]
s_add_u32 m0, s43, 114688
ds_read_b128 a[172:175], v201 offset:3072
v_mfma_f32_16x16x32_bf16 a[8:11], a[236:239], a[200:203], a[8:11]
buffer_load_dwordx4 v200, s[20:23], s38 offen offset:0 sc1 lds
v_mfma_f32_16x16x32_bf16 a[12:15], a[236:239], a[204:207], a[12:15]
v_mfma_f32_16x16x32_bf16 a[16:19], a[236:239], a[208:211], a[16:19]
v_mfma_f32_16x16x32_bf16 a[20:23], a[236:239], a[212:215], a[20:23]
buffer_store_dwordx4 v[236:239], v210, s[20:23], s37 offen offset:256 sc1
v_mfma_f32_16x16x32_bf16 a[24:27], a[236:239], a[216:219], a[24:27]
ds_read_b128 a[176:179], v201 offset:4096
v_mfma_f32_16x16x32_bf16 a[28:31], a[236:239], a[220:223], a[28:31]
ds_read_b64_tr_b16 a[236:237], v202 offset:6144
v_mfma_f32_16x16x32_bf16 v[32:35], a[240:243], a[192:195], v[32:35]
buffer_load_dwordx4 v200, s[20:23], s38 offen offset:1024 sc1 lds
v_mfma_f32_16x16x32_bf16 v[36:39], a[240:243], a[196:199], v[36:39]
ds_read_b64_tr_b16 a[238:239], v202 offset:8704
v_mfma_f32_16x16x32_bf16 v[40:43], a[240:243], a[200:203], v[40:43]
v_mfma_f32_16x16x32_bf16 v[44:47], a[240:243], a[204:207], v[44:47]
ds_read_b128 a[180:183], v201 offset:5120
v_mfma_f32_16x16x32_bf16 v[48:51], a[240:243], a[208:211], v[48:51]
v_mfma_f32_16x16x32_bf16 v[52:55], a[240:243], a[212:215], v[52:55]
buffer_load_dwordx4 v200, s[20:23], s38 offen offset:2048 sc1 lds
v_mfma_f32_16x16x32_bf16 v[56:59], a[240:243], a[216:219], v[56:59]
v_mfma_f32_16x16x32_bf16 v[60:63], a[240:243], a[220:223], v[60:63]
ds_read_b64_tr_b16 a[240:241], v202 offset:32
v_mfma_f32_16x16x32_bf16 a[32:35], a[244:247], a[192:195], a[32:35]
ds_read_b64_tr_b16 a[242:243], v202 offset:2592
ds_read_b128 a[184:187], v201 offset:6144
v_mfma_f32_16x16x32_bf16 a[36:39], a[244:247], a[196:199], a[36:39]
v_mfma_f32_16x16x32_bf16 a[40:43], a[244:247], a[200:203], a[40:43]
buffer_load_dwordx4 v200, s[20:23], s38 offen offset:3072 sc1 lds
v_mfma_f32_16x16x32_bf16 a[44:47], a[244:247], a[204:207], a[44:47]
s_add_u32 s38, s38, 16384
v_mfma_f32_16x16x32_bf16 a[48:51], a[244:247], a[208:211], a[48:51]
v_mfma_f32_16x16x32_bf16 a[52:55], a[244:247], a[212:215], a[52:55]
ds_read_b128 a[188:191], v201 offset:7168
v_mfma_f32_16x16x32_bf16 a[56:59], a[244:247], a[216:219], a[56:59]
v_mfma_f32_16x16x32_bf16 a[60:63], a[244:247], a[220:223], a[60:63]
s_waitcnt lgkmcnt(5)
ds_read_b64_tr_b16 a[244:245], v202 offset:6176
ds_read_b64_tr_b16 a[246:247], v202 offset:8736
v_mfma_f32_16x16x32_bf16 v[128:131], a[224:227], a[160:163], v[128:131]
v_mfma_f32_16x16x32_bf16 v[132:135], a[224:227], a[164:167], v[132:135]
v_mfma_f32_16x16x32_bf16 v[136:139], a[224:227], a[168:171], v[136:139]
v_mfma_f32_16x16x32_bf16 v[140:143], a[224:227], a[172:175], v[140:143]
v_mfma_f32_16x16x32_bf16 v[144:147], a[224:227], a[176:179], v[144:147]
s_waitcnt lgkmcnt(5)
v_mfma_f32_16x16x32_bf16 v[148:151], a[224:227], a[180:183], v[148:151]
s_waitcnt lgkmcnt(3)
v_mfma_f32_16x16x32_bf16 v[152:155], a[224:227], a[184:187], v[152:155]
s_waitcnt lgkmcnt(2)
v_mfma_f32_16x16x32_bf16 v[156:159], a[224:227], a[188:191], v[156:159]
s_waitcnt vmcnt(23) lgkmcnt(0)
s_barrier
ds_read_b64_tr_b16 a[224:225], v203 offset:28672
v_mfma_f32_16x16x32_bf16 a[128:131], a[228:231], a[160:163], a[128:131]
ds_read_b64_tr_b16 a[226:227], v203 offset:31232
v_mfma_f32_16x16x32_bf16 a[132:135], a[228:231], a[164:167], a[132:135]
s_add_u32 m0, s44, 16384
v_mfma_f32_16x16x32_bf16 a[136:139], a[228:231], a[168:171], a[136:139]
ds_read_b128 a[192:195], v201 offset:28672
v_mfma_f32_16x16x32_bf16 a[140:143], a[228:231], a[172:175], a[140:143]
buffer_load_dwordx4 v204, s[24:27], s39 offen lds
v_mfma_f32_16x16x32_bf16 a[144:147], a[228:231], a[176:179], a[144:147]
v_perm_b32 v248, v244, v240, s47
v_mfma_f32_16x16x32_bf16 a[148:151], a[228:231], a[180:183], a[148:151]
v_perm_b32 v249, v244, v240, s48
v_mfma_f32_16x16x32_bf16 a[152:155], a[228:231], a[184:187], a[152:155]
v_perm_b32 v250, v245, v241, s47
v_mfma_f32_16x16x32_bf16 a[156:159], a[228:231], a[188:191], a[156:159]
ds_read_b64_tr_b16 a[228:229], v203 offset:34816
ds_read_b128 a[196:199], v201 offset:29696
v_mfma_f32_16x16x32_bf16 v[0:3], a[232:235], a[160:163], v[0:3]
buffer_load_dwordx4 v205, s[24:27], s39 offen offset:1024 lds
v_mfma_f32_16x16x32_bf16 v[4:7], a[232:235], a[164:167], v[4:7]
s_add_u32 s39, s39, 294912
v_perm_b32 v251, v245, v241, s48
ds_read_b64_tr_b16 a[230:231], v203 offset:37376
v_mfma_f32_16x16x32_bf16 v[8:11], a[232:235], a[168:171], v[8:11]
v_perm_b32 v252, v246, v242, s47
v_perm_b32 v253, v246, v242, s48
v_mfma_f32_16x16x32_bf16 v[12:15], a[232:235], a[172:175], v[12:15]
v_perm_b32 v254, v247, v243, s47
s_add_u32 m0, s44, 18432
v_mfma_f32_16x16x32_bf16 v[16:19], a[232:235], a[176:179], v[16:19]
v_perm_b32 v255, v247, v243, s48
ds_read_b128 a[200:203], v201 offset:30720
v_mfma_f32_16x16x32_bf16 v[20:23], a[232:235], a[180:183], v[20:23]
buffer_load_dwordx4 v206, s[28:31], s40 offen lds
v_mfma_f32_16x16x32_bf16 v[24:27], a[232:235], a[184:187], v[24:27]
s_add_u32 s40, s40, s41
v_mfma_f32_16x16x32_bf16 v[28:31], a[232:235], a[188:191], v[28:31]
ds_read_b64_tr_b16 a[232:233], v202 offset:28672
buffer_store_dwordx4 v[248:251], v210, s[20:23], s42 offen offset:0 sc1
v_mfma_f32_16x16x32_bf16 a[0:3], a[236:239], a[160:163], a[0:3]
ds_read_b64_tr_b16 a[234:235], v202 offset:31232
v_mfma_f32_16x16x32_bf16 a[4:7], a[236:239], a[164:167], a[4:7]
s_add_u32 m0, s43, 0
ds_read_b128 a[204:207], v201 offset:31744
v_mfma_f32_16x16x32_bf16 a[8:11], a[236:239], a[168:171], a[8:11]
buffer_load_dwordx4 v200, s[20:23], s38 offen offset:0 sc1 lds
v_mfma_f32_16x16x32_bf16 a[12:15], a[236:239], a[172:175], a[12:15]
v_mfma_f32_16x16x32_bf16 a[16:19], a[236:239], a[176:179], a[16:19]
v_mfma_f32_16x16x32_bf16 a[20:23], a[236:239], a[180:183], a[20:23]
buffer_store_dwordx4 v[252:255], v210, s[20:23], s42 offen offset:256 sc1
v_mfma_f32_16x16x32_bf16 a[24:27], a[236:239], a[184:187], a[24:27]
ds_read_b128 a[208:211], v201 offset:32768
v_mfma_f32_16x16x32_bf16 a[28:31], a[236:239], a[188:191], a[28:31]
ds_read_b64_tr_b16 a[236:237], v202 offset:34816
v_mfma_f32_16x16x32_bf16 v[32:35], a[240:243], a[160:163], v[32:35]
buffer_load_dwordx4 v200, s[20:23], s38 offen offset:1024 sc1 lds
v_mfma_f32_16x16x32_bf16 v[36:39], a[240:243], a[164:167], v[36:39]
ds_read_b64_tr_b16 a[238:239], v202 offset:37376
v_mfma_f32_16x16x32_bf16 v[40:43], a[240:243], a[168:171], v[40:43]
v_mfma_f32_16x16x32_bf16 v[44:47], a[240:243], a[172:175], v[44:47]
ds_read_b128 a[212:215], v201 offset:33792
v_mfma_f32_16x16x32_bf16 v[48:51], a[240:243], a[176:179], v[48:51]
v_mfma_f32_16x16x32_bf16 v[52:55], a[240:243], a[180:183], v[52:55]
buffer_load_dwordx4 v200, s[20:23], s38 offen offset:2048 sc1 lds
v_mfma_f32_16x16x32_bf16 v[56:59], a[240:243], a[184:187], v[56:59]
v_mfma_f32_16x16x32_bf16 v[60:63], a[240:243], a[188:191], v[60:63]
ds_read_b64_tr_b16 a[240:241], v202 offset:28704
v_mfma_f32_16x16x32_bf16 a[32:35], a[244:247], a[160:163], a[32:35]
ds_read_b64_tr_b16 a[242:243], v202 offset:31264
ds_read_b128 a[216:219], v201 offset:34816
v_mfma_f32_16x16x32_bf16 a[36:39], a[244:247], a[164:167], a[36:39]
v_mfma_f32_16x16x32_bf16 a[40:43], a[244:247], a[168:171], a[40:43]
buffer_load_dwordx4 v200, s[20:23], s38 offen offset:3072 sc1 lds
v_mfma_f32_16x16x32_bf16 a[44:47], a[244:247], a[172:175], a[44:47]
s_add_u32 s38, s38, 16384
v_mfma_f32_16x16x32_bf16 a[48:51], a[244:247], a[176:179], a[48:51]
v_mfma_f32_16x16x32_bf16 a[52:55], a[244:247], a[180:183], a[52:55]
ds_read_b128 a[220:223], v201 offset:35840
v_mfma_f32_16x16x32_bf16 a[56:59], a[244:247], a[184:187], a[56:59]
v_mfma_f32_16x16x32_bf16 a[60:63], a[244:247], a[188:191], a[60:63]
s_waitcnt lgkmcnt(5)
ds_read_b64_tr_b16 a[244:245], v202 offset:34848
ds_read_b64_tr_b16 a[246:247], v202 offset:37408
v_mfma_f32_16x16x32_bf16 v[128:131], a[224:227], a[192:195], v[128:131]
v_mfma_f32_16x16x32_bf16 v[132:135], a[224:227], a[196:199], v[132:135]
v_add_u32 v201, 57344, v201
v_mfma_f32_16x16x32_bf16 v[136:139], a[224:227], a[200:203], v[136:139]
v_mfma_f32_16x16x32_bf16 v[140:143], a[224:227], a[204:207], v[140:143]
v_add_u32 v202, 57344, v202
v_mfma_f32_16x16x32_bf16 v[144:147], a[224:227], a[208:211], v[144:147]
s_waitcnt lgkmcnt(3)
v_mfma_f32_16x16x32_bf16 v[148:151], a[224:227], a[212:215], v[148:151]
v_add_u32 v203, 57344, v203
v_mfma_f32_16x16x32_bf16 v[152:155], a[224:227], a[216:219], v[152:155]
s_waitcnt lgkmcnt(2)
v_mfma_f32_16x16x32_bf16 v[156:159], a[224:227], a[220:223], v[156:159]
s_waitcnt vmcnt(25) lgkmcnt(0)
s_barrier
ds_read_b64_tr_b16 a[224:225], v203 offset:0
v_mfma_f32_16x16x32_bf16 a[128:131], a[228:231], a[192:195], a[128:131]
ds_read_b64_tr_b16 a[226:227], v203 offset:2560
v_mfma_f32_16x16x32_bf16 a[132:135], a[228:231], a[196:199], a[132:135]
s_add_u32 m0, s44, 45056
v_mfma_f32_16x16x32_bf16 a[136:139], a[228:231], a[200:203], a[136:139]
ds_read_b128 a[160:163], v201 offset:0
v_mfma_f32_16x16x32_bf16 a[140:143], a[228:231], a[204:207], a[140:143]
buffer_load_dwordx4 v204, s[24:27], s39 offen lds
v_mfma_f32_16x16x32_bf16 a[144:147], a[228:231], a[208:211], a[144:147]
v_mfma_f32_16x16x32_bf16 a[148:151], a[228:231], a[212:215], a[148:151]
s_lshl_b32 s6, s13, 1
s_add_u32 s6, s6, s16
v_mfma_f32_16x16x32_bf16 a[152:155], a[228:231], a[216:219], a[152:155]
v_mfma_f32_16x16x32_bf16 a[156:159], a[228:231], a[220:223], a[156:159]
ds_read_b64_tr_b16 a[228:229], v203 offset:6144
ds_read_b128 a[164:167], v201 offset:1024
v_mfma_f32_16x16x32_bf16 v[0:3], a[232:235], a[192:195], v[0:3]
buffer_load_dwordx4 v205, s[24:27], s39 offen offset:1024 lds
v_mfma_f32_16x16x32_bf16 v[4:7], a[232:235], a[196:199], v[4:7]
s_add_u32 s39, s39, 294912
s_mul_i32 s6, s6, 27648
s_mul_i32 s7, s12, 1152
v_mfma_f32_16x16x32_bf16 v[8:11], a[232:235], a[200:203], v[8:11]
s_add_u32 s6, s6, s7
ds_read_b64_tr_b16 a[230:231], v203 offset:8704
v_min_u32 v197, 176, v200
v_mfma_f32_16x16x32_bf16 v[12:15], a[232:235], a[204:207], v[12:15]
s_add_u32 m0, s44, 47104
v_lshrrev_b32 v198, 6, v197
v_mul_u32_u24 v198, 8704, v198
v_mfma_f32_16x16x32_bf16 v[16:19], a[232:235], a[208:211], v[16:19]
ds_read_b128 a[168:171], v201 offset:2048
v_mfma_f32_16x16x32_bf16 v[20:23], a[232:235], a[212:215], v[20:23]
buffer_load_dwordx4 v206, s[28:31], s40 offen lds
v_mfma_f32_16x16x32_bf16 v[24:27], a[232:235], a[216:219], v[24:27]
s_add_u32 s40, s40, s41
s_add_u32 s97, s6, 3538944
v_lshl_add_u32 v197, v197, 3, v198
v_mfma_f32_16x16x32_bf16 v[28:31], a[232:235], a[220:223], v[28:31]
ds_read_b64_tr_b16 a[232:233], v202 offset:0
v_mfma_f32_16x16x32_bf16 a[0:3], a[236:239], a[192:195], a[0:3]
buffer_load_dword a255, v197, s[24:27], s97 offen offset:640
v_mfma_f32_16x16x32_bf16 a[4:7], a[236:239], a[196:199], a[4:7]
s_add_u32 m0, s43, 28672
ds_read_b64_tr_b16 a[234:235], v202 offset:2560
ds_read_b128 a[172:175], v201 offset:3072
v_mfma_f32_16x16x32_bf16 a[8:11], a[236:239], a[200:203], a[8:11]
buffer_load_dwordx4 v200, s[20:23], s38 offen offset:0 sc1 lds
v_mfma_f32_16x16x32_bf16 a[12:15], a[236:239], a[204:207], a[12:15]
v_mfma_f32_16x16x32_bf16 a[16:19], a[236:239], a[208:211], a[16:19]
v_mfma_f32_16x16x32_bf16 a[20:23], a[236:239], a[212:215], a[20:23]
v_mfma_f32_16x16x32_bf16 a[24:27], a[236:239], a[216:219], a[24:27]
ds_read_b128 a[176:179], v201 offset:4096
v_mfma_f32_16x16x32_bf16 a[28:31], a[236:239], a[220:223], a[28:31]
ds_read_b64_tr_b16 a[236:237], v202 offset:6144
v_mfma_f32_16x16x32_bf16 v[32:35], a[240:243], a[192:195], v[32:35]
buffer_load_dwordx4 v200, s[20:23], s38 offen offset:1024 sc1 lds
v_mfma_f32_16x16x32_bf16 v[36:39], a[240:243], a[196:199], v[36:39]
ds_read_b64_tr_b16 a[238:239], v202 offset:8704
v_mfma_f32_16x16x32_bf16 v[40:43], a[240:243], a[200:203], v[40:43]
v_mfma_f32_16x16x32_bf16 v[44:47], a[240:243], a[204:207], v[44:47]
ds_read_b128 a[180:183], v201 offset:5120
v_mfma_f32_16x16x32_bf16 v[48:51], a[240:243], a[208:211], v[48:51]
v_mfma_f32_16x16x32_bf16 v[52:55], a[240:243], a[212:215], v[52:55]
buffer_load_dwordx4 v200, s[20:23], s38 offen offset:2048 sc1 lds
v_mfma_f32_16x16x32_bf16 v[56:59], a[240:243], a[216:219], v[56:59]
v_mfma_f32_16x16x32_bf16 v[60:63], a[240:243], a[220:223], v[60:63]
ds_read_b64_tr_b16 a[240:241], v202 offset:32
v_mfma_f32_16x16x32_bf16 a[32:35], a[244:247], a[192:195], a[32:35]
ds_read_b64_tr_b16 a[242:243], v202 offset:2592
ds_read_b128 a[184:187], v201 offset:6144
v_mfma_f32_16x16x32_bf16 a[36:39], a[244:247], a[196:199], a[36:39]
v_mfma_f32_16x16x32_bf16 a[40:43], a[244:247], a[200:203], a[40:43]
buffer_load_dwordx4 v200, s[20:23], s38 offen offset:3072 sc1 lds
v_mfma_f32_16x16x32_bf16 a[44:47], a[244:247], a[204:207], a[44:47]
s_add_u32 s38, s38, 16384
v_mfma_f32_16x16x32_bf16 a[48:51], a[244:247], a[208:211], a[48:51]
v_mfma_f32_16x16x32_bf16 a[52:55], a[244:247], a[212:215], a[52:55]
ds_read_b128 a[188:191], v201 offset:7168
v_mfma_f32_16x16x32_bf16 a[56:59], a[244:247], a[216:219], a[56:59]
v_mfma_f32_16x16x32_bf16 a[60:63], a[244:247], a[220:223], a[60:63]
s_waitcnt lgkmcnt(5)
ds_read_b64_tr_b16 a[244:245], v202 offset:6176
ds_read_b64_tr_b16 a[246:247], v202 offset:8736
v_mfma_f32_16x16x32_bf16 v[128:131], a[224:227], a[160:163], v[128:131]
v_mfma_f32_16x16x32_bf16 v[132:135], a[224:227], a[164:167], v[132:135]
v_mfma_f32_16x16x32_bf16 v[136:139], a[224:227], a[168:171], v[136:139]
v_mfma_f32_16x16x32_bf16 v[140:143], a[224:227], a[172:175], v[140:143]
v_mfma_f32_16x16x32_bf16 v[144:147], a[224:227], a[176:179], v[144:147]
s_waitcnt lgkmcnt(5)
v_mfma_f32_16x16x32_bf16 v[148:151], a[224:227], a[180:183], v[148:151]
s_waitcnt lgkmcnt(3)
v_mfma_f32_16x16x32_bf16 v[152:155], a[224:227], a[184:187], v[152:155]
s_waitcnt lgkmcnt(2)
v_mfma_f32_16x16x32_bf16 v[156:159], a[224:227], a[188:191], v[156:159]
s_waitcnt vmcnt(26) lgkmcnt(0)
s_barrier
ds_read_b64_tr_b16 a[224:225], v203 offset:28672
v_mfma_f32_16x16x32_bf16 a[128:131], a[228:231], a[160:163], a[128:131]
ds_read_b64_tr_b16 a[226:227], v203 offset:31232
v_mfma_f32_16x16x32_bf16 a[132:135], a[228:231], a[164:167], a[132:135]
s_add_u32 m0, s44, 73728
v_mfma_f32_16x16x32_bf16 a[136:139], a[228:231], a[168:171], a[136:139]
ds_read_b128 a[192:195], v201 offset:28672
v_mfma_f32_16x16x32_bf16 a[140:143], a[228:231], a[172:175], a[140:143]
buffer_load_dwordx4 v204, s[24:27], s39 offen lds
v_mfma_f32_16x16x32_bf16 a[144:147], a[228:231], a[176:179], a[144:147]
v_mfma_f32_16x16x32_bf16 a[148:151], a[228:231], a[180:183], a[148:151]
v_mfma_f32_16x16x32_bf16 a[152:155], a[228:231], a[184:187], a[152:155]
v_mfma_f32_16x16x32_bf16 a[156:159], a[228:231], a[188:191], a[156:159]
ds_read_b64_tr_b16 a[228:229], v203 offset:34816
ds_read_b128 a[196:199], v201 offset:29696
v_mfma_f32_16x16x32_bf16 v[0:3], a[232:235], a[160:163], v[0:3]
buffer_load_dwordx4 v205, s[24:27], s39 offen offset:1024 lds
v_mfma_f32_16x16x32_bf16 v[4:7], a[232:235], a[164:167], v[4:7]
s_add_u32 s39, s39, 294912
ds_read_b64_tr_b16 a[230:231], v203 offset:37376
v_mfma_f32_16x16x32_bf16 v[8:11], a[232:235], a[168:171], v[8:11]
v_mfma_f32_16x16x32_bf16 v[12:15], a[232:235], a[172:175], v[12:15]
s_add_u32 m0, s44, 75776
v_mfma_f32_16x16x32_bf16 v[16:19], a[232:235], a[176:179], v[16:19]
ds_read_b128 a[200:203], v201 offset:30720
v_mfma_f32_16x16x32_bf16 v[20:23], a[232:235], a[180:183], v[20:23]
buffer_load_dwordx4 v206, s[28:31], s40 offen lds
v_mfma_f32_16x16x32_bf16 v[24:27], a[232:235], a[184:187], v[24:27]
s_add_u32 s40, s40, s41
v_mfma_f32_16x16x32_bf16 v[28:31], a[232:235], a[188:191], v[28:31]
ds_read_b64_tr_b16 a[232:233], v202 offset:28672
v_mfma_f32_16x16x32_bf16 a[0:3], a[236:239], a[160:163], a[0:3]
ds_read_b64_tr_b16 a[234:235], v202 offset:31232
v_mfma_f32_16x16x32_bf16 a[4:7], a[236:239], a[164:167], a[4:7]
s_add_u32 m0, s43, 57344
ds_read_b128 a[204:207], v201 offset:31744
v_mfma_f32_16x16x32_bf16 a[8:11], a[236:239], a[168:171], a[8:11]
buffer_load_dwordx4 v200, s[20:23], s38 offen offset:0 sc1 lds
v_mfma_f32_16x16x32_bf16 a[12:15], a[236:239], a[172:175], a[12:15]
v_mfma_f32_16x16x32_bf16 a[16:19], a[236:239], a[176:179], a[16:19]
v_mfma_f32_16x16x32_bf16 a[20:23], a[236:239], a[180:183], a[20:23]
v_mfma_f32_16x16x32_bf16 a[24:27], a[236:239], a[184:187], a[24:27]
ds_read_b128 a[208:211], v201 offset:32768
v_mfma_f32_16x16x32_bf16 a[28:31], a[236:239], a[188:191], a[28:31]
ds_read_b64_tr_b16 a[236:237], v202 offset:34816
v_mfma_f32_16x16x32_bf16 v[32:35], a[240:243], a[160:163], v[32:35]
buffer_load_dwordx4 v200, s[20:23], s38 offen offset:1024 sc1 lds
v_mfma_f32_16x16x32_bf16 v[36:39], a[240:243], a[164:167], v[36:39]
ds_read_b64_tr_b16 a[238:239], v202 offset:37376
v_mfma_f32_16x16x32_bf16 v[40:43], a[240:243], a[168:171], v[40:43]
v_mfma_f32_16x16x32_bf16 v[44:47], a[240:243], a[172:175], v[44:47]
ds_read_b128 a[212:215], v201 offset:33792
v_mfma_f32_16x16x32_bf16 v[48:51], a[240:243], a[176:179], v[48:51]
v_mfma_f32_16x16x32_bf16 v[52:55], a[240:243], a[180:183], v[52:55]
buffer_load_dwordx4 v200, s[20:23], s38 offen offset:2048 sc1 lds
v_mfma_f32_16x16x32_bf16 v[56:59], a[240:243], a[184:187], v[56:59]
v_mfma_f32_16x16x32_bf16 v[60:63], a[240:243], a[188:191], v[60:63]
ds_read_b64_tr_b16 a[240:241], v202 offset:28704
v_mfma_f32_16x16x32_bf16 a[32:35], a[244:247], a[160:163], a[32:35]
ds_read_b64_tr_b16 a[242:243], v202 offset:31264
ds_read_b128 a[216:219], v201 offset:34816
v_mfma_f32_16x16x32_bf16 a[36:39], a[244:247], a[164:167], a[36:39]
v_mfma_f32_16x16x32_bf16 a[40:43], a[244:247], a[168:171], a[40:43]
buffer_load_dwordx4 v200, s[20:23], s38 offen offset:3072 sc1 lds
v_mfma_f32_16x16x32_bf16 a[44:47], a[244:247], a[172:175], a[44:47]
s_add_u32 s38, s38, 16384
v_mfma_f32_16x16x32_bf16 a[48:51], a[244:247], a[176:179], a[48:51]
v_mfma_f32_16x16x32_bf16 a[52:55], a[244:247], a[180:183], a[52:55]
ds_read_b128 a[220:223], v201 offset:35840
v_mfma_f32_16x16x32_bf16 a[56:59], a[244:247], a[184:187], a[56:59]
v_mfma_f32_16x16x32_bf16 a[60:63], a[244:247], a[188:191], a[60:63]
s_waitcnt lgkmcnt(5)
ds_read_b64_tr_b16 a[244:245], v202 offset:34848
ds_read_b64_tr_b16 a[246:247], v202 offset:37408
v_mfma_f32_16x16x32_bf16 v[128:131], a[224:227], a[192:195], v[128:131]
v_mfma_f32_16x16x32_bf16 v[132:135], a[224:227], a[196:199], v[132:135]
v_add_u32 v201, 57344, v201
v_mfma_f32_16x16x32_bf16 v[136:139], a[224:227], a[200:203], v[136:139]
v_mfma_f32_16x16x32_bf16 v[140:143], a[224:227], a[204:207], v[140:143]
v_add_u32 v202, 57344, v202
v_mfma_f32_16x16x32_bf16 v[144:147], a[224:227], a[208:211], v[144:147]
s_waitcnt lgkmcnt(3)
v_mfma_f32_16x16x32_bf16 v[148:151], a[224:227], a[212:215], v[148:151]
v_add_u32 v203, 57344, v203
v_mfma_f32_16x16x32_bf16 v[152:155], a[224:227], a[216:219], v[152:155]
s_waitcnt lgkmcnt(2)
v_mfma_f32_16x16x32_bf16 v[156:159], a[224:227], a[220:223], v[156:159]
s_waitcnt vmcnt(24) lgkmcnt(0)
s_barrier
ds_read_b64_tr_b16 a[224:225], v203 offset:0
v_mfma_f32_16x16x32_bf16 a[128:131], a[228:231], a[192:195], a[128:131]
ds_read_b64_tr_b16 a[226:227], v203 offset:2560
v_mfma_f32_16x16x32_bf16 a[132:135], a[228:231], a[196:199], a[132:135]
s_add_u32 m0, s44, 102400
v_mfma_f32_16x16x32_bf16 a[136:139], a[228:231], a[200:203], a[136:139]
ds_read_b128 a[160:163], v201 offset:0
v_mfma_f32_16x16x32_bf16 a[140:143], a[228:231], a[204:207], a[140:143]
buffer_load_dwordx4 v204, s[24:27], s39 offen lds
v_mfma_f32_16x16x32_bf16 a[144:147], a[228:231], a[208:211], a[144:147]
v_mfma_f32_16x16x32_bf16 a[148:151], a[228:231], a[212:215], a[148:151]
v_mfma_f32_16x16x32_bf16 a[152:155], a[228:231], a[216:219], a[152:155]
v_mfma_f32_16x16x32_bf16 a[156:159], a[228:231], a[220:223], a[156:159]
ds_read_b64_tr_b16 a[228:229], v203 offset:6144
ds_read_b128 a[164:167], v201 offset:1024
v_mfma_f32_16x16x32_bf16 v[0:3], a[232:235], a[192:195], v[0:3]
buffer_load_dwordx4 v205, s[24:27], s39 offen offset:1024 lds
v_mfma_f32_16x16x32_bf16 v[4:7], a[232:235], a[196:199], v[4:7]
s_add_u32 s39, s39, 294912
ds_read_b64_tr_b16 a[230:231], v203 offset:8704
v_mfma_f32_16x16x32_bf16 v[8:11], a[232:235], a[200:203], v[8:11]
v_mfma_f32_16x16x32_bf16 v[12:15], a[232:235], a[204:207], v[12:15]
s_add_u32 m0, s44, 104448
v_mfma_f32_16x16x32_bf16 v[16:19], a[232:235], a[208:211], v[16:19]
ds_read_b128 a[168:171], v201 offset:2048
v_mfma_f32_16x16x32_bf16 v[20:23], a[232:235], a[212:215], v[20:23]
buffer_load_dwordx4 v206, s[28:31], s40 offen lds
v_mfma_f32_16x16x32_bf16 v[24:27], a[232:235], a[216:219], v[24:27]
s_add_u32 s40, s40, s41
v_mfma_f32_16x16x32_bf16 v[28:31], a[232:235], a[220:223], v[28:31]
ds_read_b64_tr_b16 a[232:233], v202 offset:0
v_mfma_f32_16x16x32_bf16 a[0:3], a[236:239], a[192:195], a[0:3]
ds_read_b64_tr_b16 a[234:235], v202 offset:2560
v_mfma_f32_16x16x32_bf16 a[4:7], a[236:239], a[196:199], a[4:7]
s_add_u32 m0, s43, 86016
ds_read_b128 a[172:175], v201 offset:3072
v_mfma_f32_16x16x32_bf16 a[8:11], a[236:239], a[200:203], a[8:11]
buffer_load_dwordx4 v200, s[20:23], s38 offen offset:0 sc1 lds
v_mfma_f32_16x16x32_bf16 a[12:15], a[236:239], a[204:207], a[12:15]
v_mfma_f32_16x16x32_bf16 a[16:19], a[236:239], a[208:211], a[16:19]
v_mfma_f32_16x16x32_bf16 a[20:23], a[236:239], a[212:215], a[20:23]
v_mfma_f32_16x16x32_bf16 a[24:27], a[236:239], a[216:219], a[24:27]
ds_read_b128 a[176:179], v201 offset:4096
v_mfma_f32_16x16x32_bf16 a[28:31], a[236:239], a[220:223], a[28:31]
ds_read_b64_tr_b16 a[236:237], v202 offset:6144
v_mfma_f32_16x16x32_bf16 v[32:35], a[240:243], a[192:195], v[32:35]
buffer_load_dwordx4 v200, s[20:23], s38 offen offset:1024 sc1 lds
v_mfma_f32_16x16x32_bf16 v[36:39], a[240:243], a[196:199], v[36:39]
ds_read_b64_tr_b16 a[238:239], v202 offset:8704
v_mfma_f32_16x16x32_bf16 v[40:43], a[240:243], a[200:203], v[40:43]
v_mfma_f32_16x16x32_bf16 v[44:47], a[240:243], a[204:207], v[44:47]
ds_read_b128 a[180:183], v201 offset:5120
v_mfma_f32_16x16x32_bf16 v[48:51], a[240:243], a[208:211], v[48:51]
v_mfma_f32_16x16x32_bf16 v[52:55], a[240:243], a[212:215], v[52:55]
buffer_load_dwordx4 v200, s[20:23], s38 offen offset:2048 sc1 lds
v_mfma_f32_16x16x32_bf16 v[56:59], a[240:243], a[216:219], v[56:59]
v_mfma_f32_16x16x32_bf16 v[60:63], a[240:243], a[220:223], v[60:63]
ds_read_b64_tr_b16 a[240:241], v202 offset:32
v_mfma_f32_16x16x32_bf16 a[32:35], a[244:247], a[192:195], a[32:35]
ds_read_b64_tr_b16 a[242:243], v202 offset:2592
ds_read_b128 a[184:187], v201 offset:6144
v_mfma_f32_16x16x32_bf16 a[36:39], a[244:247], a[196:199], a[36:39]
v_mfma_f32_16x16x32_bf16 a[40:43], a[244:247], a[200:203], a[40:43]
buffer_load_dwordx4 v200, s[20:23], s38 offen offset:3072 sc1 lds
v_mfma_f32_16x16x32_bf16 a[44:47], a[244:247], a[204:207], a[44:47]
s_add_u32 s38, s38, 16384
v_mfma_f32_16x16x32_bf16 a[48:51], a[244:247], a[208:211], a[48:51]
v_mfma_f32_16x16x32_bf16 a[52:55], a[244:247], a[212:215], a[52:55]
ds_read_b128 a[188:191], v201 offset:7168
v_mfma_f32_16x16x32_bf16 a[56:59], a[244:247], a[216:219], a[56:59]
v_mfma_f32_16x16x32_bf16 a[60:63], a[244:247], a[220:223], a[60:63]
s_waitcnt lgkmcnt(5)
ds_read_b64_tr_b16 a[244:245], v202 offset:6176
ds_read_b64_tr_b16 a[246:247], v202 offset:8736
v_mfma_f32_16x16x32_bf16 v[128:131], a[224:227], a[160:163], v[128:131]
v_mfma_f32_16x16x32_bf16 v[132:135], a[224:227], a[164:167], v[132:135]
v_add_u32 v201, 4294852608, v201
v_mfma_f32_16x16x32_bf16 v[136:139], a[224:227], a[168:171], v[136:139]
v_mfma_f32_16x16x32_bf16 v[140:143], a[224:227], a[172:175], v[140:143]
v_add_u32 v202, 4294852608, v202
v_mfma_f32_16x16x32_bf16 v[144:147], a[224:227], a[176:179], v[144:147]
s_waitcnt lgkmcnt(3)
v_mfma_f32_16x16x32_bf16 v[148:151], a[224:227], a[180:183], v[148:151]
v_add_u32 v203, 4294852608, v203
v_mfma_f32_16x16x32_bf16 v[152:155], a[224:227], a[184:187], v[152:155]
s_waitcnt lgkmcnt(2)
v_mfma_f32_16x16x32_bf16 v[156:159], a[224:227], a[188:191], v[156:159]
s_waitcnt vmcnt(22) lgkmcnt(0)
s_barrier
ds_read_b64_tr_b16 a[224:225], v203 offset:0
v_mfma_f32_16x16x32_bf16 a[128:131], a[228:231], a[160:163], a[128:131]
ds_read_b64_tr_b16 a[226:227], v203 offset:2560
s_lshl_b32 s18, s2, 2
v_mfma_f32_16x16x32_bf16 a[132:135], a[228:231], a[164:167], a[132:135]
s_add_u32 s18, s18, 4521984
s_add_u32 m0, s44, 131072
v_mfma_f32_16x16x32_bf16 a[136:139], a[228:231], a[168:171], a[136:139]
ds_read_b128 a[192:195], v201 offset:0
v_mfma_f32_16x16x32_bf16 a[140:143], a[228:231], a[172:175], a[140:143]
buffer_load_dwordx4 v204, s[24:27], s39 offen lds
v_mfma_f32_16x16x32_bf16 a[144:147], a[228:231], a[176:179], a[144:147]
s_cmp_eq_u32 s3, 0
s_cselect_b32 s18, s18, 1073741824
v_mfma_f32_16x16x32_bf16 a[148:151], a[228:231], a[180:183], a[148:151]
buffer_store_dword v218, v217, s[20:23], s18 offen offset:0 sc1
v_mfma_f32_16x16x32_bf16 a[152:155], a[228:231], a[184:187], a[152:155]
v_mfma_f32_16x16x32_bf16 a[156:159], a[228:231], a[188:191], a[156:159]
ds_read_b64_tr_b16 a[228:229], v203 offset:6144
ds_read_b128 a[196:199], v201 offset:1024
v_mfma_f32_16x16x32_bf16 v[0:3], a[232:235], a[160:163], v[0:3]
buffer_load_dwordx4 v205, s[24:27], s39 offen offset:1024 lds
v_mfma_f32_16x16x32_bf16 v[4:7], a[232:235], a[164:167], v[4:7]
s_add_u32 s39, s39, 294912
ds_read_b64_tr_b16 a[230:231], v203 offset:8704
v_mfma_f32_16x16x32_bf16 v[8:11], a[232:235], a[168:171], v[8:11]
v_mfma_f32_16x16x32_bf16 v[12:15], a[232:235], a[172:175], v[12:15]
s_add_u32 m0, s44, 133120
v_mfma_f32_16x16x32_bf16 v[16:19], a[232:235], a[176:179], v[16:19]
ds_read_b128 a[200:203], v201 offset:2048
v_mfma_f32_16x16x32_bf16 v[20:23], a[232:235], a[180:183], v[20:23]
buffer_load_dwordx4 v206, s[28:31], s40 offen lds
v_mfma_f32_16x16x32_bf16 v[24:27], a[232:235], a[184:187], v[24:27]
s_add_u32 s40, s40, s41
s_sub_u32 s97, s97, 1769472
v_mfma_f32_16x16x32_bf16 v[28:31], a[232:235], a[188:191], v[28:31]
ds_read_b64_tr_b16 a[232:233], v202 offset:0
v_mfma_f32_16x16x32_bf16 a[0:3], a[236:239], a[160:163], a[0:3]
buffer_load_dword a255, v197, s[24:27], s97 offen offset:640
v_mfma_f32_16x16x32_bf16 a[4:7], a[236:239], a[164:167], a[4:7]
s_add_u32 m0, s43, 114688
ds_read_b64_tr_b16 a[234:235], v202 offset:2560
ds_read_b128 a[204:207], v201 offset:3072
v_mfma_f32_16x16x32_bf16 a[8:11], a[236:239], a[168:171], a[8:11]
buffer_load_dwordx4 v200, s[20:23], s38 offen offset:0 sc1 lds
v_mfma_f32_16x16x32_bf16 a[12:15], a[236:239], a[172:175], a[12:15]
v_mfma_f32_16x16x32_bf16 a[16:19], a[236:239], a[176:179], a[16:19]
v_mfma_f32_16x16x32_bf16 a[20:23], a[236:239], a[180:183], a[20:23]
v_mfma_f32_16x16x32_bf16 a[24:27], a[236:239], a[184:187], a[24:27]
ds_read_b128 a[208:211], v201 offset:4096
v_mfma_f32_16x16x32_bf16 a[28:31], a[236:239], a[188:191], a[28:31]
ds_read_b64_tr_b16 a[236:237], v202 offset:6144
v_mfma_f32_16x16x32_bf16 v[32:35], a[240:243], a[160:163], v[32:35]
buffer_load_dwordx4 v200, s[20:23], s38 offen offset:1024 sc1 lds
v_mfma_f32_16x16x32_bf16 v[36:39], a[240:243], a[164:167], v[36:39]
ds_read_b64_tr_b16 a[238:239], v202 offset:8704
v_mfma_f32_16x16x32_bf16 v[40:43], a[240:243], a[168:171], v[40:43]
v_mfma_f32_16x16x32_bf16 v[44:47], a[240:243], a[172:175], v[44:47]
ds_read_b128 a[212:215], v201 offset:5120
v_mfma_f32_16x16x32_bf16 v[48:51], a[240:243], a[176:179], v[48:51]
v_mfma_f32_16x16x32_bf16 v[52:55], a[240:243], a[180:183], v[52:55]
buffer_load_dwordx4 v200, s[20:23], s38 offen offset:2048 sc1 lds
v_mfma_f32_16x16x32_bf16 v[56:59], a[240:243], a[184:187], v[56:59]
v_mfma_f32_16x16x32_bf16 v[60:63], a[240:243], a[188:191], v[60:63]
ds_read_b64_tr_b16 a[240:241], v202 offset:32
v_mfma_f32_16x16x32_bf16 a[32:35], a[244:247], a[160:163], a[32:35]
ds_read_b64_tr_b16 a[242:243], v202 offset:2592
ds_read_b128 a[216:219], v201 offset:6144
v_mfma_f32_16x16x32_bf16 a[36:39], a[244:247], a[164:167], a[36:39]
v_mfma_f32_16x16x32_bf16 a[40:43], a[244:247], a[168:171], a[40:43]
buffer_load_dwordx4 v200, s[20:23], s38 offen offset:3072 sc1 lds
v_mfma_f32_16x16x32_bf16 a[44:47], a[244:247], a[172:175], a[44:47]
s_add_u32 s38, s38, 16384
v_mfma_f32_16x16x32_bf16 a[48:51], a[244:247], a[176:179], a[48:51]
v_mfma_f32_16x16x32_bf16 a[52:55], a[244:247], a[180:183], a[52:55]
ds_read_b128 a[220:223], v201 offset:7168
v_mfma_f32_16x16x32_bf16 a[56:59], a[244:247], a[184:187], a[56:59]
v_mfma_f32_16x16x32_bf16 a[60:63], a[244:247], a[188:191], a[60:63]
s_waitcnt lgkmcnt(5)
ds_read_b64_tr_b16 a[244:245], v202 offset:6176
ds_read_b64_tr_b16 a[246:247], v202 offset:8736
v_mfma_f32_16x16x32_bf16 v[128:131], a[224:227], a[192:195], v[128:131]
v_mfma_f32_16x16x32_bf16 v[132:135], a[224:227], a[196:199], v[132:135]
v_mfma_f32_16x16x32_bf16 v[136:139], a[224:227], a[200:203], v[136:139]
v_mfma_f32_16x16x32_bf16 v[140:143], a[224:227], a[204:207], v[140:143]
v_mfma_f32_16x16x32_bf16 v[144:147], a[224:227], a[208:211], v[144:147]
s_waitcnt lgkmcnt(5)
v_mfma_f32_16x16x32_bf16 v[148:151], a[224:227], a[212:215], v[148:151]
T_a_1:
s_cbranch_execz T_a_9
s_waitcnt lgkmcnt(3)
v_mfma_f32_16x16x32_bf16 v[152:155], a[224:227], a[216:219], v[152:155]
s_waitcnt lgkmcnt(2)
v_mfma_f32_16x16x32_bf16 v[156:159], a[224:227], a[220:223], v[156:159]
s_waitcnt vmcnt(23) lgkmcnt(0)
s_barrier
ds_read_b64_tr_b16 a[224:225], v203 offset:28672
v_mfma_f32_16x16x32_bf16 a[128:131], a[228:231], a[192:195], a[128:131]
ds_read_b64_tr_b16 a[226:227], v203 offset:31232
v_mfma_f32_16x16x32_bf16 a[132:135], a[228:231], a[196:199], a[132:135]
s_add_u32 m0, s44, 16384
v_mfma_f32_16x16x32_bf16 a[136:139], a[228:231], a[200:203], a[136:139]
ds_read_b128 a[160:163], v201 offset:28672
v_mfma_f32_16x16x32_bf16 a[140:143], a[228:231], a[204:207], a[140:143]
buffer_load_dwordx4 v204, s[24:27], s39 offen lds
v_mfma_f32_16x16x32_bf16 a[144:147], a[228:231], a[208:211], a[144:147]
v_mfma_f32_16x16x32_bf16 a[148:151], a[228:231], a[212:215], a[148:151]
v_mfma_f32_16x16x32_bf16 a[152:155], a[228:231], a[216:219], a[152:155]
v_mfma_f32_16x16x32_bf16 a[156:159], a[228:231], a[220:223], a[156:159]
ds_read_b64_tr_b16 a[228:229], v203 offset:34816
ds_read_b128 a[164:167], v201 offset:29696
v_mfma_f32_16x16x32_bf16 v[0:3], a[232:235], a[192:195], v[0:3]
buffer_load_dwordx4 v205, s[24:27], s39 offen offset:1024 lds
v_mfma_f32_16x16x32_bf16 v[4:7], a[232:235], a[196:199], v[4:7]
s_add_u32 s39, s39, 294912
ds_read_b64_tr_b16 a[230:231], v203 offset:37376
v_mfma_f32_16x16x32_bf16 v[8:11], a[232:235], a[200:203], v[8:11]
v_mfma_f32_16x16x32_bf16 v[12:15], a[232:235], a[204:207], v[12:15]
s_add_u32 m0, s44, 18432
v_mfma_f32_16x16x32_bf16 v[16:19], a[232:235], a[208:211], v[16:19]
ds_read_b128 a[168:171], v201 offset:30720
v_mfma_f32_16x16x32_bf16 v[20:23], a[232:235], a[212:215], v[20:23]
buffer_load_dwordx4 v206, s[28:31], s40 offen lds
v_mfma_f32_16x16x32_bf16 v[24:27], a[232:235], a[216:219], v[24:27]
s_add_u32 s40, s40, s41
v_mfma_f32_16x16x32_bf16 v[28:31], a[232:235], a[220:223], v[28:31]
ds_read_b64_tr_b16 a[232:233], v202 offset:28672
v_mfma_f32_16x16x32_bf16 a[0:3], a[236:239], a[192:195], a[0:3]
ds_read_b64_tr_b16 a[234:235], v202 offset:31232
v_mfma_f32_16x16x32_bf16 a[4:7], a[236:239], a[196:199], a[4:7]
s_add_u32 m0, s43, 0
ds_read_b128 a[172:175], v201 offset:31744
v_mfma_f32_16x16x32_bf16 a[8:11], a[236:239], a[200:203], a[8:11]
buffer_load_dwordx4 v200, s[20:23], s38 offen offset:0 sc1 lds
v_mfma_f32_16x16x32_bf16 a[12:15], a[236:239], a[204:207], a[12:15]
v_mfma_f32_16x16x32_bf16 a[16:19], a[236:239], a[208:211], a[16:19]
v_mfma_f32_16x16x32_bf16 a[20:23], a[236:239], a[212:215], a[20:23]
v_mfma_f32_16x16x32_bf16 a[24:27], a[236:239], a[216:219], a[24:27]
ds_read_b128 a[176:179], v201 offset:32768
v_mfma_f32_16x16x32_bf16 a[28:31], a[236:239], a[220:223], a[28:31]
ds_read_b64_tr_b16 a[236:237], v202 offset:34816
v_mfma_f32_16x16x32_bf16 v[32:35], a[240:243], a[192:195], v[32:35]
buffer_load_dwordx4 v200, s[20:23], s38 offen offset:1024 sc1 lds
v_mfma_f32_16x16x32_bf16 v[36:39], a[240:243], a[196:199], v[36:39]
ds_read_b64_tr_b16 a[238:239], v202 offset:37376
v_mfma_f32_16x16x32_bf16 v[40:43], a[240:243], a[200:203], v[40:43]
v_mfma_f32_16x16x32_bf16 v[44:47], a[240:243], a[204:207], v[44:47]
ds_read_b128 a[180:183], v201 offset:33792
v_mfma_f32_16x16x32_bf16 v[48:51], a[240:243], a[208:211], v[48:51]
v_mfma_f32_16x16x32_bf16 v[52:55], a[240:243], a[212:215], v[52:55]
buffer_load_dwordx4 v200, s[20:23], s38 offen offset:2048 sc1 lds
v_mfma_f32_16x16x32_bf16 v[56:59], a[240:243], a[216:219], v[56:59]
v_mfma_f32_16x16x32_bf16 v[60:63], a[240:243], a[220:223], v[60:63]
ds_read_b64_tr_b16 a[240:241], v202 offset:28704
v_mfma_f32_16x16x32_bf16 a[32:35], a[244:247], a[192:195], a[32:35]
ds_read_b64_tr_b16 a[242:243], v202 offset:31264
ds_read_b128 a[184:187], v201 offset:34816
v_mfma_f32_16x16x32_bf16 a[36:39], a[244:247], a[196:199], a[36:39]
v_mfma_f32_16x16x32_bf16 a[40:43], a[244:247], a[200:203], a[40:43]
buffer_load_dwordx4 v200, s[20:23], s38 offen offset:3072 sc1 lds
v_mfma_f32_16x16x32_bf16 a[44:47], a[244:247], a[204:207], a[44:47]
s_add_u32 s38, s38, 16384
v_mfma_f32_16x16x32_bf16 a[48:51], a[244:247], a[208:211], a[48:51]
v_mfma_f32_16x16x32_bf16 a[52:55], a[244:247], a[212:215], a[52:55]
ds_read_b128 a[188:191], v201 offset:35840
v_mfma_f32_16x16x32_bf16 a[56:59], a[244:247], a[216:219], a[56:59]
v_mfma_f32_16x16x32_bf16 a[60:63], a[244:247], a[220:223], a[60:63]
s_waitcnt lgkmcnt(5)
ds_read_b64_tr_b16 a[244:245], v202 offset:34848
ds_read_b64_tr_b16 a[246:247], v202 offset:37408
v_mfma_f32_16x16x32_bf16 v[128:131], a[224:227], a[160:163], v[128:131]
v_mfma_f32_16x16x32_bf16 v[132:135], a[224:227], a[164:167], v[132:135]
v_add_u32 v201, 57344, v201
v_mfma_f32_16x16x32_bf16 v[136:139], a[224:227], a[168:171], v[136:139]
v_mfma_f32_16x16x32_bf16 v[140:143], a[224:227], a[172:175], v[140:143]
v_add_u32 v202, 57344, v202
v_mfma_f32_16x16x32_bf16 v[144:147], a[224:227], a[176:179], v[144:147]
s_waitcnt lgkmcnt(3)
v_mfma_f32_16x16x32_bf16 v[148:151], a[224:227], a[180:183], v[148:151]
v_add_u32 v203, 57344, v203
v_mfma_f32_16x16x32_bf16 v[152:155], a[224:227], a[184:187], v[152:155]
s_waitcnt lgkmcnt(2)
v_mfma_f32_16x16x32_bf16 v[156:159], a[224:227], a[188:191], v[156:159]
s_waitcnt vmcnt(23) lgkmcnt(0)
s_barrier
ds_read_b64_tr_b16 a[224:225], v203 offset:0
v_mfma_f32_16x16x32_bf16 a[128:131], a[228:231], a[160:163], a[128:131]
ds_read_b64_tr_b16 a[226:227], v203 offset:2560
v_mfma_f32_16x16x32_bf16 a[132:135], a[228:231], a[164:167], a[132:135]
s_add_u32 m0, s44, 45056
v_mfma_f32_16x16x32_bf16 a[136:139], a[228:231], a[168:171], a[136:139]
ds_read_b128 a[192:195], v201 offset:0
v_mfma_f32_16x16x32_bf16 a[140:143], a[228:231], a[172:175], a[140:143]
buffer_load_dwordx4 v204, s[24:27], s39 offen lds
v_mfma_f32_16x16x32_bf16 a[144:147], a[228:231], a[176:179], a[144:147]
v_mfma_f32_16x16x32_bf16 a[148:151], a[228:231], a[180:183], a[148:151]
v_mfma_f32_16x16x32_bf16 a[152:155], a[228:231], a[184:187], a[152:155]
v_mfma_f32_16x16x32_bf16 a[156:159], a[228:231], a[188:191], a[156:159]
ds_read_b64_tr_b16 a[228:229], v203 offset:6144
ds_read_b128 a[196:199], v201 offset:1024
v_mfma_f32_16x16x32_bf16 v[0:3], a[232:235], a[160:163], v[0:3]
buffer_load_dwordx4 v205, s[24:27], s39 offen offset:1024 lds
v_mfma_f32_16x16x32_bf16 v[4:7], a[232:235], a[164:167], v[4:7]
s_add_u32 s39, s39, 294912
ds_read_b64_tr_b16 a[230:231], v203 offset:8704
v_mfma_f32_16x16x32_bf16 v[8:11], a[232:235], a[168:171], v[8:11]
v_mfma_f32_16x16x32_bf16 v[12:15], a[232:235], a[172:175], v[12:15]
s_add_u32 m0, s44, 47104
v_mfma_f32_16x16x32_bf16 v[16:19], a[232:235], a[176:179], v[16:19]
ds_read_b128 a[200:203], v201 offset:2048
v_mfma_f32_16x16x32_bf16 v[20:23], a[232:235], a[180:183], v[20:23]
buffer_load_dwordx4 v206, s[28:31], s40 offen lds
v_mfma_f32_16x16x32_bf16 v[24:27], a[232:235], a[184:187], v[24:27]
s_add_u32 s40, s40, s41
v_mfma_f32_16x16x32_bf16 v[28:31], a[232:235], a[188:191], v[28:31]
ds_read_b64_tr_b16 a[232:233], v202 offset:0
v_mfma_f32_16x16x32_bf16 a[0:3], a[236:239], a[160:163], a[0:3]
ds_read_b64_tr_b16 a[234:235], v202 offset:2560
v_mfma_f32_16x16x32_bf16 a[4:7], a[236:239], a[164:167], a[4:7]
s_add_u32 m0, s43, 28672
ds_read_b128 a[204:207], v201 offset:3072
v_mfma_f32_16x16x32_bf16 a[8:11], a[236:239], a[168:171], a[8:11]
buffer_load_dwordx4 v200, s[20:23], s38 offen offset:0 sc1 lds
v_mfma_f32_16x16x32_bf16 a[12:15], a[236:239], a[172:175], a[12:15]
v_mfma_f32_16x16x32_bf16 a[16:19], a[236:239], a[176:179], a[16:19]
v_mfma_f32_16x16x32_bf16 a[20:23], a[236:239], a[180:183], a[20:23]
v_mfma_f32_16x16x32_bf16 a[24:27], a[236:239], a[184:187], a[24:27]
ds_read_b128 a[208:211], v201 offset:4096
v_mfma_f32_16x16x32_bf16 a[28:31], a[236:239], a[188:191], a[28:31]
ds_read_b64_tr_b16 a[236:237], v202 offset:6144
v_mfma_f32_16x16x32_bf16 v[32:35], a[240:243], a[160:163], v[32:35]
buffer_load_dwordx4 v200, s[20:23], s38 offen offset:1024 sc1 lds
v_mfma_f32_16x16x32_bf16 v[36:39], a[240:243], a[164:167], v[36:39]
ds_read_b64_tr_b16 a[238:239], v202 offset:8704
v_mfma_f32_16x16x32_bf16 v[40:43], a[240:243], a[168:171], v[40:43]
v_mfma_f32_16x16x32_bf16 v[44:47], a[240:243], a[172:175], v[44:47]
ds_read_b128 a[212:215], v201 offset:5120
v_mfma_f32_16x16x32_bf16 v[48:51], a[240:243], a[176:179], v[48:51]
v_mfma_f32_16x16x32_bf16 v[52:55], a[240:243], a[180:183], v[52:55]
buffer_load_dwordx4 v200, s[20:23], s38 offen offset:2048 sc1 lds
v_mfma_f32_16x16x32_bf16 v[56:59], a[240:243], a[184:187], v[56:59]
v_mfma_f32_16x16x32_bf16 v[60:63], a[240:243], a[188:191], v[60:63]
ds_read_b64_tr_b16 a[240:241], v202 offset:32
v_mfma_f32_16x16x32_bf16 a[32:35], a[244:247], a[160:163], a[32:35]
ds_read_b64_tr_b16 a[242:243], v202 offset:2592
ds_read_b128 a[216:219], v201 offset:6144
v_mfma_f32_16x16x32_bf16 a[36:39], a[244:247], a[164:167], a[36:39]
v_mfma_f32_16x16x32_bf16 a[40:43], a[244:247], a[168:171], a[40:43]
buffer_load_dwordx4 v200, s[20:23], s38 offen offset:3072 sc1 lds
v_mfma_f32_16x16x32_bf16 a[44:47], a[244:247], a[172:175], a[44:47]
v_mfma_f32_16x16x32_bf16 a[48:51], a[244:247], a[176:179], a[48:51]
v_mfma_f32_16x16x32_bf16 a[52:55], a[244:247], a[180:183], a[52:55]
ds_read_b128 a[220:223], v201 offset:7168
v_mfma_f32_16x16x32_bf16 a[56:59], a[244:247], a[184:187], a[56:59]
v_mfma_f32_16x16x32_bf16 a[60:63], a[244:247], a[188:191], a[60:63]
s_waitcnt lgkmcnt(5)
ds_read_b64_tr_b16 a[244:245], v202 offset:6176
ds_read_b64_tr_b16 a[246:247], v202 offset:8736
v_mfma_f32_16x16x32_bf16 v[128:131], a[224:227], a[192:195], v[128:131]
v_mfma_f32_16x16x32_bf16 v[132:135], a[224:227], a[196:199], v[132:135]
v_mfma_f32_16x16x32_bf16 v[136:139], a[224:227], a[200:203], v[136:139]
v_mfma_f32_16x16x32_bf16 v[140:143], a[224:227], a[204:207], v[140:143]
v_mfma_f32_16x16x32_bf16 v[144:147], a[224:227], a[208:211], v[144:147]
s_waitcnt lgkmcnt(5)
v_mfma_f32_16x16x32_bf16 v[148:151], a[224:227], a[212:215], v[148:151]
s_waitcnt lgkmcnt(3)
v_mfma_f32_16x16x32_bf16 v[152:155], a[224:227], a[216:219], v[152:155]
s_waitcnt lgkmcnt(2)
v_mfma_f32_16x16x32_bf16 v[156:159], a[224:227], a[220:223], v[156:159]
s_waitcnt vmcnt(23) lgkmcnt(0)
s_barrier
ds_read_b64_tr_b16 a[224:225], v203 offset:28672
v_mfma_f32_16x16x32_bf16 a[128:131], a[228:231], a[192:195], a[128:131]
ds_read_b64_tr_b16 a[226:227], v203 offset:31232
v_mfma_f32_16x16x32_bf16 a[132:135], a[228:231], a[196:199], a[132:135]
s_add_u32 m0, s63, 73728
v_mfma_f32_16x16x32_bf16 a[136:139], a[228:231], a[200:203], a[136:139]
ds_read_b128 a[160:163], v201 offset:28672
v_mfma_f32_16x16x32_bf16 a[140:143], a[228:231], a[204:207], a[140:143]
buffer_load_dwordx4 v207, s[24:27], s46 offen lds
v_mfma_f32_16x16x32_bf16 a[144:147], a[228:231], a[208:211], a[144:147]
v_mfma_f32_16x16x32_bf16 a[148:151], a[228:231], a[212:215], a[148:151]
v_mfma_f32_16x16x32_bf16 a[152:155], a[228:231], a[216:219], a[152:155]
v_mfma_f32_16x16x32_bf16 a[156:159], a[228:231], a[220:223], a[156:159]
ds_read_b64_tr_b16 a[228:229], v203 offset:34816
ds_read_b128 a[164:167], v201 offset:29696
v_mfma_f32_16x16x32_bf16 v[0:3], a[232:235], a[192:195], v[0:3]
ds_read_b64_tr_b16 a[230:231], v203 offset:37376
v_mfma_f32_16x16x32_bf16 v[4:7], a[232:235], a[196:199], v[4:7]
buffer_load_dwordx4 v208, s[24:27], s46 offen offset:1024 lds
v_mfma_f32_16x16x32_bf16 v[8:11], a[232:235], a[200:203], v[8:11]
s_sub_u32 s46, s46, 294912
v_mfma_f32_16x16x32_bf16 v[12:15], a[232:235], a[204:207], v[12:15]
v_mfma_f32_16x16x32_bf16 v[16:19], a[232:235], a[208:211], v[16:19]
ds_read_b128 a[168:171], v201 offset:30720
v_mfma_f32_16x16x32_bf16 v[20:23], a[232:235], a[212:215], v[20:23]
s_add_u32 m0, s43, 57344
s_sub_u32 s97, s97, 1769472
v_mfma_f32_16x16x32_bf16 v[24:27], a[232:235], a[216:219], v[24:27]
buffer_load_dwordx4 v200, s[20:23], s38 offen offset:0 sc1 lds
v_mfma_f32_16x16x32_bf16 v[28:31], a[232:235], a[220:223], v[28:31]
ds_read_b64_tr_b16 a[232:233], v202 offset:28672
v_mfma_f32_16x16x32_bf16 a[0:3], a[236:239], a[192:195], a[0:3]
buffer_load_dword a255, v197, s[24:27], s97 offen offset:640
v_mfma_f32_16x16x32_bf16 a[4:7], a[236:239], a[196:199], a[4:7]
ds_read_b64_tr_b16 a[234:235], v202 offset:31232
ds_read_b128 a[172:175], v201 offset:31744
v_mfma_f32_16x16x32_bf16 a[8:11], a[236:239], a[200:203], a[8:11]
v_mfma_f32_16x16x32_bf16 a[12:15], a[236:239], a[204:207], a[12:15]
v_mfma_f32_16x16x32_bf16 a[16:19], a[236:239], a[208:211], a[16:19]
v_mfma_f32_16x16x32_bf16 a[20:23], a[236:239], a[212:215], a[20:23]
buffer_load_dwordx4 v200, s[20:23], s38 offen offset:1024 sc1 lds
v_mfma_f32_16x16x32_bf16 a[24:27], a[236:239], a[216:219], a[24:27]
ds_read_b128 a[176:179], v201 offset:32768
v_mfma_f32_16x16x32_bf16 a[28:31], a[236:239], a[220:223], a[28:31]
ds_read_b64_tr_b16 a[236:237], v202 offset:34816
v_mfma_f32_16x16x32_bf16 v[32:35], a[240:243], a[192:195], v[32:35]
ds_read_b64_tr_b16 a[238:239], v202 offset:37376
v_mfma_f32_16x16x32_bf16 v[36:39], a[240:243], a[196:199], v[36:39]
v_mfma_f32_16x16x32_bf16 v[40:43], a[240:243], a[200:203], v[40:43]
v_mfma_f32_16x16x32_bf16 v[44:47], a[240:243], a[204:207], v[44:47]
ds_read_b128 a[180:183], v201 offset:33792
v_mfma_f32_16x16x32_bf16 v[48:51], a[240:243], a[208:211], v[48:51]
buffer_load_dwordx4 v200, s[20:23], s38 offen offset:2048 sc1 lds
v_mfma_f32_16x16x32_bf16 v[52:55], a[240:243], a[212:215], v[52:55]
v_mfma_f32_16x16x32_bf16 v[56:59], a[240:243], a[216:219], v[56:59]
v_mfma_f32_16x16x32_bf16 v[60:63], a[240:243], a[220:223], v[60:63]
ds_read_b64_tr_b16 a[240:241], v202 offset:28704
v_mfma_f32_16x16x32_bf16 a[32:35], a[244:247], a[192:195], a[32:35]
ds_read_b64_tr_b16 a[242:243], v202 offset:31264
ds_read_b128 a[184:187], v201 offset:34816
v_mfma_f32_16x16x32_bf16 a[36:39], a[244:247], a[196:199], a[36:39]
buffer_load_dwordx4 v200, s[20:23], s38 offen offset:3072 sc1 lds
v_mfma_f32_16x16x32_bf16 a[40:43], a[244:247], a[200:203], a[40:43]
s_sub_u32 s38, s38, 16384
v_mfma_f32_16x16x32_bf16 a[44:47], a[244:247], a[204:207], a[44:47]
v_mfma_f32_16x16x32_bf16 a[48:51], a[244:247], a[208:211], a[48:51]
v_mfma_f32_16x16x32_bf16 a[52:55], a[244:247], a[212:215], a[52:55]
ds_read_b128 a[188:191], v201 offset:35840
v_mfma_f32_16x16x32_bf16 a[56:59], a[244:247], a[216:219], a[56:59]
v_mfma_f32_16x16x32_bf16 a[60:63], a[244:247], a[220:223], a[60:63]
s_waitcnt lgkmcnt(5)
ds_read_b64_tr_b16 a[244:245], v202 offset:34848
ds_read_b64_tr_b16 a[246:247], v202 offset:37408
v_mfma_f32_16x16x32_bf16 v[128:131], a[224:227], a[160:163], v[128:131]
s_lshl_b32 s18, s17, 12
v_add_u32 v204, s18, v200
v_lshrrev_b32 v160, 6, v200
v_mfma_f32_16x16x32_bf16 v[132:135], a[224:227], a[164:167], v[132:135]
v_add_u32 v201, 57344, v201
v_mul_u32_u24 v160, 384, v160
v_mfma_f32_16x16x32_bf16 v[136:139], a[224:227], a[168:171], v[136:139]
v_bfe_u32 v161, v200, 4, 2
v_lshl_add_u32 v160, v161, 3, v160
v_mfma_f32_16x16x32_bf16 v[140:143], a[224:227], a[172:175], v[140:143]
v_add_u32 v202, 57344, v202
v_add_u32 v160, 8192, v160
v_mfma_f32_16x16x32_bf16 v[144:147], a[224:227], a[176:179], v[144:147]
s_waitcnt lgkmcnt(3)
v_bfe_u32 v161, v200, 7, 2
s_and_b32 s18, s66, 2
s_add_u32 s18, s18, s16
v_mfma_f32_16x16x32_bf16 v[148:151], a[224:227], a[180:183], v[148:151]
v_add_u32 v203, 57344, v203
v_xor_b32 v161, s18, v161
v_mfma_f32_16x16x32_bf16 v[152:155], a[224:227], a[184:187], v[152:155]
s_waitcnt lgkmcnt(0)
v_lshl_add_u32 v205, v161, 5, v160
v_xor_b32 v206, 64, v205
v_mfma_f32_16x16x32_bf16 v[156:159], a[224:227], a[188:191], v[156:159]
s_waitcnt vmcnt(21)
s_barrier
ds_read_b64_tr_b16 a[224:225], v203 offset:0
v_mfma_f32_16x16x32_bf16 a[128:131], a[228:231], a[160:163], a[128:131]
ds_read_b64_tr_b16 a[226:227], v203 offset:2560
v_add_u32 v214, s51, v200
v_mfma_f32_16x16x32_bf16 a[132:135], a[228:231], a[164:167], a[132:135]
s_add_u32 m0, s63, 102400
v_mfma_f32_16x16x32_bf16 a[136:139], a[228:231], a[168:171], a[136:139]
ds_read_b128 a[192:195], v201 offset:0
v_mfma_f32_16x16x32_bf16 a[140:143], a[228:231], a[172:175], a[140:143]
buffer_load_dwordx4 v207, s[24:27], s46 offen lds
v_mfma_f32_16x16x32_bf16 a[144:147], a[228:231], a[176:179], a[144:147]
v_mfma_f32_16x16x32_bf16 a[148:151], a[228:231], a[180:183], a[148:151]
v_mfma_f32_16x16x32_bf16 a[152:155], a[228:231], a[184:187], a[152:155]
v_mfma_f32_16x16x32_bf16 a[156:159], a[228:231], a[188:191], a[156:159]
ds_read_b64_tr_b16 a[228:229], v203 offset:6144
ds_read_b128 a[196:199], v201 offset:1024
v_mfma_f32_16x16x32_bf16 v[0:3], a[232:235], a[160:163], v[0:3]
ds_read_b64_tr_b16 a[230:231], v203 offset:8704
v_mfma_f32_16x16x32_bf16 v[4:7], a[232:235], a[164:167], v[4:7]
buffer_load_dwordx4 v208, s[24:27], s46 offen offset:1024 lds
v_mfma_f32_16x16x32_bf16 v[8:11], a[232:235], a[168:171], v[8:11]
s_sub_u32 s46, s46, 294912
v_mfma_f32_16x16x32_bf16 v[12:15], a[232:235], a[172:175], v[12:15]
v_mfma_f32_16x16x32_bf16 v[16:19], a[232:235], a[176:179], v[16:19]
ds_read_b128 a[200:203], v201 offset:2048
v_mfma_f32_16x16x32_bf16 v[20:23], a[232:235], a[180:183], v[20:23]
s_add_u32 m0, s43, 86016
v_mfma_f32_16x16x32_bf16 v[24:27], a[232:235], a[184:187], v[24:27]
buffer_load_dwordx4 v200, s[20:23], s38 offen offset:0 sc1 lds
v_mfma_f32_16x16x32_bf16 v[28:31], a[232:235], a[188:191], v[28:31]
ds_read_b64_tr_b16 a[232:233], v202 offset:0
v_mfma_f32_16x16x32_bf16 a[0:3], a[236:239], a[160:163], a[0:3]
ds_read_b64_tr_b16 a[234:235], v202 offset:2560
v_mfma_f32_16x16x32_bf16 a[4:7], a[236:239], a[164:167], a[4:7]
ds_read_b128 a[204:207], v201 offset:3072
v_mfma_f32_16x16x32_bf16 a[8:11], a[236:239], a[168:171], a[8:11]
v_mfma_f32_16x16x32_bf16 a[12:15], a[236:239], a[172:175], a[12:15]
v_mfma_f32_16x16x32_bf16 a[16:19], a[236:239], a[176:179], a[16:19]
v_mfma_f32_16x16x32_bf16 a[20:23], a[236:239], a[180:183], a[20:23]
buffer_load_dwordx4 v200, s[20:23], s38 offen offset:1024 sc1 lds
v_mfma_f32_16x16x32_bf16 a[24:27], a[236:239], a[184:187], a[24:27]
ds_read_b128 a[208:211], v201 offset:4096
v_mfma_f32_16x16x32_bf16 a[28:31], a[236:239], a[188:191], a[28:31]
ds_read_b64_tr_b16 a[236:237], v202 offset:6144
v_mfma_f32_16x16x32_bf16 v[32:35], a[240:243], a[160:163], v[32:35]
ds_read_b64_tr_b16 a[238:239], v202 offset:8704
v_mfma_f32_16x16x32_bf16 v[36:39], a[240:243], a[164:167], v[36:39]
v_mfma_f32_16x16x32_bf16 v[40:43], a[240:243], a[168:171], v[40:43]
v_mfma_f32_16x16x32_bf16 v[44:47], a[240:243], a[172:175], v[44:47]
ds_read_b128 a[212:215], v201 offset:5120
v_mfma_f32_16x16x32_bf16 v[48:51], a[240:243], a[176:179], v[48:51]
buffer_load_dwordx4 v200, s[20:23], s38 offen offset:2048 sc1 lds
v_mfma_f32_16x16x32_bf16 v[52:55], a[240:243], a[180:183], v[52:55]
v_mfma_f32_16x16x32_bf16 v[56:59], a[240:243], a[184:187], v[56:59]
v_mfma_f32_16x16x32_bf16 v[60:63], a[240:243], a[188:191], v[60:63]
ds_read_b64_tr_b16 a[240:241], v202 offset:32
v_mfma_f32_16x16x32_bf16 a[32:35], a[244:247], a[160:163], a[32:35]
ds_read_b64_tr_b16 a[242:243], v202 offset:2592
ds_read_b128 a[216:219], v201 offset:6144
v_mfma_f32_16x16x32_bf16 a[36:39], a[244:247], a[164:167], a[36:39]
buffer_load_dwordx4 v200, s[20:23], s38 offen offset:3072 sc1 lds
v_mfma_f32_16x16x32_bf16 a[40:43], a[244:247], a[168:171], a[40:43]
s_sub_u32 s38, s38, 16384
v_mfma_f32_16x16x32_bf16 a[44:47], a[244:247], a[172:175], a[44:47]
v_mfma_f32_16x16x32_bf16 a[48:51], a[244:247], a[176:179], a[48:51]
v_mfma_f32_16x16x32_bf16 a[52:55], a[244:247], a[180:183], a[52:55]
ds_read_b128 a[220:223], v201 offset:7168
v_mfma_f32_16x16x32_bf16 a[56:59], a[244:247], a[184:187], a[56:59]
v_mfma_f32_16x16x32_bf16 a[60:63], a[244:247], a[188:191], a[60:63]
s_waitcnt lgkmcnt(5)
ds_read_b64_tr_b16 a[244:245], v202 offset:6176
ds_read_b64_tr_b16 a[246:247], v202 offset:8736
v_mfma_f32_16x16x32_bf16 v[128:131], a[224:227], a[192:195], v[128:131]
v_mfma_f32_16x16x32_bf16 v[132:135], a[224:227], a[196:199], v[132:135]
v_add_u32 v201, 4294852608, v201
v_mfma_f32_16x16x32_bf16 v[136:139], a[224:227], a[200:203], v[136:139]
v_mfma_f32_16x16x32_bf16 v[140:143], a[224:227], a[204:207], v[140:143]
v_add_u32 v202, 4294852608, v202
v_mfma_f32_16x16x32_bf16 v[144:147], a[224:227], a[208:211], v[144:147]
s_waitcnt lgkmcnt(3)
v_mfma_f32_16x16x32_bf16 v[148:151], a[224:227], a[212:215], v[148:151]
v_add_u32 v203, 4294852608, v203
v_mfma_f32_16x16x32_bf16 v[152:155], a[224:227], a[216:219], v[152:155]
s_waitcnt lgkmcnt(2)
v_mfma_f32_16x16x32_bf16 v[156:159], a[224:227], a[220:223], v[156:159]
s_waitcnt vmcnt(20) lgkmcnt(0)
s_barrier
ds_read_b64_tr_b16 a[224:225], v203 offset:0
v_mfma_f32_16x16x32_bf16 a[128:131], a[228:231], a[192:195], a[128:131]
s_lshl_b32 s6, s13, 2
s_add_u32 s6, s6, s3
ds_read_b64_tr_b16 a[226:227], v203 offset:2560
v_mfma_f32_16x16x32_bf16 a[132:135], a[228:231], a[196:199], a[132:135]
s_add_u32 m0, s63, 131072
s_and_b32 s7, s12, 3
s_lshl_b32 s7, s7, 7
v_mfma_f32_16x16x32_bf16 a[136:139], a[228:231], a[200:203], a[136:139]
ds_read_b128 a[160:163], v201 offset:0
v_mfma_f32_16x16x32_bf16 a[140:143], a[228:231], a[204:207], a[140:143]
buffer_load_dwordx4 v207, s[24:27], s46 offen lds
v_mfma_f32_16x16x32_bf16 a[144:147], a[228:231], a[208:211], a[144:147]
s_add_u32 s6, s6, s7
s_mul_i32 s49, s6, 10368
v_mfma_f32_16x16x32_bf16 a[148:151], a[228:231], a[212:215], a[148:151]
s_mov_b32 s74, 5308416
s_mov_b32 s75, 0x20000
v_mfma_f32_16x16x32_bf16 a[152:155], a[228:231], a[216:219], a[152:155]
v_mfma_f32_16x16x32_bf16 a[156:159], a[228:231], a[220:223], a[156:159]
s_lshr_b32 s7, s12, 2
ds_read_b64_tr_b16 a[228:229], v203 offset:6144
ds_read_b128 a[164:167], v201 offset:1024
v_mfma_f32_16x16x32_bf16 v[0:3], a[232:235], a[192:195], v[0:3]
s_mul_i32 s7, s7, 5120
ds_read_b64_tr_b16 a[230:231], v203 offset:8704
v_mfma_f32_16x16x32_bf16 v[4:7], a[232:235], a[196:199], v[4:7]
buffer_load_dwordx4 v208, s[24:27], s46 offen offset:1024 lds
v_mfma_f32_16x16x32_bf16 v[8:11], a[232:235], a[200:203], v[8:11]
s_sub_u32 s46, s46, 294912
s_add_u32 s49, s49, s7
v_mfma_f32_16x16x32_bf16 v[12:15], a[232:235], a[204:207], v[12:15]
v_lshlrev_b32 v222, 3, v200
v_min_u32 v222, 5120, v222
buffer_load_dword a255, v222, s[72:75], s49 offen
v_mfma_f32_16x16x32_bf16 v[16:19], a[232:235], a[208:211], v[16:19]
ds_read_b128 a[168:171], v201 offset:2048
v_mfma_f32_16x16x32_bf16 v[20:23], a[232:235], a[212:215], v[20:23]
s_add_u32 m0, s43, 114688
v_mfma_f32_16x16x32_bf16 v[24:27], a[232:235], a[216:219], v[24:27]
buffer_load_dwordx4 v200, s[20:23], s38 offen offset:0 sc1 lds
v_mfma_f32_16x16x32_bf16 v[28:31], a[232:235], a[220:223], v[28:31]
ds_read_b64_tr_b16 a[232:233], v202 offset:0
v_mfma_f32_16x16x32_bf16 a[0:3], a[236:239], a[192:195], a[0:3]
ds_read_b64_tr_b16 a[234:235], v202 offset:2560
v_mfma_f32_16x16x32_bf16 a[4:7], a[236:239], a[196:199], a[4:7]
ds_read_b128 a[172:175], v201 offset:3072
v_mfma_f32_16x16x32_bf16 a[8:11], a[236:239], a[200:203], a[8:11]
v_mfma_f32_16x16x32_bf16 a[12:15], a[236:239], a[204:207], a[12:15]
v_mfma_f32_16x16x32_bf16 a[16:19], a[236:239], a[208:211], a[16:19]
v_mfma_f32_16x16x32_bf16 a[20:23], a[236:239], a[212:215], a[20:23]
buffer_load_dwordx4 v200, s[20:23], s38 offen offset:1024 sc1 lds
v_mfma_f32_16x16x32_bf16 a[24:27], a[236:239], a[216:219], a[24:27]
ds_read_b128 a[176:179], v201 offset:4096
v_mfma_f32_16x16x32_bf16 a[28:31], a[236:239], a[220:223], a[28:31]
ds_read_b64_tr_b16 a[236:237], v202 offset:6144
v_mfma_f32_16x16x32_bf16 v[32:35], a[240:243], a[192:195], v[32:35]
ds_read_b64_tr_b16 a[238:239], v202 offset:8704
v_mfma_f32_16x16x32_bf16 v[36:39], a[240:243], a[196:199], v[36:39]
v_mfma_f32_16x16x32_bf16 v[40:43], a[240:243], a[200:203], v[40:43]
v_mfma_f32_16x16x32_bf16 v[44:47], a[240:243], a[204:207], v[44:47]
ds_read_b128 a[180:183], v201 offset:5120
v_mfma_f32_16x16x32_bf16 v[48:51], a[240:243], a[208:211], v[48:51]
buffer_load_dwordx4 v200, s[20:23], s38 offen offset:2048 sc1 lds
v_mfma_f32_16x16x32_bf16 v[52:55], a[240:243], a[212:215], v[52:55]
v_mfma_f32_16x16x32_bf16 v[56:59], a[240:243], a[216:219], v[56:59]
v_mfma_f32_16x16x32_bf16 v[60:63], a[240:243], a[220:223], v[60:63]
ds_read_b64_tr_b16 a[240:241], v202 offset:32
v_mfma_f32_16x16x32_bf16 a[32:35], a[244:247], a[192:195], a[32:35]
ds_read_b64_tr_b16 a[242:243], v202 offset:2592
ds_read_b128 a[184:187], v201 offset:6144
v_mfma_f32_16x16x32_bf16 a[36:39], a[244:247], a[196:199], a[36:39]
buffer_load_dwordx4 v200, s[20:23], s38 offen offset:3072 sc1 lds
v_mfma_f32_16x16x32_bf16 a[40:43], a[244:247], a[200:203], a[40:43]
s_sub_u32 s38, s38, 16384
v_mfma_f32_16x16x32_bf16 a[44:47], a[244:247], a[204:207], a[44:47]
v_mfma_f32_16x16x32_bf16 a[48:51], a[244:247], a[208:211], a[48:51]
v_mfma_f32_16x16x32_bf16 a[52:55], a[244:247], a[212:215], a[52:55]
ds_read_b128 a[188:191], v201 offset:7168
v_mfma_f32_16x16x32_bf16 a[56:59], a[244:247], a[216:219], a[56:59]
v_mfma_f32_16x16x32_bf16 a[60:63], a[244:247], a[220:223], a[60:63]
s_waitcnt lgkmcnt(5)
ds_read_b64_tr_b16 a[244:245], v202 offset:6176
ds_read_b64_tr_b16 a[246:247], v202 offset:8736
v_mfma_f32_16x16x32_bf16 v[128:131], a[224:227], a[160:163], v[128:131]
v_mfma_f32_16x16x32_bf16 v[132:135], a[224:227], a[164:167], v[132:135]
v_mfma_f32_16x16x32_bf16 v[136:139], a[224:227], a[168:171], v[136:139]
v_mfma_f32_16x16x32_bf16 v[140:143], a[224:227], a[172:175], v[140:143]
v_mfma_f32_16x16x32_bf16 v[144:147], a[224:227], a[176:179], v[144:147]
s_waitcnt lgkmcnt(5)
v_mfma_f32_16x16x32_bf16 v[148:151], a[224:227], a[180:183], v[148:151]
s_waitcnt lgkmcnt(3)
v_mfma_f32_16x16x32_bf16 v[152:155], a[224:227], a[184:187], v[152:155]
s_waitcnt lgkmcnt(2)
v_mfma_f32_16x16x32_bf16 v[156:159], a[224:227], a[188:191], v[156:159]
s_waitcnt vmcnt(20) lgkmcnt(0)
s_barrier
ds_read_b64_tr_b16 a[224:225], v203 offset:28672
v_mfma_f32_16x16x32_bf16 a[128:131], a[228:231], a[160:163], a[128:131]
ds_read_b64_tr_b16 a[226:227], v203 offset:31232
v_mfma_f32_16x16x32_bf16 a[132:135], a[228:231], a[164:167], a[132:135]
s_add_u32 m0, s63, 16384
v_mfma_f32_16x16x32_bf16 a[136:139], a[228:231], a[168:171], a[136:139]
ds_read_b128 a[192:195], v201 offset:28672
v_mfma_f32_16x16x32_bf16 a[140:143], a[228:231], a[172:175], a[140:143]
buffer_load_dwordx4 v207, s[24:27], s46 offen lds
v_mfma_f32_16x16x32_bf16 a[144:147], a[228:231], a[176:179], a[144:147]
v_mfma_f32_16x16x32_bf16 a[148:151], a[228:231], a[180:183], a[148:151]
v_mfma_f32_16x16x32_bf16 a[152:155], a[228:231], a[184:187], a[152:155]
v_mfma_f32_16x16x32_bf16 a[156:159], a[228:231], a[188:191], a[156:159]
ds_read_b64_tr_b16 a[228:229], v203 offset:34816
ds_read_b128 a[196:199], v201 offset:29696
v_mfma_f32_16x16x32_bf16 v[0:3], a[232:235], a[160:163], v[0:3]
ds_read_b64_tr_b16 a[230:231], v203 offset:37376
v_mfma_f32_16x16x32_bf16 v[4:7], a[232:235], a[164:167], v[4:7]
buffer_load_dwordx4 v208, s[24:27], s46 offen offset:1024 lds
v_mfma_f32_16x16x32_bf16 v[8:11], a[232:235], a[168:171], v[8:11]
s_sub_u32 s46, s46, 294912
v_mfma_f32_16x16x32_bf16 v[12:15], a[232:235], a[172:175], v[12:15]
v_mfma_f32_16x16x32_bf16 v[16:19], a[232:235], a[176:179], v[16:19]
ds_read_b128 a[200:203], v201 offset:30720
v_mfma_f32_16x16x32_bf16 v[20:23], a[232:235], a[180:183], v[20:23]
s_add_u32 m0, s43, 0
v_mfma_f32_16x16x32_bf16 v[24:27], a[232:235], a[184:187], v[24:27]
buffer_load_dwordx4 v200, s[20:23], s38 offen offset:0 sc1 lds
v_mfma_f32_16x16x32_bf16 v[28:31], a[232:235], a[188:191], v[28:31]
ds_read_b64_tr_b16 a[232:233], v202 offset:28672
v_mfma_f32_16x16x32_bf16 a[0:3], a[236:239], a[160:163], a[0:3]
ds_read_b64_tr_b16 a[234:235], v202 offset:31232
v_mfma_f32_16x16x32_bf16 a[4:7], a[236:239], a[164:167], a[4:7]
ds_read_b128 a[204:207], v201 offset:31744
v_mfma_f32_16x16x32_bf16 a[8:11], a[236:239], a[168:171], a[8:11]
v_mfma_f32_16x16x32_bf16 a[12:15], a[236:239], a[172:175], a[12:15]
v_mfma_f32_16x16x32_bf16 a[16:19], a[236:239], a[176:179], a[16:19]
v_mfma_f32_16x16x32_bf16 a[20:23], a[236:239], a[180:183], a[20:23]
buffer_load_dwordx4 v200, s[20:23], s38 offen offset:1024 sc1 lds
v_mfma_f32_16x16x32_bf16 a[24:27], a[236:239], a[184:187], a[24:27]
ds_read_b128 a[208:211], v201 offset:32768
v_mfma_f32_16x16x32_bf16 a[28:31], a[236:239], a[188:191], a[28:31]
ds_read_b64_tr_b16 a[236:237], v202 offset:34816
v_mfma_f32_16x16x32_bf16 v[32:35], a[240:243], a[160:163], v[32:35]
ds_read_b64_tr_b16 a[238:239], v202 offset:37376
v_mfma_f32_16x16x32_bf16 v[36:39], a[240:243], a[164:167], v[36:39]
v_mfma_f32_16x16x32_bf16 v[40:43], a[240:243], a[168:171], v[40:43]
v_mfma_f32_16x16x32_bf16 v[44:47], a[240:243], a[172:175], v[44:47]
ds_read_b128 a[212:215], v201 offset:33792
v_mfma_f32_16x16x32_bf16 v[48:51], a[240:243], a[176:179], v[48:51]
buffer_load_dwordx4 v200, s[20:23], s38 offen offset:2048 sc1 lds
v_mfma_f32_16x16x32_bf16 v[52:55], a[240:243], a[180:183], v[52:55]
v_mfma_f32_16x16x32_bf16 v[56:59], a[240:243], a[184:187], v[56:59]
v_mfma_f32_16x16x32_bf16 v[60:63], a[240:243], a[188:191], v[60:63]
ds_read_b64_tr_b16 a[240:241], v202 offset:28704
v_mfma_f32_16x16x32_bf16 a[32:35], a[244:247], a[160:163], a[32:35]
ds_read_b64_tr_b16 a[242:243], v202 offset:31264
ds_read_b128 a[216:219], v201 offset:34816
v_mfma_f32_16x16x32_bf16 a[36:39], a[244:247], a[164:167], a[36:39]
buffer_load_dwordx4 v200, s[20:23], s38 offen offset:3072 sc1 lds
v_mfma_f32_16x16x32_bf16 a[40:43], a[244:247], a[168:171], a[40:43]
s_sub_u32 s38, s38, 16384
v_mfma_f32_16x16x32_bf16 a[44:47], a[244:247], a[172:175], a[44:47]
v_mfma_f32_16x16x32_bf16 a[48:51], a[244:247], a[176:179], a[48:51]
v_mfma_f32_16x16x32_bf16 a[52:55], a[244:247], a[180:183], a[52:55]
ds_read_b128 a[220:223], v201 offset:35840
v_mfma_f32_16x16x32_bf16 a[56:59], a[244:247], a[184:187], a[56:59]
v_mfma_f32_16x16x32_bf16 a[60:63], a[244:247], a[188:191], a[60:63]
s_waitcnt lgkmcnt(5)
ds_read_b64_tr_b16 a[244:245], v202 offset:34848
T_a_2:
s_cbranch_execz T_a_10
ds_read_b64_tr_b16 a[246:247], v202 offset:37408
v_mfma_f32_16x16x32_bf16 v[128:131], a[224:227], a[192:195], v[128:131]
v_mfma_f32_16x16x32_bf16 v[132:135], a[224:227], a[196:199], v[132:135]
v_add_u32 v201, 57344, v201
v_mfma_f32_16x16x32_bf16 v[136:139], a[224:227], a[200:203], v[136:139]
v_mfma_f32_16x16x32_bf16 v[140:143], a[224:227], a[204:207], v[140:143]
v_add_u32 v202, 73728, v199
v_mfma_f32_16x16x32_bf16 v[144:147], a[224:227], a[208:211], v[144:147]
s_waitcnt lgkmcnt(3)
v_mfma_f32_16x16x32_bf16 v[148:151], a[224:227], a[212:215], v[148:151]
v_xor_b32 v203, 32, v202
v_mfma_f32_16x16x32_bf16 v[152:155], a[224:227], a[216:219], v[152:155]
s_waitcnt lgkmcnt(2)
v_mfma_f32_16x16x32_bf16 v[156:159], a[224:227], a[220:223], v[156:159]
s_waitcnt vmcnt(19) lgkmcnt(0)
s_barrier
ds_read_b64_tr_b16 a[224:225], v202 offset:0
v_mfma_f32_16x16x32_bf16 a[128:131], a[228:231], a[192:195], a[128:131]
ds_read_b64_tr_b16 a[226:227], v202 offset:2048
v_mfma_f32_16x16x32_bf16 a[132:135], a[228:231], a[196:199], a[132:135]
s_add_u32 m0, s63, 45056
v_mfma_f32_16x16x32_bf16 a[136:139], a[228:231], a[200:203], a[136:139]
ds_read_b128 a[160:163], v201 offset:0
v_mfma_f32_16x16x32_bf16 a[140:143], a[228:231], a[204:207], a[140:143]
buffer_load_dwordx4 v207, s[24:27], s46 offen lds
v_mfma_f32_16x16x32_bf16 a[144:147], a[228:231], a[208:211], a[144:147]
v_accvgpr_read_b32 v196, a128
v_accvgpr_read_b32 v197, a129
v_accvgpr_read_b32 v198, a130
v_mfma_f32_16x16x32_bf16 a[148:151], a[228:231], a[212:215], a[148:151]
v_accvgpr_read_b32 v199, a131
v_mul_f32 v128, v196, v128
v_mfma_f32_16x16x32_bf16 a[152:155], a[228:231], a[216:219], a[152:155]
v_mul_f32 v129, v197, v129
v_mul_f32 v130, v198, v130
v_mfma_f32_16x16x32_bf16 a[156:159], a[228:231], a[220:223], a[156:159]
ds_read_b64_tr_b16 a[228:229], v202 offset:4096
ds_read_b128 a[164:167], v201 offset:1024
v_mfma_f32_16x16x32_bf16 v[0:3], a[232:235], a[192:195], v[0:3]
ds_read_b64_tr_b16 a[230:231], v202 offset:6144
v_mul_f32 v131, v199, v131
v_mfma_f32_16x16x32_bf16 v[4:7], a[232:235], a[196:199], v[4:7]
buffer_load_dwordx4 v208, s[24:27], s46 offen offset:1024 lds
v_mfma_f32_16x16x32_bf16 v[8:11], a[232:235], a[200:203], v[8:11]
s_sub_u32 s46, s46, 294912
v_accvgpr_read_b32 v196, a132
v_accvgpr_read_b32 v197, a133
v_accvgpr_read_b32 v198, a134
v_mfma_f32_16x16x32_bf16 v[12:15], a[232:235], a[204:207], v[12:15]
v_accvgpr_read_b32 v199, a135
v_mul_f32 v132, v196, v132
v_mfma_f32_16x16x32_bf16 v[16:19], a[232:235], a[208:211], v[16:19]
ds_read_b128 a[168:171], v201 offset:2048
v_mul_f32 v133, v197, v133
v_mfma_f32_16x16x32_bf16 v[20:23], a[232:235], a[212:215], v[20:23]
s_add_u32 m0, s43, 28672
v_mul_f32 v134, v198, v134
v_mul_f32 v135, v199, v135
v_mfma_f32_16x16x32_bf16 v[24:27], a[232:235], a[216:219], v[24:27]
buffer_load_dwordx4 v200, s[20:23], s38 offen offset:0 sc1 lds
v_mfma_f32_16x16x32_bf16 v[28:31], a[232:235], a[220:223], v[28:31]
ds_read_b64_tr_b16 a[232:233], v203 offset:0
v_cvt_pk_bf16_f32 v128, v128, v129
v_cvt_pk_bf16_f32 v129, v130, v131
v_mfma_f32_16x16x32_bf16 a[0:3], a[236:239], a[192:195], a[0:3]
ds_read_b64_tr_b16 a[234:235], v203 offset:2048
v_cvt_pk_bf16_f32 v130, v132, v133
v_mfma_f32_16x16x32_bf16 a[4:7], a[236:239], a[196:199], a[4:7]
ds_read_b128 a[172:175], v201 offset:3072
v_cvt_pk_bf16_f32 v131, v134, v135
v_mfma_f32_16x16x32_bf16 a[8:11], a[236:239], a[200:203], a[8:11]
v_permlane32_swap_b32 v128, v130
v_permlane32_swap_b32 v129, v131
v_mfma_f32_16x16x32_bf16 a[12:15], a[236:239], a[204:207], a[12:15]
v_accvgpr_read_b32 v196, a136
v_accvgpr_read_b32 v197, a137
v_accvgpr_read_b32 v198, a138
v_mfma_f32_16x16x32_bf16 a[16:19], a[236:239], a[208:211], a[16:19]
buffer_store_dwordx4 v[128:131], v211, s[20:23], s95 offen sc1
s_add_u32 s95, s95, 368640
v_mfma_f32_16x16x32_bf16 a[20:23], a[236:239], a[212:215], a[20:23]
buffer_load_dwordx4 v200, s[20:23], s38 offen offset:1024 sc1 lds
v_mfma_f32_16x16x32_bf16 a[24:27], a[236:239], a[216:219], a[24:27]
ds_read_b128 a[176:179], v201 offset:4096
v_accvgpr_read_b32 v199, a139
v_mfma_f32_16x16x32_bf16 a[28:31], a[236:239], a[220:223], a[28:31]
ds_read_b64_tr_b16 a[236:237], v203 offset:4096
v_mul_f32 v136, v196, v136
v_mfma_f32_16x16x32_bf16 v[32:35], a[240:243], a[192:195], v[32:35]
ds_read_b64_tr_b16 a[238:239], v203 offset:6144
v_mul_f32 v137, v197, v137
v_mul_f32 v138, v198, v138
v_mfma_f32_16x16x32_bf16 v[36:39], a[240:243], a[196:199], v[36:39]
v_mul_f32 v139, v199, v139
v_accvgpr_read_b32 v196, a140
v_mfma_f32_16x16x32_bf16 v[40:43], a[240:243], a[200:203], v[40:43]
v_accvgpr_read_b32 v197, a141
v_accvgpr_read_b32 v198, a142
v_mfma_f32_16x16x32_bf16 v[44:47], a[240:243], a[204:207], v[44:47]
ds_read_b128 a[180:183], v201 offset:5120
v_accvgpr_read_b32 v199, a143
v_mfma_f32_16x16x32_bf16 v[48:51], a[240:243], a[208:211], v[48:51]
buffer_load_dwordx4 v200, s[20:23], s38 offen offset:2048 sc1 lds
v_mfma_f32_16x16x32_bf16 v[52:55], a[240:243], a[212:215], v[52:55]
v_mul_f32 v140, v196, v140
v_mul_f32 v141, v197, v141
v_mul_f32 v142, v198, v142
v_mfma_f32_16x16x32_bf16 v[56:59], a[240:243], a[216:219], v[56:59]
v_mul_f32 v143, v199, v143
v_cvt_pk_bf16_f32 v136, v136, v137
v_mfma_f32_16x16x32_bf16 v[60:63], a[240:243], a[220:223], v[60:63]
v_cvt_pk_bf16_f32 v137, v138, v139
v_cvt_pk_bf16_f32 v138, v140, v141
v_mfma_f32_16x16x32_bf16 a[32:35], a[244:247], a[192:195], a[32:35]
ds_read_b128 a[184:187], v201 offset:6144
v_cvt_pk_bf16_f32 v139, v142, v143
v_mfma_f32_16x16x32_bf16 a[36:39], a[244:247], a[196:199], a[36:39]
buffer_load_dwordx4 v200, s[20:23], s38 offen offset:3072 sc1 lds
v_mfma_f32_16x16x32_bf16 a[40:43], a[244:247], a[200:203], a[40:43]
s_sub_u32 s38, s38, 16384
v_permlane32_swap_b32 v136, v138
v_permlane32_swap_b32 v137, v139
v_accvgpr_read_b32 v196, a144
v_mfma_f32_16x16x32_bf16 a[44:47], a[244:247], a[204:207], a[44:47]
v_accvgpr_read_b32 v197, a145
v_accvgpr_read_b32 v198, a146
v_mfma_f32_16x16x32_bf16 a[48:51], a[244:247], a[208:211], a[48:51]
buffer_store_dwordx4 v[136:139], v211, s[20:23], s95 offen sc1
s_add_u32 s95, s95, 368640
v_mfma_f32_16x16x32_bf16 a[52:55], a[244:247], a[212:215], a[52:55]
ds_read_b128 a[188:191], v201 offset:7168
v_accvgpr_read_b32 v199, a147
v_mfma_f32_16x16x32_bf16 a[56:59], a[244:247], a[216:219], a[56:59]
v_mul_f32 v144, v196, v144
v_mul_f32 v145, v197, v145
v_mfma_f32_16x16x32_bf16 a[60:63], a[244:247], a[220:223], a[60:63]
s_waitcnt lgkmcnt(1)
v_mul_f32 v146, v198, v146
v_mul_f32 v147, v199, v147
v_accvgpr_read_b32 v196, a148
v_mfma_f32_16x16x32_bf16 v[64:67], a[224:227], a[160:163], 0
v_accvgpr_read_b32 v197, a149
v_accvgpr_read_b32 v198, a150
v_mfma_f32_16x16x32_bf16 v[68:71], a[224:227], a[164:167], 0
v_accvgpr_read_b32 v199, a151
v_mul_f32 v148, v196, v148
v_mfma_f32_16x16x32_bf16 v[72:75], a[224:227], a[168:171], 0
v_mul_f32 v149, v197, v149
v_mul_f32 v150, v198, v150
v_mfma_f32_16x16x32_bf16 v[76:79], a[224:227], a[172:175], 0
v_mul_f32 v151, v199, v151
v_cvt_pk_bf16_f32 v144, v144, v145
v_mfma_f32_16x16x32_bf16 v[80:83], a[224:227], a[176:179], 0
v_cvt_pk_bf16_f32 v145, v146, v147
v_cvt_pk_bf16_f32 v146, v148, v149
v_cvt_pk_bf16_f32 v147, v150, v151
v_mfma_f32_16x16x32_bf16 v[84:87], a[224:227], a[180:183], 0
v_permlane32_swap_b32 v144, v146
v_permlane32_swap_b32 v145, v147
v_mfma_f32_16x16x32_bf16 v[88:91], a[224:227], a[184:187], 0
s_waitcnt lgkmcnt(0)
v_accvgpr_read_b32 v196, a152
v_accvgpr_read_b32 v197, a153
v_mfma_f32_16x16x32_bf16 v[92:95], a[224:227], a[188:191], 0
s_waitcnt vmcnt(21)
s_barrier
ds_read_b64_tr_b16 a[224:225], v202 offset:28672
v_mfma_f32_16x16x32_bf16 a[64:67], a[228:231], a[160:163], 0
ds_read_b64_tr_b16 a[226:227], v202 offset:30720
v_accvgpr_read_b32 v198, a154
v_mfma_f32_16x16x32_bf16 a[68:71], a[228:231], a[164:167], 0
s_add_u32 m0, s63, 73728
ds_read_b128 a[192:195], v201 offset:28672
buffer_store_dwordx4 v[144:147], v211, s[20:23], s95 offen sc1
s_add_u32 s95, s95, 368640
v_mfma_f32_16x16x32_bf16 a[72:75], a[228:231], a[168:171], 0
buffer_load_dwordx4 v207, s[24:27], s46 offen lds
v_mfma_f32_16x16x32_bf16 a[76:79], a[228:231], a[172:175], 0
v_accvgpr_read_b32 v199, a155
v_mul_f32 v152, v196, v152
v_mfma_f32_16x16x32_bf16 a[80:83], a[228:231], a[176:179], 0
ds_read_b128 a[196:199], v201 offset:29696
v_mul_f32 v153, v197, v153
v_mfma_f32_16x16x32_bf16 a[84:87], a[228:231], a[180:183], 0
buffer_load_dwordx4 v208, s[24:27], s46 offen offset:1024 lds
v_mfma_f32_16x16x32_bf16 a[88:91], a[228:231], a[184:187], 0
s_sub_u32 s46, s46, 294912
v_mul_f32 v154, v198, v154
v_mul_f32 v155, v199, v155
v_accvgpr_read_b32 v196, a156
v_mfma_f32_16x16x32_bf16 a[92:95], a[228:231], a[188:191], 0
ds_read_b64_tr_b16 a[228:229], v202 offset:32768
ds_read_b128 a[200:203], v201 offset:30720
v_mfma_f32_16x16x32_bf16 v[96:99], a[232:235], a[160:163], 0
s_add_u32 m0, s43, 57344
ds_read_b64_tr_b16 a[230:231], v202 offset:34816
v_accvgpr_read_b32 v197, a157
v_mfma_f32_16x16x32_bf16 v[100:103], a[232:235], a[164:167], 0
buffer_load_dwordx4 v200, s[20:23], s38 offen offset:0 sc1 lds
v_mfma_f32_16x16x32_bf16 v[104:107], a[232:235], a[168:171], 0
ds_read_b128 a[204:207], v201 offset:31744
v_accvgpr_read_b32 v198, a158
v_mfma_f32_16x16x32_bf16 v[108:111], a[232:235], a[172:175], 0
v_accvgpr_read_b32 v199, a159
v_mul_f32 v156, v196, v156
v_mul_f32 v157, v197, v157
v_mfma_f32_16x16x32_bf16 v[112:115], a[232:235], a[176:179], 0
v_mul_f32 v158, v198, v158
v_mul_f32 v159, v199, v159
v_mfma_f32_16x16x32_bf16 v[116:119], a[232:235], a[180:183], 0
ds_read_b128 a[208:211], v201 offset:32768
v_cvt_pk_bf16_f32 v152, v152, v153
v_mfma_f32_16x16x32_bf16 v[120:123], a[232:235], a[184:187], 0
buffer_load_dwordx4 v200, s[20:23], s38 offen offset:1024 sc1 lds
v_mfma_f32_16x16x32_bf16 v[124:127], a[232:235], a[188:191], 0
ds_read_b64_tr_b16 a[232:233], v203 offset:28672
v_cvt_pk_bf16_f32 v153, v154, v155
v_mfma_f32_16x16x32_bf16 a[96:99], a[236:239], a[160:163], 0
ds_read_b64_tr_b16 a[234:235], v203 offset:30720
ds_read_b128 a[212:215], v201 offset:33792
v_cvt_pk_bf16_f32 v154, v156, v157
v_mfma_f32_16x16x32_bf16 a[100:103], a[236:239], a[164:167], 0
buffer_load_dwordx4 v200, s[20:23], s38 offen offset:2048 sc1 lds
v_mfma_f32_16x16x32_bf16 a[104:107], a[236:239], a[168:171], 0
v_cvt_pk_bf16_f32 v155, v158, v159
v_permlane32_swap_b32 v152, v154
v_mfma_f32_16x16x32_bf16 a[108:111], a[236:239], a[172:175], 0
ds_read_b128 a[216:219], v201 offset:34816
v_permlane32_swap_b32 v153, v155
v_mfma_f32_16x16x32_bf16 a[112:115], a[236:239], a[176:179], 0
buffer_load_dwordx4 v200, s[20:23], s38 offen offset:3072 sc1 lds
v_mfma_f32_16x16x32_bf16 a[116:119], a[236:239], a[180:183], 0
s_sub_u32 s38, s38, 16384
v_accvgpr_read_b32 v196, a0
v_accvgpr_read_b32 v197, a1
v_accvgpr_read_b32 v198, a2
v_mfma_f32_16x16x32_bf16 a[120:123], a[236:239], a[184:187], 0
ds_read_b128 a[220:223], v201 offset:35840
buffer_store_dwordx4 v[152:155], v211, s[20:23], s95 offen sc1
v_mfma_f32_16x16x32_bf16 a[124:127], a[236:239], a[188:191], 0
s_waitcnt lgkmcnt(2)
ds_read_b64_tr_b16 a[236:237], v203 offset:32768
ds_read_b64_tr_b16 a[238:239], v203 offset:34816
v_mfma_f32_16x16x32_bf16 v[64:67], a[224:227], a[192:195], v[64:67]
s_add_u32 s95, s95, 368640
v_accvgpr_read_b32 v199, a3
v_mul_f32 v0, v196, v0
v_mfma_f32_16x16x32_bf16 v[68:71], a[224:227], a[196:199], v[68:71]
v_add_u32 v201, 57344, v201
v_mul_f32 v1, v197, v1
v_mfma_f32_16x16x32_bf16 v[72:75], a[224:227], a[200:203], v[72:75]
v_mul_f32 v2, v198, v2
v_mul_f32 v3, v199, v3
v_accvgpr_read_b32 v196, a32
v_mfma_f32_16x16x32_bf16 v[76:79], a[224:227], a[204:207], v[76:79]
v_add_u32 v202, 57344, v202
v_accvgpr_read_b32 v197, a33
v_mfma_f32_16x16x32_bf16 v[80:83], a[224:227], a[208:211], v[80:83]
v_accvgpr_read_b32 v198, a34
v_accvgpr_read_b32 v199, a35
v_mfma_f32_16x16x32_bf16 v[84:87], a[224:227], a[212:215], v[84:87]
s_waitcnt lgkmcnt(2)
v_add_u32 v203, 57344, v203
v_mul_f32 v32, v196, v32
v_mfma_f32_16x16x32_bf16 v[88:91], a[224:227], a[216:219], v[88:91]
v_mul_f32 v33, v197, v33
v_mul_f32 v34, v198, v34
v_mfma_f32_16x16x32_bf16 v[92:95], a[224:227], a[220:223], v[92:95]
s_waitcnt vmcnt(22) lgkmcnt(0)
s_barrier
ds_read_b64_tr_b16 a[224:225], v202 offset:0
v_mul_f32 v35, v199, v35
v_mfma_f32_16x16x32_bf16 a[64:67], a[228:231], a[192:195], a[64:67]
ds_read_b64_tr_b16 a[226:227], v202 offset:2048
v_cvt_pk_bf16_f32 v0, v0, v1
v_mfma_f32_16x16x32_bf16 a[68:71], a[228:231], a[196:199], a[68:71]
s_add_u32 m0, s63, 102400
ds_read_b128 a[160:163], v201 offset:0
v_cvt_pk_bf16_f32 v1, v2, v3
v_mfma_f32_16x16x32_bf16 a[72:75], a[228:231], a[200:203], a[72:75]
buffer_load_dwordx4 v207, s[24:27], s46 offen lds
v_mfma_f32_16x16x32_bf16 a[76:79], a[228:231], a[204:207], a[76:79]
v_cvt_pk_bf16_f32 v2, v32, v33
v_cvt_pk_bf16_f32 v3, v34, v35
v_mfma_f32_16x16x32_bf16 a[80:83], a[228:231], a[208:211], a[80:83]
ds_read_b128 a[164:167], v201 offset:1024
v_accvgpr_read_b32 v196, a4
v_accvgpr_read_b32 v197, a5
v_mfma_f32_16x16x32_bf16 a[84:87], a[228:231], a[212:215], a[84:87]
buffer_load_dwordx4 v208, s[24:27], s46 offen offset:1024 lds
v_mfma_f32_16x16x32_bf16 a[88:91], a[228:231], a[216:219], a[88:91]
s_sub_u32 s46, s46, 294912
v_accvgpr_read_b32 v198, a6
buffer_store_dwordx4 v[0:3], v200, s[20:23], s89 offen sc1
v_mfma_f32_16x16x32_bf16 a[92:95], a[228:231], a[220:223], a[92:95]
s_add_u32 s89, s89, 184320
ds_read_b64_tr_b16 a[228:229], v202 offset:4096
ds_read_b128 a[168:171], v201 offset:2048
v_mfma_f32_16x16x32_bf16 v[96:99], a[232:235], a[192:195], v[96:99]
s_add_u32 m0, s43, 86016
ds_read_b64_tr_b16 a[230:231], v202 offset:6144
v_accvgpr_read_b32 v199, a7
v_mfma_f32_16x16x32_bf16 v[100:103], a[232:235], a[196:199], v[100:103]
buffer_load_dwordx4 v200, s[20:23], s38 offen offset:0 sc1 lds
v_mfma_f32_16x16x32_bf16 v[104:107], a[232:235], a[200:203], v[104:107]
ds_read_b128 a[172:175], v201 offset:3072
v_mul_f32 v4, v196, v4
v_mul_f32 v5, v197, v5
v_mfma_f32_16x16x32_bf16 v[108:111], a[232:235], a[204:207], v[108:111]
v_mul_f32 v6, v198, v6
v_mul_f32 v7, v199, v7
v_mfma_f32_16x16x32_bf16 v[112:115], a[232:235], a[208:211], v[112:115]
v_accvgpr_read_b32 v196, a36
v_accvgpr_read_b32 v197, a37
v_mfma_f32_16x16x32_bf16 v[116:119], a[232:235], a[212:215], v[116:119]
ds_read_b128 a[176:179], v201 offset:4096
v_accvgpr_read_b32 v198, a38
v_mfma_f32_16x16x32_bf16 v[120:123], a[232:235], a[216:219], v[120:123]
buffer_load_dwordx4 v200, s[20:23], s38 offen offset:1024 sc1 lds
v_mfma_f32_16x16x32_bf16 v[124:127], a[232:235], a[220:223], v[124:127]
ds_read_b64_tr_b16 a[232:233], v203 offset:0
v_accvgpr_read_b32 v199, a39
v_mul_f32 v36, v196, v36
v_mfma_f32_16x16x32_bf16 a[96:99], a[236:239], a[192:195], a[96:99]
ds_read_b64_tr_b16 a[234:235], v203 offset:2048
ds_read_b128 a[180:183], v201 offset:5120
v_mfma_f32_16x16x32_bf16 a[100:103], a[236:239], a[196:199], a[100:103]
buffer_load_dwordx4 v200, s[20:23], s38 offen offset:2048 sc1 lds
v_mfma_f32_16x16x32_bf16 a[104:107], a[236:239], a[200:203], a[104:107]
v_mul_f32 v37, v197, v37
v_mul_f32 v38, v198, v38
v_mfma_f32_16x16x32_bf16 a[108:111], a[236:239], a[204:207], a[108:111]
ds_read_b128 a[184:187], v201 offset:6144
v_mul_f32 v39, v199, v39
v_cvt_pk_bf16_f32 v4, v4, v5
v_mfma_f32_16x16x32_bf16 a[112:115], a[236:239], a[208:211], a[112:115]
buffer_load_dwordx4 v200, s[20:23], s38 offen offset:3072 sc1 lds
v_mfma_f32_16x16x32_bf16 a[116:119], a[236:239], a[212:215], a[116:119]
s_sub_u32 s38, s38, 16384
v_cvt_pk_bf16_f32 v5, v6, v7
v_cvt_pk_bf16_f32 v6, v36, v37
v_mfma_f32_16x16x32_bf16 a[120:123], a[236:239], a[216:219], a[120:123]
ds_read_b128 a[188:191], v201 offset:7168
v_cvt_pk_bf16_f32 v7, v38, v39
v_mfma_f32_16x16x32_bf16 a[124:127], a[236:239], a[220:223], a[124:127]
s_waitcnt lgkmcnt(3)
ds_read_b64_tr_b16 a[236:237], v203 offset:4096
ds_read_b64_tr_b16 a[238:239], v203 offset:6144
v_mfma_f32_16x16x32_bf16 v[64:67], a[224:227], a[160:163], v[64:67]
v_accvgpr_read_b32 v196, a8
v_accvgpr_read_b32 v197, a9
v_accvgpr_read_b32 v198, a10
v_mfma_f32_16x16x32_bf16 v[68:71], a[224:227], a[164:167], v[68:71]
v_add_u32 v201, 4294852608, v201
buffer_store_dwordx4 v[4:7], v200, s[20:23], s89 offen sc1
v_mfma_f32_16x16x32_bf16 v[72:75], a[224:227], a[168:171], v[72:75]
s_add_u32 s89, s89, 184320
v_accvgpr_read_b32 v199, a11
v_mul_f32 v8, v196, v8
v_mfma_f32_16x16x32_bf16 v[76:79], a[224:227], a[172:175], v[76:79]
v_add_u32 v202, 4294852608, v202
v_mul_f32 v9, v197, v9
v_mfma_f32_16x16x32_bf16 v[80:83], a[224:227], a[176:179], v[80:83]
s_waitcnt lgkmcnt(2)
v_mul_f32 v10, v198, v10
v_mul_f32 v11, v199, v11
v_mfma_f32_16x16x32_bf16 v[84:87], a[224:227], a[180:183], v[84:87]
v_add_u32 v203, 4294852608, v203
v_accvgpr_read_b32 v196, a40
v_accvgpr_read_b32 v197, a41
v_mfma_f32_16x16x32_bf16 v[88:91], a[224:227], a[184:187], v[88:91]
v_accvgpr_read_b32 v198, a42
v_accvgpr_read_b32 v199, a43
v_mfma_f32_16x16x32_bf16 v[92:95], a[224:227], a[188:191], v[92:95]
s_waitcnt vmcnt(24) lgkmcnt(0)
s_barrier
ds_read_b64_tr_b16 a[224:225], v202 offset:0
v_mfma_f32_16x16x32_bf16 a[64:67], a[228:231], a[160:163], a[64:67]
ds_read_b64_tr_b16 a[226:227], v202 offset:2048
v_mul_f32 v40, v196, v40
v_mfma_f32_16x16x32_bf16 a[68:71], a[228:231], a[164:167], a[68:71]
s_add_u32 m0, s63, 131072
ds_read_b128 a[192:195], v201 offset:0
v_mul_f32 v41, v197, v41
v_mfma_f32_16x16x32_bf16 a[72:75], a[228:231], a[168:171], a[72:75]
buffer_load_dwordx4 v207, s[24:27], s46 offen lds
v_mfma_f32_16x16x32_bf16 a[76:79], a[228:231], a[172:175], a[76:79]
v_mul_f32 v42, v198, v42
v_mul_f32 v43, v199, v43
v_cvt_pk_bf16_f32 v8, v8, v9
v_mfma_f32_16x16x32_bf16 a[80:83], a[228:231], a[176:179], a[80:83]
ds_read_b128 a[196:199], v201 offset:1024
v_cvt_pk_bf16_f32 v9, v10, v11
v_mfma_f32_16x16x32_bf16 a[84:87], a[228:231], a[180:183], a[84:87]
buffer_load_dwordx4 v208, s[24:27], s46 offen offset:1024 lds
v_mfma_f32_16x16x32_bf16 a[88:91], a[228:231], a[184:187], a[88:91]
s_sub_u32 s46, s46, 294912
v_cvt_pk_bf16_f32 v10, v40, v41
v_cvt_pk_bf16_f32 v11, v42, v43
v_mfma_f32_16x16x32_bf16 a[92:95], a[228:231], a[188:191], a[92:95]
ds_read_b64_tr_b16 a[228:229], v202 offset:4096
ds_read_b128 a[200:203], v201 offset:2048
v_accvgpr_read_b32 v196, a12
v_mfma_f32_16x16x32_bf16 v[96:99], a[232:235], a[160:163], v[96:99]
s_add_u32 m0, s43, 114688
ds_read_b64_tr_b16 a[230:231], v202 offset:6144
v_accvgpr_read_b32 v197, a13
v_mfma_f32_16x16x32_bf16 v[100:103], a[232:235], a[164:167], v[100:103]
buffer_load_dwordx4 v200, s[20:23], s38 offen offset:0 sc1 lds
v_mfma_f32_16x16x32_bf16 v[104:107], a[232:235], a[168:171], v[104:107]
ds_read_b128 a[204:207], v201 offset:3072
v_accvgpr_read_b32 v198, a14
v_mfma_f32_16x16x32_bf16 v[108:111], a[232:235], a[172:175], v[108:111]
buffer_store_dwordx4 v[8:11], v200, s[20:23], s89 offen sc1
s_add_u32 s89, s89, 184320
v_mfma_f32_16x16x32_bf16 v[112:115], a[232:235], a[176:179], v[112:115]
v_accvgpr_read_b32 v199, a15
v_mul_f32 v12, v196, v12
v_mul_f32 v13, v197, v13
v_mfma_f32_16x16x32_bf16 v[116:119], a[232:235], a[180:183], v[116:119]
ds_read_b128 a[208:211], v201 offset:4096
v_mul_f32 v14, v198, v14
v_mfma_f32_16x16x32_bf16 v[120:123], a[232:235], a[184:187], v[120:123]
buffer_load_dwordx4 v200, s[20:23], s38 offen offset:1024 sc1 lds
v_mfma_f32_16x16x32_bf16 v[124:127], a[232:235], a[188:191], v[124:127]
ds_read_b64_tr_b16 a[232:233], v203 offset:0
v_mul_f32 v15, v199, v15
v_mfma_f32_16x16x32_bf16 a[96:99], a[236:239], a[160:163], a[96:99]
ds_read_b64_tr_b16 a[234:235], v203 offset:2048
ds_read_b128 a[212:215], v201 offset:5120
v_mfma_f32_16x16x32_bf16 a[100:103], a[236:239], a[164:167], a[100:103]
buffer_load_dwordx4 v200, s[20:23], s38 offen offset:2048 sc1 lds
v_mfma_f32_16x16x32_bf16 a[104:107], a[236:239], a[168:171], a[104:107]
v_accvgpr_read_b32 v196, a44
v_accvgpr_read_b32 v197, a45
v_accvgpr_read_b32 v198, a46
v_mfma_f32_16x16x32_bf16 a[108:111], a[236:239], a[172:175], a[108:111]
ds_read_b128 a[216:219], v201 offset:6144
v_accvgpr_read_b32 v199, a47
v_mfma_f32_16x16x32_bf16 a[112:115], a[236:239], a[176:179], a[112:115]
buffer_load_dwordx4 v200, s[20:23], s38 offen offset:3072 sc1 lds
v_mfma_f32_16x16x32_bf16 a[116:119], a[236:239], a[180:183], a[116:119]
s_sub_u32 s38, s38, 16384
v_mul_f32 v44, v196, v44
v_mul_f32 v45, v197, v45
v_mfma_f32_16x16x32_bf16 a[120:123], a[236:239], a[184:187], a[120:123]
ds_read_b128 a[220:223], v201 offset:7168
v_mul_f32 v46, v198, v46
v_mul_f32 v47, v199, v47
v_mfma_f32_16x16x32_bf16 a[124:127], a[236:239], a[188:191], a[124:127]
s_waitcnt lgkmcnt(2)
ds_read_b64_tr_b16 a[236:237], v203 offset:4096
ds_read_b64_tr_b16 a[238:239], v203 offset:6144
v_mfma_f32_16x16x32_bf16 v[64:67], a[224:227], a[192:195], v[64:67]
v_cvt_pk_bf16_f32 v12, v12, v13
v_cvt_pk_bf16_f32 v13, v14, v15
v_mfma_f32_16x16x32_bf16 v[68:71], a[224:227], a[196:199], v[68:71]
v_cvt_pk_bf16_f32 v14, v44, v45
v_cvt_pk_bf16_f32 v15, v46, v47
v_mfma_f32_16x16x32_bf16 v[72:75], a[224:227], a[200:203], v[72:75]
v_accvgpr_read_b32 v196, a16
v_accvgpr_read_b32 v197, a17
v_mfma_f32_16x16x32_bf16 v[76:79], a[224:227], a[204:207], v[76:79]
v_accvgpr_read_b32 v198, a18
buffer_store_dwordx4 v[12:15], v200, s[20:23], s89 offen sc1
s_add_u32 s89, s89, 184320
v_mfma_f32_16x16x32_bf16 v[80:83], a[224:227], a[208:211], v[80:83]
v_accvgpr_read_b32 v199, a19
v_mul_f32 v16, v196, v16
v_mfma_f32_16x16x32_bf16 v[84:87], a[224:227], a[212:215], v[84:87]
s_waitcnt lgkmcnt(2)
v_mul_f32 v17, v197, v17
v_mul_f32 v18, v198, v18
v_mfma_f32_16x16x32_bf16 v[88:91], a[224:227], a[216:219], v[88:91]
v_mul_f32 v19, v199, v19
v_accvgpr_read_b32 v196, a48
v_mfma_f32_16x16x32_bf16 v[92:95], a[224:227], a[220:223], v[92:95]
s_waitcnt vmcnt(25) lgkmcnt(0)
s_barrier
ds_read_b64_tr_b16 a[224:225], v202 offset:28672
v_mfma_f32_16x16x32_bf16 a[64:67], a[228:231], a[192:195], a[64:67]
ds_read_b64_tr_b16 a[226:227], v202 offset:30720
v_accvgpr_read_b32 v197, a49
v_accvgpr_read_b32 v198, a50
v_mfma_f32_16x16x32_bf16 a[68:71], a[228:231], a[196:199], a[68:71]
s_add_u32 m0, s63, 16384
ds_read_b128 a[160:163], v201 offset:28672
v_accvgpr_read_b32 v199, a51
v_mfma_f32_16x16x32_bf16 a[72:75], a[228:231], a[200:203], a[72:75]
buffer_load_dwordx4 v207, s[24:27], s46 offen lds
v_mfma_f32_16x16x32_bf16 a[76:79], a[228:231], a[204:207], a[76:79]
v_mul_f32 v48, v196, v48
v_mul_f32 v49, v197, v49
v_mfma_f32_16x16x32_bf16 a[80:83], a[228:231], a[208:211], a[80:83]
ds_read_b128 a[164:167], v201 offset:29696
v_mul_f32 v50, v198, v50
v_mfma_f32_16x16x32_bf16 a[84:87], a[228:231], a[212:215], a[84:87]
buffer_load_dwordx4 v208, s[24:27], s46 offen offset:1024 lds
v_mfma_f32_16x16x32_bf16 a[88:91], a[228:231], a[216:219], a[88:91]
s_sub_u32 s46, s46, 294912
v_mul_f32 v51, v199, v51
v_cvt_pk_bf16_f32 v16, v16, v17
v_cvt_pk_bf16_f32 v17, v18, v19
v_mfma_f32_16x16x32_bf16 a[92:95], a[228:231], a[220:223], a[92:95]
ds_read_b64_tr_b16 a[228:229], v202 offset:32768
ds_read_b128 a[168:171], v201 offset:30720
v_mfma_f32_16x16x32_bf16 v[96:99], a[232:235], a[192:195], v[96:99]
s_add_u32 m0, s43, 0
ds_read_b64_tr_b16 a[230:231], v202 offset:34816
v_cvt_pk_bf16_f32 v18, v48, v49
v_mfma_f32_16x16x32_bf16 v[100:103], a[232:235], a[196:199], v[100:103]
buffer_load_dwordx4 v200, s[20:23], s38 offen offset:0 sc1 lds
v_mfma_f32_16x16x32_bf16 v[104:107], a[232:235], a[200:203], v[104:107]
ds_read_b128 a[172:175], v201 offset:31744
v_cvt_pk_bf16_f32 v19, v50, v51
v_accvgpr_read_b32 v196, a20
v_mfma_f32_16x16x32_bf16 v[108:111], a[232:235], a[204:207], v[108:111]
v_accvgpr_read_b32 v197, a21
v_accvgpr_read_b32 v198, a22
v_mfma_f32_16x16x32_bf16 v[112:115], a[232:235], a[208:211], v[112:115]
buffer_store_dwordx4 v[16:19], v200, s[20:23], s89 offen sc1
s_add_u32 s89, s89, 184320
v_mfma_f32_16x16x32_bf16 v[116:119], a[232:235], a[212:215], v[116:119]
ds_read_b128 a[176:179], v201 offset:32768
v_accvgpr_read_b32 v199, a23
v_mfma_f32_16x16x32_bf16 v[120:123], a[232:235], a[216:219], v[120:123]
buffer_load_dwordx4 v200, s[20:23], s38 offen offset:1024 sc1 lds
v_mfma_f32_16x16x32_bf16 v[124:127], a[232:235], a[220:223], v[124:127]
ds_read_b64_tr_b16 a[232:233], v203 offset:28672
v_mul_f32 v20, v196, v20
v_mul_f32 v21, v197, v21
v_mfma_f32_16x16x32_bf16 a[96:99], a[236:239], a[192:195], a[96:99]
ds_read_b64_tr_b16 a[234:235], v203 offset:30720
ds_read_b128 a[180:183], v201 offset:33792
v_mfma_f32_16x16x32_bf16 a[100:103], a[236:239], a[196:199], a[100:103]
buffer_load_dwordx4 v200, s[20:23], s38 offen offset:2048 sc1 lds
v_mfma_f32_16x16x32_bf16 a[104:107], a[236:239], a[200:203], a[104:107]
v_mul_f32 v22, v198, v22
v_mul_f32 v23, v199, v23
v_mfma_f32_16x16x32_bf16 a[108:111], a[236:239], a[204:207], a[108:111]
ds_read_b128 a[184:187], v201 offset:34816
v_accvgpr_read_b32 v196, a52
v_mfma_f32_16x16x32_bf16 a[112:115], a[236:239], a[208:211], a[112:115]
buffer_load_dwordx4 v200, s[20:23], s38 offen offset:3072 sc1 lds
v_mfma_f32_16x16x32_bf16 a[116:119], a[236:239], a[212:215], a[116:119]
s_sub_u32 s38, s38, 16384
v_accvgpr_read_b32 v197, a53
v_accvgpr_read_b32 v198, a54
v_accvgpr_read_b32 v199, a55
v_mfma_f32_16x16x32_bf16 a[120:123], a[236:239], a[216:219], a[120:123]
ds_read_b128 a[188:191], v201 offset:35840
v_mul_f32 v52, v196, v52
v_mfma_f32_16x16x32_bf16 a[124:127], a[236:239], a[220:223], a[124:127]
s_waitcnt lgkmcnt(3)
ds_read_b64_tr_b16 a[236:237], v203 offset:32768
ds_read_b64_tr_b16 a[238:239], v203 offset:34816
v_mfma_f32_16x16x32_bf16 v[64:67], a[224:227], a[160:163], v[64:67]
v_mul_f32 v53, v197, v53
v_mul_f32 v54, v198, v54
v_mfma_f32_16x16x32_bf16 v[68:71], a[224:227], a[164:167], v[68:71]
v_add_u32 v201, 57344, v201
v_mul_f32 v55, v199, v55
v_cvt_pk_bf16_f32 v20, v20, v21
v_mfma_f32_16x16x32_bf16 v[72:75], a[224:227], a[168:171], v[72:75]
v_cvt_pk_bf16_f32 v21, v22, v23
v_cvt_pk_bf16_f32 v22, v52, v53
v_mfma_f32_16x16x32_bf16 v[76:79], a[224:227], a[172:175], v[76:79]
T_a_3:
s_cbranch_execz T_a_11
v_add_u32 v202, 57344, v202
v_cvt_pk_bf16_f32 v23, v54, v55
v_mfma_f32_16x16x32_bf16 v[80:83], a[224:227], a[176:179], v[80:83]
s_waitcnt lgkmcnt(3)
v_accvgpr_read_b32 v196, a24
v_accvgpr_read_b32 v197, a25
v_mfma_f32_16x16x32_bf16 v[84:87], a[224:227], a[180:183], v[84:87]
v_add_u32 v203, 57344, v203
v_accvgpr_read_b32 v198, a26
v_mfma_f32_16x16x32_bf16 v[88:91], a[224:227], a[184:187], v[88:91]
s_waitcnt lgkmcnt(0)
buffer_store_dwordx4 v[20:23], v200, s[20:23], s89 offen sc1
s_add_u32 s89, s89, 184320
v_accvgpr_read_b32 v199, a27
v_mfma_f32_16x16x32_bf16 v[92:95], a[224:227], a[188:191], v[92:95]
s_waitcnt vmcnt(25)
s_barrier
ds_read_b64_tr_b16 a[224:225], v202 offset:0
v_mfma_f32_16x16x32_bf16 a[64:67], a[228:231], a[160:163], a[64:67]
ds_read_b64_tr_b16 a[226:227], v202 offset:2048
v_mul_f32 v24, v196, v24
v_mfma_f32_16x16x32_bf16 a[68:71], a[228:231], a[164:167], a[68:71]
s_add_u32 m0, s63, 45056
ds_read_b128 a[192:195], v201 offset:0
v_mul_f32 v25, v197, v25
v_mfma_f32_16x16x32_bf16 a[72:75], a[228:231], a[168:171], a[72:75]
buffer_load_dwordx4 v207, s[24:27], s46 offen lds
v_mfma_f32_16x16x32_bf16 a[76:79], a[228:231], a[172:175], a[76:79]
v_mul_f32 v26, v198, v26
v_mul_f32 v27, v199, v27
v_accvgpr_read_b32 v196, a56
v_mfma_f32_16x16x32_bf16 a[80:83], a[228:231], a[176:179], a[80:83]
ds_read_b128 a[196:199], v201 offset:1024
v_accvgpr_read_b32 v197, a57
v_mfma_f32_16x16x32_bf16 a[84:87], a[228:231], a[180:183], a[84:87]
s_mov_b64 exec, 0
s_cmp_ge_u32 s13, 24
s_cbranch_scc1 T_x0
s_cmp_eq_u32 s17, 0
s_cbranch_scc1 T_b_0
s_branch T_b_1
T_x0:
s_cmp_ge_u32 s13, 30
s_cbranch_scc1 T_y0
s_cmp_eq_u32 s17, 0
s_cbranch_scc1 T_c_0
s_branch T_c_1
T_y0:
s_cmp_eq_u32 s17, 0
s_cbranch_scc1 T_d_0
s_branch T_d_1
T_r0:
s_mov_b64 exec, -1
v_mfma_f32_16x16x32_bf16 a[88:91], a[228:231], a[184:187], a[88:91]
buffer_load_dwordx4 v208, s[24:27], s46 offen offset:1024 lds
v_mfma_f32_16x16x32_bf16 a[92:95], a[228:231], a[188:191], a[92:95]
s_sub_u32 s46, s46, 294912
ds_read_b64_tr_b16 a[228:229], v202 offset:4096
ds_read_b128 a[200:203], v201 offset:2048
v_mfma_f32_16x16x32_bf16 v[96:99], a[232:235], a[160:163], v[96:99]
s_add_u32 m0, s43, 28672
ds_read_b64_tr_b16 a[230:231], v202 offset:6144
v_accvgpr_read_b32 v198, a58
v_accvgpr_read_b32 v199, a59
v_mfma_f32_16x16x32_bf16 v[100:103], a[232:235], a[164:167], v[100:103]
buffer_load_dwordx4 v200, s[20:23], s38 offen offset:0 sc1 lds
v_mfma_f32_16x16x32_bf16 v[104:107], a[232:235], a[168:171], v[104:107]
ds_read_b128 a[204:207], v201 offset:3072
v_mul_f32 v56, v196, v56
v_mfma_f32_16x16x32_bf16 v[108:111], a[232:235], a[172:175], v[108:111]
v_mul_f32 v57, v197, v57
v_mul_f32 v58, v198, v58
v_mfma_f32_16x16x32_bf16 v[112:115], a[232:235], a[176:179], v[112:115]
v_mul_f32 v59, v199, v59
v_cvt_pk_bf16_f32 v24, v24, v25
v_mfma_f32_16x16x32_bf16 v[116:119], a[232:235], a[180:183], v[116:119]
ds_read_b128 a[208:211], v201 offset:4096
v_cvt_pk_bf16_f32 v25, v26, v27
v_cvt_pk_bf16_f32 v26, v56, v57
v_mfma_f32_16x16x32_bf16 v[120:123], a[232:235], a[184:187], v[120:123]
buffer_load_dwordx4 v200, s[20:23], s38 offen offset:1024 sc1 lds
v_mfma_f32_16x16x32_bf16 v[124:127], a[232:235], a[188:191], v[124:127]
ds_read_b64_tr_b16 a[232:233], v203 offset:0
v_cvt_pk_bf16_f32 v27, v58, v59
v_mfma_f32_16x16x32_bf16 a[96:99], a[236:239], a[160:163], a[96:99]
ds_read_b64_tr_b16 a[234:235], v203 offset:2048
ds_read_b128 a[212:215], v201 offset:5120
v_mfma_f32_16x16x32_bf16 a[100:103], a[236:239], a[164:167], a[100:103]
buffer_load_dwordx4 v200, s[20:23], s38 offen offset:2048 sc1 lds
v_mfma_f32_16x16x32_bf16 a[104:107], a[236:239], a[168:171], a[104:107]
v_accvgpr_read_b32 v196, a28
v_accvgpr_read_b32 v197, a29
v_accvgpr_read_b32 v198, a30
v_mfma_f32_16x16x32_bf16 a[108:111], a[236:239], a[172:175], a[108:111]
ds_read_b128 a[216:219], v201 offset:6144
buffer_store_dwordx4 v[24:27], v200, s[20:23], s89 offen sc1
v_mfma_f32_16x16x32_bf16 a[112:115], a[236:239], a[176:179], a[112:115]
s_add_u32 s89, s89, 184320
buffer_load_dwordx4 v200, s[20:23], s38 offen offset:3072 sc1 lds
v_mfma_f32_16x16x32_bf16 a[116:119], a[236:239], a[180:183], a[116:119]
s_sub_u32 s38, s38, 16384
v_accvgpr_read_b32 v199, a31
v_mul_f32 v28, v196, v28
v_mfma_f32_16x16x32_bf16 a[120:123], a[236:239], a[184:187], a[120:123]
ds_read_b128 a[220:223], v201 offset:7168
v_mul_f32 v29, v197, v29
v_mfma_f32_16x16x32_bf16 a[124:127], a[236:239], a[188:191], a[124:127]
s_waitcnt lgkmcnt(2)
ds_read_b64_tr_b16 a[236:237], v203 offset:4096
ds_read_b64_tr_b16 a[238:239], v203 offset:6144
v_mul_f32 v30, v198, v30
v_mfma_f32_16x16x32_bf16 v[64:67], a[224:227], a[192:195], v[64:67]
v_mul_f32 v31, v199, v31
v_accvgpr_read_b32 v196, a60
v_mfma_f32_16x16x32_bf16 v[68:71], a[224:227], a[196:199], v[68:71]
v_accvgpr_read_b32 v197, a61
v_accvgpr_read_b32 v198, a62
v_mfma_f32_16x16x32_bf16 v[72:75], a[224:227], a[200:203], v[72:75]
s_add_u32 s35, s46, 36864
v_accvgpr_read_b32 v199, a63
v_mul_f32 v60, v196, v60
v_mfma_f32_16x16x32_bf16 v[76:79], a[224:227], a[204:207], v[76:79]
v_mul_f32 v61, v197, v61
v_mul_f32 v62, v198, v62
v_mfma_f32_16x16x32_bf16 v[80:83], a[224:227], a[208:211], v[80:83]
s_add_u32 s36, s38, 4096
v_mul_f32 v63, v199, v63
v_cvt_pk_bf16_f32 v28, v28, v29
v_cvt_pk_bf16_f32 v29, v30, v31
v_mfma_f32_16x16x32_bf16 v[84:87], a[224:227], a[212:215], v[84:87]
s_waitcnt lgkmcnt(0)
v_cvt_pk_bf16_f32 v30, v60, v61
v_cvt_pk_bf16_f32 v31, v62, v63
v_mfma_f32_16x16x32_bf16 v[88:91], a[224:227], a[216:219], v[88:91]
buffer_store_dwordx4 v[28:31], v200, s[20:23], s89 offen sc1
s_add_u32 s89, s89, 184320
v_mfma_f32_16x16x32_bf16 v[92:95], a[224:227], a[220:223], v[92:95]
s_waitcnt vmcnt(25)
s_barrier
ds_read_b64_tr_b16 a[224:225], v202 offset:28672
v_mfma_f32_16x16x32_bf16 a[64:67], a[228:231], a[192:195], a[64:67]
ds_read_b64_tr_b16 a[226:227], v202 offset:30720
v_mfma_f32_16x16x32_bf16 a[68:71], a[228:231], a[196:199], a[68:71]
s_add_u32 m0, s63, 73728
ds_read_b128 a[160:163], v201 offset:28672
v_mfma_f32_16x16x32_bf16 a[72:75], a[228:231], a[200:203], a[72:75]
buffer_load_dwordx4 v207, s[24:27], s46 offen lds
v_mfma_f32_16x16x32_bf16 a[76:79], a[228:231], a[204:207], a[76:79]
buffer_load_dwordx4 v208, s[24:27], s46 offen offset:1024 lds
v_mfma_f32_16x16x32_bf16 a[80:83], a[228:231], a[208:211], a[80:83]
s_sub_u32 s46, s46, 294912
ds_read_b128 a[164:167], v201 offset:29696
s_add_u32 m0, s63, 75776
v_mfma_f32_16x16x32_bf16 a[84:87], a[228:231], a[212:215], a[84:87]
buffer_load_dwordx4 v207, s[24:27], s35 offen lds
v_mfma_f32_16x16x32_bf16 a[88:91], a[228:231], a[216:219], a[88:91]
v_mfma_f32_16x16x32_bf16 a[92:95], a[228:231], a[220:223], a[92:95]
ds_read_b64_tr_b16 a[228:229], v202 offset:32768
ds_read_b128 a[168:171], v201 offset:30720
v_mfma_f32_16x16x32_bf16 v[96:99], a[232:235], a[192:195], v[96:99]
buffer_load_dwordx4 v208, s[24:27], s35 offen offset:1024 lds
v_mfma_f32_16x16x32_bf16 v[100:103], a[232:235], a[196:199], v[100:103]
s_add_u32 m0, s43, 57344
ds_read_b64_tr_b16 a[230:231], v202 offset:34816
v_mfma_f32_16x16x32_bf16 v[104:107], a[232:235], a[200:203], v[104:107]
buffer_load_dwordx4 v200, s[20:23], s38 offen offset:0 sc1 lds
v_mfma_f32_16x16x32_bf16 v[108:111], a[232:235], a[204:207], v[108:111]
ds_read_b128 a[172:175], v201 offset:31744
v_mfma_f32_16x16x32_bf16 v[112:115], a[232:235], a[208:211], v[112:115]
buffer_load_dwordx4 v200, s[20:23], s38 offen offset:1024 sc1 lds
v_mfma_f32_16x16x32_bf16 v[116:119], a[232:235], a[212:215], v[116:119]
ds_read_b128 a[176:179], v201 offset:32768
v_mfma_f32_16x16x32_bf16 v[120:123], a[232:235], a[216:219], v[120:123]
buffer_load_dwordx4 v200, s[20:23], s38 offen offset:2048 sc1 lds
v_mfma_f32_16x16x32_bf16 v[124:127], a[232:235], a[220:223], v[124:127]
buffer_load_dwordx4 v200, s[20:23], s38 offen offset:3072 sc1 lds
v_mfma_f32_16x16x32_bf16 a[96:99], a[236:239], a[192:195], a[96:99]
s_sub_u32 s38, s38, 16384
ds_read_b64_tr_b16 a[232:233], v203 offset:28672
s_add_u32 m0, s43, 61440
v_mfma_f32_16x16x32_bf16 a[100:103], a[236:239], a[196:199], a[100:103]
ds_read_b64_tr_b16 a[234:235], v203 offset:30720
ds_read_b128 a[180:183], v201 offset:33792
v_mfma_f32_16x16x32_bf16 a[104:107], a[236:239], a[200:203], a[104:107]
buffer_load_dwordx4 v200, s[20:23], s36 offen offset:0 sc1 lds
v_mfma_f32_16x16x32_bf16 a[108:111], a[236:239], a[204:207], a[108:111]
buffer_load_dwordx4 v200, s[20:23], s36 offen offset:1024 sc1 lds
v_mfma_f32_16x16x32_bf16 a[112:115], a[236:239], a[208:211], a[112:115]
ds_read_b128 a[184:187], v201 offset:34816
v_mfma_f32_16x16x32_bf16 a[116:119], a[236:239], a[212:215], a[116:119]
buffer_load_dwordx4 v200, s[20:23], s36 offen offset:2048 sc1 lds
v_mfma_f32_16x16x32_bf16 a[120:123], a[236:239], a[216:219], a[120:123]
ds_read_b128 a[188:191], v201 offset:35840
v_mfma_f32_16x16x32_bf16 a[124:127], a[236:239], a[220:223], a[124:127]
s_waitcnt lgkmcnt(5)
buffer_load_dwordx4 v200, s[20:23], s36 offen offset:3072 sc1 lds
v_mfma_f32_16x16x32_bf16 v[64:67], a[224:227], a[160:163], v[64:67]
ds_read_b64_tr_b16 a[236:237], v203 offset:32768
ds_read_b64_tr_b16 a[238:239], v203 offset:34816
v_mfma_f32_16x16x32_bf16 v[68:71], a[224:227], a[164:167], v[68:71]
v_add_u32 v201, 57344, v201
v_mfma_f32_16x16x32_bf16 v[72:75], a[224:227], a[168:171], v[72:75]
s_add_u32 s35, s46, 36864
v_mfma_f32_16x16x32_bf16 v[76:79], a[224:227], a[172:175], v[76:79]
v_add_u32 v202, 57344, v202
s_mov_b32 s19, 4521984
v_mfma_f32_16x16x32_bf16 v[80:83], a[224:227], a[176:179], v[80:83]
s_waitcnt lgkmcnt(4)
buffer_load_dwordx4 v[160:163], v200, s[20:23], s19 offen sc1
v_mfma_f32_16x16x32_bf16 v[84:87], a[224:227], a[180:183], v[84:87]
s_waitcnt lgkmcnt(3)
s_add_u32 s36, s38, 4096
v_add_u32 v203, 57344, v203
v_mfma_f32_16x16x32_bf16 v[88:91], a[224:227], a[184:187], v[88:91]
s_waitcnt lgkmcnt(2)
v_mfma_f32_16x16x32_bf16 v[92:95], a[224:227], a[188:191], v[92:95]
s_waitcnt vmcnt(30) lgkmcnt(0)
s_barrier
ds_read_b64_tr_b16 a[224:225], v202 offset:0
v_mfma_f32_16x16x32_bf16 a[64:67], a[228:231], a[160:163], a[64:67]
ds_read_b64_tr_b16 a[226:227], v202 offset:2048
v_mfma_f32_16x16x32_bf16 a[68:71], a[228:231], a[164:167], a[68:71]
s_add_u32 m0, s63, 102400
ds_read_b128 a[192:195], v201 offset:0
v_mfma_f32_16x16x32_bf16 a[72:75], a[228:231], a[168:171], a[72:75]
buffer_load_dwordx4 v207, s[24:27], s46 offen lds
v_mfma_f32_16x16x32_bf16 a[76:79], a[228:231], a[172:175], a[76:79]
buffer_load_dwordx4 v208, s[24:27], s46 offen offset:1024 lds
v_mfma_f32_16x16x32_bf16 a[80:83], a[228:231], a[176:179], a[80:83]
s_sub_u32 s46, s46, 294912
ds_read_b128 a[196:199], v201 offset:1024
s_add_u32 m0, s63, 104448
v_mfma_f32_16x16x32_bf16 a[84:87], a[228:231], a[180:183], a[84:87]
s_mov_b64 exec, 0
s_cmp_ge_u32 s13, 24
s_cbranch_scc1 T_x1
s_cmp_eq_u32 s17, 0
s_cbranch_scc1 T_b_2
s_branch T_b_3
T_x1:
s_cmp_ge_u32 s13, 30
s_cbranch_scc1 T_y1
s_cmp_eq_u32 s17, 0
s_cbranch_scc1 T_c_2
s_branch T_r1
T_y1:
s_cmp_eq_u32 s17, 0
s_cbranch_scc1 T_d_2
s_branch T_d_3
T_r1:
s_mov_b64 exec, -1
v_mfma_f32_16x16x32_bf16 a[88:91], a[228:231], a[184:187], a[88:91]
buffer_load_dwordx4 v207, s[24:27], s35 offen lds
v_mfma_f32_16x16x32_bf16 a[92:95], a[228:231], a[188:191], a[92:95]
ds_read_b64_tr_b16 a[228:229], v202 offset:4096
ds_read_b128 a[200:203], v201 offset:2048
v_mfma_f32_16x16x32_bf16 v[96:99], a[232:235], a[160:163], v[96:99]
buffer_load_dwordx4 v208, s[24:27], s35 offen offset:1024 lds
v_mfma_f32_16x16x32_bf16 v[100:103], a[232:235], a[164:167], v[100:103]
s_add_u32 m0, s43, 86016
ds_read_b64_tr_b16 a[230:231], v202 offset:6144
v_mfma_f32_16x16x32_bf16 v[104:107], a[232:235], a[168:171], v[104:107]
buffer_load_dwordx4 v200, s[20:23], s38 offen offset:0 sc1 lds
v_mfma_f32_16x16x32_bf16 v[108:111], a[232:235], a[172:175], v[108:111]
ds_read_b128 a[204:207], v201 offset:3072
v_mfma_f32_16x16x32_bf16 v[112:115], a[232:235], a[176:179], v[112:115]
buffer_load_dwordx4 v200, s[20:23], s38 offen offset:1024 sc1 lds
v_mfma_f32_16x16x32_bf16 v[116:119], a[232:235], a[180:183], v[116:119]
ds_read_b128 a[208:211], v201 offset:4096
v_mfma_f32_16x16x32_bf16 v[120:123], a[232:235], a[184:187], v[120:123]
buffer_load_dwordx4 v200, s[20:23], s38 offen offset:2048 sc1 lds
v_mfma_f32_16x16x32_bf16 v[124:127], a[232:235], a[188:191], v[124:127]
buffer_load_dwordx4 v200, s[20:23], s38 offen offset:3072 sc1 lds
v_mfma_f32_16x16x32_bf16 a[96:99], a[236:239], a[160:163], a[96:99]
s_sub_u32 s38, s38, 16384
ds_read_b64_tr_b16 a[232:233], v203 offset:0
s_add_u32 m0, s43, 90112
v_mfma_f32_16x16x32_bf16 a[100:103], a[236:239], a[164:167], a[100:103]
ds_read_b64_tr_b16 a[234:235], v203 offset:2048
ds_read_b128 a[212:215], v201 offset:5120
v_mfma_f32_16x16x32_bf16 a[104:107], a[236:239], a[168:171], a[104:107]
buffer_load_dwordx4 v200, s[20:23], s36 offen offset:0 sc1 lds
v_mfma_f32_16x16x32_bf16 a[108:111], a[236:239], a[172:175], a[108:111]
buffer_load_dwordx4 v200, s[20:23], s36 offen offset:1024 sc1 lds
v_mfma_f32_16x16x32_bf16 a[112:115], a[236:239], a[176:179], a[112:115]
ds_read_b128 a[216:219], v201 offset:6144
v_mfma_f32_16x16x32_bf16 a[116:119], a[236:239], a[180:183], a[116:119]
buffer_load_dwordx4 v200, s[20:23], s36 offen offset:2048 sc1 lds
v_mfma_f32_16x16x32_bf16 a[120:123], a[236:239], a[184:187], a[120:123]
ds_read_b128 a[220:223], v201 offset:7168
v_mfma_f32_16x16x32_bf16 a[124:127], a[236:239], a[188:191], a[124:127]
s_waitcnt lgkmcnt(5)
buffer_load_dwordx4 v200, s[20:23], s36 offen offset:3072 sc1 lds
v_mfma_f32_16x16x32_bf16 v[64:67], a[224:227], a[192:195], v[64:67]
ds_read_b64_tr_b16 a[236:237], v203 offset:4096
ds_read_b64_tr_b16 a[238:239], v203 offset:6144
v_mfma_f32_16x16x32_bf16 v[68:71], a[224:227], a[196:199], v[68:71]
v_add_u32 v201, 4294852608, v201
v_mfma_f32_16x16x32_bf16 v[72:75], a[224:227], a[200:203], v[72:75]
s_add_u32 s35, s46, 36864
v_mfma_f32_16x16x32_bf16 v[76:79], a[224:227], a[204:207], v[76:79]
v_add_u32 v202, 4294852608, v202
v_mfma_f32_16x16x32_bf16 v[80:83], a[224:227], a[208:211], v[80:83]
s_waitcnt lgkmcnt(4)
s_add_u32 s36, s38, 4096
v_mfma_f32_16x16x32_bf16 v[84:87], a[224:227], a[212:215], v[84:87]
s_waitcnt lgkmcnt(3)
v_add_u32 v203, 4294852608, v203
v_mfma_f32_16x16x32_bf16 v[88:91], a[224:227], a[216:219], v[88:91]
s_waitcnt lgkmcnt(2)
v_mfma_f32_16x16x32_bf16 v[92:95], a[224:227], a[220:223], v[92:95]
s_waitcnt vmcnt(34) lgkmcnt(0)
s_barrier
ds_read_b64_tr_b16 a[224:225], v202 offset:0
v_mfma_f32_16x16x32_bf16 a[64:67], a[228:231], a[192:195], a[64:67]
ds_read_b64_tr_b16 a[226:227], v202 offset:2048
v_mfma_f32_16x16x32_bf16 a[68:71], a[228:231], a[196:199], a[68:71]
s_add_u32 m0, s63, 131072
ds_read_b128 a[160:163], v201 offset:0
v_mfma_f32_16x16x32_bf16 a[72:75], a[228:231], a[200:203], a[72:75]
buffer_load_dwordx4 v207, s[24:27], s46 offen lds
v_mfma_f32_16x16x32_bf16 a[76:79], a[228:231], a[204:207], a[76:79]
buffer_load_dwordx4 v208, s[24:27], s46 offen offset:1024 lds
v_mfma_f32_16x16x32_bf16 a[80:83], a[228:231], a[208:211], a[80:83]
s_sub_u32 s46, s46, 294912
ds_read_b128 a[164:167], v201 offset:1024
s_add_u32 m0, s63, 133120
v_mfma_f32_16x16x32_bf16 a[84:87], a[228:231], a[212:215], a[84:87]
buffer_load_dwordx4 v207, s[24:27], s35 offen lds
v_mfma_f32_16x16x32_bf16 a[88:91], a[228:231], a[216:219], a[88:91]
v_mfma_f32_16x16x32_bf16 a[92:95], a[228:231], a[220:223], a[92:95]
ds_read_b64_tr_b16 a[228:229], v202 offset:4096
ds_read_b128 a[168:171], v201 offset:2048
v_mfma_f32_16x16x32_bf16 v[96:99], a[232:235], a[192:195], v[96:99]
buffer_load_dwordx4 v208, s[24:27], s35 offen offset:1024 lds
v_mfma_f32_16x16x32_bf16 v[100:103], a[232:235], a[196:199], v[100:103]
s_add_u32 m0, s43, 114688
ds_read_b64_tr_b16 a[230:231], v202 offset:6144
v_mfma_f32_16x16x32_bf16 v[104:107], a[232:235], a[200:203], v[104:107]
buffer_load_dwordx4 v200, s[20:23], s38 offen offset:0 sc1 lds
v_mfma_f32_16x16x32_bf16 v[108:111], a[232:235], a[204:207], v[108:111]
ds_read_b128 a[172:175], v201 offset:3072
v_mfma_f32_16x16x32_bf16 v[112:115], a[232:235], a[208:211], v[112:115]
buffer_load_dwordx4 v200, s[20:23], s38 offen offset:1024 sc1 lds
v_mfma_f32_16x16x32_bf16 v[116:119], a[232:235], a[212:215], v[116:119]
ds_read_b128 a[176:179], v201 offset:4096
v_mfma_f32_16x16x32_bf16 v[120:123], a[232:235], a[216:219], v[120:123]
buffer_load_dwordx4 v200, s[20:23], s38 offen offset:2048 sc1 lds
v_mfma_f32_16x16x32_bf16 v[124:127], a[232:235], a[220:223], v[124:127]
buffer_load_dwordx4 v200, s[20:23], s38 offen offset:3072 sc1 lds
v_mfma_f32_16x16x32_bf16 a[96:99], a[236:239], a[192:195], a[96:99]
s_sub_u32 s38, s38, 16384
ds_read_b64_tr_b16 a[232:233], v203 offset:0
s_add_u32 m0, s43, 118784
v_mfma_f32_16x16x32_bf16 a[100:103], a[236:239], a[196:199], a[100:103]
ds_read_b64_tr_b16 a[234:235], v203 offset:2048
ds_read_b128 a[180:183], v201 offset:5120
v_mfma_f32_16x16x32_bf16 a[104:107], a[236:239], a[200:203], a[104:107]
buffer_load_dwordx4 v200, s[20:23], s36 offen offset:0 sc1 lds
v_mfma_f32_16x16x32_bf16 a[108:111], a[236:239], a[204:207], a[108:111]
buffer_load_dwordx4 v200, s[20:23], s36 offen offset:1024 sc1 lds
v_mfma_f32_16x16x32_bf16 a[112:115], a[236:239], a[208:211], a[112:115]
ds_read_b128 a[184:187], v201 offset:6144
v_mfma_f32_16x16x32_bf16 a[116:119], a[236:239], a[212:215], a[116:119]
buffer_load_dwordx4 v200, s[20:23], s36 offen offset:2048 sc1 lds
v_mfma_f32_16x16x32_bf16 a[120:123], a[236:239], a[216:219], a[120:123]
ds_read_b128 a[188:191], v201 offset:7168
v_mfma_f32_16x16x32_bf16 a[124:127], a[236:239], a[220:223], a[124:127]
s_waitcnt lgkmcnt(5)
buffer_load_dwordx4 v200, s[20:23], s36 offen offset:3072 sc1 lds
v_mfma_f32_16x16x32_bf16 v[64:67], a[224:227], a[160:163], v[64:67]
ds_read_b64_tr_b16 a[236:237], v203 offset:4096
ds_read_b64_tr_b16 a[238:239], v203 offset:6144
v_mfma_f32_16x16x32_bf16 v[68:71], a[224:227], a[164:167], v[68:71]
v_mfma_f32_16x16x32_bf16 v[72:75], a[224:227], a[168:171], v[72:75]
s_add_u32 s35, s46, 36864
v_mfma_f32_16x16x32_bf16 v[76:79], a[224:227], a[172:175], v[76:79]
v_mfma_f32_16x16x32_bf16 v[80:83], a[224:227], a[176:179], v[80:83]
s_waitcnt lgkmcnt(4)
s_add_u32 s36, s38, 4096
v_mfma_f32_16x16x32_bf16 v[84:87], a[224:227], a[180:183], v[84:87]
s_waitcnt lgkmcnt(3)
v_mfma_f32_16x16x32_bf16 v[88:91], a[224:227], a[184:187], v[88:91]
s_waitcnt lgkmcnt(2)
s_waitcnt vmcnt(37)
buffer_store_dword v218, v217, s[20:23], s45 offen offset:4 sc1
v_mfma_f32_16x16x32_bf16 v[92:95], a[224:227], a[188:191], v[92:95]
s_waitcnt lgkmcnt(0)
s_barrier
ds_read_b64_tr_b16 a[224:225], v202 offset:28672
v_mfma_f32_16x16x32_bf16 a[64:67], a[228:231], a[160:163], a[64:67]
ds_read_b64_tr_b16 a[226:227], v202 offset:30720
v_mfma_f32_16x16x32_bf16 a[68:71], a[228:231], a[164:167], a[68:71]
s_add_u32 m0, s63, 16384
ds_read_b128 a[192:195], v201 offset:28672
v_mfma_f32_16x16x32_bf16 a[72:75], a[228:231], a[168:171], a[72:75]
buffer_load_dwordx4 v207, s[24:27], s46 offen lds
v_mfma_f32_16x16x32_bf16 a[76:79], a[228:231], a[172:175], a[76:79]
buffer_load_dwordx4 v208, s[24:27], s46 offen offset:1024 lds
v_mfma_f32_16x16x32_bf16 a[80:83], a[228:231], a[176:179], a[80:83]
s_sub_u32 s46, s46, 294912
ds_read_b128 a[196:199], v201 offset:29696
s_add_u32 m0, s63, 18432
v_mfma_f32_16x16x32_bf16 a[84:87], a[228:231], a[180:183], a[84:87]
s_mov_b64 exec, 0
s_cmp_ge_u32 s13, 24
s_cbranch_scc1 T_x2
s_cmp_eq_u32 s17, 0
s_cbranch_scc1 T_b_4
s_branch T_r2
T_x2:
s_cmp_ge_u32 s13, 30
s_cbranch_scc1 T_y2
s_cmp_eq_u32 s17, 0
s_cbranch_scc1 T_r2
s_branch T_r2
T_y2:
s_cmp_eq_u32 s17, 0
s_cbranch_scc1 T_r2
s_branch T_r2
T_r2:
s_mov_b64 exec, -1
v_mfma_f32_16x16x32_bf16 a[88:91], a[228:231], a[184:187], a[88:91]
buffer_load_dwordx4 v207, s[24:27], s35 offen lds
v_mfma_f32_16x16x32_bf16 a[92:95], a[228:231], a[188:191], a[92:95]
ds_read_b64_tr_b16 a[228:229], v202 offset:32768
ds_read_b128 a[200:203], v201 offset:30720
v_mfma_f32_16x16x32_bf16 v[96:99], a[232:235], a[160:163], v[96:99]
buffer_load_dwordx4 v208, s[24:27], s35 offen offset:1024 lds
v_mfma_f32_16x16x32_bf16 v[100:103], a[232:235], a[164:167], v[100:103]
s_add_u32 m0, s43, 0
ds_read_b64_tr_b16 a[230:231], v202 offset:34816
v_mfma_f32_16x16x32_bf16 v[104:107], a[232:235], a[168:171], v[104:107]
buffer_load_dwordx4 v200, s[20:23], s38 offen offset:0 sc1 lds
v_mfma_f32_16x16x32_bf16 v[108:111], a[232:235], a[172:175], v[108:111]
ds_read_b128 a[204:207], v201 offset:31744
v_mfma_f32_16x16x32_bf16 v[112:115], a[232:235], a[176:179], v[112:115]
buffer_load_dwordx4 v200, s[20:23], s38 offen offset:1024 sc1 lds
v_mfma_f32_16x16x32_bf16 v[116:119], a[232:235], a[180:183], v[116:119]
ds_read_b128 a[208:211], v201 offset:32768
v_mfma_f32_16x16x32_bf16 v[120:123], a[232:235], a[184:187], v[120:123]
buffer_load_dwordx4 v200, s[20:23], s38 offen offset:2048 sc1 lds
v_mfma_f32_16x16x32_bf16 v[124:127], a[232:235], a[188:191], v[124:127]
buffer_load_dwordx4 v200, s[20:23], s38 offen offset:3072 sc1 lds
v_mfma_f32_16x16x32_bf16 a[96:99], a[236:239], a[160:163], a[96:99]
s_sub_u32 s38, s38, 16384
ds_read_b64_tr_b16 a[232:233], v203 offset:28672
s_add_u32 m0, s43, 4096
v_mfma_f32_16x16x32_bf16 a[100:103], a[236:239], a[164:167], a[100:103]
ds_read_b64_tr_b16 a[234:235], v203 offset:30720
ds_read_b128 a[212:215], v201 offset:33792
v_mfma_f32_16x16x32_bf16 a[104:107], a[236:239], a[168:171], a[104:107]
buffer_load_dwordx4 v200, s[20:23], s36 offen offset:0 sc1 lds
v_mfma_f32_16x16x32_bf16 a[108:111], a[236:239], a[172:175], a[108:111]
buffer_load_dwordx4 v200, s[20:23], s36 offen offset:1024 sc1 lds
v_mfma_f32_16x16x32_bf16 a[112:115], a[236:239], a[176:179], a[112:115]
ds_read_b128 a[216:219], v201 offset:34816
v_mfma_f32_16x16x32_bf16 a[116:119], a[236:239], a[180:183], a[116:119]
buffer_load_dwordx4 v200, s[20:23], s36 offen offset:2048 sc1 lds
v_mfma_f32_16x16x32_bf16 a[120:123], a[236:239], a[184:187], a[120:123]
ds_read_b128 a[220:223], v201 offset:35840
v_mfma_f32_16x16x32_bf16 a[124:127], a[236:239], a[188:191], a[124:127]
s_waitcnt lgkmcnt(5)
buffer_load_dwordx4 v200, s[20:23], s36 offen offset:3072 sc1 lds
v_mfma_f32_16x16x32_bf16 v[64:67], a[224:227], a[192:195], v[64:67]
ds_read_b64_tr_b16 a[236:237], v203 offset:32768
ds_read_b64_tr_b16 a[238:239], v203 offset:34816
v_mfma_f32_16x16x32_bf16 v[68:71], a[224:227], a[196:199], v[68:71]
v_add_u32 v201, 57344, v201
v_mfma_f32_16x16x32_bf16 v[72:75], a[224:227], a[200:203], v[72:75]
s_add_u32 s35, s46, 36864
v_mfma_f32_16x16x32_bf16 v[76:79], a[224:227], a[204:207], v[76:79]
v_add_u32 v202, 57344, v202
v_mfma_f32_16x16x32_bf16 v[80:83], a[224:227], a[208:211], v[80:83]
s_waitcnt lgkmcnt(4)
s_add_u32 s36, s38, 4096
v_mfma_f32_16x16x32_bf16 v[84:87], a[224:227], a[212:215], v[84:87]
s_waitcnt lgkmcnt(3)
v_add_u32 v203, 57344, v203
v_mfma_f32_16x16x32_bf16 v[88:91], a[224:227], a[216:219], v[88:91]
s_waitcnt lgkmcnt(2)
v_mfma_f32_16x16x32_bf16 v[92:95], a[224:227], a[220:223], v[92:95]
s_waitcnt vmcnt(38) lgkmcnt(0)
s_barrier
ds_read_b64_tr_b16 a[224:225], v202 offset:0
v_mfma_f32_16x16x32_bf16 a[64:67], a[228:231], a[192:195], a[64:67]
s_waitcnt vmcnt(37)
ds_read_b64_tr_b16 a[226:227], v202 offset:2048
v_xor_b32 v160, s96, v160
v_mfma_f32_16x16x32_bf16 a[68:71], a[228:231], a[196:199], a[68:71]
s_add_u32 m0, s63, 45056
ds_read_b128 a[160:163], v201 offset:0
v_xor_b32 v161, s96, v161
v_mfma_f32_16x16x32_bf16 a[72:75], a[228:231], a[200:203], a[72:75]
buffer_load_dwordx4 v207, s[24:27], s46 offen lds
v_mfma_f32_16x16x32_bf16 a[76:79], a[228:231], a[204:207], a[76:79]
buffer_load_dwordx4 v208, s[24:27], s46 offen offset:1024 lds
v_mfma_f32_16x16x32_bf16 a[80:83], a[228:231], a[208:211], a[80:83]
s_sub_u32 s46, s46, 294912
s_lshl_b32 s6, s13, 2
s_add_u32 s6, s6, s3
ds_read_b128 a[164:167], v201 offset:1024
v_mfma_f32_16x16x32_bf16 a[84:87], a[228:231], a[212:215], a[84:87]
s_add_u32 m0, s63, 47104
v_xor_b32 v162, s96, v162
v_xor_b32 v163, s96, v163
v_mfma_f32_16x16x32_bf16 a[88:91], a[228:231], a[216:219], a[88:91]
buffer_load_dwordx4 v207, s[24:27], s35 offen lds
v_mfma_f32_16x16x32_bf16 a[92:95], a[228:231], a[220:223], a[92:95]
s_cmp_ge_u32 s6, 64
s_cselect_b32 s80, s10, s8
s_cselect_b32 s81, s11, s9
ds_read_b64_tr_b16 a[228:229], v202 offset:4096
v_mfma_f32_16x16x32_bf16 v[96:99], a[232:235], a[192:195], v[96:99]
ds_read_b128 a[168:171], v201 offset:2048
v_or3_b32 v160, v160, v161, v162
v_mfma_f32_16x16x32_bf16 v[100:103], a[232:235], a[196:199], v[100:103]
buffer_load_dwordx4 v208, s[24:27], s35 offen offset:1024 lds
v_mfma_f32_16x16x32_bf16 v[104:107], a[232:235], a[200:203], v[104:107]
s_and_b32 s6, s6, 63
s_add_u32 s6, s6, 512
ds_read_b64_tr_b16 a[230:231], v202 offset:6144
v_mfma_f32_16x16x32_bf16 v[108:111], a[232:235], a[204:207], v[108:111]
s_add_u32 m0, s43, 28672
v_or_b32 v160, v160, v163
v_cmp_ne_u32 vcc, 0, v160
s_cbranch_vccnz chk_2
chk_2_r:
v_mfma_f32_16x16x32_bf16 v[112:115], a[232:235], a[208:211], v[112:115]
s_or_b32 s18, s2, s3
s_cmp_eq_u32 s18, 0
s_mov_b32 s19, 1073741824
s_cselect_b32 s18, 4587520, s19
buffer_load_dwordx4 v200, s[20:23], s38 offen offset:0 sc1 lds
s_mul_i32 s6, s6, 1152
v_mfma_f32_16x16x32_bf16 v[116:119], a[232:235], a[212:215], v[116:119]
ds_read_b128 a[172:175], v201 offset:3072
buffer_store_dword v218, v217, s[20:23], s18 offen offset:0 sc1
v_mfma_f32_16x16x32_bf16 v[120:123], a[232:235], a[216:219], v[120:123]
buffer_load_dwordx4 v200, s[20:23], s38 offen offset:1024 sc1 lds
v_lshlrev_b32 v222, 3, v200
v_min_u32 v222, 1024, v222
buffer_load_dword a255, v222, s[80:83], s6 offen
v_mfma_f32_16x16x32_bf16 v[124:127], a[232:235], a[220:223], v[124:127]
ds_read_b128 a[176:179], v201 offset:4096
v_mfma_f32_16x16x32_bf16 a[96:99], a[236:239], a[192:195], a[96:99]
buffer_load_dwordx4 v200, s[20:23], s38 offen offset:2048 sc1 lds
v_mfma_f32_16x16x32_bf16 a[100:103], a[236:239], a[196:199], a[100:103]
buffer_load_dwordx4 v200, s[20:23], s38 offen offset:3072 sc1 lds
s_sub_u32 s38, s38, 16384
v_mfma_f32_16x16x32_bf16 a[104:107], a[236:239], a[200:203], a[104:107]
s_add_u32 m0, s43, 32768
ds_read_b64_tr_b16 a[232:233], v203 offset:0
ds_read_b64_tr_b16 a[234:235], v203 offset:2048
v_mfma_f32_16x16x32_bf16 a[108:111], a[236:239], a[204:207], a[108:111]
ds_read_b128 a[180:183], v201 offset:5120
buffer_load_dwordx4 v200, s[20:23], s36 offen offset:0 sc1 lds
v_mfma_f32_16x16x32_bf16 a[112:115], a[236:239], a[208:211], a[112:115]
buffer_load_dwordx4 v200, s[20:23], s36 offen offset:1024 sc1 lds
v_mfma_f32_16x16x32_bf16 a[116:119], a[236:239], a[212:215], a[116:119]
ds_read_b128 a[184:187], v201 offset:6144
v_mfma_f32_16x16x32_bf16 a[120:123], a[236:239], a[216:219], a[120:123]
buffer_load_dwordx4 v200, s[20:23], s36 offen offset:2048 sc1 lds
v_mfma_f32_16x16x32_bf16 a[124:127], a[236:239], a[220:223], a[124:127]
s_waitcnt lgkmcnt(5)
ds_read_b128 a[188:191], v201 offset:7168
v_mfma_f32_16x16x32_bf16 v[64:67], a[224:227], a[160:163], v[64:67]
buffer_load_dwordx4 v200, s[20:23], s36 offen offset:3072 sc1 lds
v_mfma_f32_16x16x32_bf16 v[68:71], a[224:227], a[164:167], v[68:71]
ds_read_b64_tr_b16 a[236:237], v203 offset:4096
ds_read_b64_tr_b16 a[238:239], v203 offset:6144
v_mfma_f32_16x16x32_bf16 v[72:75], a[224:227], a[168:171], v[72:75]
s_add_u32 s35, s46, 36864
v_mfma_f32_16x16x32_bf16 v[76:79], a[224:227], a[172:175], v[76:79]
s_waitcnt lgkmcnt(5)
v_mfma_f32_16x16x32_bf16 v[80:83], a[224:227], a[176:179], v[80:83]
s_waitcnt lgkmcnt(4)
s_add_u32 s36, s38, 4096
v_mfma_f32_16x16x32_bf16 v[84:87], a[224:227], a[180:183], v[84:87]
s_waitcnt lgkmcnt(3)
T_a_4:
s_cbranch_execz T_a_12
v_mfma_f32_16x16x32_bf16 v[88:91], a[224:227], a[184:187], v[88:91]
s_waitcnt lgkmcnt(2)
v_mfma_f32_16x16x32_bf16 v[92:95], a[224:227], a[188:191], v[92:95]
s_waitcnt vmcnt(39) lgkmcnt(0)
s_barrier
ds_read_b64_tr_b16 a[224:225], v202 offset:28672
v_mfma_f32_16x16x32_bf16 a[64:67], a[228:231], a[160:163], a[64:67]
ds_read_b64_tr_b16 a[226:227], v202 offset:30720
v_mfma_f32_16x16x32_bf16 a[68:71], a[228:231], a[164:167], a[68:71]
s_add_u32 m0, s63, 73728
ds_read_b128 a[192:195], v201 offset:28672
v_mfma_f32_16x16x32_bf16 a[72:75], a[228:231], a[168:171], a[72:75]
buffer_load_dwordx4 v207, s[24:27], s46 offen lds
v_mfma_f32_16x16x32_bf16 a[76:79], a[228:231], a[172:175], a[76:79]
buffer_load_dwordx4 v208, s[24:27], s46 offen offset:1024 lds
v_mfma_f32_16x16x32_bf16 a[80:83], a[228:231], a[176:179], a[80:83]
s_sub_u32 s46, s46, 294912
ds_read_b128 a[196:199], v201 offset:29696
s_add_u32 m0, s63, 75776
v_mfma_f32_16x16x32_bf16 a[84:87], a[228:231], a[180:183], a[84:87]
buffer_load_dwordx4 v207, s[24:27], s35 offen lds
v_mfma_f32_16x16x32_bf16 a[88:91], a[228:231], a[184:187], a[88:91]
v_mfma_f32_16x16x32_bf16 a[92:95], a[228:231], a[188:191], a[92:95]
ds_read_b64_tr_b16 a[228:229], v202 offset:32768
ds_read_b128 a[200:203], v201 offset:30720
v_mfma_f32_16x16x32_bf16 v[96:99], a[232:235], a[160:163], v[96:99]
buffer_load_dwordx4 v208, s[24:27], s35 offen offset:1024 lds
v_mfma_f32_16x16x32_bf16 v[100:103], a[232:235], a[164:167], v[100:103]
s_add_u32 m0, s43, 57344
ds_read_b64_tr_b16 a[230:231], v202 offset:34816
v_mfma_f32_16x16x32_bf16 v[104:107], a[232:235], a[168:171], v[104:107]
buffer_load_dwordx4 v200, s[20:23], s38 offen offset:0 sc1 lds
v_mfma_f32_16x16x32_bf16 v[108:111], a[232:235], a[172:175], v[108:111]
ds_read_b128 a[204:207], v201 offset:31744
v_mfma_f32_16x16x32_bf16 v[112:115], a[232:235], a[176:179], v[112:115]
buffer_load_dwordx4 v200, s[20:23], s38 offen offset:1024 sc1 lds
v_mfma_f32_16x16x32_bf16 v[116:119], a[232:235], a[180:183], v[116:119]
ds_read_b128 a[208:211], v201 offset:32768
v_mfma_f32_16x16x32_bf16 v[120:123], a[232:235], a[184:187], v[120:123]
buffer_load_dwordx4 v200, s[20:23], s38 offen offset:2048 sc1 lds
v_mfma_f32_16x16x32_bf16 v[124:127], a[232:235], a[188:191], v[124:127]
buffer_load_dwordx4 v200, s[20:23], s38 offen offset:3072 sc1 lds
v_mfma_f32_16x16x32_bf16 a[96:99], a[236:239], a[160:163], a[96:99]
s_sub_u32 s38, s38, 16384
ds_read_b64_tr_b16 a[232:233], v203 offset:28672
s_add_u32 m0, s43, 61440
v_mfma_f32_16x16x32_bf16 a[100:103], a[236:239], a[164:167], a[100:103]
ds_read_b64_tr_b16 a[234:235], v203 offset:30720
ds_read_b128 a[212:215], v201 offset:33792
v_mfma_f32_16x16x32_bf16 a[104:107], a[236:239], a[168:171], a[104:107]
buffer_load_dwordx4 v200, s[20:23], s36 offen offset:0 sc1 lds
v_mfma_f32_16x16x32_bf16 a[108:111], a[236:239], a[172:175], a[108:111]
buffer_load_dwordx4 v200, s[20:23], s36 offen offset:1024 sc1 lds
v_mfma_f32_16x16x32_bf16 a[112:115], a[236:239], a[176:179], a[112:115]
ds_read_b128 a[216:219], v201 offset:34816
v_mfma_f32_16x16x32_bf16 a[116:119], a[236:239], a[180:183], a[116:119]
buffer_load_dwordx4 v200, s[20:23], s36 offen offset:2048 sc1 lds
v_mfma_f32_16x16x32_bf16 a[120:123], a[236:239], a[184:187], a[120:123]
ds_read_b128 a[220:223], v201 offset:35840
v_mfma_f32_16x16x32_bf16 a[124:127], a[236:239], a[188:191], a[124:127]
s_waitcnt lgkmcnt(5)
buffer_load_dwordx4 v200, s[20:23], s36 offen offset:3072 sc1 lds
v_mfma_f32_16x16x32_bf16 v[64:67], a[224:227], a[192:195], v[64:67]
ds_read_b64_tr_b16 a[236:237], v203 offset:32768
ds_read_b64_tr_b16 a[238:239], v203 offset:34816
v_mfma_f32_16x16x32_bf16 v[68:71], a[224:227], a[196:199], v[68:71]
v_add_u32 v201, 57344, v201
v_mfma_f32_16x16x32_bf16 v[72:75], a[224:227], a[200:203], v[72:75]
s_add_u32 s35, s46, 36864
v_mfma_f32_16x16x32_bf16 v[76:79], a[224:227], a[204:207], v[76:79]
v_add_u32 v202, 57344, v202
v_mfma_f32_16x16x32_bf16 v[80:83], a[224:227], a[208:211], v[80:83]
s_waitcnt lgkmcnt(4)
buffer_load_dword v216, v215, s[20:23], s68 offen offset:4 sc1
v_mfma_f32_16x16x32_bf16 v[84:87], a[224:227], a[212:215], v[84:87]
s_waitcnt lgkmcnt(3)
s_add_u32 s36, s38, 4096
v_add_u32 v203, 57344, v203
v_mfma_f32_16x16x32_bf16 v[88:91], a[224:227], a[216:219], v[88:91]
s_waitcnt lgkmcnt(2)
v_mfma_f32_16x16x32_bf16 v[92:95], a[224:227], a[220:223], v[92:95]
s_waitcnt vmcnt(40) lgkmcnt(0)
s_barrier
ds_read_b64_tr_b16 a[224:225], v202 offset:0
v_mfma_f32_16x16x32_bf16 a[64:67], a[228:231], a[192:195], a[64:67]
ds_read_b64_tr_b16 a[226:227], v202 offset:2048
v_mfma_f32_16x16x32_bf16 a[68:71], a[228:231], a[196:199], a[68:71]
s_add_u32 m0, s63, 102400
ds_read_b128 a[160:163], v201 offset:0
v_mfma_f32_16x16x32_bf16 a[72:75], a[228:231], a[200:203], a[72:75]
buffer_load_dwordx4 v207, s[24:27], s46 offen lds
v_mfma_f32_16x16x32_bf16 a[76:79], a[228:231], a[204:207], a[76:79]
buffer_load_dwordx4 v208, s[24:27], s46 offen offset:1024 lds
v_mfma_f32_16x16x32_bf16 a[80:83], a[228:231], a[208:211], a[80:83]
s_sub_u32 s46, s46, 294912
ds_read_b128 a[164:167], v201 offset:1024
s_add_u32 m0, s63, 104448
v_mfma_f32_16x16x32_bf16 a[84:87], a[228:231], a[212:215], a[84:87]
buffer_load_dwordx4 v207, s[24:27], s35 offen lds
v_mfma_f32_16x16x32_bf16 a[88:91], a[228:231], a[216:219], a[88:91]
v_mfma_f32_16x16x32_bf16 a[92:95], a[228:231], a[220:223], a[92:95]
ds_read_b64_tr_b16 a[228:229], v202 offset:4096
ds_read_b128 a[168:171], v201 offset:2048
v_mfma_f32_16x16x32_bf16 v[96:99], a[232:235], a[192:195], v[96:99]
buffer_load_dwordx4 v208, s[24:27], s35 offen offset:1024 lds
v_mfma_f32_16x16x32_bf16 v[100:103], a[232:235], a[196:199], v[100:103]
s_add_u32 m0, s43, 86016
ds_read_b64_tr_b16 a[230:231], v202 offset:6144
v_mfma_f32_16x16x32_bf16 v[104:107], a[232:235], a[200:203], v[104:107]
buffer_load_dwordx4 v200, s[20:23], s38 offen offset:0 sc1 lds
v_mfma_f32_16x16x32_bf16 v[108:111], a[232:235], a[204:207], v[108:111]
ds_read_b128 a[172:175], v201 offset:3072
v_mfma_f32_16x16x32_bf16 v[112:115], a[232:235], a[208:211], v[112:115]
buffer_load_dwordx4 v200, s[20:23], s38 offen offset:1024 sc1 lds
v_mfma_f32_16x16x32_bf16 v[116:119], a[232:235], a[212:215], v[116:119]
ds_read_b128 a[176:179], v201 offset:4096
v_mfma_f32_16x16x32_bf16 v[120:123], a[232:235], a[216:219], v[120:123]
buffer_load_dwordx4 v200, s[20:23], s38 offen offset:2048 sc1 lds
v_mfma_f32_16x16x32_bf16 v[124:127], a[232:235], a[220:223], v[124:127]
buffer_load_dwordx4 v200, s[20:23], s38 offen offset:3072 sc1 lds
v_mfma_f32_16x16x32_bf16 a[96:99], a[236:239], a[192:195], a[96:99]
s_sub_u32 s38, s38, 16384
ds_read_b64_tr_b16 a[232:233], v203 offset:0
s_add_u32 m0, s43, 90112
v_mfma_f32_16x16x32_bf16 a[100:103], a[236:239], a[196:199], a[100:103]
ds_read_b64_tr_b16 a[234:235], v203 offset:2048
ds_read_b128 a[180:183], v201 offset:5120
v_mfma_f32_16x16x32_bf16 a[104:107], a[236:239], a[200:203], a[104:107]
buffer_load_dwordx4 v200, s[20:23], s36 offen offset:0 sc1 lds
v_mfma_f32_16x16x32_bf16 a[108:111], a[236:239], a[204:207], a[108:111]
buffer_load_dwordx4 v200, s[20:23], s36 offen offset:1024 sc1 lds
v_mfma_f32_16x16x32_bf16 a[112:115], a[236:239], a[208:211], a[112:115]
ds_read_b128 a[184:187], v201 offset:6144
v_mfma_f32_16x16x32_bf16 a[116:119], a[236:239], a[212:215], a[116:119]
buffer_load_dwordx4 v200, s[20:23], s36 offen offset:2048 sc1 lds
v_mfma_f32_16x16x32_bf16 a[120:123], a[236:239], a[216:219], a[120:123]
ds_read_b128 a[188:191], v201 offset:7168
v_mfma_f32_16x16x32_bf16 a[124:127], a[236:239], a[220:223], a[124:127]
s_waitcnt lgkmcnt(5)
buffer_load_dwordx4 v200, s[20:23], s36 offen offset:3072 sc1 lds
v_mfma_f32_16x16x32_bf16 v[64:67], a[224:227], a[160:163], v[64:67]
ds_read_b64_tr_b16 a[236:237], v203 offset:4096
ds_read_b64_tr_b16 a[238:239], v203 offset:6144
v_mfma_f32_16x16x32_bf16 v[68:71], a[224:227], a[164:167], v[68:71]
v_add_u32 v201, 4294852608, v201
v_mfma_f32_16x16x32_bf16 v[72:75], a[224:227], a[168:171], v[72:75]
s_add_u32 s35, s46, 36864
v_mfma_f32_16x16x32_bf16 v[76:79], a[224:227], a[172:175], v[76:79]
v_add_u32 v202, 4294852608, v202
v_mfma_f32_16x16x32_bf16 v[80:83], a[224:227], a[176:179], v[80:83]
s_waitcnt lgkmcnt(4)
s_add_u32 s36, s38, 4096
v_mfma_f32_16x16x32_bf16 v[84:87], a[224:227], a[180:183], v[84:87]
s_waitcnt lgkmcnt(3)
v_add_u32 v203, 4294852608, v203
v_mfma_f32_16x16x32_bf16 v[88:91], a[224:227], a[184:187], v[88:91]
s_waitcnt lgkmcnt(2)
v_mfma_f32_16x16x32_bf16 v[92:95], a[224:227], a[188:191], v[92:95]
s_waitcnt vmcnt(39) lgkmcnt(0)
s_barrier
ds_read_b64_tr_b16 a[224:225], v202 offset:0
v_mfma_f32_16x16x32_bf16 a[64:67], a[228:231], a[160:163], a[64:67]
ds_read_b64_tr_b16 a[226:227], v202 offset:2048
v_mfma_f32_16x16x32_bf16 a[68:71], a[228:231], a[164:167], a[68:71]
s_add_u32 m0, s63, 131072
ds_read_b128 a[192:195], v201 offset:0
v_mfma_f32_16x16x32_bf16 a[72:75], a[228:231], a[168:171], a[72:75]
buffer_load_dwordx4 v207, s[24:27], s46 offen lds
v_mfma_f32_16x16x32_bf16 a[76:79], a[228:231], a[172:175], a[76:79]
buffer_load_dwordx4 v208, s[24:27], s46 offen offset:1024 lds
v_mfma_f32_16x16x32_bf16 a[80:83], a[228:231], a[176:179], a[80:83]
s_sub_u32 s46, s46, 294912
ds_read_b128 a[196:199], v201 offset:1024
s_add_u32 m0, s63, 133120
v_mfma_f32_16x16x32_bf16 a[84:87], a[228:231], a[180:183], a[84:87]
buffer_load_dwordx4 v207, s[24:27], s35 offen lds
v_mfma_f32_16x16x32_bf16 a[88:91], a[228:231], a[184:187], a[88:91]
v_mfma_f32_16x16x32_bf16 a[92:95], a[228:231], a[188:191], a[92:95]
ds_read_b64_tr_b16 a[228:229], v202 offset:4096
ds_read_b128 a[200:203], v201 offset:2048
v_mfma_f32_16x16x32_bf16 v[96:99], a[232:235], a[160:163], v[96:99]
buffer_load_dwordx4 v208, s[24:27], s35 offen offset:1024 lds
v_mfma_f32_16x16x32_bf16 v[100:103], a[232:235], a[164:167], v[100:103]
s_add_u32 m0, s43, 114688
ds_read_b64_tr_b16 a[230:231], v202 offset:6144
v_mfma_f32_16x16x32_bf16 v[104:107], a[232:235], a[168:171], v[104:107]
buffer_load_dwordx4 v200, s[20:23], s38 offen offset:0 sc1 lds
v_mfma_f32_16x16x32_bf16 v[108:111], a[232:235], a[172:175], v[108:111]
ds_read_b128 a[204:207], v201 offset:3072
v_mfma_f32_16x16x32_bf16 v[112:115], a[232:235], a[176:179], v[112:115]
buffer_load_dwordx4 v200, s[20:23], s38 offen offset:1024 sc1 lds
v_mfma_f32_16x16x32_bf16 v[116:119], a[232:235], a[180:183], v[116:119]
ds_read_b128 a[208:211], v201 offset:4096
v_mfma_f32_16x16x32_bf16 v[120:123], a[232:235], a[184:187], v[120:123]
buffer_load_dwordx4 v200, s[20:23], s38 offen offset:2048 sc1 lds
v_mfma_f32_16x16x32_bf16 v[124:127], a[232:235], a[188:191], v[124:127]
buffer_load_dwordx4 v200, s[20:23], s38 offen offset:3072 sc1 lds
v_mfma_f32_16x16x32_bf16 a[96:99], a[236:239], a[160:163], a[96:99]
s_sub_u32 s38, s38, 16384
ds_read_b64_tr_b16 a[232:233], v203 offset:0
s_add_u32 m0, s43, 118784
v_mfma_f32_16x16x32_bf16 a[100:103], a[236:239], a[164:167], a[100:103]
ds_read_b64_tr_b16 a[234:235], v203 offset:2048
ds_read_b128 a[212:215], v201 offset:5120
v_mfma_f32_16x16x32_bf16 a[104:107], a[236:239], a[168:171], a[104:107]
buffer_load_dwordx4 v200, s[20:23], s36 offen offset:0 sc1 lds
v_mfma_f32_16x16x32_bf16 a[108:111], a[236:239], a[172:175], a[108:111]
buffer_load_dwordx4 v200, s[20:23], s36 offen offset:1024 sc1 lds
v_mfma_f32_16x16x32_bf16 a[112:115], a[236:239], a[176:179], a[112:115]
ds_read_b128 a[216:219], v201 offset:6144
v_mfma_f32_16x16x32_bf16 a[116:119], a[236:239], a[180:183], a[116:119]
buffer_load_dwordx4 v200, s[20:23], s36 offen offset:2048 sc1 lds
v_mfma_f32_16x16x32_bf16 a[120:123], a[236:239], a[184:187], a[120:123]
ds_read_b128 a[220:223], v201 offset:7168
v_mfma_f32_16x16x32_bf16 a[124:127], a[236:239], a[188:191], a[124:127]
s_waitcnt lgkmcnt(5)
buffer_load_dwordx4 v200, s[20:23], s36 offen offset:3072 sc1 lds
v_mfma_f32_16x16x32_bf16 v[64:67], a[224:227], a[192:195], v[64:67]
ds_read_b64_tr_b16 a[236:237], v203 offset:4096
ds_read_b64_tr_b16 a[238:239], v203 offset:6144
v_mfma_f32_16x16x32_bf16 v[68:71], a[224:227], a[196:199], v[68:71]
v_mfma_f32_16x16x32_bf16 v[72:75], a[224:227], a[200:203], v[72:75]
v_mfma_f32_16x16x32_bf16 v[76:79], a[224:227], a[204:207], v[76:79]
v_mfma_f32_16x16x32_bf16 v[80:83], a[224:227], a[208:211], v[80:83]
s_waitcnt lgkmcnt(4)
v_mfma_f32_16x16x32_bf16 v[84:87], a[224:227], a[212:215], v[84:87]
s_waitcnt lgkmcnt(3)
s_waitcnt vmcnt(24)
v_cmp_ne_u32 vcc, s96, v216
s_cbranch_vccnz chk_4
chk_4_r:
v_mfma_f32_16x16x32_bf16 v[88:91], a[224:227], a[216:219], v[88:91]
s_waitcnt lgkmcnt(2)
v_mfma_f32_16x16x32_bf16 v[92:95], a[224:227], a[220:223], v[92:95]
s_waitcnt lgkmcnt(0)
s_barrier
ds_read_b64_tr_b16 a[224:225], v202 offset:28672
v_mfma_f32_16x16x32_bf16 a[64:67], a[228:231], a[192:195], a[64:67]
ds_read_b64_tr_b16 a[226:227], v202 offset:30720
v_mfma_f32_16x16x32_bf16 a[68:71], a[228:231], a[196:199], a[68:71]
s_add_u32 m0, s93, 8192
ds_read_b128 a[160:163], v201 offset:28672
v_mfma_f32_16x16x32_bf16 a[72:75], a[228:231], a[200:203], a[72:75]
buffer_load_dwordx4 v219, s[76:79], s54 offen sc1 lds
v_mfma_f32_16x16x32_bf16 a[76:79], a[228:231], a[204:207], a[76:79]
v_mfma_f32_16x16x32_bf16 a[80:83], a[228:231], a[208:211], a[80:83]
ds_read_b128 a[164:167], v201 offset:29696
v_mfma_f32_16x16x32_bf16 a[84:87], a[228:231], a[212:215], a[84:87]
v_mfma_f32_16x16x32_bf16 a[88:91], a[228:231], a[216:219], a[88:91]
buffer_load_dwordx4 v220, s[76:79], s54 offen offset:1024 sc1 lds
v_mfma_f32_16x16x32_bf16 a[92:95], a[228:231], a[220:223], a[92:95]
ds_read_b64_tr_b16 a[228:229], v202 offset:32768
ds_read_b128 a[168:171], v201 offset:30720
v_mfma_f32_16x16x32_bf16 v[96:99], a[232:235], a[192:195], v[96:99]
ds_read_b64_tr_b16 a[230:231], v202 offset:34816
v_mfma_f32_16x16x32_bf16 v[100:103], a[232:235], a[196:199], v[100:103]
v_mfma_f32_16x16x32_bf16 v[104:107], a[232:235], a[200:203], v[104:107]
ds_read_b128 a[172:175], v201 offset:31744
v_mfma_f32_16x16x32_bf16 v[108:111], a[232:235], a[204:207], v[108:111]
buffer_load_dwordx4 v221, s[76:79], s54 offen offset:2048 sc1 lds
v_mfma_f32_16x16x32_bf16 v[112:115], a[232:235], a[208:211], v[112:115]
s_add_u32 s54, s54, s92
v_mfma_f32_16x16x32_bf16 v[116:119], a[232:235], a[212:215], v[116:119]
ds_read_b128 a[176:179], v201 offset:32768
v_mfma_f32_16x16x32_bf16 v[120:123], a[232:235], a[216:219], v[120:123]
s_add_u32 m0, s63, 0
v_mfma_f32_16x16x32_bf16 v[124:127], a[232:235], a[220:223], v[124:127]
ds_read_b64_tr_b16 a[232:233], v203 offset:28672
v_mfma_f32_16x16x32_bf16 a[96:99], a[236:239], a[192:195], a[96:99]
buffer_load_dwordx4 v200, s[20:23], s67 offen sc1 lds
v_mfma_f32_16x16x32_bf16 a[100:103], a[236:239], a[196:199], a[100:103]
ds_read_b64_tr_b16 a[234:235], v203 offset:30720
ds_read_b128 a[180:183], v201 offset:33792
v_mfma_f32_16x16x32_bf16 a[104:107], a[236:239], a[200:203], a[104:107]
v_mfma_f32_16x16x32_bf16 a[108:111], a[236:239], a[204:207], a[108:111]
ds_read_b128 a[184:187], v201 offset:34816
v_mfma_f32_16x16x32_bf16 a[112:115], a[236:239], a[208:211], a[112:115]
buffer_load_dwordx4 v214, s[20:23], s67 offen offset:1024 sc1 lds
v_mfma_f32_16x16x32_bf16 a[116:119], a[236:239], a[212:215], a[116:119]
s_add_u32 s67, s67, s33
v_mfma_f32_16x16x32_bf16 a[120:123], a[236:239], a[216:219], a[120:123]
ds_read_b128 a[188:191], v201 offset:35840
v_mfma_f32_16x16x32_bf16 a[124:127], a[236:239], a[220:223], a[124:127]
s_waitcnt lgkmcnt(6)
ds_read_b64_tr_b16 a[236:237], v203 offset:32768
ds_read_b64_tr_b16 a[238:239], v203 offset:34816
v_mfma_f32_16x16x32_bf16 v[64:67], a[224:227], a[160:163], v[64:67]
v_mfma_f32_16x16x32_bf16 v[68:71], a[224:227], a[164:167], v[68:71]
v_add_u32 v201, 57344, v201
v_mfma_f32_16x16x32_bf16 v[72:75], a[224:227], a[168:171], v[72:75]
v_mfma_f32_16x16x32_bf16 v[76:79], a[224:227], a[172:175], v[76:79]
s_waitcnt lgkmcnt(6)
v_add_u32 v202, 57344, v202
v_mfma_f32_16x16x32_bf16 v[80:83], a[224:227], a[176:179], v[80:83]
s_waitcnt lgkmcnt(4)
v_mfma_f32_16x16x32_bf16 v[84:87], a[224:227], a[180:183], v[84:87]
s_waitcnt lgkmcnt(3)
v_add_u32 v203, 57344, v203
v_mfma_f32_16x16x32_bf16 v[88:91], a[224:227], a[184:187], v[88:91]
s_waitcnt lgkmcnt(2)
v_mfma_f32_16x16x32_bf16 v[92:95], a[224:227], a[188:191], v[92:95]
s_waitcnt lgkmcnt(0)
s_barrier
ds_read_b64_tr_b16 a[224:225], v202 offset:0
v_mfma_f32_16x16x32_bf16 a[64:67], a[228:231], a[160:163], a[64:67]
ds_read_b64_tr_b16 a[226:227], v202 offset:2048
v_mfma_f32_16x16x32_bf16 a[68:71], a[228:231], a[164:167], a[68:71]
s_add_u32 m0, s93, 28672
ds_read_b128 a[192:195], v201 offset:0
v_mfma_f32_16x16x32_bf16 a[72:75], a[228:231], a[168:171], a[72:75]
buffer_load_dwordx4 v219, s[76:79], s54 offen sc1 lds
v_mfma_f32_16x16x32_bf16 a[76:79], a[228:231], a[172:175], a[76:79]
v_mfma_f32_16x16x32_bf16 a[80:83], a[228:231], a[176:179], a[80:83]
ds_read_b128 a[196:199], v201 offset:1024
v_mfma_f32_16x16x32_bf16 a[84:87], a[228:231], a[180:183], a[84:87]
v_mfma_f32_16x16x32_bf16 a[88:91], a[228:231], a[184:187], a[88:91]
buffer_load_dwordx4 v220, s[76:79], s54 offen offset:1024 sc1 lds
v_mfma_f32_16x16x32_bf16 a[92:95], a[228:231], a[188:191], a[92:95]
ds_read_b64_tr_b16 a[228:229], v202 offset:4096
ds_read_b128 a[200:203], v201 offset:2048
v_mfma_f32_16x16x32_bf16 v[96:99], a[232:235], a[160:163], v[96:99]
ds_read_b64_tr_b16 a[230:231], v202 offset:6144
v_mfma_f32_16x16x32_bf16 v[100:103], a[232:235], a[164:167], v[100:103]
v_mfma_f32_16x16x32_bf16 v[104:107], a[232:235], a[168:171], v[104:107]
ds_read_b128 a[204:207], v201 offset:3072
v_mfma_f32_16x16x32_bf16 v[108:111], a[232:235], a[172:175], v[108:111]
buffer_load_dwordx4 v221, s[76:79], s54 offen offset:2048 sc1 lds
v_mfma_f32_16x16x32_bf16 v[112:115], a[232:235], a[176:179], v[112:115]
s_add_u32 s54, s54, s70
v_mfma_f32_16x16x32_bf16 v[116:119], a[232:235], a[180:183], v[116:119]
ds_read_b128 a[208:211], v201 offset:4096
v_mfma_f32_16x16x32_bf16 v[120:123], a[232:235], a[184:187], v[120:123]
s_add_u32 m0, s63, 20480
v_mfma_f32_16x16x32_bf16 v[124:127], a[232:235], a[188:191], v[124:127]
ds_read_b64_tr_b16 a[232:233], v203 offset:0
v_mfma_f32_16x16x32_bf16 a[96:99], a[236:239], a[160:163], a[96:99]
buffer_load_dwordx4 v200, s[20:23], s67 offen sc1 lds
v_mfma_f32_16x16x32_bf16 a[100:103], a[236:239], a[164:167], a[100:103]
ds_read_b64_tr_b16 a[234:235], v203 offset:2048
ds_read_b128 a[212:215], v201 offset:5120
v_mfma_f32_16x16x32_bf16 a[104:107], a[236:239], a[168:171], a[104:107]
v_mfma_f32_16x16x32_bf16 a[108:111], a[236:239], a[172:175], a[108:111]
ds_read_b128 a[216:219], v201 offset:6144
v_mfma_f32_16x16x32_bf16 a[112:115], a[236:239], a[176:179], a[112:115]
buffer_load_dwordx4 v214, s[20:23], s67 offen offset:1024 sc1 lds
v_mfma_f32_16x16x32_bf16 a[116:119], a[236:239], a[180:183], a[116:119]
s_add_u32 s67, s67, s33
v_mfma_f32_16x16x32_bf16 a[120:123], a[236:239], a[184:187], a[120:123]
ds_read_b128 a[220:223], v201 offset:7168
v_mfma_f32_16x16x32_bf16 a[124:127], a[236:239], a[188:191], a[124:127]
s_waitcnt lgkmcnt(6)
ds_read_b64_tr_b16 a[236:237], v203 offset:4096
ds_read_b64_tr_b16 a[238:239], v203 offset:6144
v_mfma_f32_16x16x32_bf16 v[64:67], a[224:227], a[192:195], v[64:67]
v_mfma_f32_16x16x32_bf16 v[68:71], a[224:227], a[196:199], v[68:71]
v_mfma_f32_16x16x32_bf16 v[72:75], a[224:227], a[200:203], v[72:75]
v_mfma_f32_16x16x32_bf16 v[76:79], a[224:227], a[204:207], v[76:79]
s_waitcnt lgkmcnt(6)
v_mfma_f32_16x16x32_bf16 v[80:83], a[224:227], a[208:211], v[80:83]
s_waitcnt lgkmcnt(4)
v_mfma_f32_16x16x32_bf16 v[84:87], a[224:227], a[212:215], v[84:87]
s_waitcnt lgkmcnt(3)
v_mfma_f32_16x16x32_bf16 v[88:91], a[224:227], a[216:219], v[88:91]
s_waitcnt lgkmcnt(2)
v_mfma_f32_16x16x32_bf16 v[92:95], a[224:227], a[220:223], v[92:95]
s_waitcnt vmcnt(22) lgkmcnt(0)
s_barrier
ds_read_b64_tr_b16 a[224:225], v202 offset:28672
v_mfma_f32_16x16x32_bf16 a[64:67], a[228:231], a[192:195], a[64:67]
ds_read_b64_tr_b16 a[226:227], v202 offset:30720
v_mfma_f32_16x16x32_bf16 a[68:71], a[228:231], a[196:199], a[68:71]
s_add_u32 m0, s93, 49152
ds_read_b128 a[160:163], v201 offset:28672
v_mfma_f32_16x16x32_bf16 a[72:75], a[228:231], a[200:203], a[72:75]
buffer_load_dwordx4 v219, s[76:79], s54 offen sc1 lds
v_mfma_f32_16x16x32_bf16 a[76:79], a[228:231], a[204:207], a[76:79]
v_mfma_f32_16x16x32_bf16 a[80:83], a[228:231], a[208:211], a[80:83]
ds_read_b128 a[164:167], v201 offset:29696
v_mfma_f32_16x16x32_bf16 a[84:87], a[228:231], a[212:215], a[84:87]
buffer_load_dwordx4 v220, s[76:79], s54 offen offset:1024 sc1 lds
v_mfma_f32_16x16x32_bf16 a[88:91], a[228:231], a[216:219], a[88:91]
buffer_load_dwordx4 v221, s[76:79], s54 offen offset:2048 sc1 lds
v_mfma_f32_16x16x32_bf16 a[92:95], a[228:231], a[220:223], a[92:95]
s_add_u32 s54, s54, s92
ds_read_b64_tr_b16 a[228:229], v202 offset:32768
ds_read_b128 a[168:171], v201 offset:30720
v_mfma_f32_16x16x32_bf16 v[96:99], a[232:235], a[192:195], v[96:99]
s_add_u32 m0, s63, 40960
ds_read_b64_tr_b16 a[230:231], v202 offset:34816
v_mfma_f32_16x16x32_bf16 v[100:103], a[232:235], a[196:199], v[100:103]
buffer_load_dwordx4 v200, s[20:23], s67 offen sc1 lds
v_mfma_f32_16x16x32_bf16 v[104:107], a[232:235], a[200:203], v[104:107]
ds_read_b128 a[172:175], v201 offset:31744
v_mfma_f32_16x16x32_bf16 v[108:111], a[232:235], a[204:207], v[108:111]
buffer_load_dwordx4 v214, s[20:23], s67 offen offset:1024 sc1 lds
v_mfma_f32_16x16x32_bf16 v[112:115], a[232:235], a[208:211], v[112:115]
s_add_u32 s67, s67, s33
s_add_u32 m0, s93, 69632
v_mfma_f32_16x16x32_bf16 v[116:119], a[232:235], a[212:215], v[116:119]
ds_read_b128 a[176:179], v201 offset:32768
v_mfma_f32_16x16x32_bf16 v[120:123], a[232:235], a[216:219], v[120:123]
buffer_load_dwordx4 v219, s[76:79], s54 offen sc1 lds
v_mfma_f32_16x16x32_bf16 v[124:127], a[232:235], a[220:223], v[124:127]
ds_read_b64_tr_b16 a[232:233], v203 offset:28672
v_mfma_f32_16x16x32_bf16 a[96:99], a[236:239], a[192:195], a[96:99]
buffer_load_dwordx4 v220, s[76:79], s54 offen offset:1024 sc1 lds
v_mfma_f32_16x16x32_bf16 a[100:103], a[236:239], a[196:199], a[100:103]
ds_read_b64_tr_b16 a[234:235], v203 offset:30720
ds_read_b128 a[180:183], v201 offset:33792
v_mfma_f32_16x16x32_bf16 a[104:107], a[236:239], a[200:203], a[104:107]
buffer_load_dwordx4 v221, s[76:79], s54 offen offset:2048 sc1 lds
v_mfma_f32_16x16x32_bf16 a[108:111], a[236:239], a[204:207], a[108:111]
s_add_u32 s54, s54, s91
s_add_u32 m0, s63, 61440
ds_read_b128 a[184:187], v201 offset:34816
v_mfma_f32_16x16x32_bf16 a[112:115], a[236:239], a[208:211], a[112:115]
buffer_load_dwordx4 v200, s[20:23], s67 offen sc1 lds
v_mfma_f32_16x16x32_bf16 a[116:119], a[236:239], a[212:215], a[116:119]
buffer_load_dwordx4 v214, s[20:23], s67 offen offset:1024 sc1 lds
v_mfma_f32_16x16x32_bf16 a[120:123], a[236:239], a[216:219], a[120:123]
s_add_u32 s67, s67, s33
ds_read_b128 a[188:191], v201 offset:35840
v_mfma_f32_16x16x32_bf16 a[124:127], a[236:239], a[220:223], a[124:127]
s_waitcnt lgkmcnt(5)
ds_read_b64_tr_b16 a[236:237], v203 offset:32768
ds_read_b64_tr_b16 a[238:239], v203 offset:34816
v_mfma_f32_16x16x32_bf16 v[64:67], a[224:227], a[160:163], v[64:67]
v_mfma_f32_16x16x32_bf16 v[68:71], a[224:227], a[164:167], v[68:71]
v_add_u32 v201, 57344, v201
v_mfma_f32_16x16x32_bf16 v[72:75], a[224:227], a[168:171], v[72:75]
v_mfma_f32_16x16x32_bf16 v[76:79], a[224:227], a[172:175], v[76:79]
v_add_u32 v202, 57344, v202
v_mfma_f32_16x16x32_bf16 v[80:83], a[224:227], a[176:179], v[80:83]
s_waitcnt lgkmcnt(4)
v_mfma_f32_16x16x32_bf16 v[84:87], a[224:227], a[180:183], v[84:87]
s_waitcnt lgkmcnt(3)
v_add_u32 v203, 57344, v203
v_mfma_f32_16x16x32_bf16 v[88:91], a[224:227], a[184:187], v[88:91]
s_waitcnt lgkmcnt(2)
v_mfma_f32_16x16x32_bf16 v[92:95], a[224:227], a[188:191], v[92:95]
s_waitcnt vmcnt(20) lgkmcnt(0)
s_barrier
ds_read_b64_tr_b16 a[224:225], v202 offset:0
v_mfma_f32_16x16x32_bf16 a[64:67], a[228:231], a[160:163], a[64:67]
ds_read_b64_tr_b16 a[226:227], v202 offset:2048
v_mfma_f32_16x16x32_bf16 a[68:71], a[228:231], a[164:167], a[68:71]
s_add_u32 m0, s93, 90112
ds_read_b128 a[192:195], v201 offset:0
v_mfma_f32_16x16x32_bf16 a[72:75], a[228:231], a[168:171], a[72:75]
buffer_load_dwordx4 v219, s[76:79], s54 offen sc1 lds
v_mfma_f32_16x16x32_bf16 a[76:79], a[228:231], a[172:175], a[76:79]
v_mfma_f32_16x16x32_bf16 a[80:83], a[228:231], a[176:179], a[80:83]
ds_read_b128 a[196:199], v201 offset:1024
v_mfma_f32_16x16x32_bf16 a[84:87], a[228:231], a[180:183], a[84:87]
v_mfma_f32_16x16x32_bf16 a[88:91], a[228:231], a[184:187], a[88:91]
buffer_load_dwordx4 v220, s[76:79], s54 offen offset:1024 sc1 lds
v_mfma_f32_16x16x32_bf16 a[92:95], a[228:231], a[188:191], a[92:95]
ds_read_b64_tr_b16 a[228:229], v202 offset:4096
ds_read_b128 a[200:203], v201 offset:2048
v_mfma_f32_16x16x32_bf16 v[96:99], a[232:235], a[160:163], v[96:99]
ds_read_b64_tr_b16 a[230:231], v202 offset:6144
v_mfma_f32_16x16x32_bf16 v[100:103], a[232:235], a[164:167], v[100:103]
v_mfma_f32_16x16x32_bf16 v[104:107], a[232:235], a[168:171], v[104:107]
ds_read_b128 a[204:207], v201 offset:3072
v_mfma_f32_16x16x32_bf16 v[108:111], a[232:235], a[172:175], v[108:111]
buffer_load_dwordx4 v221, s[76:79], s54 offen offset:2048 sc1 lds
v_mfma_f32_16x16x32_bf16 v[112:115], a[232:235], a[176:179], v[112:115]
s_add_u32 s54, s54, s71
v_mfma_f32_16x16x32_bf16 v[116:119], a[232:235], a[180:183], v[116:119]
ds_read_b128 a[208:211], v201 offset:4096
v_mfma_f32_16x16x32_bf16 v[120:123], a[232:235], a[184:187], v[120:123]
s_add_u32 m0, s63, 81920
v_mfma_f32_16x16x32_bf16 v[124:127], a[232:235], a[188:191], v[124:127]
ds_read_b64_tr_b16 a[232:233], v203 offset:0
v_mfma_f32_16x16x32_bf16 a[96:99], a[236:239], a[160:163], a[96:99]
buffer_load_dwordx4 v200, s[20:23], s67 offen sc1 lds
v_mfma_f32_16x16x32_bf16 a[100:103], a[236:239], a[164:167], a[100:103]
ds_read_b64_tr_b16 a[234:235], v203 offset:2048
ds_read_b128 a[212:215], v201 offset:5120
v_mfma_f32_16x16x32_bf16 a[104:107], a[236:239], a[168:171], a[104:107]
v_mfma_f32_16x16x32_bf16 a[108:111], a[236:239], a[172:175], a[108:111]
ds_read_b128 a[216:219], v201 offset:6144
v_mfma_f32_16x16x32_bf16 a[112:115], a[236:239], a[176:179], a[112:115]
buffer_load_dwordx4 v214, s[20:23], s67 offen offset:1024 sc1 lds
v_mfma_f32_16x16x32_bf16 a[116:119], a[236:239], a[180:183], a[116:119]
s_add_u32 s67, s67, s33
v_mfma_f32_16x16x32_bf16 a[120:123], a[236:239], a[184:187], a[120:123]
ds_read_b128 a[220:223], v201 offset:7168
v_mfma_f32_16x16x32_bf16 a[124:127], a[236:239], a[188:191], a[124:127]
s_waitcnt lgkmcnt(6)
ds_read_b64_tr_b16 a[236:237], v203 offset:4096
ds_read_b64_tr_b16 a[238:239], v203 offset:6144
v_mfma_f32_16x16x32_bf16 v[64:67], a[224:227], a[192:195], v[64:67]
v_mfma_f32_16x16x32_bf16 v[68:71], a[224:227], a[196:199], v[68:71]
v_mfma_f32_16x16x32_bf16 v[72:75], a[224:227], a[200:203], v[72:75]
v_mfma_f32_16x16x32_bf16 v[76:79], a[224:227], a[204:207], v[76:79]
s_waitcnt lgkmcnt(6)
v_mfma_f32_16x16x32_bf16 v[80:83], a[224:227], a[208:211], v[80:83]
s_waitcnt lgkmcnt(4)
v_mfma_f32_16x16x32_bf16 v[84:87], a[224:227], a[212:215], v[84:87]
s_waitcnt lgkmcnt(3)
v_mfma_f32_16x16x32_bf16 v[88:91], a[224:227], a[216:219], v[88:91]
s_waitcnt lgkmcnt(2)
v_mfma_f32_16x16x32_bf16 v[92:95], a[224:227], a[220:223], v[92:95]
s_waitcnt vmcnt(20) lgkmcnt(0)
s_barrier
v_mfma_f32_16x16x32_bf16 a[64:67], a[228:231], a[192:195], a[64:67]
ds_read_b64_tr_b16 a[16:17], v205 offset:0
v_mfma_f32_16x16x32_bf16 a[68:71], a[228:231], a[196:199], a[68:71]
s_add_u32 m0, s93, 110592
ds_read_b64_tr_b16 a[18:19], v205 offset:6144
v_mfma_f32_16x16x32_bf16 a[72:75], a[228:231], a[200:203], a[72:75]
ds_read_b128 a[0:3], v204 offset:0
v_mfma_f32_16x16x32_bf16 a[76:79], a[228:231], a[204:207], a[76:79]
buffer_load_dwordx4 v219, s[76:79], s54 offen sc1 lds
v_mfma_f32_16x16x32_bf16 a[80:83], a[228:231], a[208:211], a[80:83]
ds_read_b128 a[4:7], v204 offset:1024
v_mfma_f32_16x16x32_bf16 a[84:87], a[228:231], a[212:215], a[84:87]
buffer_load_dwordx4 v220, s[76:79], s54 offen offset:1024 sc1 lds
v_mfma_f32_16x16x32_bf16 a[88:91], a[228:231], a[216:219], a[88:91]
ds_read_b128 a[8:11], v204 offset:2048
ds_read_b128 a[12:15], v204 offset:3072
v_mfma_f32_16x16x32_bf16 a[92:95], a[228:231], a[220:223], a[92:95]
buffer_load_dwordx4 v221, s[76:79], s54 offen offset:2048 sc1 lds
v_mfma_f32_16x16x32_bf16 v[96:99], a[232:235], a[192:195], v[96:99]
s_add_u32 s54, s54, s71
s_add_u32 m0, s63, 102400
ds_read_b64_tr_b16 a[20:21], v205 offset:128
v_mfma_f32_16x16x32_bf16 v[100:103], a[232:235], a[196:199], v[100:103]
buffer_load_dwordx4 v200, s[20:23], s67 offen sc1 lds
v_mfma_f32_16x16x32_bf16 v[104:107], a[232:235], a[200:203], v[104:107]
ds_read_b64_tr_b16 a[22:23], v205 offset:6272
ds_read_b64_tr_b16 a[24:25], v205 offset:256
v_mfma_f32_16x16x32_bf16 v[108:111], a[232:235], a[204:207], v[108:111]
buffer_load_dwordx4 v214, s[20:23], s67 offen offset:1024 sc1 lds
v_mfma_f32_16x16x32_bf16 v[112:115], a[232:235], a[208:211], v[112:115]
s_add_u32 s67, s67, s33
s_cmp_ge_u32 s13, 30
s_cselect_b32 s76, s10, s76
s_cselect_b32 s77, s11, s77
s_cselect_b32 s54, 0, s54
v_mfma_f32_16x16x32_bf16 v[116:119], a[232:235], a[212:215], v[116:119]
s_add_u32 m0, s93, 131072
ds_read_b64_tr_b16 a[26:27], v205 offset:6400
ds_read_b64_tr_b16 a[28:29], v206 offset:0
v_mfma_f32_16x16x32_bf16 v[120:123], a[232:235], a[216:219], v[120:123]
buffer_load_dwordx4 v219, s[76:79], s54 offen sc1 lds
T_a_5:
s_cbranch_execz T_a_q
v_mfma_f32_16x16x32_bf16 v[124:127], a[232:235], a[220:223], v[124:127]
ds_read_b64_tr_b16 a[30:31], v206 offset:6144
v_mfma_f32_16x16x32_bf16 a[96:99], a[236:239], a[192:195], a[96:99]
buffer_load_dwordx4 v220, s[76:79], s54 offen offset:1024 sc1 lds
v_mfma_f32_16x16x32_bf16 a[100:103], a[236:239], a[196:199], a[100:103]
ds_read_b64_tr_b16 a[32:33], v206 offset:128
ds_read_b64_tr_b16 a[34:35], v206 offset:6272
v_mfma_f32_16x16x32_bf16 a[104:107], a[236:239], a[200:203], a[104:107]
buffer_load_dwordx4 v221, s[76:79], s54 offen offset:2048 sc1 lds
v_mfma_f32_16x16x32_bf16 a[108:111], a[236:239], a[204:207], a[108:111]
s_add_u32 s54, s54, s71
ds_read_b64_tr_b16 a[36:37], v206 offset:256
s_add_u32 m0, s63, 122880
v_mfma_f32_16x16x32_bf16 a[112:115], a[236:239], a[208:211], a[112:115]
buffer_load_dwordx4 v200, s[20:23], s67 offen sc1 lds
v_mfma_f32_16x16x32_bf16 a[116:119], a[236:239], a[212:215], a[116:119]
ds_read_b64_tr_b16 a[38:39], v206 offset:6400
v_mfma_f32_16x16x32_bf16 a[120:123], a[236:239], a[216:219], a[120:123]
buffer_load_dwordx4 v214, s[20:23], s67 offen offset:1024 sc1 lds
v_mfma_f32_16x16x32_bf16 a[124:127], a[236:239], a[220:223], a[124:127]
s_add_u32 s67, s67, s33
s_cmp_ge_u32 s13, 24
s_cbranch_scc1 P2_other
s_branch P2g_join
P1_e0:
chk_2:
s_mov_b32 s97, 0
poll_3:
buffer_load_dwordx4 v[160:163], v200, s[20:23], s19 offen offset:0 sc1
s_waitcnt vmcnt(0)
v_xor_b32 v160, s96, v160
v_xor_b32 v161, s96, v161
v_xor_b32 v162, s96, v162
v_xor_b32 v163, s96, v163
v_or3_b32 v160, v160, v161, v162
v_or_b32 v160, v160, v163
v_cmp_ne_u32 vcc, 0, v160
s_add_u32 s97, s97, 1
s_cmp_ge_u32 s97, 32768
s_cbranch_scc1 poll_3_x
s_cbranch_vccnz poll_3
poll_3_x:
s_branch chk_2_r
chk_4:
s_mov_b32 s97, 0
poll_5:
buffer_load_dword v216, v215, s[20:23], s68 offen offset:4 sc1
s_waitcnt vmcnt(0)
v_cmp_ne_u32 vcc, s96, v216
s_add_u32 s97, s97, 1
s_cmp_ge_u32 s97, 32768
s_cbranch_scc1 poll_5_x
s_cbranch_vccnz poll_5
poll_5_x:
s_branch chk_4_r
P1_role1:
T_a_6:
s_cbranch_execz T_a_q
ds_read_b128 a[224:227], v203 offset:0
ds_read_b128 a[228:231], v203 offset:6144
ds_read_b64_tr_b16 a[232:233], v202 offset:0
ds_read_b64_tr_b16 a[234:235], v202 offset:2560
ds_read_b64_tr_b16 a[236:237], v202 offset:6144
ds_read_b64_tr_b16 a[238:239], v202 offset:8704
ds_read_b64_tr_b16 a[240:241], v202 offset:32
ds_read_b64_tr_b16 a[242:243], v202 offset:2592
ds_read_b64_tr_b16 a[244:245], v202 offset:6176
ds_read_b64_tr_b16 a[246:247], v202 offset:8736
s_waitcnt lgkmcnt(9)
v_mfma_f32_16x16x32_bf16 v[128:131], a[160:163], a[224:227], 0
v_mfma_f32_16x16x32_bf16 v[132:135], a[164:167], a[224:227], 0
v_add_u32 v201, 4294852608, v201
v_mfma_f32_16x16x32_bf16 v[136:139], a[168:171], a[224:227], 0
s_add_u32 m0, s44, 102400
v_mfma_f32_16x16x32_bf16 v[140:143], a[172:175], a[224:227], 0
v_add_u32 v202, 4294852608, v202
v_mfma_f32_16x16x32_bf16 v[144:147], a[176:179], a[224:227], 0
buffer_load_dwordx4 v204, s[24:27], s39 offen lds
v_mfma_f32_16x16x32_bf16 v[148:151], a[180:183], a[224:227], 0
v_add_u32 v203, 4294852608, v203
v_mfma_f32_16x16x32_bf16 v[152:155], a[184:187], a[224:227], 0
buffer_load_dwordx4 v205, s[24:27], s39 offen offset:1024 lds
v_mfma_f32_16x16x32_bf16 v[156:159], a[188:191], a[224:227], 0
s_waitcnt lgkmcnt(5)
s_add_u32 s39, s39, 294912
s_waitcnt vmcnt(10) lgkmcnt(0)
v_mfma_f32_16x16x32_bf16 v[224:227], a[160:163], a[228:231], 0
s_barrier
ds_read_b128 a[224:227], v203 offset:0
s_add_u32 m0, s44, 104448
v_mfma_f32_16x16x32_bf16 v[228:231], a[164:167], a[228:231], 0
buffer_load_dwordx4 v206, s[28:31], s40 offen lds
v_mfma_f32_16x16x32_bf16 v[232:235], a[168:171], a[228:231], 0
s_add_u32 s40, s40, s41
ds_read_b128 a[192:195], v201 offset:0
v_mfma_f32_16x16x32_bf16 v[236:239], a[172:175], a[228:231], 0
s_add_u32 m0, s43, 86016
v_mfma_f32_16x16x32_bf16 v[240:243], a[176:179], a[228:231], 0
buffer_load_dwordx4 v200, s[20:23], s38 offen offset:0 sc1 lds
v_mfma_f32_16x16x32_bf16 v[244:247], a[180:183], a[228:231], 0
v_mfma_f32_16x16x32_bf16 v[248:251], a[184:187], a[228:231], 0
v_mfma_f32_16x16x32_bf16 v[252:255], a[188:191], a[228:231], 0
ds_read_b128 a[228:231], v203 offset:6144
ds_read_b128 a[196:199], v201 offset:1024
v_mfma_f32_16x16x32_bf16 v[0:3], a[232:235], a[160:163], 0
buffer_load_dwordx4 v200, s[20:23], s38 offen offset:1024 sc1 lds
v_mfma_f32_16x16x32_bf16 v[4:7], a[232:235], a[164:167], 0
v_mfma_f32_16x16x32_bf16 v[8:11], a[232:235], a[168:171], 0
buffer_load_dwordx4 v200, s[20:23], s38 offen offset:2048 sc1 lds
v_mfma_f32_16x16x32_bf16 v[12:15], a[232:235], a[172:175], 0
v_mfma_f32_16x16x32_bf16 v[16:19], a[232:235], a[176:179], 0
ds_read_b128 a[200:203], v201 offset:2048
v_mfma_f32_16x16x32_bf16 v[20:23], a[232:235], a[180:183], 0
buffer_load_dwordx4 v200, s[20:23], s38 offen offset:3072 sc1 lds
v_mfma_f32_16x16x32_bf16 v[24:27], a[232:235], a[184:187], 0
s_add_u32 s38, s38, 16384
v_mfma_f32_16x16x32_bf16 v[28:31], a[232:235], a[188:191], 0
s_add_u32 m0, s44, 131072
ds_read_b64_tr_b16 a[232:233], v202 offset:0
v_mfma_f32_16x16x32_bf16 a[0:3], a[236:239], a[160:163], 0
ds_read_b64_tr_b16 a[234:235], v202 offset:2560
v_mfma_f32_16x16x32_bf16 a[4:7], a[236:239], a[164:167], 0
buffer_load_dwordx4 v204, s[24:27], s39 offen lds
v_mfma_f32_16x16x32_bf16 a[8:11], a[236:239], a[168:171], 0
ds_read_b128 a[204:207], v201 offset:3072
v_mfma_f32_16x16x32_bf16 a[12:15], a[236:239], a[172:175], 0
buffer_load_dwordx4 v205, s[24:27], s39 offen offset:1024 lds
v_mfma_f32_16x16x32_bf16 a[16:19], a[236:239], a[176:179], 0
s_add_u32 s39, s39, 294912
v_mfma_f32_16x16x32_bf16 a[20:23], a[236:239], a[180:183], 0
s_add_u32 m0, s44, 133120
v_mfma_f32_16x16x32_bf16 a[24:27], a[236:239], a[184:187], 0
ds_read_b128 a[208:211], v201 offset:4096
v_mfma_f32_16x16x32_bf16 a[28:31], a[236:239], a[188:191], 0
buffer_load_dwordx4 v206, s[28:31], s40 offen lds
v_mfma_f32_16x16x32_bf16 v[32:35], a[240:243], a[160:163], 0
s_add_u32 s40, s40, s41
ds_read_b64_tr_b16 a[236:237], v202 offset:6144
ds_read_b64_tr_b16 a[238:239], v202 offset:8704
v_mfma_f32_16x16x32_bf16 v[36:39], a[240:243], a[164:167], 0
s_add_u32 m0, s43, 114688
v_mfma_f32_16x16x32_bf16 v[40:43], a[240:243], a[168:171], 0
buffer_load_dwordx4 v200, s[20:23], s38 offen offset:0 sc1 lds
v_mfma_f32_16x16x32_bf16 v[44:47], a[240:243], a[172:175], 0
ds_read_b128 a[212:215], v201 offset:5120
v_mfma_f32_16x16x32_bf16 v[48:51], a[240:243], a[176:179], 0
buffer_load_dwordx4 v200, s[20:23], s38 offen offset:1024 sc1 lds
v_mfma_f32_16x16x32_bf16 v[52:55], a[240:243], a[180:183], 0
v_mfma_f32_16x16x32_bf16 v[56:59], a[240:243], a[184:187], 0
v_mfma_f32_16x16x32_bf16 v[60:63], a[240:243], a[188:191], 0
ds_read_b64_tr_b16 a[240:241], v202 offset:32
v_mfma_f32_16x16x32_bf16 a[32:35], a[244:247], a[160:163], 0
buffer_load_dwordx4 v200, s[20:23], s38 offen offset:2048 sc1 lds
v_mfma_f32_16x16x32_bf16 a[36:39], a[244:247], a[164:167], 0
ds_read_b64_tr_b16 a[242:243], v202 offset:2592
ds_read_b128 a[216:219], v201 offset:6144
v_mfma_f32_16x16x32_bf16 a[40:43], a[244:247], a[168:171], 0
buffer_load_dwordx4 v200, s[20:23], s38 offen offset:3072 sc1 lds
v_mfma_f32_16x16x32_bf16 a[44:47], a[244:247], a[172:175], 0
s_add_u32 s38, s38, 16384
v_mfma_f32_16x16x32_bf16 a[48:51], a[244:247], a[176:179], 0
v_mfma_f32_16x16x32_bf16 a[52:55], a[244:247], a[180:183], 0
ds_read_b128 a[220:223], v201 offset:7168
v_mfma_f32_16x16x32_bf16 a[56:59], a[244:247], a[184:187], 0
v_mfma_f32_16x16x32_bf16 a[60:63], a[244:247], a[188:191], 0
s_waitcnt lgkmcnt(4)
ds_read_b64_tr_b16 a[244:245], v202 offset:6176
ds_read_b64_tr_b16 a[246:247], v202 offset:8736
v_mfma_f32_16x16x32_bf16 v[128:131], a[192:195], a[224:227], v[128:131]
v_mfma_f32_16x16x32_bf16 v[132:135], a[196:199], a[224:227], v[132:135]
v_mfma_f32_16x16x32_bf16 v[136:139], a[200:203], a[224:227], v[136:139]
v_mfma_f32_16x16x32_bf16 v[140:143], a[204:207], a[224:227], v[140:143]
v_mfma_f32_16x16x32_bf16 v[144:147], a[208:211], a[224:227], v[144:147]
v_mfma_f32_16x16x32_bf16 v[148:151], a[212:215], a[224:227], v[148:151]
s_waitcnt lgkmcnt(3)
v_mfma_f32_16x16x32_bf16 v[152:155], a[216:219], a[224:227], v[152:155]
s_waitcnt lgkmcnt(2)
v_mfma_f32_16x16x32_bf16 v[156:159], a[220:223], a[224:227], v[156:159]
s_waitcnt vmcnt(18) lgkmcnt(0)
s_barrier
ds_read_b128 a[224:227], v203 offset:28672
v_mfma_f32_16x16x32_bf16 v[224:227], a[192:195], a[228:231], v[224:227]
v_mfma_f32_16x16x32_bf16 v[228:231], a[196:199], a[228:231], v[228:231]
s_add_u32 m0, s44, 16384
v_mfma_f32_16x16x32_bf16 v[232:235], a[200:203], a[228:231], v[232:235]
ds_read_b128 a[160:163], v201 offset:28672
v_mfma_f32_16x16x32_bf16 v[236:239], a[204:207], a[228:231], v[236:239]
buffer_load_dwordx4 v204, s[24:27], s39 offen lds
v_mfma_f32_16x16x32_bf16 v[240:243], a[208:211], a[228:231], v[240:243]
v_mfma_f32_16x16x32_bf16 v[244:247], a[212:215], a[228:231], v[244:247]
v_mfma_f32_16x16x32_bf16 v[248:251], a[216:219], a[228:231], v[248:251]
v_mfma_f32_16x16x32_bf16 v[252:255], a[220:223], a[228:231], v[252:255]
ds_read_b128 a[228:231], v203 offset:34816
ds_read_b128 a[164:167], v201 offset:29696
v_mfma_f32_16x16x32_bf16 v[0:3], a[232:235], a[192:195], v[0:3]
buffer_load_dwordx4 v205, s[24:27], s39 offen offset:1024 lds
v_mfma_f32_16x16x32_bf16 v[4:7], a[232:235], a[196:199], v[4:7]
s_add_u32 s39, s39, 294912
v_mfma_f32_16x16x32_bf16 v[8:11], a[232:235], a[200:203], v[8:11]
v_mfma_f32_16x16x32_bf16 v[12:15], a[232:235], a[204:207], v[12:15]
s_add_u32 m0, s44, 18432
v_mfma_f32_16x16x32_bf16 v[16:19], a[232:235], a[208:211], v[16:19]
ds_read_b128 a[168:171], v201 offset:30720
v_mfma_f32_16x16x32_bf16 v[20:23], a[232:235], a[212:215], v[20:23]
buffer_load_dwordx4 v206, s[28:31], s40 offen lds
v_mfma_f32_16x16x32_bf16 v[24:27], a[232:235], a[216:219], v[24:27]
s_add_u32 s40, s40, s41
v_mfma_f32_16x16x32_bf16 v[28:31], a[232:235], a[220:223], v[28:31]
ds_read_b64_tr_b16 a[232:233], v202 offset:28672
v_mfma_f32_16x16x32_bf16 a[0:3], a[236:239], a[192:195], a[0:3]
ds_read_b64_tr_b16 a[234:235], v202 offset:31232
v_mfma_f32_16x16x32_bf16 a[4:7], a[236:239], a[196:199], a[4:7]
s_add_u32 m0, s43, 0
ds_read_b128 a[172:175], v201 offset:31744
v_mfma_f32_16x16x32_bf16 a[8:11], a[236:239], a[200:203], a[8:11]
buffer_load_dwordx4 v200, s[20:23], s38 offen offset:0 sc1 lds
v_mfma_f32_16x16x32_bf16 a[12:15], a[236:239], a[204:207], a[12:15]
v_mfma_f32_16x16x32_bf16 a[16:19], a[236:239], a[208:211], a[16:19]
v_mfma_f32_16x16x32_bf16 a[20:23], a[236:239], a[212:215], a[20:23]
v_mfma_f32_16x16x32_bf16 a[24:27], a[236:239], a[216:219], a[24:27]
ds_read_b128 a[176:179], v201 offset:32768
v_mfma_f32_16x16x32_bf16 a[28:31], a[236:239], a[220:223], a[28:31]
ds_read_b64_tr_b16 a[236:237], v202 offset:34816
v_mfma_f32_16x16x32_bf16 v[32:35], a[240:243], a[192:195], v[32:35]
buffer_load_dwordx4 v200, s[20:23], s38 offen offset:1024 sc1 lds
v_mfma_f32_16x16x32_bf16 v[36:39], a[240:243], a[196:199], v[36:39]
ds_read_b64_tr_b16 a[238:239], v202 offset:37376
v_mfma_f32_16x16x32_bf16 v[40:43], a[240:243], a[200:203], v[40:43]
v_mfma_f32_16x16x32_bf16 v[44:47], a[240:243], a[204:207], v[44:47]
ds_read_b128 a[180:183], v201 offset:33792
v_mfma_f32_16x16x32_bf16 v[48:51], a[240:243], a[208:211], v[48:51]
v_mfma_f32_16x16x32_bf16 v[52:55], a[240:243], a[212:215], v[52:55]
buffer_load_dwordx4 v200, s[20:23], s38 offen offset:2048 sc1 lds
v_mfma_f32_16x16x32_bf16 v[56:59], a[240:243], a[216:219], v[56:59]
v_mfma_f32_16x16x32_bf16 v[60:63], a[240:243], a[220:223], v[60:63]
ds_read_b64_tr_b16 a[240:241], v202 offset:28704
v_mfma_f32_16x16x32_bf16 a[32:35], a[244:247], a[192:195], a[32:35]
ds_read_b64_tr_b16 a[242:243], v202 offset:31264
ds_read_b128 a[184:187], v201 offset:34816
v_mfma_f32_16x16x32_bf16 a[36:39], a[244:247], a[196:199], a[36:39]
v_mfma_f32_16x16x32_bf16 a[40:43], a[244:247], a[200:203], a[40:43]
buffer_load_dwordx4 v200, s[20:23], s38 offen offset:3072 sc1 lds
v_mfma_f32_16x16x32_bf16 a[44:47], a[244:247], a[204:207], a[44:47]
s_add_u32 s38, s38, 16384
v_mfma_f32_16x16x32_bf16 a[48:51], a[244:247], a[208:211], a[48:51]
v_mfma_f32_16x16x32_bf16 a[52:55], a[244:247], a[212:215], a[52:55]
ds_read_b128 a[188:191], v201 offset:35840
v_mfma_f32_16x16x32_bf16 a[56:59], a[244:247], a[216:219], a[56:59]
v_mfma_f32_16x16x32_bf16 a[60:63], a[244:247], a[220:223], a[60:63]
s_waitcnt lgkmcnt(5)
ds_read_b64_tr_b16 a[244:245], v202 offset:34848
ds_read_b64_tr_b16 a[246:247], v202 offset:37408
v_mfma_f32_16x16x32_bf16 v[128:131], a[160:163], a[224:227], v[128:131]
v_mfma_f32_16x16x32_bf16 v[132:135], a[164:167], a[224:227], v[132:135]
v_add_u32 v201, 57344, v201
v_mfma_f32_16x16x32_bf16 v[136:139], a[168:171], a[224:227], v[136:139]
v_mfma_f32_16x16x32_bf16 v[140:143], a[172:175], a[224:227], v[140:143]
v_add_u32 v202, 57344, v202
v_mfma_f32_16x16x32_bf16 v[144:147], a[176:179], a[224:227], v[144:147]
s_waitcnt lgkmcnt(3)
v_mfma_f32_16x16x32_bf16 v[148:151], a[180:183], a[224:227], v[148:151]
v_add_u32 v203, 57344, v203
v_mfma_f32_16x16x32_bf16 v[152:155], a[184:187], a[224:227], v[152:155]
s_waitcnt lgkmcnt(2)
v_mfma_f32_16x16x32_bf16 v[156:159], a[188:191], a[224:227], v[156:159]
s_waitcnt vmcnt(21) lgkmcnt(0)
s_barrier
ds_read_b128 a[224:227], v203 offset:0
v_mfma_f32_16x16x32_bf16 v[224:227], a[160:163], a[228:231], v[224:227]
v_mfma_f32_16x16x32_bf16 v[228:231], a[164:167], a[228:231], v[228:231]
s_add_u32 m0, s44, 45056
v_mfma_f32_16x16x32_bf16 v[232:235], a[168:171], a[228:231], v[232:235]
ds_read_b128 a[192:195], v201 offset:0
v_mfma_f32_16x16x32_bf16 v[236:239], a[172:175], a[228:231], v[236:239]
buffer_load_dwordx4 v204, s[24:27], s39 offen lds
v_mfma_f32_16x16x32_bf16 v[240:243], a[176:179], a[228:231], v[240:243]
s_lshl_b32 s6, s13, 1
s_add_u32 s6, s6, s16
v_mfma_f32_16x16x32_bf16 v[244:247], a[180:183], a[228:231], v[244:247]
s_mul_i32 s6, s6, 18432
s_mul_i32 s7, s12, 1152
v_mfma_f32_16x16x32_bf16 v[248:251], a[184:187], a[228:231], v[248:251]
v_mfma_f32_16x16x32_bf16 v[252:255], a[188:191], a[228:231], v[252:255]
ds_read_b128 a[228:231], v203 offset:6144
ds_read_b128 a[196:199], v201 offset:1024
v_mfma_f32_16x16x32_bf16 v[0:3], a[232:235], a[160:163], v[0:3]
buffer_load_dwordx4 v205, s[24:27], s39 offen offset:1024 lds
v_mfma_f32_16x16x32_bf16 v[4:7], a[232:235], a[164:167], v[4:7]
s_add_u32 s39, s39, 294912
s_add_u32 s6, s6, s7
v_min_u32 v197, 144, v200
v_mfma_f32_16x16x32_bf16 v[8:11], a[232:235], a[168:171], v[8:11]
v_mul_u32_u24 v198, 52, v197
v_lshrrev_b32 v198, 12, v198
v_mfma_f32_16x16x32_bf16 v[12:15], a[232:235], a[172:175], v[12:15]
s_add_u32 m0, s44, 47104
s_add_u32 s97, s6, 3833856
v_mul_u32_u24 v198, 8576, v198
v_mfma_f32_16x16x32_bf16 v[16:19], a[232:235], a[176:179], v[16:19]
ds_read_b128 a[200:203], v201 offset:2048
v_mfma_f32_16x16x32_bf16 v[20:23], a[232:235], a[180:183], v[20:23]
buffer_load_dwordx4 v206, s[28:31], s40 offen lds
v_mfma_f32_16x16x32_bf16 v[24:27], a[232:235], a[184:187], v[24:27]
s_add_u32 s40, s40, s41
v_lshl_add_u32 v197, v197, 3, v198
v_mfma_f32_16x16x32_bf16 v[28:31], a[232:235], a[188:191], v[28:31]
ds_read_b64_tr_b16 a[232:233], v202 offset:0
v_mfma_f32_16x16x32_bf16 a[0:3], a[236:239], a[160:163], a[0:3]
buffer_load_dword a255, v197, s[24:27], s97 offen
v_mfma_f32_16x16x32_bf16 a[4:7], a[236:239], a[164:167], a[4:7]
s_add_u32 m0, s43, 28672
ds_read_b64_tr_b16 a[234:235], v202 offset:2560
ds_read_b128 a[204:207], v201 offset:3072
v_mfma_f32_16x16x32_bf16 a[8:11], a[236:239], a[168:171], a[8:11]
buffer_load_dwordx4 v200, s[20:23], s38 offen offset:0 sc1 lds
v_mfma_f32_16x16x32_bf16 a[12:15], a[236:239], a[172:175], a[12:15]
v_mfma_f32_16x16x32_bf16 a[16:19], a[236:239], a[176:179], a[16:19]
v_mfma_f32_16x16x32_bf16 a[20:23], a[236:239], a[180:183], a[20:23]
v_mfma_f32_16x16x32_bf16 a[24:27], a[236:239], a[184:187], a[24:27]
ds_read_b128 a[208:211], v201 offset:4096
v_mfma_f32_16x16x32_bf16 a[28:31], a[236:239], a[188:191], a[28:31]
ds_read_b64_tr_b16 a[236:237], v202 offset:6144
v_mfma_f32_16x16x32_bf16 v[32:35], a[240:243], a[160:163], v[32:35]
buffer_load_dwordx4 v200, s[20:23], s38 offen offset:1024 sc1 lds
v_mfma_f32_16x16x32_bf16 v[36:39], a[240:243], a[164:167], v[36:39]
ds_read_b64_tr_b16 a[238:239], v202 offset:8704
v_mfma_f32_16x16x32_bf16 v[40:43], a[240:243], a[168:171], v[40:43]
v_mfma_f32_16x16x32_bf16 v[44:47], a[240:243], a[172:175], v[44:47]
ds_read_b128 a[212:215], v201 offset:5120
v_mfma_f32_16x16x32_bf16 v[48:51], a[240:243], a[176:179], v[48:51]
v_mfma_f32_16x16x32_bf16 v[52:55], a[240:243], a[180:183], v[52:55]
buffer_load_dwordx4 v200, s[20:23], s38 offen offset:2048 sc1 lds
v_mfma_f32_16x16x32_bf16 v[56:59], a[240:243], a[184:187], v[56:59]
v_mfma_f32_16x16x32_bf16 v[60:63], a[240:243], a[188:191], v[60:63]
ds_read_b64_tr_b16 a[240:241], v202 offset:32
v_mfma_f32_16x16x32_bf16 a[32:35], a[244:247], a[160:163], a[32:35]
ds_read_b64_tr_b16 a[242:243], v202 offset:2592
ds_read_b128 a[216:219], v201 offset:6144
v_mfma_f32_16x16x32_bf16 a[36:39], a[244:247], a[164:167], a[36:39]
v_mfma_f32_16x16x32_bf16 a[40:43], a[244:247], a[168:171], a[40:43]
buffer_load_dwordx4 v200, s[20:23], s38 offen offset:3072 sc1 lds
v_mfma_f32_16x16x32_bf16 a[44:47], a[244:247], a[172:175], a[44:47]
s_add_u32 s38, s38, 16384
v_mfma_f32_16x16x32_bf16 a[48:51], a[244:247], a[176:179], a[48:51]
v_mfma_f32_16x16x32_bf16 a[52:55], a[244:247], a[180:183], a[52:55]
ds_read_b128 a[220:223], v201 offset:7168
v_mfma_f32_16x16x32_bf16 a[56:59], a[244:247], a[184:187], a[56:59]
v_mfma_f32_16x16x32_bf16 a[60:63], a[244:247], a[188:191], a[60:63]
s_waitcnt lgkmcnt(5)
ds_read_b64_tr_b16 a[244:245], v202 offset:6176
ds_read_b64_tr_b16 a[246:247], v202 offset:8736
v_mfma_f32_16x16x32_bf16 v[128:131], a[192:195], a[224:227], v[128:131]
v_mfma_f32_16x16x32_bf16 v[132:135], a[196:199], a[224:227], v[132:135]
v_mfma_f32_16x16x32_bf16 v[136:139], a[200:203], a[224:227], v[136:139]
v_mfma_f32_16x16x32_bf16 v[140:143], a[204:207], a[224:227], v[140:143]
v_mfma_f32_16x16x32_bf16 v[144:147], a[208:211], a[224:227], v[144:147]
s_waitcnt lgkmcnt(5)
v_mfma_f32_16x16x32_bf16 v[148:151], a[212:215], a[224:227], v[148:151]
s_waitcnt lgkmcnt(3)
v_mfma_f32_16x16x32_bf16 v[152:155], a[216:219], a[224:227], v[152:155]
s_waitcnt lgkmcnt(2)
v_mfma_f32_16x16x32_bf16 v[156:159], a[220:223], a[224:227], v[156:159]
s_waitcnt vmcnt(22) lgkmcnt(0)
s_barrier
ds_read_b128 a[224:227], v203 offset:28672
v_mfma_f32_16x16x32_bf16 v[224:227], a[192:195], a[228:231], v[224:227]
v_mfma_f32_16x16x32_bf16 v[228:231], a[196:199], a[228:231], v[228:231]
s_add_u32 m0, s44, 73728
v_mfma_f32_16x16x32_bf16 v[232:235], a[200:203], a[228:231], v[232:235]
ds_read_b128 a[160:163], v201 offset:28672
v_mfma_f32_16x16x32_bf16 v[236:239], a[204:207], a[228:231], v[236:239]
buffer_load_dwordx4 v204, s[24:27], s39 offen lds
v_mfma_f32_16x16x32_bf16 v[240:243], a[208:211], a[228:231], v[240:243]
v_mfma_f32_16x16x32_bf16 v[244:247], a[212:215], a[228:231], v[244:247]
v_mfma_f32_16x16x32_bf16 v[248:251], a[216:219], a[228:231], v[248:251]
v_mfma_f32_16x16x32_bf16 v[252:255], a[220:223], a[228:231], v[252:255]
ds_read_b128 a[228:231], v203 offset:34816
ds_read_b128 a[164:167], v201 offset:29696
v_mfma_f32_16x16x32_bf16 v[0:3], a[232:235], a[192:195], v[0:3]
buffer_load_dwordx4 v205, s[24:27], s39 offen offset:1024 lds
v_mfma_f32_16x16x32_bf16 v[4:7], a[232:235], a[196:199], v[4:7]
s_add_u32 s39, s39, 294912
v_mfma_f32_16x16x32_bf16 v[8:11], a[232:235], a[200:203], v[8:11]
v_mfma_f32_16x16x32_bf16 v[12:15], a[232:235], a[204:207], v[12:15]
s_add_u32 m0, s44, 75776
v_mfma_f32_16x16x32_bf16 v[16:19], a[232:235], a[208:211], v[16:19]
ds_read_b128 a[168:171], v201 offset:30720
v_mfma_f32_16x16x32_bf16 v[20:23], a[232:235], a[212:215], v[20:23]
buffer_load_dwordx4 v206, s[28:31], s40 offen lds
v_mfma_f32_16x16x32_bf16 v[24:27], a[232:235], a[216:219], v[24:27]
s_add_u32 s40, s40, s41
v_mfma_f32_16x16x32_bf16 v[28:31], a[232:235], a[220:223], v[28:31]
ds_read_b64_tr_b16 a[232:233], v202 offset:28672
v_mfma_f32_16x16x32_bf16 a[0:3], a[236:239], a[192:195], a[0:3]
ds_read_b64_tr_b16 a[234:235], v202 offset:31232
v_mfma_f32_16x16x32_bf16 a[4:7], a[236:239], a[196:199], a[4:7]
s_add_u32 m0, s43, 57344
ds_read_b128 a[172:175], v201 offset:31744
v_mfma_f32_16x16x32_bf16 a[8:11], a[236:239], a[200:203], a[8:11]
buffer_load_dwordx4 v200, s[20:23], s38 offen offset:0 sc1 lds
v_mfma_f32_16x16x32_bf16 a[12:15], a[236:239], a[204:207], a[12:15]
v_mfma_f32_16x16x32_bf16 a[16:19], a[236:239], a[208:211], a[16:19]
v_mfma_f32_16x16x32_bf16 a[20:23], a[236:239], a[212:215], a[20:23]
v_mfma_f32_16x16x32_bf16 a[24:27], a[236:239], a[216:219], a[24:27]
ds_read_b128 a[176:179], v201 offset:32768
v_mfma_f32_16x16x32_bf16 a[28:31], a[236:239], a[220:223], a[28:31]
ds_read_b64_tr_b16 a[236:237], v202 offset:34816
v_mfma_f32_16x16x32_bf16 v[32:35], a[240:243], a[192:195], v[32:35]
buffer_load_dwordx4 v200, s[20:23], s38 offen offset:1024 sc1 lds
v_mfma_f32_16x16x32_bf16 v[36:39], a[240:243], a[196:199], v[36:39]
ds_read_b64_tr_b16 a[238:239], v202 offset:37376
v_mfma_f32_16x16x32_bf16 v[40:43], a[240:243], a[200:203], v[40:43]
v_mfma_f32_16x16x32_bf16 v[44:47], a[240:243], a[204:207], v[44:47]
ds_read_b128 a[180:183], v201 offset:33792
v_mfma_f32_16x16x32_bf16 v[48:51], a[240:243], a[208:211], v[48:51]
v_mfma_f32_16x16x32_bf16 v[52:55], a[240:243], a[212:215], v[52:55]
buffer_load_dwordx4 v200, s[20:23], s38 offen offset:2048 sc1 lds
v_mfma_f32_16x16x32_bf16 v[56:59], a[240:243], a[216:219], v[56:59]
v_mfma_f32_16x16x32_bf16 v[60:63], a[240:243], a[220:223], v[60:63]
ds_read_b64_tr_b16 a[240:241], v202 offset:28704
v_mfma_f32_16x16x32_bf16 a[32:35], a[244:247], a[192:195], a[32:35]
ds_read_b64_tr_b16 a[242:243], v202 offset:31264
ds_read_b128 a[184:187], v201 offset:34816
v_mfma_f32_16x16x32_bf16 a[36:39], a[244:247], a[196:199], a[36:39]
v_mfma_f32_16x16x32_bf16 a[40:43], a[244:247], a[200:203], a[40:43]
buffer_load_dwordx4 v200, s[20:23], s38 offen offset:3072 sc1 lds
v_mfma_f32_16x16x32_bf16 a[44:47], a[244:247], a[204:207], a[44:47]
s_add_u32 s38, s38, 16384
v_mfma_f32_16x16x32_bf16 a[48:51], a[244:247], a[208:211], a[48:51]
v_mfma_f32_16x16x32_bf16 a[52:55], a[244:247], a[212:215], a[52:55]
ds_read_b128 a[188:191], v201 offset:35840
v_mfma_f32_16x16x32_bf16 a[56:59], a[244:247], a[216:219], a[56:59]
v_mfma_f32_16x16x32_bf16 a[60:63], a[244:247], a[220:223], a[60:63]
s_waitcnt lgkmcnt(5)
ds_read_b64_tr_b16 a[244:245], v202 offset:34848
ds_read_b64_tr_b16 a[246:247], v202 offset:37408
v_mfma_f32_16x16x32_bf16 v[128:131], a[160:163], a[224:227], v[128:131]
v_mfma_f32_16x16x32_bf16 v[132:135], a[164:167], a[224:227], v[132:135]
v_add_u32 v201, 57344, v201
v_mfma_f32_16x16x32_bf16 v[136:139], a[168:171], a[224:227], v[136:139]
v_mfma_f32_16x16x32_bf16 v[140:143], a[172:175], a[224:227], v[140:143]
v_add_u32 v202, 57344, v202
v_mfma_f32_16x16x32_bf16 v[144:147], a[176:179], a[224:227], v[144:147]
s_waitcnt lgkmcnt(3)
v_mfma_f32_16x16x32_bf16 v[148:151], a[180:183], a[224:227], v[148:151]
v_add_u32 v203, 57344, v203
v_mfma_f32_16x16x32_bf16 v[152:155], a[184:187], a[224:227], v[152:155]
s_waitcnt lgkmcnt(2)
v_mfma_f32_16x16x32_bf16 v[156:159], a[188:191], a[224:227], v[156:159]
s_waitcnt vmcnt(22) lgkmcnt(0)
s_barrier
ds_read_b128 a[224:227], v203 offset:0
v_mfma_f32_16x16x32_bf16 v[224:227], a[160:163], a[228:231], v[224:227]
v_mfma_f32_16x16x32_bf16 v[228:231], a[164:167], a[228:231], v[228:231]
s_add_u32 m0, s44, 102400
v_mfma_f32_16x16x32_bf16 v[232:235], a[168:171], a[228:231], v[232:235]
ds_read_b128 a[192:195], v201 offset:0
v_mfma_f32_16x16x32_bf16 v[236:239], a[172:175], a[228:231], v[236:239]
buffer_load_dwordx4 v204, s[24:27], s39 offen lds
v_mfma_f32_16x16x32_bf16 v[240:243], a[176:179], a[228:231], v[240:243]
v_mfma_f32_16x16x32_bf16 v[244:247], a[180:183], a[228:231], v[244:247]
v_mfma_f32_16x16x32_bf16 v[248:251], a[184:187], a[228:231], v[248:251]
v_mfma_f32_16x16x32_bf16 v[252:255], a[188:191], a[228:231], v[252:255]
ds_read_b128 a[228:231], v203 offset:6144
ds_read_b128 a[196:199], v201 offset:1024
v_mfma_f32_16x16x32_bf16 v[0:3], a[232:235], a[160:163], v[0:3]
buffer_load_dwordx4 v205, s[24:27], s39 offen offset:1024 lds
v_mfma_f32_16x16x32_bf16 v[4:7], a[232:235], a[164:167], v[4:7]
s_add_u32 s39, s39, 294912
v_mfma_f32_16x16x32_bf16 v[8:11], a[232:235], a[168:171], v[8:11]
v_mfma_f32_16x16x32_bf16 v[12:15], a[232:235], a[172:175], v[12:15]
s_add_u32 m0, s44, 104448
v_mfma_f32_16x16x32_bf16 v[16:19], a[232:235], a[176:179], v[16:19]
ds_read_b128 a[200:203], v201 offset:2048
v_mfma_f32_16x16x32_bf16 v[20:23], a[232:235], a[180:183], v[20:23]
buffer_load_dwordx4 v206, s[28:31], s40 offen lds
v_mfma_f32_16x16x32_bf16 v[24:27], a[232:235], a[184:187], v[24:27]
s_add_u32 s40, s40, s41
v_mfma_f32_16x16x32_bf16 v[28:31], a[232:235], a[188:191], v[28:31]
ds_read_b64_tr_b16 a[232:233], v202 offset:0
v_mfma_f32_16x16x32_bf16 a[0:3], a[236:239], a[160:163], a[0:3]
ds_read_b64_tr_b16 a[234:235], v202 offset:2560
v_mfma_f32_16x16x32_bf16 a[4:7], a[236:239], a[164:167], a[4:7]
s_add_u32 m0, s43, 86016
ds_read_b128 a[204:207], v201 offset:3072
v_mfma_f32_16x16x32_bf16 a[8:11], a[236:239], a[168:171], a[8:11]
buffer_load_dwordx4 v200, s[20:23], s38 offen offset:0 sc1 lds
v_mfma_f32_16x16x32_bf16 a[12:15], a[236:239], a[172:175], a[12:15]
v_mfma_f32_16x16x32_bf16 a[16:19], a[236:239], a[176:179], a[16:19]
v_mfma_f32_16x16x32_bf16 a[20:23], a[236:239], a[180:183], a[20:23]
v_mfma_f32_16x16x32_bf16 a[24:27], a[236:239], a[184:187], a[24:27]
ds_read_b128 a[208:211], v201 offset:4096
v_mfma_f32_16x16x32_bf16 a[28:31], a[236:239], a[188:191], a[28:31]
ds_read_b64_tr_b16 a[236:237], v202 offset:6144
v_mfma_f32_16x16x32_bf16 v[32:35], a[240:243], a[160:163], v[32:35]
buffer_load_dwordx4 v200, s[20:23], s38 offen offset:1024 sc1 lds
v_mfma_f32_16x16x32_bf16 v[36:39], a[240:243], a[164:167], v[36:39]
ds_read_b64_tr_b16 a[238:239], v202 offset:8704
v_mfma_f32_16x16x32_bf16 v[40:43], a[240:243], a[168:171], v[40:43]
v_mfma_f32_16x16x32_bf16 v[44:47], a[240:243], a[172:175], v[44:47]
ds_read_b128 a[212:215], v201 offset:5120
v_mfma_f32_16x16x32_bf16 v[48:51], a[240:243], a[176:179], v[48:51]
v_mfma_f32_16x16x32_bf16 v[52:55], a[240:243], a[180:183], v[52:55]
buffer_load_dwordx4 v200, s[20:23], s38 offen offset:2048 sc1 lds
v_mfma_f32_16x16x32_bf16 v[56:59], a[240:243], a[184:187], v[56:59]
v_mfma_f32_16x16x32_bf16 v[60:63], a[240:243], a[188:191], v[60:63]
ds_read_b64_tr_b16 a[240:241], v202 offset:32
v_mfma_f32_16x16x32_bf16 a[32:35], a[244:247], a[160:163], a[32:35]
ds_read_b64_tr_b16 a[242:243], v202 offset:2592
ds_read_b128 a[216:219], v201 offset:6144
v_mfma_f32_16x16x32_bf16 a[36:39], a[244:247], a[164:167], a[36:39]
v_mfma_f32_16x16x32_bf16 a[40:43], a[244:247], a[168:171], a[40:43]
buffer_load_dwordx4 v200, s[20:23], s38 offen offset:3072 sc1 lds
v_mfma_f32_16x16x32_bf16 a[44:47], a[244:247], a[172:175], a[44:47]
s_add_u32 s38, s38, 16384
v_mfma_f32_16x16x32_bf16 a[48:51], a[244:247], a[176:179], a[48:51]
v_mfma_f32_16x16x32_bf16 a[52:55], a[244:247], a[180:183], a[52:55]
ds_read_b128 a[220:223], v201 offset:7168
v_mfma_f32_16x16x32_bf16 a[56:59], a[244:247], a[184:187], a[56:59]
v_mfma_f32_16x16x32_bf16 a[60:63], a[244:247], a[188:191], a[60:63]
s_waitcnt lgkmcnt(5)
ds_read_b64_tr_b16 a[244:245], v202 offset:6176
ds_read_b64_tr_b16 a[246:247], v202 offset:8736
v_mfma_f32_16x16x32_bf16 v[128:131], a[192:195], a[224:227], v[128:131]
v_mfma_f32_16x16x32_bf16 v[132:135], a[196:199], a[224:227], v[132:135]
v_add_u32 v201, 4294852608, v201
v_mfma_f32_16x16x32_bf16 v[136:139], a[200:203], a[224:227], v[136:139]
v_mfma_f32_16x16x32_bf16 v[140:143], a[204:207], a[224:227], v[140:143]
v_add_u32 v202, 4294852608, v202
v_mfma_f32_16x16x32_bf16 v[144:147], a[208:211], a[224:227], v[144:147]
s_waitcnt lgkmcnt(3)
v_mfma_f32_16x16x32_bf16 v[148:151], a[212:215], a[224:227], v[148:151]
v_add_u32 v203, 4294852608, v203
v_mfma_f32_16x16x32_bf16 v[152:155], a[216:219], a[224:227], v[152:155]
s_waitcnt lgkmcnt(2)
v_mfma_f32_16x16x32_bf16 v[156:159], a[220:223], a[224:227], v[156:159]
s_waitcnt vmcnt(22) lgkmcnt(0)
s_barrier
ds_read_b128 a[224:227], v203 offset:0
v_mfma_f32_16x16x32_bf16 v[224:227], a[192:195], a[228:231], v[224:227]
v_mfma_f32_16x16x32_bf16 v[228:231], a[196:199], a[228:231], v[228:231]
s_add_u32 m0, s44, 131072
v_mfma_f32_16x16x32_bf16 v[232:235], a[200:203], a[228:231], v[232:235]
ds_read_b128 a[160:163], v201 offset:0
v_mfma_f32_16x16x32_bf16 v[236:239], a[204:207], a[228:231], v[236:239]
buffer_load_dwordx4 v204, s[24:27], s39 offen lds
v_mfma_f32_16x16x32_bf16 v[240:243], a[208:211], a[228:231], v[240:243]
v_mfma_f32_16x16x32_bf16 v[244:247], a[212:215], a[228:231], v[244:247]
v_mfma_f32_16x16x32_bf16 v[248:251], a[216:219], a[228:231], v[248:251]
v_mfma_f32_16x16x32_bf16 v[252:255], a[220:223], a[228:231], v[252:255]
ds_read_b128 a[228:231], v203 offset:6144
ds_read_b128 a[164:167], v201 offset:1024
v_mfma_f32_16x16x32_bf16 v[0:3], a[232:235], a[192:195], v[0:3]
buffer_load_dwordx4 v205, s[24:27], s39 offen offset:1024 lds
T_a_7:
s_cbranch_execz T_a_q
v_mfma_f32_16x16x32_bf16 v[4:7], a[232:235], a[196:199], v[4:7]
s_add_u32 s39, s39, 294912
v_mfma_f32_16x16x32_bf16 v[8:11], a[232:235], a[200:203], v[8:11]
v_mfma_f32_16x16x32_bf16 v[12:15], a[232:235], a[204:207], v[12:15]
s_add_u32 m0, s44, 133120
v_mfma_f32_16x16x32_bf16 v[16:19], a[232:235], a[208:211], v[16:19]
ds_read_b128 a[168:171], v201 offset:2048
v_mfma_f32_16x16x32_bf16 v[20:23], a[232:235], a[212:215], v[20:23]
buffer_load_dwordx4 v206, s[28:31], s40 offen lds
v_mfma_f32_16x16x32_bf16 v[24:27], a[232:235], a[216:219], v[24:27]
s_add_u32 s40, s40, s41
v_mfma_f32_16x16x32_bf16 v[28:31], a[232:235], a[220:223], v[28:31]
ds_read_b64_tr_b16 a[232:233], v202 offset:0
v_mfma_f32_16x16x32_bf16 a[0:3], a[236:239], a[192:195], a[0:3]
ds_read_b64_tr_b16 a[234:235], v202 offset:2560
v_mfma_f32_16x16x32_bf16 a[4:7], a[236:239], a[196:199], a[4:7]
s_add_u32 m0, s43, 114688
ds_read_b128 a[172:175], v201 offset:3072
v_mfma_f32_16x16x32_bf16 a[8:11], a[236:239], a[200:203], a[8:11]
buffer_load_dwordx4 v200, s[20:23], s38 offen offset:0 sc1 lds
v_mfma_f32_16x16x32_bf16 a[12:15], a[236:239], a[204:207], a[12:15]
v_mfma_f32_16x16x32_bf16 a[16:19], a[236:239], a[208:211], a[16:19]
v_mfma_f32_16x16x32_bf16 a[20:23], a[236:239], a[212:215], a[20:23]
v_mfma_f32_16x16x32_bf16 a[24:27], a[236:239], a[216:219], a[24:27]
ds_read_b128 a[176:179], v201 offset:4096
v_mfma_f32_16x16x32_bf16 a[28:31], a[236:239], a[220:223], a[28:31]
ds_read_b64_tr_b16 a[236:237], v202 offset:6144
v_mfma_f32_16x16x32_bf16 v[32:35], a[240:243], a[192:195], v[32:35]
buffer_load_dwordx4 v200, s[20:23], s38 offen offset:1024 sc1 lds
v_mfma_f32_16x16x32_bf16 v[36:39], a[240:243], a[196:199], v[36:39]
ds_read_b64_tr_b16 a[238:239], v202 offset:8704
v_mfma_f32_16x16x32_bf16 v[40:43], a[240:243], a[200:203], v[40:43]
v_mfma_f32_16x16x32_bf16 v[44:47], a[240:243], a[204:207], v[44:47]
ds_read_b128 a[180:183], v201 offset:5120
v_mfma_f32_16x16x32_bf16 v[48:51], a[240:243], a[208:211], v[48:51]
v_mfma_f32_16x16x32_bf16 v[52:55], a[240:243], a[212:215], v[52:55]
buffer_load_dwordx4 v200, s[20:23], s38 offen offset:2048 sc1 lds
v_mfma_f32_16x16x32_bf16 v[56:59], a[240:243], a[216:219], v[56:59]
v_mfma_f32_16x16x32_bf16 v[60:63], a[240:243], a[220:223], v[60:63]
ds_read_b64_tr_b16 a[240:241], v202 offset:32
v_mfma_f32_16x16x32_bf16 a[32:35], a[244:247], a[192:195], a[32:35]
ds_read_b64_tr_b16 a[242:243], v202 offset:2592
ds_read_b128 a[184:187], v201 offset:6144
v_mfma_f32_16x16x32_bf16 a[36:39], a[244:247], a[196:199], a[36:39]
v_mfma_f32_16x16x32_bf16 a[40:43], a[244:247], a[200:203], a[40:43]
buffer_load_dwordx4 v200, s[20:23], s38 offen offset:3072 sc1 lds
v_mfma_f32_16x16x32_bf16 a[44:47], a[244:247], a[204:207], a[44:47]
s_add_u32 s38, s38, 16384
v_mfma_f32_16x16x32_bf16 a[48:51], a[244:247], a[208:211], a[48:51]
v_mfma_f32_16x16x32_bf16 a[52:55], a[244:247], a[212:215], a[52:55]
ds_read_b128 a[188:191], v201 offset:7168
v_mfma_f32_16x16x32_bf16 a[56:59], a[244:247], a[216:219], a[56:59]
v_mfma_f32_16x16x32_bf16 a[60:63], a[244:247], a[220:223], a[60:63]
s_waitcnt lgkmcnt(5)
ds_read_b64_tr_b16 a[244:245], v202 offset:6176
ds_read_b64_tr_b16 a[246:247], v202 offset:8736
v_mfma_f32_16x16x32_bf16 v[128:131], a[160:163], a[224:227], v[128:131]
v_mfma_f32_16x16x32_bf16 v[132:135], a[164:167], a[224:227], v[132:135]
v_mfma_f32_16x16x32_bf16 v[136:139], a[168:171], a[224:227], v[136:139]
v_mfma_f32_16x16x32_bf16 v[140:143], a[172:175], a[224:227], v[140:143]
v_mfma_f32_16x16x32_bf16 v[144:147], a[176:179], a[224:227], v[144:147]
s_waitcnt lgkmcnt(5)
v_mfma_f32_16x16x32_bf16 v[148:151], a[180:183], a[224:227], v[148:151]
s_waitcnt lgkmcnt(3)
v_mfma_f32_16x16x32_bf16 v[152:155], a[184:187], a[224:227], v[152:155]
s_waitcnt lgkmcnt(2)
v_mfma_f32_16x16x32_bf16 v[156:159], a[188:191], a[224:227], v[156:159]
s_waitcnt vmcnt(21) lgkmcnt(0)
s_barrier
ds_read_b128 a[224:227], v203 offset:28672
v_mfma_f32_16x16x32_bf16 v[224:227], a[160:163], a[228:231], v[224:227]
v_mfma_f32_16x16x32_bf16 v[228:231], a[164:167], a[228:231], v[228:231]
s_add_u32 m0, s44, 16384
v_mfma_f32_16x16x32_bf16 v[232:235], a[168:171], a[228:231], v[232:235]
ds_read_b128 a[192:195], v201 offset:28672
v_mfma_f32_16x16x32_bf16 v[236:239], a[172:175], a[228:231], v[236:239]
buffer_load_dwordx4 v204, s[24:27], s39 offen lds
v_mfma_f32_16x16x32_bf16 v[240:243], a[176:179], a[228:231], v[240:243]
v_mfma_f32_16x16x32_bf16 v[244:247], a[180:183], a[228:231], v[244:247]
v_mfma_f32_16x16x32_bf16 v[248:251], a[184:187], a[228:231], v[248:251]
v_mfma_f32_16x16x32_bf16 v[252:255], a[188:191], a[228:231], v[252:255]
ds_read_b128 a[228:231], v203 offset:34816
ds_read_b128 a[196:199], v201 offset:29696
v_mfma_f32_16x16x32_bf16 v[0:3], a[232:235], a[160:163], v[0:3]
buffer_load_dwordx4 v205, s[24:27], s39 offen offset:1024 lds
v_mfma_f32_16x16x32_bf16 v[4:7], a[232:235], a[164:167], v[4:7]
s_add_u32 s39, s39, 294912
v_mfma_f32_16x16x32_bf16 v[8:11], a[232:235], a[168:171], v[8:11]
v_mfma_f32_16x16x32_bf16 v[12:15], a[232:235], a[172:175], v[12:15]
s_add_u32 m0, s44, 18432
v_mfma_f32_16x16x32_bf16 v[16:19], a[232:235], a[176:179], v[16:19]
ds_read_b128 a[200:203], v201 offset:30720
v_mfma_f32_16x16x32_bf16 v[20:23], a[232:235], a[180:183], v[20:23]
buffer_load_dwordx4 v206, s[28:31], s40 offen lds
v_mfma_f32_16x16x32_bf16 v[24:27], a[232:235], a[184:187], v[24:27]
s_add_u32 s40, s40, s41
v_mfma_f32_16x16x32_bf16 v[28:31], a[232:235], a[188:191], v[28:31]
ds_read_b64_tr_b16 a[232:233], v202 offset:28672
v_mfma_f32_16x16x32_bf16 a[0:3], a[236:239], a[160:163], a[0:3]
ds_read_b64_tr_b16 a[234:235], v202 offset:31232
v_mfma_f32_16x16x32_bf16 a[4:7], a[236:239], a[164:167], a[4:7]
s_add_u32 m0, s43, 0
ds_read_b128 a[204:207], v201 offset:31744
v_mfma_f32_16x16x32_bf16 a[8:11], a[236:239], a[168:171], a[8:11]
buffer_load_dwordx4 v200, s[20:23], s38 offen offset:0 sc1 lds
v_mfma_f32_16x16x32_bf16 a[12:15], a[236:239], a[172:175], a[12:15]
v_mfma_f32_16x16x32_bf16 a[16:19], a[236:239], a[176:179], a[16:19]
v_mfma_f32_16x16x32_bf16 a[20:23], a[236:239], a[180:183], a[20:23]
v_mfma_f32_16x16x32_bf16 a[24:27], a[236:239], a[184:187], a[24:27]
ds_read_b128 a[208:211], v201 offset:32768
v_mfma_f32_16x16x32_bf16 a[28:31], a[236:239], a[188:191], a[28:31]
ds_read_b64_tr_b16 a[236:237], v202 offset:34816
v_mfma_f32_16x16x32_bf16 v[32:35], a[240:243], a[160:163], v[32:35]
buffer_load_dwordx4 v200, s[20:23], s38 offen offset:1024 sc1 lds
v_mfma_f32_16x16x32_bf16 v[36:39], a[240:243], a[164:167], v[36:39]
ds_read_b64_tr_b16 a[238:239], v202 offset:37376
v_mfma_f32_16x16x32_bf16 v[40:43], a[240:243], a[168:171], v[40:43]
v_mfma_f32_16x16x32_bf16 v[44:47], a[240:243], a[172:175], v[44:47]
ds_read_b128 a[212:215], v201 offset:33792
v_mfma_f32_16x16x32_bf16 v[48:51], a[240:243], a[176:179], v[48:51]
v_mfma_f32_16x16x32_bf16 v[52:55], a[240:243], a[180:183], v[52:55]
buffer_load_dwordx4 v200, s[20:23], s38 offen offset:2048 sc1 lds
v_mfma_f32_16x16x32_bf16 v[56:59], a[240:243], a[184:187], v[56:59]
v_mfma_f32_16x16x32_bf16 v[60:63], a[240:243], a[188:191], v[60:63]
ds_read_b64_tr_b16 a[240:241], v202 offset:28704
v_mfma_f32_16x16x32_bf16 a[32:35], a[244:247], a[160:163], a[32:35]
ds_read_b64_tr_b16 a[242:243], v202 offset:31264
ds_read_b128 a[216:219], v201 offset:34816
v_mfma_f32_16x16x32_bf16 a[36:39], a[244:247], a[164:167], a[36:39]
v_mfma_f32_16x16x32_bf16 a[40:43], a[244:247], a[168:171], a[40:43]
buffer_load_dwordx4 v200, s[20:23], s38 offen offset:3072 sc1 lds
v_mfma_f32_16x16x32_bf16 a[44:47], a[244:247], a[172:175], a[44:47]
s_add_u32 s38, s38, 16384
v_mfma_f32_16x16x32_bf16 a[48:51], a[244:247], a[176:179], a[48:51]
v_mfma_f32_16x16x32_bf16 a[52:55], a[244:247], a[180:183], a[52:55]
ds_read_b128 a[220:223], v201 offset:35840
v_mfma_f32_16x16x32_bf16 a[56:59], a[244:247], a[184:187], a[56:59]
v_mfma_f32_16x16x32_bf16 a[60:63], a[244:247], a[188:191], a[60:63]
s_waitcnt lgkmcnt(5)
ds_read_b64_tr_b16 a[244:245], v202 offset:34848
ds_read_b64_tr_b16 a[246:247], v202 offset:37408
v_mfma_f32_16x16x32_bf16 v[128:131], a[192:195], a[224:227], v[128:131]
v_mfma_f32_16x16x32_bf16 v[132:135], a[196:199], a[224:227], v[132:135]
v_add_u32 v201, 57344, v201
v_mfma_f32_16x16x32_bf16 v[136:139], a[200:203], a[224:227], v[136:139]
v_mfma_f32_16x16x32_bf16 v[140:143], a[204:207], a[224:227], v[140:143]
v_add_u32 v202, 57344, v202
v_mfma_f32_16x16x32_bf16 v[144:147], a[208:211], a[224:227], v[144:147]
s_waitcnt lgkmcnt(3)
v_mfma_f32_16x16x32_bf16 v[148:151], a[212:215], a[224:227], v[148:151]
v_add_u32 v203, 57344, v203
v_mfma_f32_16x16x32_bf16 v[152:155], a[216:219], a[224:227], v[152:155]
s_waitcnt lgkmcnt(2)
v_mfma_f32_16x16x32_bf16 v[156:159], a[220:223], a[224:227], v[156:159]
s_waitcnt vmcnt(21) lgkmcnt(0)
s_barrier
ds_read_b128 a[224:227], v203 offset:0
v_mfma_f32_16x16x32_bf16 v[224:227], a[192:195], a[228:231], v[224:227]
v_mfma_f32_16x16x32_bf16 v[228:231], a[196:199], a[228:231], v[228:231]
s_add_u32 m0, s44, 45056
v_mfma_f32_16x16x32_bf16 v[232:235], a[200:203], a[228:231], v[232:235]
ds_read_b128 a[160:163], v201 offset:0
v_mfma_f32_16x16x32_bf16 v[236:239], a[204:207], a[228:231], v[236:239]
buffer_load_dwordx4 v204, s[24:27], s39 offen lds
v_mfma_f32_16x16x32_bf16 v[240:243], a[208:211], a[228:231], v[240:243]
v_mfma_f32_16x16x32_bf16 v[244:247], a[212:215], a[228:231], v[244:247]
s_lshl_b32 s6, s13, 1
s_add_u32 s6, s6, s16
v_mfma_f32_16x16x32_bf16 v[248:251], a[216:219], a[228:231], v[248:251]
v_mfma_f32_16x16x32_bf16 v[252:255], a[220:223], a[228:231], v[252:255]
ds_read_b128 a[228:231], v203 offset:6144
ds_read_b128 a[164:167], v201 offset:1024
v_mfma_f32_16x16x32_bf16 v[0:3], a[232:235], a[192:195], v[0:3]
buffer_load_dwordx4 v205, s[24:27], s39 offen offset:1024 lds
v_mfma_f32_16x16x32_bf16 v[4:7], a[232:235], a[196:199], v[4:7]
s_add_u32 s39, s39, 294912
s_mul_i32 s6, s6, 27648
s_mul_i32 s7, s12, 1152
v_mfma_f32_16x16x32_bf16 v[8:11], a[232:235], a[200:203], v[8:11]
s_add_u32 s6, s6, s7
v_min_u32 v197, 176, v200
v_mfma_f32_16x16x32_bf16 v[12:15], a[232:235], a[204:207], v[12:15]
s_add_u32 m0, s44, 47104
v_lshrrev_b32 v198, 6, v197
v_mul_u32_u24 v198, 8704, v198
v_mfma_f32_16x16x32_bf16 v[16:19], a[232:235], a[208:211], v[16:19]
ds_read_b128 a[168:171], v201 offset:2048
v_mfma_f32_16x16x32_bf16 v[20:23], a[232:235], a[212:215], v[20:23]
buffer_load_dwordx4 v206, s[28:31], s40 offen lds
v_mfma_f32_16x16x32_bf16 v[24:27], a[232:235], a[216:219], v[24:27]
s_add_u32 s40, s40, s41
s_add_u32 s97, s6, 3538944
v_lshl_add_u32 v197, v197, 3, v198
v_mfma_f32_16x16x32_bf16 v[28:31], a[232:235], a[220:223], v[28:31]
ds_read_b64_tr_b16 a[232:233], v202 offset:0
v_mfma_f32_16x16x32_bf16 a[0:3], a[236:239], a[192:195], a[0:3]
buffer_load_dword a255, v197, s[24:27], s97 offen offset:640
v_mfma_f32_16x16x32_bf16 a[4:7], a[236:239], a[196:199], a[4:7]
s_add_u32 m0, s43, 28672
ds_read_b64_tr_b16 a[234:235], v202 offset:2560
ds_read_b128 a[172:175], v201 offset:3072
v_mfma_f32_16x16x32_bf16 a[8:11], a[236:239], a[200:203], a[8:11]
buffer_load_dwordx4 v200, s[20:23], s38 offen offset:0 sc1 lds
v_mfma_f32_16x16x32_bf16 a[12:15], a[236:239], a[204:207], a[12:15]
v_mfma_f32_16x16x32_bf16 a[16:19], a[236:239], a[208:211], a[16:19]
v_mfma_f32_16x16x32_bf16 a[20:23], a[236:239], a[212:215], a[20:23]
v_mfma_f32_16x16x32_bf16 a[24:27], a[236:239], a[216:219], a[24:27]
ds_read_b128 a[176:179], v201 offset:4096
v_mfma_f32_16x16x32_bf16 a[28:31], a[236:239], a[220:223], a[28:31]
ds_read_b64_tr_b16 a[236:237], v202 offset:6144
v_mfma_f32_16x16x32_bf16 v[32:35], a[240:243], a[192:195], v[32:35]
buffer_load_dwordx4 v200, s[20:23], s38 offen offset:1024 sc1 lds
v_mfma_f32_16x16x32_bf16 v[36:39], a[240:243], a[196:199], v[36:39]
ds_read_b64_tr_b16 a[238:239], v202 offset:8704
v_mfma_f32_16x16x32_bf16 v[40:43], a[240:243], a[200:203], v[40:43]
v_mfma_f32_16x16x32_bf16 v[44:47], a[240:243], a[204:207], v[44:47]
ds_read_b128 a[180:183], v201 offset:5120
v_mfma_f32_16x16x32_bf16 v[48:51], a[240:243], a[208:211], v[48:51]
v_mfma_f32_16x16x32_bf16 v[52:55], a[240:243], a[212:215], v[52:55]
buffer_load_dwordx4 v200, s[20:23], s38 offen offset:2048 sc1 lds
v_mfma_f32_16x16x32_bf16 v[56:59], a[240:243], a[216:219], v[56:59]
v_mfma_f32_16x16x32_bf16 v[60:63], a[240:243], a[220:223], v[60:63]
ds_read_b64_tr_b16 a[240:241], v202 offset:32
v_mfma_f32_16x16x32_bf16 a[32:35], a[244:247], a[192:195], a[32:35]
ds_read_b64_tr_b16 a[242:243], v202 offset:2592
ds_read_b128 a[184:187], v201 offset:6144
v_mfma_f32_16x16x32_bf16 a[36:39], a[244:247], a[196:199], a[36:39]
v_mfma_f32_16x16x32_bf16 a[40:43], a[244:247], a[200:203], a[40:43]
buffer_load_dwordx4 v200, s[20:23], s38 offen offset:3072 sc1 lds
v_mfma_f32_16x16x32_bf16 a[44:47], a[244:247], a[204:207], a[44:47]
s_add_u32 s38, s38, 16384
v_mfma_f32_16x16x32_bf16 a[48:51], a[244:247], a[208:211], a[48:51]
v_mfma_f32_16x16x32_bf16 a[52:55], a[244:247], a[212:215], a[52:55]
ds_read_b128 a[188:191], v201 offset:7168
v_mfma_f32_16x16x32_bf16 a[56:59], a[244:247], a[216:219], a[56:59]
v_mfma_f32_16x16x32_bf16 a[60:63], a[244:247], a[220:223], a[60:63]
s_waitcnt lgkmcnt(5)
ds_read_b64_tr_b16 a[244:245], v202 offset:6176
ds_read_b64_tr_b16 a[246:247], v202 offset:8736
v_mfma_f32_16x16x32_bf16 v[128:131], a[160:163], a[224:227], v[128:131]
v_mfma_f32_16x16x32_bf16 v[132:135], a[164:167], a[224:227], v[132:135]
v_mfma_f32_16x16x32_bf16 v[136:139], a[168:171], a[224:227], v[136:139]
v_mfma_f32_16x16x32_bf16 v[140:143], a[172:175], a[224:227], v[140:143]
v_mfma_f32_16x16x32_bf16 v[144:147], a[176:179], a[224:227], v[144:147]
s_waitcnt lgkmcnt(5)
v_mfma_f32_16x16x32_bf16 v[148:151], a[180:183], a[224:227], v[148:151]
s_waitcnt lgkmcnt(3)
v_mfma_f32_16x16x32_bf16 v[152:155], a[184:187], a[224:227], v[152:155]
s_waitcnt lgkmcnt(2)
v_mfma_f32_16x16x32_bf16 v[156:159], a[188:191], a[224:227], v[156:159]
s_waitcnt vmcnt(22) lgkmcnt(0)
s_barrier
ds_read_b128 a[224:227], v203 offset:28672
v_mfma_f32_16x16x32_bf16 v[224:227], a[160:163], a[228:231], v[224:227]
v_mfma_f32_16x16x32_bf16 v[228:231], a[164:167], a[228:231], v[228:231]
s_add_u32 m0, s44, 73728
v_mfma_f32_16x16x32_bf16 v[232:235], a[168:171], a[228:231], v[232:235]
ds_read_b128 a[192:195], v201 offset:28672
v_mfma_f32_16x16x32_bf16 v[236:239], a[172:175], a[228:231], v[236:239]
buffer_load_dwordx4 v204, s[24:27], s39 offen lds
v_mfma_f32_16x16x32_bf16 v[240:243], a[176:179], a[228:231], v[240:243]
v_mfma_f32_16x16x32_bf16 v[244:247], a[180:183], a[228:231], v[244:247]
v_mfma_f32_16x16x32_bf16 v[248:251], a[184:187], a[228:231], v[248:251]
v_mfma_f32_16x16x32_bf16 v[252:255], a[188:191], a[228:231], v[252:255]
ds_read_b128 a[228:231], v203 offset:34816
ds_read_b128 a[196:199], v201 offset:29696
v_mfma_f32_16x16x32_bf16 v[0:3], a[232:235], a[160:163], v[0:3]
buffer_load_dwordx4 v205, s[24:27], s39 offen offset:1024 lds
v_mfma_f32_16x16x32_bf16 v[4:7], a[232:235], a[164:167], v[4:7]
s_add_u32 s39, s39, 294912
v_mfma_f32_16x16x32_bf16 v[8:11], a[232:235], a[168:171], v[8:11]
v_mfma_f32_16x16x32_bf16 v[12:15], a[232:235], a[172:175], v[12:15]
s_add_u32 m0, s44, 75776
v_mfma_f32_16x16x32_bf16 v[16:19], a[232:235], a[176:179], v[16:19]
ds_read_b128 a[200:203], v201 offset:30720
v_mfma_f32_16x16x32_bf16 v[20:23], a[232:235], a[180:183], v[20:23]
buffer_load_dwordx4 v206, s[28:31], s40 offen lds
v_mfma_f32_16x16x32_bf16 v[24:27], a[232:235], a[184:187], v[24:27]
s_add_u32 s40, s40, s41
v_mfma_f32_16x16x32_bf16 v[28:31], a[232:235], a[188:191], v[28:31]
ds_read_b64_tr_b16 a[232:233], v202 offset:28672
v_mfma_f32_16x16x32_bf16 a[0:3], a[236:239], a[160:163], a[0:3]
ds_read_b64_tr_b16 a[234:235], v202 offset:31232
v_mfma_f32_16x16x32_bf16 a[4:7], a[236:239], a[164:167], a[4:7]
s_add_u32 m0, s43, 57344
ds_read_b128 a[204:207], v201 offset:31744
v_mfma_f32_16x16x32_bf16 a[8:11], a[236:239], a[168:171], a[8:11]
buffer_load_dwordx4 v200, s[20:23], s38 offen offset:0 sc1 lds
v_mfma_f32_16x16x32_bf16 a[12:15], a[236:239], a[172:175], a[12:15]
v_mfma_f32_16x16x32_bf16 a[16:19], a[236:239], a[176:179], a[16:19]
v_mfma_f32_16x16x32_bf16 a[20:23], a[236:239], a[180:183], a[20:23]
v_mfma_f32_16x16x32_bf16 a[24:27], a[236:239], a[184:187], a[24:27]
ds_read_b128 a[208:211], v201 offset:32768
v_mfma_f32_16x16x32_bf16 a[28:31], a[236:239], a[188:191], a[28:31]
ds_read_b64_tr_b16 a[236:237], v202 offset:34816
v_mfma_f32_16x16x32_bf16 v[32:35], a[240:243], a[160:163], v[32:35]
buffer_load_dwordx4 v200, s[20:23], s38 offen offset:1024 sc1 lds
v_mfma_f32_16x16x32_bf16 v[36:39], a[240:243], a[164:167], v[36:39]
ds_read_b64_tr_b16 a[238:239], v202 offset:37376
v_mfma_f32_16x16x32_bf16 v[40:43], a[240:243], a[168:171], v[40:43]
v_mfma_f32_16x16x32_bf16 v[44:47], a[240:243], a[172:175], v[44:47]
ds_read_b128 a[212:215], v201 offset:33792
v_mfma_f32_16x16x32_bf16 v[48:51], a[240:243], a[176:179], v[48:51]
v_mfma_f32_16x16x32_bf16 v[52:55], a[240:243], a[180:183], v[52:55]
buffer_load_dwordx4 v200, s[20:23], s38 offen offset:2048 sc1 lds
v_mfma_f32_16x16x32_bf16 v[56:59], a[240:243], a[184:187], v[56:59]
v_mfma_f32_16x16x32_bf16 v[60:63], a[240:243], a[188:191], v[60:63]
ds_read_b64_tr_b16 a[240:241], v202 offset:28704
v_mfma_f32_16x16x32_bf16 a[32:35], a[244:247], a[160:163], a[32:35]
ds_read_b64_tr_b16 a[242:243], v202 offset:31264
ds_read_b128 a[216:219], v201 offset:34816
v_mfma_f32_16x16x32_bf16 a[36:39], a[244:247], a[164:167], a[36:39]
v_mfma_f32_16x16x32_bf16 a[40:43], a[244:247], a[168:171], a[40:43]
buffer_load_dwordx4 v200, s[20:23], s38 offen offset:3072 sc1 lds
v_mfma_f32_16x16x32_bf16 a[44:47], a[244:247], a[172:175], a[44:47]
s_add_u32 s38, s38, 16384
v_mfma_f32_16x16x32_bf16 a[48:51], a[244:247], a[176:179], a[48:51]
v_mfma_f32_16x16x32_bf16 a[52:55], a[244:247], a[180:183], a[52:55]
ds_read_b128 a[220:223], v201 offset:35840
v_mfma_f32_16x16x32_bf16 a[56:59], a[244:247], a[184:187], a[56:59]
v_mfma_f32_16x16x32_bf16 a[60:63], a[244:247], a[188:191], a[60:63]
s_waitcnt lgkmcnt(5)
ds_read_b64_tr_b16 a[244:245], v202 offset:34848
ds_read_b64_tr_b16 a[246:247], v202 offset:37408
v_mfma_f32_16x16x32_bf16 v[128:131], a[192:195], a[224:227], v[128:131]
v_mfma_f32_16x16x32_bf16 v[132:135], a[196:199], a[224:227], v[132:135]
v_add_u32 v201, 57344, v201
v_mfma_f32_16x16x32_bf16 v[136:139], a[200:203], a[224:227], v[136:139]
v_mfma_f32_16x16x32_bf16 v[140:143], a[204:207], a[224:227], v[140:143]
v_add_u32 v202, 57344, v202
v_mfma_f32_16x16x32_bf16 v[144:147], a[208:211], a[224:227], v[144:147]
s_waitcnt lgkmcnt(3)
v_mfma_f32_16x16x32_bf16 v[148:151], a[212:215], a[224:227], v[148:151]
v_add_u32 v203, 57344, v203
v_mfma_f32_16x16x32_bf16 v[152:155], a[216:219], a[224:227], v[152:155]
s_waitcnt lgkmcnt(2)
v_mfma_f32_16x16x32_bf16 v[156:159], a[220:223], a[224:227], v[156:159]
s_waitcnt vmcnt(22) lgkmcnt(0)
s_barrier
ds_read_b128 a[224:227], v203 offset:0
v_mfma_f32_16x16x32_bf16 v[224:227], a[192:195], a[228:231], v[224:227]
v_mfma_f32_16x16x32_bf16 v[228:231], a[196:199], a[228:231], v[228:231]
s_add_u32 m0, s44, 102400
v_mfma_f32_16x16x32_bf16 v[232:235], a[200:203], a[228:231], v[232:235]
ds_read_b128 a[160:163], v201 offset:0
v_mfma_f32_16x16x32_bf16 v[236:239], a[204:207], a[228:231], v[236:239]
buffer_load_dwordx4 v204, s[24:27], s39 offen lds
v_mfma_f32_16x16x32_bf16 v[240:243], a[208:211], a[228:231], v[240:243]
v_mfma_f32_16x16x32_bf16 v[244:247], a[212:215], a[228:231], v[244:247]
v_mfma_f32_16x16x32_bf16 v[248:251], a[216:219], a[228:231], v[248:251]
v_mfma_f32_16x16x32_bf16 v[252:255], a[220:223], a[228:231], v[252:255]
ds_read_b128 a[228:231], v203 offset:6144
ds_read_b128 a[164:167], v201 offset:1024
v_mfma_f32_16x16x32_bf16 v[0:3], a[232:235], a[192:195], v[0:3]
buffer_load_dwordx4 v205, s[24:27], s39 offen offset:1024 lds
v_mfma_f32_16x16x32_bf16 v[4:7], a[232:235], a[196:199], v[4:7]
s_add_u32 s39, s39, 294912
v_mfma_f32_16x16x32_bf16 v[8:11], a[232:235], a[200:203], v[8:11]
v_mfma_f32_16x16x32_bf16 v[12:15], a[232:235], a[204:207], v[12:15]
s_add_u32 m0, s44, 104448
v_mfma_f32_16x16x32_bf16 v[16:19], a[232:235], a[208:211], v[16:19]
ds_read_b128 a[168:171], v201 offset:2048
v_mfma_f32_16x16x32_bf16 v[20:23], a[232:235], a[212:215], v[20:23]
buffer_load_dwordx4 v206, s[28:31], s40 offen lds
v_mfma_f32_16x16x32_bf16 v[24:27], a[232:235], a[216:219], v[24:27]
s_add_u32 s40, s40, s41
v_mfma_f32_16x16x32_bf16 v[28:31], a[232:235], a[220:223], v[28:31]
ds_read_b64_tr_b16 a[232:233], v202 offset:0
v_mfma_f32_16x16x32_bf16 a[0:3], a[236:239], a[192:195], a[0:3]
ds_read_b64_tr_b16 a[234:235], v202 offset:2560
v_mfma_f32_16x16x32_bf16 a[4:7], a[236:239], a[196:199], a[4:7]
s_add_u32 m0, s43, 86016
ds_read_b128 a[172:175], v201 offset:3072
v_mfma_f32_16x16x32_bf16 a[8:11], a[236:239], a[200:203], a[8:11]
buffer_load_dwordx4 v200, s[20:23], s38 offen offset:0 sc1 lds
v_mfma_f32_16x16x32_bf16 a[12:15], a[236:239], a[204:207], a[12:15]
v_mfma_f32_16x16x32_bf16 a[16:19], a[236:239], a[208:211], a[16:19]
v_mfma_f32_16x16x32_bf16 a[20:23], a[236:239], a[212:215], a[20:23]
v_mfma_f32_16x16x32_bf16 a[24:27], a[236:239], a[216:219], a[24:27]
ds_read_b128 a[176:179], v201 offset:4096
v_mfma_f32_16x16x32_bf16 a[28:31], a[236:239], a[220:223], a[28:31]
ds_read_b64_tr_b16 a[236:237], v202 offset:6144
v_mfma_f32_16x16x32_bf16 v[32:35], a[240:243], a[192:195], v[32:35]
buffer_load_dwordx4 v200, s[20:23], s38 offen offset:1024 sc1 lds
v_mfma_f32_16x16x32_bf16 v[36:39], a[240:243], a[196:199], v[36:39]
ds_read_b64_tr_b16 a[238:239], v202 offset:8704
v_mfma_f32_16x16x32_bf16 v[40:43], a[240:243], a[200:203], v[40:43]
v_mfma_f32_16x16x32_bf16 v[44:47], a[240:243], a[204:207], v[44:47]
ds_read_b128 a[180:183], v201 offset:5120
v_mfma_f32_16x16x32_bf16 v[48:51], a[240:243], a[208:211], v[48:51]
v_mfma_f32_16x16x32_bf16 v[52:55], a[240:243], a[212:215], v[52:55]
buffer_load_dwordx4 v200, s[20:23], s38 offen offset:2048 sc1 lds
v_mfma_f32_16x16x32_bf16 v[56:59], a[240:243], a[216:219], v[56:59]
v_mfma_f32_16x16x32_bf16 v[60:63], a[240:243], a[220:223], v[60:63]
ds_read_b64_tr_b16 a[240:241], v202 offset:32
v_mfma_f32_16x16x32_bf16 a[32:35], a[244:247], a[192:195], a[32:35]
ds_read_b64_tr_b16 a[242:243], v202 offset:2592
ds_read_b128 a[184:187], v201 offset:6144
v_mfma_f32_16x16x32_bf16 a[36:39], a[244:247], a[196:199], a[36:39]
v_mfma_f32_16x16x32_bf16 a[40:43], a[244:247], a[200:203], a[40:43]
buffer_load_dwordx4 v200, s[20:23], s38 offen offset:3072 sc1 lds
v_mfma_f32_16x16x32_bf16 a[44:47], a[244:247], a[204:207], a[44:47]
s_add_u32 s38, s38, 16384
v_mfma_f32_16x16x32_bf16 a[48:51], a[244:247], a[208:211], a[48:51]
v_mfma_f32_16x16x32_bf16 a[52:55], a[244:247], a[212:215], a[52:55]
ds_read_b128 a[188:191], v201 offset:7168
v_mfma_f32_16x16x32_bf16 a[56:59], a[244:247], a[216:219], a[56:59]
v_mfma_f32_16x16x32_bf16 a[60:63], a[244:247], a[220:223], a[60:63]
s_waitcnt lgkmcnt(5)
ds_read_b64_tr_b16 a[244:245], v202 offset:6176
ds_read_b64_tr_b16 a[246:247], v202 offset:8736
v_mfma_f32_16x16x32_bf16 v[128:131], a[160:163], a[224:227], v[128:131]
v_mfma_f32_16x16x32_bf16 v[132:135], a[164:167], a[224:227], v[132:135]
v_add_u32 v201, 4294852608, v201
v_mfma_f32_16x16x32_bf16 v[136:139], a[168:171], a[224:227], v[136:139]
v_mfma_f32_16x16x32_bf16 v[140:143], a[172:175], a[224:227], v[140:143]
v_add_u32 v202, 4294852608, v202
v_mfma_f32_16x16x32_bf16 v[144:147], a[176:179], a[224:227], v[144:147]
s_waitcnt lgkmcnt(3)
v_mfma_f32_16x16x32_bf16 v[148:151], a[180:183], a[224:227], v[148:151]
v_add_u32 v203, 4294852608, v203
v_mfma_f32_16x16x32_bf16 v[152:155], a[184:187], a[224:227], v[152:155]
s_waitcnt lgkmcnt(2)
v_mfma_f32_16x16x32_bf16 v[156:159], a[188:191], a[224:227], v[156:159]
s_waitcnt vmcnt(22) lgkmcnt(0)
s_barrier
ds_read_b128 a[224:227], v203 offset:0
v_mfma_f32_16x16x32_bf16 v[224:227], a[160:163], a[228:231], v[224:227]
v_mfma_f32_16x16x32_bf16 v[228:231], a[164:167], a[228:231], v[228:231]
s_add_u32 m0, s44, 131072
v_mfma_f32_16x16x32_bf16 v[232:235], a[168:171], a[228:231], v[232:235]
ds_read_b128 a[192:195], v201 offset:0
v_mfma_f32_16x16x32_bf16 v[236:239], a[172:175], a[228:231], v[236:239]
buffer_load_dwordx4 v204, s[24:27], s39 offen lds
v_mfma_f32_16x16x32_bf16 v[240:243], a[176:179], a[228:231], v[240:243]
v_mfma_f32_16x16x32_bf16 v[244:247], a[180:183], a[228:231], v[244:247]
v_mfma_f32_16x16x32_bf16 v[248:251], a[184:187], a[228:231], v[248:251]
v_mfma_f32_16x16x32_bf16 v[252:255], a[188:191], a[228:231], v[252:255]
ds_read_b128 a[228:231], v203 offset:6144
ds_read_b128 a[196:199], v201 offset:1024
v_mfma_f32_16x16x32_bf16 v[0:3], a[232:235], a[160:163], v[0:3]
buffer_load_dwordx4 v205, s[24:27], s39 offen offset:1024 lds
v_mfma_f32_16x16x32_bf16 v[4:7], a[232:235], a[164:167], v[4:7]
s_add_u32 s39, s39, 294912
v_mfma_f32_16x16x32_bf16 v[8:11], a[232:235], a[168:171], v[8:11]
v_mfma_f32_16x16x32_bf16 v[12:15], a[232:235], a[172:175], v[12:15]
s_add_u32 m0, s44, 133120
v_mfma_f32_16x16x32_bf16 v[16:19], a[232:235], a[176:179], v[16:19]
ds_read_b128 a[200:203], v201 offset:2048
v_mfma_f32_16x16x32_bf16 v[20:23], a[232:235], a[180:183], v[20:23]
buffer_load_dwordx4 v206, s[28:31], s40 offen lds
v_mfma_f32_16x16x32_bf16 v[24:27], a[232:235], a[184:187], v[24:27]
s_add_u32 s40, s40, s41
s_sub_u32 s97, s97, 1769472
v_mfma_f32_16x16x32_bf16 v[28:31], a[232:235], a[188:191], v[28:31]
ds_read_b64_tr_b16 a[232:233], v202 offset:0
v_mfma_f32_16x16x32_bf16 a[0:3], a[236:239], a[160:163], a[0:3]
buffer_load_dword a255, v197, s[24:27], s97 offen offset:640
v_mfma_f32_16x16x32_bf16 a[4:7], a[236:239], a[164:167], a[4:7]
s_add_u32 m0, s43, 114688
ds_read_b64_tr_b16 a[234:235], v202 offset:2560
ds_read_b128 a[204:207], v201 offset:3072
v_mfma_f32_16x16x32_bf16 a[8:11], a[236:239], a[168:171], a[8:11]
buffer_load_dwordx4 v200, s[20:23], s38 offen offset:0 sc1 lds
v_mfma_f32_16x16x32_bf16 a[12:15], a[236:239], a[172:175], a[12:15]
v_mfma_f32_16x16x32_bf16 a[16:19], a[236:239], a[176:179], a[16:19]
v_mfma_f32_16x16x32_bf16 a[20:23], a[236:239], a[180:183], a[20:23]
v_mfma_f32_16x16x32_bf16 a[24:27], a[236:239], a[184:187], a[24:27]
ds_read_b128 a[208:211], v201 offset:4096
v_mfma_f32_16x16x32_bf16 a[28:31], a[236:239], a[188:191], a[28:31]
ds_read_b64_tr_b16 a[236:237], v202 offset:6144
v_mfma_f32_16x16x32_bf16 v[32:35], a[240:243], a[160:163], v[32:35]
buffer_load_dwordx4 v200, s[20:23], s38 offen offset:1024 sc1 lds
v_mfma_f32_16x16x32_bf16 v[36:39], a[240:243], a[164:167], v[36:39]
ds_read_b64_tr_b16 a[238:239], v202 offset:8704
v_mfma_f32_16x16x32_bf16 v[40:43], a[240:243], a[168:171], v[40:43]
v_mfma_f32_16x16x32_bf16 v[44:47], a[240:243], a[172:175], v[44:47]
ds_read_b128 a[212:215], v201 offset:5120
v_mfma_f32_16x16x32_bf16 v[48:51], a[240:243], a[176:179], v[48:51]
v_mfma_f32_16x16x32_bf16 v[52:55], a[240:243], a[180:183], v[52:55]
buffer_load_dwordx4 v200, s[20:23], s38 offen offset:2048 sc1 lds
v_mfma_f32_16x16x32_bf16 v[56:59], a[240:243], a[184:187], v[56:59]
v_mfma_f32_16x16x32_bf16 v[60:63], a[240:243], a[188:191], v[60:63]
ds_read_b64_tr_b16 a[240:241], v202 offset:32
v_mfma_f32_16x16x32_bf16 a[32:35], a[244:247], a[160:163], a[32:35]
ds_read_b64_tr_b16 a[242:243], v202 offset:2592
ds_read_b128 a[216:219], v201 offset:6144
v_mfma_f32_16x16x32_bf16 a[36:39], a[244:247], a[164:167], a[36:39]
v_mfma_f32_16x16x32_bf16 a[40:43], a[244:247], a[168:171], a[40:43]
buffer_load_dwordx4 v200, s[20:23], s38 offen offset:3072 sc1 lds
v_mfma_f32_16x16x32_bf16 a[44:47], a[244:247], a[172:175], a[44:47]
s_add_u32 s38, s38, 16384
v_mfma_f32_16x16x32_bf16 a[48:51], a[244:247], a[176:179], a[48:51]
v_mfma_f32_16x16x32_bf16 a[52:55], a[244:247], a[180:183], a[52:55]
ds_read_b128 a[220:223], v201 offset:7168
v_mfma_f32_16x16x32_bf16 a[56:59], a[244:247], a[184:187], a[56:59]
v_mfma_f32_16x16x32_bf16 a[60:63], a[244:247], a[188:191], a[60:63]
s_waitcnt lgkmcnt(5)
ds_read_b64_tr_b16 a[244:245], v202 offset:6176
ds_read_b64_tr_b16 a[246:247], v202 offset:8736
v_mfma_f32_16x16x32_bf16 v[128:131], a[192:195], a[224:227], v[128:131]
v_mfma_f32_16x16x32_bf16 v[132:135], a[196:199], a[224:227], v[132:135]
v_mfma_f32_16x16x32_bf16 v[136:139], a[200:203], a[224:227], v[136:139]
v_mfma_f32_16x16x32_bf16 v[140:143], a[204:207], a[224:227], v[140:143]
v_mfma_f32_16x16x32_bf16 v[144:147], a[208:211], a[224:227], v[144:147]
s_waitcnt lgkmcnt(5)
v_mfma_f32_16x16x32_bf16 v[148:151], a[212:215], a[224:227], v[148:151]
s_waitcnt lgkmcnt(3)
v_mfma_f32_16x16x32_bf16 v[152:155], a[216:219], a[224:227], v[152:155]
s_waitcnt lgkmcnt(2)
v_mfma_f32_16x16x32_bf16 v[156:159], a[220:223], a[224:227], v[156:159]
s_waitcnt vmcnt(22) lgkmcnt(0)
s_barrier
ds_read_b128 a[224:227], v203 offset:28672
v_mfma_f32_16x16x32_bf16 v[224:227], a[192:195], a[228:231], v[224:227]
v_mfma_f32_16x16x32_bf16 v[228:231], a[196:199], a[228:231], v[228:231]
s_add_u32 m0, s44, 16384
v_mfma_f32_16x16x32_bf16 v[232:235], a[200:203], a[228:231], v[232:235]
ds_read_b128 a[160:163], v201 offset:28672
v_mfma_f32_16x16x32_bf16 v[236:239], a[204:207], a[228:231], v[236:239]
buffer_load_dwordx4 v204, s[24:27], s39 offen lds
v_mfma_f32_16x16x32_bf16 v[240:243], a[208:211], a[228:231], v[240:243]
v_mfma_f32_16x16x32_bf16 v[244:247], a[212:215], a[228:231], v[244:247]
v_mfma_f32_16x16x32_bf16 v[248:251], a[216:219], a[228:231], v[248:251]
v_mfma_f32_16x16x32_bf16 v[252:255], a[220:223], a[228:231], v[252:255]
ds_read_b128 a[228:231], v203 offset:34816
ds_read_b128 a[164:167], v201 offset:29696
v_mfma_f32_16x16x32_bf16 v[0:3], a[232:235], a[192:195], v[0:3]
buffer_load_dwordx4 v205, s[24:27], s39 offen offset:1024 lds
v_mfma_f32_16x16x32_bf16 v[4:7], a[232:235], a[196:199], v[4:7]
s_add_u32 s39, s39, 294912
v_mfma_f32_16x16x32_bf16 v[8:11], a[232:235], a[200:203], v[8:11]
v_mfma_f32_16x16x32_bf16 v[12:15], a[232:235], a[204:207], v[12:15]
T_a_8:
s_cbranch_execz T_a_r
s_add_u32 m0, s44, 18432
v_mfma_f32_16x16x32_bf16 v[16:19], a[232:235], a[208:211], v[16:19]
ds_read_b128 a[168:171], v201 offset:30720
v_mfma_f32_16x16x32_bf16 v[20:23], a[232:235], a[212:215], v[20:23]
buffer_load_dwordx4 v206, s[28:31], s40 offen lds
v_mfma_f32_16x16x32_bf16 v[24:27], a[232:235], a[216:219], v[24:27]
s_add_u32 s40, s40, s41
v_mfma_f32_16x16x32_bf16 v[28:31], a[232:235], a[220:223], v[28:31]
ds_read_b64_tr_b16 a[232:233], v202 offset:28672
v_mfma_f32_16x16x32_bf16 a[0:3], a[236:239], a[192:195], a[0:3]
ds_read_b64_tr_b16 a[234:235], v202 offset:31232
v_mfma_f32_16x16x32_bf16 a[4:7], a[236:239], a[196:199], a[4:7]
s_add_u32 m0, s43, 0
ds_read_b128 a[172:175], v201 offset:31744
v_mfma_f32_16x16x32_bf16 a[8:11], a[236:239], a[200:203], a[8:11]
buffer_load_dwordx4 v200, s[20:23], s38 offen offset:0 sc1 lds
v_mfma_f32_16x16x32_bf16 a[12:15], a[236:239], a[204:207], a[12:15]
v_mfma_f32_16x16x32_bf16 a[16:19], a[236:239], a[208:211], a[16:19]
v_mfma_f32_16x16x32_bf16 a[20:23], a[236:239], a[212:215], a[20:23]
v_mfma_f32_16x16x32_bf16 a[24:27], a[236:239], a[216:219], a[24:27]
ds_read_b128 a[176:179], v201 offset:32768
v_mfma_f32_16x16x32_bf16 a[28:31], a[236:239], a[220:223], a[28:31]
ds_read_b64_tr_b16 a[236:237], v202 offset:34816
v_mfma_f32_16x16x32_bf16 v[32:35], a[240:243], a[192:195], v[32:35]
buffer_load_dwordx4 v200, s[20:23], s38 offen offset:1024 sc1 lds
v_mfma_f32_16x16x32_bf16 v[36:39], a[240:243], a[196:199], v[36:39]
ds_read_b64_tr_b16 a[238:239], v202 offset:37376
v_mfma_f32_16x16x32_bf16 v[40:43], a[240:243], a[200:203], v[40:43]
v_mfma_f32_16x16x32_bf16 v[44:47], a[240:243], a[204:207], v[44:47]
ds_read_b128 a[180:183], v201 offset:33792
v_mfma_f32_16x16x32_bf16 v[48:51], a[240:243], a[208:211], v[48:51]
v_mfma_f32_16x16x32_bf16 v[52:55], a[240:243], a[212:215], v[52:55]
buffer_load_dwordx4 v200, s[20:23], s38 offen offset:2048 sc1 lds
v_mfma_f32_16x16x32_bf16 v[56:59], a[240:243], a[216:219], v[56:59]
v_mfma_f32_16x16x32_bf16 v[60:63], a[240:243], a[220:223], v[60:63]
ds_read_b64_tr_b16 a[240:241], v202 offset:28704
v_mfma_f32_16x16x32_bf16 a[32:35], a[244:247], a[192:195], a[32:35]
ds_read_b64_tr_b16 a[242:243], v202 offset:31264
ds_read_b128 a[184:187], v201 offset:34816
v_mfma_f32_16x16x32_bf16 a[36:39], a[244:247], a[196:199], a[36:39]
v_mfma_f32_16x16x32_bf16 a[40:43], a[244:247], a[200:203], a[40:43]
buffer_load_dwordx4 v200, s[20:23], s38 offen offset:3072 sc1 lds
v_mfma_f32_16x16x32_bf16 a[44:47], a[244:247], a[204:207], a[44:47]
s_add_u32 s38, s38, 16384
v_mfma_f32_16x16x32_bf16 a[48:51], a[244:247], a[208:211], a[48:51]
v_mfma_f32_16x16x32_bf16 a[52:55], a[244:247], a[212:215], a[52:55]
ds_read_b128 a[188:191], v201 offset:35840
v_mfma_f32_16x16x32_bf16 a[56:59], a[244:247], a[216:219], a[56:59]
v_mfma_f32_16x16x32_bf16 a[60:63], a[244:247], a[220:223], a[60:63]
s_waitcnt lgkmcnt(5)
ds_read_b64_tr_b16 a[244:245], v202 offset:34848
ds_read_b64_tr_b16 a[246:247], v202 offset:37408
v_mfma_f32_16x16x32_bf16 v[128:131], a[160:163], a[224:227], v[128:131]
v_mfma_f32_16x16x32_bf16 v[132:135], a[164:167], a[224:227], v[132:135]
v_add_u32 v201, 57344, v201
v_mfma_f32_16x16x32_bf16 v[136:139], a[168:171], a[224:227], v[136:139]
v_mfma_f32_16x16x32_bf16 v[140:143], a[172:175], a[224:227], v[140:143]
v_add_u32 v202, 57344, v202
v_mfma_f32_16x16x32_bf16 v[144:147], a[176:179], a[224:227], v[144:147]
s_waitcnt lgkmcnt(3)
v_mfma_f32_16x16x32_bf16 v[148:151], a[180:183], a[224:227], v[148:151]
v_add_u32 v203, 57344, v203
v_mfma_f32_16x16x32_bf16 v[152:155], a[184:187], a[224:227], v[152:155]
s_waitcnt lgkmcnt(2)
v_mfma_f32_16x16x32_bf16 v[156:159], a[188:191], a[224:227], v[156:159]
s_waitcnt vmcnt(22) lgkmcnt(0)
s_barrier
ds_read_b128 a[224:227], v203 offset:0
v_mfma_f32_16x16x32_bf16 v[224:227], a[160:163], a[228:231], v[224:227]
v_mfma_f32_16x16x32_bf16 v[228:231], a[164:167], a[228:231], v[228:231]
s_add_u32 m0, s44, 45056
v_mfma_f32_16x16x32_bf16 v[232:235], a[168:171], a[228:231], v[232:235]
ds_read_b128 a[192:195], v201 offset:0
v_mfma_f32_16x16x32_bf16 v[236:239], a[172:175], a[228:231], v[236:239]
buffer_load_dwordx4 v204, s[24:27], s39 offen lds
v_mfma_f32_16x16x32_bf16 v[240:243], a[176:179], a[228:231], v[240:243]
v_mfma_f32_16x16x32_bf16 v[244:247], a[180:183], a[228:231], v[244:247]
v_mfma_f32_16x16x32_bf16 v[248:251], a[184:187], a[228:231], v[248:251]
v_mfma_f32_16x16x32_bf16 v[252:255], a[188:191], a[228:231], v[252:255]
ds_read_b128 a[228:231], v203 offset:6144
ds_read_b128 a[196:199], v201 offset:1024
v_mfma_f32_16x16x32_bf16 v[0:3], a[232:235], a[160:163], v[0:3]
buffer_load_dwordx4 v205, s[24:27], s39 offen offset:1024 lds
v_mfma_f32_16x16x32_bf16 v[4:7], a[232:235], a[164:167], v[4:7]
s_add_u32 s39, s39, 294912
v_mfma_f32_16x16x32_bf16 v[8:11], a[232:235], a[168:171], v[8:11]
v_mfma_f32_16x16x32_bf16 v[12:15], a[232:235], a[172:175], v[12:15]
s_add_u32 m0, s44, 47104
v_mfma_f32_16x16x32_bf16 v[16:19], a[232:235], a[176:179], v[16:19]
ds_read_b128 a[200:203], v201 offset:2048
v_mfma_f32_16x16x32_bf16 v[20:23], a[232:235], a[180:183], v[20:23]
buffer_load_dwordx4 v206, s[28:31], s40 offen lds
v_mfma_f32_16x16x32_bf16 v[24:27], a[232:235], a[184:187], v[24:27]
s_add_u32 s40, s40, s41
v_mfma_f32_16x16x32_bf16 v[28:31], a[232:235], a[188:191], v[28:31]
ds_read_b64_tr_b16 a[232:233], v202 offset:0
v_mfma_f32_16x16x32_bf16 a[0:3], a[236:239], a[160:163], a[0:3]
ds_read_b64_tr_b16 a[234:235], v202 offset:2560
v_mfma_f32_16x16x32_bf16 a[4:7], a[236:239], a[164:167], a[4:7]
s_add_u32 m0, s43, 28672
ds_read_b128 a[204:207], v201 offset:3072
v_mfma_f32_16x16x32_bf16 a[8:11], a[236:239], a[168:171], a[8:11]
buffer_load_dwordx4 v200, s[20:23], s38 offen offset:0 sc1 lds
v_mfma_f32_16x16x32_bf16 a[12:15], a[236:239], a[172:175], a[12:15]
v_mfma_f32_16x16x32_bf16 a[16:19], a[236:239], a[176:179], a[16:19]
v_mfma_f32_16x16x32_bf16 a[20:23], a[236:239], a[180:183], a[20:23]
v_mfma_f32_16x16x32_bf16 a[24:27], a[236:239], a[184:187], a[24:27]
ds_read_b128 a[208:211], v201 offset:4096
v_mfma_f32_16x16x32_bf16 a[28:31], a[236:239], a[188:191], a[28:31]
ds_read_b64_tr_b16 a[236:237], v202 offset:6144
v_mfma_f32_16x16x32_bf16 v[32:35], a[240:243], a[160:163], v[32:35]
buffer_load_dwordx4 v200, s[20:23], s38 offen offset:1024 sc1 lds
v_mfma_f32_16x16x32_bf16 v[36:39], a[240:243], a[164:167], v[36:39]
ds_read_b64_tr_b16 a[238:239], v202 offset:8704
v_mfma_f32_16x16x32_bf16 v[40:43], a[240:243], a[168:171], v[40:43]
v_mfma_f32_16x16x32_bf16 v[44:47], a[240:243], a[172:175], v[44:47]
ds_read_b128 a[212:215], v201 offset:5120
v_mfma_f32_16x16x32_bf16 v[48:51], a[240:243], a[176:179], v[48:51]
v_mfma_f32_16x16x32_bf16 v[52:55], a[240:243], a[180:183], v[52:55]
buffer_load_dwordx4 v200, s[20:23], s38 offen offset:2048 sc1 lds
v_mfma_f32_16x16x32_bf16 v[56:59], a[240:243], a[184:187], v[56:59]
v_mfma_f32_16x16x32_bf16 v[60:63], a[240:243], a[188:191], v[60:63]
ds_read_b64_tr_b16 a[240:241], v202 offset:32
v_mfma_f32_16x16x32_bf16 a[32:35], a[244:247], a[160:163], a[32:35]
ds_read_b64_tr_b16 a[242:243], v202 offset:2592
ds_read_b128 a[216:219], v201 offset:6144
v_mfma_f32_16x16x32_bf16 a[36:39], a[244:247], a[164:167], a[36:39]
v_mfma_f32_16x16x32_bf16 a[40:43], a[244:247], a[168:171], a[40:43]
buffer_load_dwordx4 v200, s[20:23], s38 offen offset:3072 sc1 lds
v_mfma_f32_16x16x32_bf16 a[44:47], a[244:247], a[172:175], a[44:47]
v_mfma_f32_16x16x32_bf16 a[48:51], a[244:247], a[176:179], a[48:51]
v_mfma_f32_16x16x32_bf16 a[52:55], a[244:247], a[180:183], a[52:55]
ds_read_b128 a[220:223], v201 offset:7168
v_mfma_f32_16x16x32_bf16 a[56:59], a[244:247], a[184:187], a[56:59]
v_mfma_f32_16x16x32_bf16 a[60:63], a[244:247], a[188:191], a[60:63]
s_waitcnt lgkmcnt(5)
ds_read_b64_tr_b16 a[244:245], v202 offset:6176
ds_read_b64_tr_b16 a[246:247], v202 offset:8736
v_mfma_f32_16x16x32_bf16 v[128:131], a[192:195], a[224:227], v[128:131]
v_mfma_f32_16x16x32_bf16 v[132:135], a[196:199], a[224:227], v[132:135]
v_mfma_f32_16x16x32_bf16 v[136:139], a[200:203], a[224:227], v[136:139]
v_mfma_f32_16x16x32_bf16 v[140:143], a[204:207], a[224:227], v[140:143]
v_mfma_f32_16x16x32_bf16 v[144:147], a[208:211], a[224:227], v[144:147]
s_waitcnt lgkmcnt(5)
v_mfma_f32_16x16x32_bf16 v[148:151], a[212:215], a[224:227], v[148:151]
s_waitcnt lgkmcnt(3)
v_mfma_f32_16x16x32_bf16 v[152:155], a[216:219], a[224:227], v[152:155]
s_waitcnt lgkmcnt(2)
v_mfma_f32_16x16x32_bf16 v[156:159], a[220:223], a[224:227], v[156:159]
s_waitcnt vmcnt(22) lgkmcnt(0)
s_barrier
ds_read_b128 a[224:227], v203 offset:28672
v_mfma_f32_16x16x32_bf16 v[224:227], a[192:195], a[228:231], v[224:227]
v_mfma_f32_16x16x32_bf16 v[228:231], a[196:199], a[228:231], v[228:231]
s_add_u32 m0, s63, 73728
v_mfma_f32_16x16x32_bf16 v[232:235], a[200:203], a[228:231], v[232:235]
ds_read_b128 a[160:163], v201 offset:28672
v_mfma_f32_16x16x32_bf16 v[236:239], a[204:207], a[228:231], v[236:239]
buffer_load_dwordx4 v207, s[24:27], s46 offen lds
v_mfma_f32_16x16x32_bf16 v[240:243], a[208:211], a[228:231], v[240:243]
v_mfma_f32_16x16x32_bf16 v[244:247], a[212:215], a[228:231], v[244:247]
v_mfma_f32_16x16x32_bf16 v[248:251], a[216:219], a[228:231], v[248:251]
v_mfma_f32_16x16x32_bf16 v[252:255], a[220:223], a[228:231], v[252:255]
ds_read_b128 a[228:231], v203 offset:34816
ds_read_b128 a[164:167], v201 offset:29696
v_mfma_f32_16x16x32_bf16 v[0:3], a[232:235], a[192:195], v[0:3]
buffer_load_dwordx4 v208, s[24:27], s46 offen offset:1024 lds
v_mfma_f32_16x16x32_bf16 v[4:7], a[232:235], a[196:199], v[4:7]
s_sub_u32 s46, s46, 294912
v_mfma_f32_16x16x32_bf16 v[8:11], a[232:235], a[200:203], v[8:11]
v_mfma_f32_16x16x32_bf16 v[12:15], a[232:235], a[204:207], v[12:15]
v_mfma_f32_16x16x32_bf16 v[16:19], a[232:235], a[208:211], v[16:19]
ds_read_b128 a[168:171], v201 offset:30720
v_mfma_f32_16x16x32_bf16 v[20:23], a[232:235], a[212:215], v[20:23]
s_add_u32 m0, s43, 57344
s_sub_u32 s97, s97, 1769472
v_mfma_f32_16x16x32_bf16 v[24:27], a[232:235], a[216:219], v[24:27]
buffer_load_dwordx4 v200, s[20:23], s38 offen offset:0 sc1 lds
v_mfma_f32_16x16x32_bf16 v[28:31], a[232:235], a[220:223], v[28:31]
ds_read_b64_tr_b16 a[232:233], v202 offset:28672
v_mfma_f32_16x16x32_bf16 a[0:3], a[236:239], a[192:195], a[0:3]
buffer_load_dword a255, v197, s[24:27], s97 offen offset:640
v_mfma_f32_16x16x32_bf16 a[4:7], a[236:239], a[196:199], a[4:7]
ds_read_b64_tr_b16 a[234:235], v202 offset:31232
ds_read_b128 a[172:175], v201 offset:31744
v_mfma_f32_16x16x32_bf16 a[8:11], a[236:239], a[200:203], a[8:11]
v_mfma_f32_16x16x32_bf16 a[12:15], a[236:239], a[204:207], a[12:15]
v_mfma_f32_16x16x32_bf16 a[16:19], a[236:239], a[208:211], a[16:19]
v_mfma_f32_16x16x32_bf16 a[20:23], a[236:239], a[212:215], a[20:23]
buffer_load_dwordx4 v200, s[20:23], s38 offen offset:1024 sc1 lds
v_mfma_f32_16x16x32_bf16 a[24:27], a[236:239], a[216:219], a[24:27]
ds_read_b128 a[176:179], v201 offset:32768
v_mfma_f32_16x16x32_bf16 a[28:31], a[236:239], a[220:223], a[28:31]
ds_read_b64_tr_b16 a[236:237], v202 offset:34816
v_mfma_f32_16x16x32_bf16 v[32:35], a[240:243], a[192:195], v[32:35]
ds_read_b64_tr_b16 a[238:239], v202 offset:37376
v_mfma_f32_16x16x32_bf16 v[36:39], a[240:243], a[196:199], v[36:39]
v_mfma_f32_16x16x32_bf16 v[40:43], a[240:243], a[200:203], v[40:43]
v_mfma_f32_16x16x32_bf16 v[44:47], a[240:243], a[204:207], v[44:47]
ds_read_b128 a[180:183], v201 offset:33792
v_mfma_f32_16x16x32_bf16 v[48:51], a[240:243], a[208:211], v[48:51]
buffer_load_dwordx4 v200, s[20:23], s38 offen offset:2048 sc1 lds
v_mfma_f32_16x16x32_bf16 v[52:55], a[240:243], a[212:215], v[52:55]
v_mfma_f32_16x16x32_bf16 v[56:59], a[240:243], a[216:219], v[56:59]
v_mfma_f32_16x16x32_bf16 v[60:63], a[240:243], a[220:223], v[60:63]
ds_read_b64_tr_b16 a[240:241], v202 offset:28704
v_mfma_f32_16x16x32_bf16 a[32:35], a[244:247], a[192:195], a[32:35]
ds_read_b64_tr_b16 a[242:243], v202 offset:31264
ds_read_b128 a[184:187], v201 offset:34816
v_mfma_f32_16x16x32_bf16 a[36:39], a[244:247], a[196:199], a[36:39]
buffer_load_dwordx4 v200, s[20:23], s38 offen offset:3072 sc1 lds
v_mfma_f32_16x16x32_bf16 a[40:43], a[244:247], a[200:203], a[40:43]
s_sub_u32 s38, s38, 16384
v_mfma_f32_16x16x32_bf16 a[44:47], a[244:247], a[204:207], a[44:47]
v_mfma_f32_16x16x32_bf16 a[48:51], a[244:247], a[208:211], a[48:51]
v_mfma_f32_16x16x32_bf16 a[52:55], a[244:247], a[212:215], a[52:55]
ds_read_b128 a[188:191], v201 offset:35840
v_mfma_f32_16x16x32_bf16 a[56:59], a[244:247], a[216:219], a[56:59]
v_mfma_f32_16x16x32_bf16 a[60:63], a[244:247], a[220:223], a[60:63]
s_waitcnt lgkmcnt(5)
ds_read_b64_tr_b16 a[244:245], v202 offset:34848
ds_read_b64_tr_b16 a[246:247], v202 offset:37408
v_mfma_f32_16x16x32_bf16 v[128:131], a[160:163], a[224:227], v[128:131]
s_lshl_b32 s18, s17, 12
v_add_u32 v204, s18, v200
v_lshrrev_b32 v160, 6, v200
v_mfma_f32_16x16x32_bf16 v[132:135], a[164:167], a[224:227], v[132:135]
v_add_u32 v201, 57344, v201
v_mul_u32_u24 v160, 384, v160
v_mfma_f32_16x16x32_bf16 v[136:139], a[168:171], a[224:227], v[136:139]
v_bfe_u32 v161, v200, 4, 2
v_lshl_add_u32 v160, v161, 3, v160
v_add_u32 v160, 8192, v160
v_mfma_f32_16x16x32_bf16 v[140:143], a[172:175], a[224:227], v[140:143]
v_add_u32 v202, 57344, v202
v_bfe_u32 v161, v200, 7, 2
v_mfma_f32_16x16x32_bf16 v[144:147], a[176:179], a[224:227], v[144:147]
s_waitcnt lgkmcnt(2)
s_and_b32 s18, s66, 2
s_add_u32 s18, s18, s16
v_mfma_f32_16x16x32_bf16 v[148:151], a[180:183], a[224:227], v[148:151]
v_add_u32 v203, 57344, v203
v_xor_b32 v161, s18, v161
v_lshl_add_u32 v205, v161, 5, v160
v_mfma_f32_16x16x32_bf16 v[152:155], a[184:187], a[224:227], v[152:155]
v_xor_b32 v206, 64, v205
s_lshl_b32 s37, s62, 12
v_mfma_f32_16x16x32_bf16 v[156:159], a[188:191], a[224:227], v[156:159]
s_waitcnt vmcnt(21) lgkmcnt(0)
s_barrier
ds_read_b128 a[224:227], v203 offset:0
s_add_u32 s37, s37, 4194304
v_mfma_f32_16x16x32_bf16 v[224:227], a[160:163], a[228:231], v[224:227]
s_lshl_b32 s36, s55, 8
s_add_u32 s36, s36, s37
s_sub_u32 s18, s55, 16
v_mfma_f32_16x16x32_bf16 v[228:231], a[164:167], a[228:231], v[228:231]
s_add_u32 m0, s63, 102400
v_and_b32 v176, 0xf0, v200
v_lshrrev_b32 v177, 8, v200
v_mfma_f32_16x16x32_bf16 v[232:235], a[168:171], a[228:231], v[232:235]
ds_read_b128 a[192:195], v201 offset:0
v_lshl_add_u32 v178, v177, 28, v176
v_lshl_add_u32 v177, v177, 2, s18
v_mfma_f32_16x16x32_bf16 v[236:239], a[172:175], a[228:231], v[236:239]
buffer_load_dwordx4 v207, s[24:27], s46 offen lds
v_mfma_f32_16x16x32_bf16 v[240:243], a[176:179], a[228:231], v[240:243]
v_mov_b32 v173, s96
v_mov_b32 v175, s96
v_add_u32 v179, 0, v177
v_mfma_f32_16x16x32_bf16 v[244:247], a[180:183], a[228:231], v[244:247]
v_and_b32 v179, 0xbfffff, v179
v_lshl_add_u32 v180, v179, 8, v176
v_mfma_f32_16x16x32_bf16 v[248:251], a[184:187], a[228:231], v[248:251]
v_add_u32 v179, 1, v177
v_and_b32 v179, 0xbfffff, v179
v_mfma_f32_16x16x32_bf16 v[252:255], a[188:191], a[228:231], v[252:255]
ds_read_b128 a[228:231], v203 offset:6144
ds_read_b128 a[196:199], v201 offset:1024
v_lshl_add_u32 v181, v179, 8, v176
v_mfma_f32_16x16x32_bf16 v[0:3], a[232:235], a[160:163], v[0:3]
buffer_load_dwordx4 v208, s[24:27], s46 offen offset:1024 lds
v_mfma_f32_16x16x32_bf16 v[4:7], a[232:235], a[164:167], v[4:7]
s_sub_u32 s46, s46, 294912
v_add_u32 v179, 2, v177
v_and_b32 v179, 0xbfffff, v179
v_lshl_add_u32 v182, v179, 8, v176
v_mfma_f32_16x16x32_bf16 v[8:11], a[232:235], a[168:171], v[8:11]
v_add_u32 v179, 3, v177
v_and_b32 v179, 0xbfffff, v179
v_mfma_f32_16x16x32_bf16 v[12:15], a[232:235], a[172:175], v[12:15]
v_lshl_add_u32 v183, v179, 8, v176
v_mfma_f32_16x16x32_bf16 v[16:19], a[232:235], a[176:179], v[16:19]
ds_read_b128 a[200:203], v201 offset:2048
v_mfma_f32_16x16x32_bf16 v[20:23], a[232:235], a[180:183], v[20:23]
s_add_u32 m0, s43, 86016
v_mfma_f32_16x16x32_bf16 v[24:27], a[232:235], a[184:187], v[24:27]
buffer_load_dwordx4 v200, s[20:23], s38 offen offset:0 sc1 lds
v_mfma_f32_16x16x32_bf16 v[28:31], a[232:235], a[188:191], v[28:31]
ds_read_b64_tr_b16 a[232:233], v202 offset:0
v_mfma_f32_16x16x32_bf16 a[0:3], a[236:239], a[160:163], a[0:3]
ds_read_b64_tr_b16 a[234:235], v202 offset:2560
v_mfma_f32_16x16x32_bf16 a[4:7], a[236:239], a[164:167], a[4:7]
ds_read_b128 a[204:207], v201 offset:3072
v_mfma_f32_16x16x32_bf16 a[8:11], a[236:239], a[168:171], a[8:11]
v_mfma_f32_16x16x32_bf16 a[12:15], a[236:239], a[172:175], a[12:15]
v_mfma_f32_16x16x32_bf16 a[16:19], a[236:239], a[176:179], a[16:19]
v_mfma_f32_16x16x32_bf16 a[20:23], a[236:239], a[180:183], a[20:23]
buffer_load_dwordx4 v200, s[20:23], s38 offen offset:1024 sc1 lds
v_mfma_f32_16x16x32_bf16 a[24:27], a[236:239], a[184:187], a[24:27]
ds_read_b128 a[208:211], v201 offset:4096
v_mfma_f32_16x16x32_bf16 a[28:31], a[236:239], a[188:191], a[28:31]
ds_read_b64_tr_b16 a[236:237], v202 offset:6144
v_mfma_f32_16x16x32_bf16 v[32:35], a[240:243], a[160:163], v[32:35]
ds_read_b64_tr_b16 a[238:239], v202 offset:8704
v_mfma_f32_16x16x32_bf16 v[36:39], a[240:243], a[164:167], v[36:39]
v_mfma_f32_16x16x32_bf16 v[40:43], a[240:243], a[168:171], v[40:43]
v_mfma_f32_16x16x32_bf16 v[44:47], a[240:243], a[172:175], v[44:47]
ds_read_b128 a[212:215], v201 offset:5120
v_mfma_f32_16x16x32_bf16 v[48:51], a[240:243], a[176:179], v[48:51]
buffer_load_dwordx4 v200, s[20:23], s38 offen offset:2048 sc1 lds
v_mfma_f32_16x16x32_bf16 v[52:55], a[240:243], a[180:183], v[52:55]
v_mfma_f32_16x16x32_bf16 v[56:59], a[240:243], a[184:187], v[56:59]
v_mfma_f32_16x16x32_bf16 v[60:63], a[240:243], a[188:191], v[60:63]
ds_read_b64_tr_b16 a[240:241], v202 offset:32
v_mfma_f32_16x16x32_bf16 a[32:35], a[244:247], a[160:163], a[32:35]
ds_read_b64_tr_b16 a[242:243], v202 offset:2592
ds_read_b128 a[216:219], v201 offset:6144
v_mfma_f32_16x16x32_bf16 a[36:39], a[244:247], a[164:167], a[36:39]
buffer_load_dwordx4 v200, s[20:23], s38 offen offset:3072 sc1 lds
v_mfma_f32_16x16x32_bf16 a[40:43], a[244:247], a[168:171], a[40:43]
s_sub_u32 s38, s38, 16384
v_mfma_f32_16x16x32_bf16 a[44:47], a[244:247], a[172:175], a[44:47]
v_mfma_f32_16x16x32_bf16 a[48:51], a[244:247], a[176:179], a[48:51]
v_mfma_f32_16x16x32_bf16 a[52:55], a[244:247], a[180:183], a[52:55]
ds_read_b128 a[220:223], v201 offset:7168
v_mfma_f32_16x16x32_bf16 a[56:59], a[244:247], a[184:187], a[56:59]
v_mfma_f32_16x16x32_bf16 a[60:63], a[244:247], a[188:191], a[60:63]
s_waitcnt lgkmcnt(5)
ds_read_b64_tr_b16 a[244:245], v202 offset:6176
ds_read_b64_tr_b16 a[246:247], v202 offset:8736
v_mfma_f32_16x16x32_bf16 v[128:131], a[192:195], a[224:227], v[128:131]
v_mfma_f32_16x16x32_bf16 v[132:135], a[196:199], a[224:227], v[132:135]
v_add_u32 v201, 4294852608, v201
v_mfma_f32_16x16x32_bf16 v[136:139], a[200:203], a[224:227], v[136:139]
v_mfma_f32_16x16x32_bf16 v[140:143], a[204:207], a[224:227], v[140:143]
v_add_u32 v202, 4294852608, v202
v_mfma_f32_16x16x32_bf16 v[144:147], a[208:211], a[224:227], v[144:147]
s_waitcnt lgkmcnt(3)
v_mfma_f32_16x16x32_bf16 v[148:151], a[212:215], a[224:227], v[148:151]
v_add_u32 v203, 4294852608, v203
v_mfma_f32_16x16x32_bf16 v[152:155], a[216:219], a[224:227], v[152:155]
s_waitcnt lgkmcnt(2)
v_mfma_f32_16x16x32_bf16 v[156:159], a[220:223], a[224:227], v[156:159]
s_waitcnt vmcnt(20) lgkmcnt(0)
s_barrier
ds_read_b128 a[224:227], v203 offset:0
v_mfma_f32_16x16x32_bf16 v[224:227], a[192:195], a[228:231], v[224:227]
s_lshl_b32 s6, s13, 2
s_add_u32 s6, s6, s3
v_mfma_f32_16x16x32_bf16 v[228:231], a[196:199], a[228:231], v[228:231]
s_add_u32 m0, s63, 131072
s_and_b32 s7, s12, 3
s_lshl_b32 s7, s7, 7
v_mfma_f32_16x16x32_bf16 v[232:235], a[200:203], a[228:231], v[232:235]
ds_read_b128 a[160:163], v201 offset:0
v_mfma_f32_16x16x32_bf16 v[236:239], a[204:207], a[228:231], v[236:239]
buffer_load_dwordx4 v207, s[24:27], s46 offen lds
v_mfma_f32_16x16x32_bf16 v[240:243], a[208:211], a[228:231], v[240:243]
s_add_u32 s6, s6, s7
s_mul_i32 s49, s6, 10368
v_mfma_f32_16x16x32_bf16 v[244:247], a[212:215], a[228:231], v[244:247]
s_mov_b32 s74, 5308416
s_mov_b32 s75, 0x20000
v_mfma_f32_16x16x32_bf16 v[248:251], a[216:219], a[228:231], v[248:251]
v_mfma_f32_16x16x32_bf16 v[252:255], a[220:223], a[228:231], v[252:255]
s_lshr_b32 s7, s12, 2
ds_read_b128 a[228:231], v203 offset:6144
ds_read_b128 a[164:167], v201 offset:1024
v_mfma_f32_16x16x32_bf16 v[0:3], a[232:235], a[192:195], v[0:3]
s_mul_i32 s7, s7, 5120
buffer_load_dwordx4 v208, s[24:27], s46 offen offset:1024 lds
v_mfma_f32_16x16x32_bf16 v[4:7], a[232:235], a[196:199], v[4:7]
s_sub_u32 s46, s46, 294912
s_add_u32 s49, s49, s7
v_mfma_f32_16x16x32_bf16 v[8:11], a[232:235], a[200:203], v[8:11]
v_mfma_f32_16x16x32_bf16 v[12:15], a[232:235], a[204:207], v[12:15]
v_lshlrev_b32 v222, 3, v200
v_min_u32 v222, 5120, v222
buffer_load_dword a255, v222, s[72:75], s49 offen
v_mfma_f32_16x16x32_bf16 v[16:19], a[232:235], a[208:211], v[16:19]
ds_read_b128 a[168:171], v201 offset:2048
v_mfma_f32_16x16x32_bf16 v[20:23], a[232:235], a[212:215], v[20:23]
s_add_u32 m0, s43, 114688
v_mfma_f32_16x16x32_bf16 v[24:27], a[232:235], a[216:219], v[24:27]
buffer_load_dwordx4 v200, s[20:23], s38 offen offset:0 sc1 lds
v_mfma_f32_16x16x32_bf16 v[28:31], a[232:235], a[220:223], v[28:31]
ds_read_b64_tr_b16 a[232:233], v202 offset:0
v_mfma_f32_16x16x32_bf16 a[0:3], a[236:239], a[192:195], a[0:3]
ds_read_b64_tr_b16 a[234:235], v202 offset:2560
v_mfma_f32_16x16x32_bf16 a[4:7], a[236:239], a[196:199], a[4:7]
ds_read_b128 a[172:175], v201 offset:3072
v_mfma_f32_16x16x32_bf16 a[8:11], a[236:239], a[200:203], a[8:11]
v_mfma_f32_16x16x32_bf16 a[12:15], a[236:239], a[204:207], a[12:15]
v_mfma_f32_16x16x32_bf16 a[16:19], a[236:239], a[208:211], a[16:19]
v_mfma_f32_16x16x32_bf16 a[20:23], a[236:239], a[212:215], a[20:23]
buffer_load_dwordx4 v200, s[20:23], s38 offen offset:1024 sc1 lds
v_mfma_f32_16x16x32_bf16 a[24:27], a[236:239], a[216:219], a[24:27]
ds_read_b128 a[176:179], v201 offset:4096
v_mfma_f32_16x16x32_bf16 a[28:31], a[236:239], a[220:223], a[28:31]
ds_read_b64_tr_b16 a[236:237], v202 offset:6144
v_mfma_f32_16x16x32_bf16 v[32:35], a[240:243], a[192:195], v[32:35]
ds_read_b64_tr_b16 a[238:239], v202 offset:8704
v_mfma_f32_16x16x32_bf16 v[36:39], a[240:243], a[196:199], v[36:39]
v_mfma_f32_16x16x32_bf16 v[40:43], a[240:243], a[200:203], v[40:43]
v_mfma_f32_16x16x32_bf16 v[44:47], a[240:243], a[204:207], v[44:47]
ds_read_b128 a[180:183], v201 offset:5120
v_mfma_f32_16x16x32_bf16 v[48:51], a[240:243], a[208:211], v[48:51]
buffer_load_dwordx4 v200, s[20:23], s38 offen offset:2048 sc1 lds
v_mfma_f32_16x16x32_bf16 v[52:55], a[240:243], a[212:215], v[52:55]
v_mfma_f32_16x16x32_bf16 v[56:59], a[240:243], a[216:219], v[56:59]
v_mfma_f32_16x16x32_bf16 v[60:63], a[240:243], a[220:223], v[60:63]
ds_read_b64_tr_b16 a[240:241], v202 offset:32
v_mfma_f32_16x16x32_bf16 a[32:35], a[244:247], a[192:195], a[32:35]
ds_read_b64_tr_b16 a[242:243], v202 offset:2592
ds_read_b128 a[184:187], v201 offset:6144
v_mfma_f32_16x16x32_bf16 a[36:39], a[244:247], a[196:199], a[36:39]
buffer_load_dwordx4 v200, s[20:23], s38 offen offset:3072 sc1 lds
v_mfma_f32_16x16x32_bf16 a[40:43], a[244:247], a[200:203], a[40:43]
s_sub_u32 s38, s38, 16384
v_mfma_f32_16x16x32_bf16 a[44:47], a[244:247], a[204:207], a[44:47]
v_mfma_f32_16x16x32_bf16 a[48:51], a[244:247], a[208:211], a[48:51]
v_mfma_f32_16x16x32_bf16 a[52:55], a[244:247], a[212:215], a[52:55]
ds_read_b128 a[188:191], v201 offset:7168
v_mfma_f32_16x16x32_bf16 a[56:59], a[244:247], a[216:219], a[56:59]
v_mfma_f32_16x16x32_bf16 a[60:63], a[244:247], a[220:223], a[60:63]
s_waitcnt lgkmcnt(5)
ds_read_b64_tr_b16 a[244:245], v202 offset:6176
ds_read_b64_tr_b16 a[246:247], v202 offset:8736
v_mfma_f32_16x16x32_bf16 v[128:131], a[160:163], a[224:227], v[128:131]
v_mfma_f32_16x16x32_bf16 v[132:135], a[164:167], a[224:227], v[132:135]
v_mfma_f32_16x16x32_bf16 v[136:139], a[168:171], a[224:227], v[136:139]
v_mfma_f32_16x16x32_bf16 v[140:143], a[172:175], a[224:227], v[140:143]
v_mfma_f32_16x16x32_bf16 v[144:147], a[176:179], a[224:227], v[144:147]
s_waitcnt lgkmcnt(5)
v_mfma_f32_16x16x32_bf16 v[148:151], a[180:183], a[224:227], v[148:151]
s_waitcnt lgkmcnt(3)
v_mfma_f32_16x16x32_bf16 v[152:155], a[184:187], a[224:227], v[152:155]
s_waitcnt lgkmcnt(2)
v_mfma_f32_16x16x32_bf16 v[156:159], a[188:191], a[224:227], v[156:159]
s_waitcnt vmcnt(20) lgkmcnt(0)
s_barrier
ds_read_b128 a[224:227], v203 offset:28672
v_mfma_f32_16x16x32_bf16 v[224:227], a[160:163], a[228:231], v[224:227]
v_mfma_f32_16x16x32_bf16 v[228:231], a[164:167], a[228:231], v[228:231]
s_add_u32 m0, s63, 16384
v_mfma_f32_16x16x32_bf16 v[232:235], a[168:171], a[228:231], v[232:235]
ds_read_b128 a[192:195], v201 offset:28672
v_mfma_f32_16x16x32_bf16 v[236:239], a[172:175], a[228:231], v[236:239]
buffer_load_dwordx4 v207, s[24:27], s46 offen lds
v_mfma_f32_16x16x32_bf16 v[240:243], a[176:179], a[228:231], v[240:243]
v_mfma_f32_16x16x32_bf16 v[244:247], a[180:183], a[228:231], v[244:247]
v_mfma_f32_16x16x32_bf16 v[248:251], a[184:187], a[228:231], v[248:251]
v_mfma_f32_16x16x32_bf16 v[252:255], a[188:191], a[228:231], v[252:255]
ds_read_b128 a[228:231], v203 offset:34816
ds_read_b128 a[196:199], v201 offset:29696
v_mfma_f32_16x16x32_bf16 v[0:3], a[232:235], a[160:163], v[0:3]
buffer_load_dwordx4 v208, s[24:27], s46 offen offset:1024 lds
v_mfma_f32_16x16x32_bf16 v[4:7], a[232:235], a[164:167], v[4:7]
s_sub_u32 s46, s46, 294912
v_mfma_f32_16x16x32_bf16 v[8:11], a[232:235], a[168:171], v[8:11]
v_mfma_f32_16x16x32_bf16 v[12:15], a[232:235], a[172:175], v[12:15]
v_mfma_f32_16x16x32_bf16 v[16:19], a[232:235], a[176:179], v[16:19]
ds_read_b128 a[200:203], v201 offset:30720
v_mfma_f32_16x16x32_bf16 v[20:23], a[232:235], a[180:183], v[20:23]
s_add_u32 m0, s43, 0
v_mfma_f32_16x16x32_bf16 v[24:27], a[232:235], a[184:187], v[24:27]
buffer_load_dwordx4 v200, s[20:23], s38 offen offset:0 sc1 lds
v_mfma_f32_16x16x32_bf16 v[28:31], a[232:235], a[188:191], v[28:31]
ds_read_b64_tr_b16 a[232:233], v202 offset:28672
v_mfma_f32_16x16x32_bf16 a[0:3], a[236:239], a[160:163], a[0:3]
ds_read_b64_tr_b16 a[234:235], v202 offset:31232
v_mfma_f32_16x16x32_bf16 a[4:7], a[236:239], a[164:167], a[4:7]
ds_read_b128 a[204:207], v201 offset:31744
v_mfma_f32_16x16x32_bf16 a[8:11], a[236:239], a[168:171], a[8:11]
v_mfma_f32_16x16x32_bf16 a[12:15], a[236:239], a[172:175], a[12:15]
v_mfma_f32_16x16x32_bf16 a[16:19], a[236:239], a[176:179], a[16:19]
v_mfma_f32_16x16x32_bf16 a[20:23], a[236:239], a[180:183], a[20:23]
buffer_load_dwordx4 v200, s[20:23], s38 offen offset:1024 sc1 lds
v_mfma_f32_16x16x32_bf16 a[24:27], a[236:239], a[184:187], a[24:27]
ds_read_b128 a[208:211], v201 offset:32768
v_mfma_f32_16x16x32_bf16 a[28:31], a[236:239], a[188:191], a[28:31]
ds_read_b64_tr_b16 a[236:237], v202 offset:34816
v_mfma_f32_16x16x32_bf16 v[32:35], a[240:243], a[160:163], v[32:35]
ds_read_b64_tr_b16 a[238:239], v202 offset:37376
v_mfma_f32_16x16x32_bf16 v[36:39], a[240:243], a[164:167], v[36:39]
v_mfma_f32_16x16x32_bf16 v[40:43], a[240:243], a[168:171], v[40:43]
v_mfma_f32_16x16x32_bf16 v[44:47], a[240:243], a[172:175], v[44:47]
ds_read_b128 a[212:215], v201 offset:33792
v_mfma_f32_16x16x32_bf16 v[48:51], a[240:243], a[176:179], v[48:51]
buffer_load_dwordx4 v200, s[20:23], s38 offen offset:2048 sc1 lds
v_mfma_f32_16x16x32_bf16 v[52:55], a[240:243], a[180:183], v[52:55]
v_mfma_f32_16x16x32_bf16 v[56:59], a[240:243], a[184:187], v[56:59]
v_mfma_f32_16x16x32_bf16 v[60:63], a[240:243], a[188:191], v[60:63]
ds_read_b64_tr_b16 a[240:241], v202 offset:28704
v_mfma_f32_16x16x32_bf16 a[32:35], a[244:247], a[160:163], a[32:35]
ds_read_b64_tr_b16 a[242:243], v202 offset:31264
ds_read_b128 a[216:219], v201 offset:34816
v_mfma_f32_16x16x32_bf16 a[36:39], a[244:247], a[164:167], a[36:39]
buffer_load_dwordx4 v200, s[20:23], s38 offen offset:3072 sc1 lds
v_mfma_f32_16x16x32_bf16 a[40:43], a[244:247], a[168:171], a[40:43]
s_sub_u32 s38, s38, 16384
v_mfma_f32_16x16x32_bf16 a[44:47], a[244:247], a[172:175], a[44:47]
v_mfma_f32_16x16x32_bf16 a[48:51], a[244:247], a[176:179], a[48:51]
v_mfma_f32_16x16x32_bf16 a[52:55], a[244:247], a[180:183], a[52:55]
ds_read_b128 a[220:223], v201 offset:35840
v_mfma_f32_16x16x32_bf16 a[56:59], a[244:247], a[184:187], a[56:59]
v_mfma_f32_16x16x32_bf16 a[60:63], a[244:247], a[188:191], a[60:63]
s_waitcnt lgkmcnt(5)
ds_read_b64_tr_b16 a[244:245], v202 offset:34848
ds_read_b64_tr_b16 a[246:247], v202 offset:37408
v_mfma_f32_16x16x32_bf16 v[128:131], a[192:195], a[224:227], v[128:131]
v_mfma_f32_16x16x32_bf16 v[132:135], a[196:199], a[224:227], v[132:135]
v_add_u32 v201, 57344, v201
v_mfma_f32_16x16x32_bf16 v[136:139], a[200:203], a[224:227], v[136:139]
v_mfma_f32_16x16x32_bf16 v[140:143], a[204:207], a[224:227], v[140:143]
v_add_u32 v202, 73728, v199
v_mfma_f32_16x16x32_bf16 v[144:147], a[208:211], a[224:227], v[144:147]
s_waitcnt lgkmcnt(3)
v_mfma_f32_16x16x32_bf16 v[148:151], a[212:215], a[224:227], v[148:151]
v_xor_b32 v203, 32, v202
v_mfma_f32_16x16x32_bf16 v[152:155], a[216:219], a[224:227], v[152:155]
s_waitcnt lgkmcnt(2)
v_mfma_f32_16x16x32_bf16 v[156:159], a[220:223], a[224:227], v[156:159]
s_waitcnt vmcnt(19) lgkmcnt(0)
s_barrier
ds_read_b64_tr_b16 a[224:225], v202 offset:0
v_mfma_f32_16x16x32_bf16 v[224:227], a[192:195], a[228:231], v[224:227]
ds_read_b64_tr_b16 a[226:227], v202 offset:2048
v_mfma_f32_16x16x32_bf16 v[228:231], a[196:199], a[228:231], v[228:231]
s_add_u32 m0, s63, 45056
v_mfma_f32_16x16x32_bf16 v[232:235], a[200:203], a[228:231], v[232:235]
ds_read_b128 a[160:163], v201 offset:0
T_a_9:
s_cbranch_execz T_a_r
v_mfma_f32_16x16x32_bf16 v[236:239], a[204:207], a[228:231], v[236:239]
buffer_load_dwordx4 v207, s[24:27], s46 offen lds
v_mfma_f32_16x16x32_bf16 v[240:243], a[208:211], a[228:231], v[240:243]
v_fma_f32 v160, v209, v128, v129
v_fma_f32 v161, v209, v224, v225
v_fma_f32 v160, -v210, v224, v160
v_mfma_f32_16x16x32_bf16 v[244:247], a[212:215], a[228:231], v[244:247]
v_fma_f32 v161, v210, v128, v161
v_fma_f32 v162, v209, v160, v130
v_fma_f32 v163, v209, v161, v226
v_mfma_f32_16x16x32_bf16 v[248:251], a[216:219], a[228:231], v[248:251]
v_fma_f32 v162, -v210, v161, v162
v_fma_f32 v163, v210, v160, v163
v_mfma_f32_16x16x32_bf16 v[252:255], a[220:223], a[228:231], v[252:255]
ds_read_b64_tr_b16 a[228:229], v202 offset:4096
ds_read_b128 a[164:167], v201 offset:1024
v_mfma_f32_16x16x32_bf16 v[0:3], a[232:235], a[192:195], v[0:3]
ds_read_b64_tr_b16 a[230:231], v202 offset:6144
v_fma_f32 v160, v209, v162, v131
v_fma_f32 v161, v209, v163, v227
v_mfma_f32_16x16x32_bf16 v[4:7], a[232:235], a[196:199], v[4:7]
buffer_load_dwordx4 v208, s[24:27], s46 offen offset:1024 lds
v_mfma_f32_16x16x32_bf16 v[8:11], a[232:235], a[200:203], v[8:11]
s_sub_u32 s46, s46, 294912
v_fma_f32 v160, -v210, v163, v160
v_fma_f32 v161, v210, v162, v161
v_fma_f32 v162, v209, v160, v132
v_mfma_f32_16x16x32_bf16 v[12:15], a[232:235], a[204:207], v[12:15]
v_fma_f32 v163, v209, v161, v228
v_fma_f32 v162, -v210, v161, v162
v_mfma_f32_16x16x32_bf16 v[16:19], a[232:235], a[208:211], v[16:19]
ds_read_b128 a[168:171], v201 offset:2048
v_fma_f32 v163, v210, v160, v163
v_mfma_f32_16x16x32_bf16 v[20:23], a[232:235], a[212:215], v[20:23]
s_add_u32 m0, s43, 28672
v_fma_f32 v160, v209, v162, v133
v_fma_f32 v161, v209, v163, v229
v_fma_f32 v160, -v210, v163, v160
v_mfma_f32_16x16x32_bf16 v[24:27], a[232:235], a[216:219], v[24:27]
buffer_load_dwordx4 v200, s[20:23], s38 offen offset:0 sc1 lds
v_mfma_f32_16x16x32_bf16 v[28:31], a[232:235], a[220:223], v[28:31]
ds_read_b64_tr_b16 a[232:233], v203 offset:0
v_fma_f32 v161, v210, v162, v161
v_fma_f32 v162, v209, v160, v134
v_mfma_f32_16x16x32_bf16 a[0:3], a[236:239], a[192:195], a[0:3]
ds_read_b64_tr_b16 a[234:235], v203 offset:2048
v_fma_f32 v163, v209, v161, v230
v_mfma_f32_16x16x32_bf16 a[4:7], a[236:239], a[196:199], a[4:7]
ds_read_b128 a[172:175], v201 offset:3072
v_fma_f32 v162, -v210, v161, v162
v_mfma_f32_16x16x32_bf16 a[8:11], a[236:239], a[200:203], a[8:11]
v_fma_f32 v163, v210, v160, v163
v_fma_f32 v160, v209, v162, v135
v_fma_f32 v161, v209, v163, v231
v_mfma_f32_16x16x32_bf16 a[12:15], a[236:239], a[204:207], a[12:15]
v_fma_f32 v160, -v210, v163, v160
v_fma_f32 v161, v210, v162, v161
v_mfma_f32_16x16x32_bf16 a[16:19], a[236:239], a[208:211], a[16:19]
v_fma_f32 v162, v209, v160, v136
v_fma_f32 v163, v209, v161, v232
v_fma_f32 v162, -v210, v161, v162
v_mfma_f32_16x16x32_bf16 a[20:23], a[236:239], a[212:215], a[20:23]
buffer_load_dwordx4 v200, s[20:23], s38 offen offset:1024 sc1 lds
v_mfma_f32_16x16x32_bf16 a[24:27], a[236:239], a[216:219], a[24:27]
ds_read_b128 a[176:179], v201 offset:4096
v_fma_f32 v163, v210, v160, v163
v_mfma_f32_16x16x32_bf16 a[28:31], a[236:239], a[220:223], a[28:31]
ds_read_b64_tr_b16 a[236:237], v203 offset:4096
v_fma_f32 v160, v209, v162, v137
v_fma_f32 v161, v209, v163, v233
v_mfma_f32_16x16x32_bf16 v[32:35], a[240:243], a[192:195], v[32:35]
ds_read_b64_tr_b16 a[238:239], v203 offset:6144
v_fma_f32 v160, -v210, v163, v160
v_mfma_f32_16x16x32_bf16 v[36:39], a[240:243], a[196:199], v[36:39]
v_fma_f32 v161, v210, v162, v161
v_fma_f32 v162, v209, v160, v138
v_fma_f32 v163, v209, v161, v234
v_mfma_f32_16x16x32_bf16 v[40:43], a[240:243], a[200:203], v[40:43]
v_fma_f32 v162, -v210, v161, v162
v_fma_f32 v163, v210, v160, v163
v_mfma_f32_16x16x32_bf16 v[44:47], a[240:243], a[204:207], v[44:47]
ds_read_b128 a[180:183], v201 offset:5120
v_fma_f32 v160, v209, v162, v139
v_mfma_f32_16x16x32_bf16 v[48:51], a[240:243], a[208:211], v[48:51]
buffer_load_dwordx4 v200, s[20:23], s38 offen offset:2048 sc1 lds
v_mfma_f32_16x16x32_bf16 v[52:55], a[240:243], a[212:215], v[52:55]
v_fma_f32 v161, v209, v163, v235
v_fma_f32 v160, -v210, v163, v160
v_fma_f32 v161, v210, v162, v161
v_mfma_f32_16x16x32_bf16 v[56:59], a[240:243], a[216:219], v[56:59]
v_fma_f32 v162, v209, v160, v140
v_fma_f32 v163, v209, v161, v236
v_fma_f32 v162, -v210, v161, v162
v_mfma_f32_16x16x32_bf16 v[60:63], a[240:243], a[220:223], v[60:63]
v_fma_f32 v163, v210, v160, v163
v_fma_f32 v160, v209, v162, v141
v_mfma_f32_16x16x32_bf16 a[32:35], a[244:247], a[192:195], a[32:35]
ds_read_b128 a[184:187], v201 offset:6144
v_fma_f32 v161, v209, v163, v237
v_mfma_f32_16x16x32_bf16 a[36:39], a[244:247], a[196:199], a[36:39]
buffer_load_dwordx4 v200, s[20:23], s38 offen offset:3072 sc1 lds
v_mfma_f32_16x16x32_bf16 a[40:43], a[244:247], a[200:203], a[40:43]
s_sub_u32 s38, s38, 16384
v_fma_f32 v160, -v210, v163, v160
v_fma_f32 v161, v210, v162, v161
v_fma_f32 v162, v209, v160, v142
v_mfma_f32_16x16x32_bf16 a[44:47], a[244:247], a[204:207], a[44:47]
v_fma_f32 v163, v209, v161, v238
v_fma_f32 v162, -v210, v161, v162
v_fma_f32 v163, v210, v160, v163
v_mfma_f32_16x16x32_bf16 a[48:51], a[244:247], a[208:211], a[48:51]
v_fma_f32 v160, v209, v162, v143
v_fma_f32 v161, v209, v163, v239
v_mfma_f32_16x16x32_bf16 a[52:55], a[244:247], a[212:215], a[52:55]
ds_read_b128 a[188:191], v201 offset:7168
v_fma_f32 v160, -v210, v163, v160
v_mfma_f32_16x16x32_bf16 a[56:59], a[244:247], a[216:219], a[56:59]
v_fma_f32 v161, v210, v162, v161
v_fma_f32 v162, v209, v160, v144
v_fma_f32 v163, v209, v161, v240
v_mfma_f32_16x16x32_bf16 a[60:63], a[244:247], a[220:223], a[60:63]
s_waitcnt lgkmcnt(1)
v_fma_f32 v162, -v210, v161, v162
v_fma_f32 v163, v210, v160, v163
v_mfma_f32_16x16x32_bf16 v[64:67], a[224:227], a[160:163], 0
v_fma_f32 v160, v209, v162, v145
v_fma_f32 v161, v209, v163, v241
v_fma_f32 v160, -v210, v163, v160
v_mfma_f32_16x16x32_bf16 v[68:71], a[224:227], a[164:167], 0
v_fma_f32 v161, v210, v162, v161
v_fma_f32 v162, v209, v160, v146
v_mfma_f32_16x16x32_bf16 v[72:75], a[224:227], a[168:171], 0
v_fma_f32 v163, v209, v161, v242
v_fma_f32 v162, -v210, v161, v162
v_mfma_f32_16x16x32_bf16 v[76:79], a[224:227], a[172:175], 0
v_fma_f32 v163, v210, v160, v163
v_fma_f32 v160, v209, v162, v147
v_fma_f32 v161, v209, v163, v243
v_mfma_f32_16x16x32_bf16 v[80:83], a[224:227], a[176:179], 0
v_fma_f32 v160, -v210, v163, v160
v_fma_f32 v161, v210, v162, v161
v_mfma_f32_16x16x32_bf16 v[84:87], a[224:227], a[180:183], 0
v_fma_f32 v162, v209, v160, v148
v_fma_f32 v163, v209, v161, v244
v_fma_f32 v162, -v210, v161, v162
v_mfma_f32_16x16x32_bf16 v[88:91], a[224:227], a[184:187], 0
s_waitcnt lgkmcnt(0)
v_fma_f32 v163, v210, v160, v163
v_fma_f32 v160, v209, v162, v149
v_mfma_f32_16x16x32_bf16 v[92:95], a[224:227], a[188:191], 0
s_waitcnt vmcnt(19)
s_barrier
ds_read_b64_tr_b16 a[224:225], v202 offset:28672
v_mfma_f32_16x16x32_bf16 a[64:67], a[228:231], a[160:163], 0
ds_read_b64_tr_b16 a[226:227], v202 offset:30720
v_fma_f32 v161, v209, v163, v245
v_fma_f32 v160, -v210, v163, v160
v_mfma_f32_16x16x32_bf16 a[68:71], a[228:231], a[164:167], 0
s_add_u32 m0, s63, 73728
ds_read_b128 a[192:195], v201 offset:28672
v_fma_f32 v161, v210, v162, v161
v_mfma_f32_16x16x32_bf16 a[72:75], a[228:231], a[168:171], 0
buffer_load_dwordx4 v207, s[24:27], s46 offen lds
v_mfma_f32_16x16x32_bf16 a[76:79], a[228:231], a[172:175], 0
v_fma_f32 v162, v209, v160, v150
v_fma_f32 v163, v209, v161, v246
v_fma_f32 v162, -v210, v161, v162
v_mfma_f32_16x16x32_bf16 a[80:83], a[228:231], a[176:179], 0
ds_read_b128 a[196:199], v201 offset:29696
v_fma_f32 v163, v210, v160, v163
v_mfma_f32_16x16x32_bf16 a[84:87], a[228:231], a[180:183], 0
buffer_load_dwordx4 v208, s[24:27], s46 offen offset:1024 lds
v_mfma_f32_16x16x32_bf16 a[88:91], a[228:231], a[184:187], 0
s_sub_u32 s46, s46, 294912
v_fma_f32 v160, v209, v162, v151
v_fma_f32 v161, v209, v163, v247
v_fma_f32 v160, -v210, v163, v160
v_mfma_f32_16x16x32_bf16 a[92:95], a[228:231], a[188:191], 0
ds_read_b64_tr_b16 a[228:229], v202 offset:32768
ds_read_b128 a[200:203], v201 offset:30720
v_fma_f32 v161, v210, v162, v161
v_mfma_f32_16x16x32_bf16 v[96:99], a[232:235], a[160:163], 0
s_add_u32 m0, s43, 57344
ds_read_b64_tr_b16 a[230:231], v202 offset:34816
v_fma_f32 v162, v209, v160, v152
v_mfma_f32_16x16x32_bf16 v[100:103], a[232:235], a[164:167], 0
buffer_load_dwordx4 v200, s[20:23], s38 offen offset:0 sc1 lds
v_mfma_f32_16x16x32_bf16 v[104:107], a[232:235], a[168:171], 0
ds_read_b128 a[204:207], v201 offset:31744
v_fma_f32 v163, v209, v161, v248
v_fma_f32 v162, -v210, v161, v162
v_mfma_f32_16x16x32_bf16 v[108:111], a[232:235], a[172:175], 0
v_fma_f32 v163, v210, v160, v163
v_fma_f32 v160, v209, v162, v153
v_mfma_f32_16x16x32_bf16 v[112:115], a[232:235], a[176:179], 0
v_fma_f32 v161, v209, v163, v249
v_fma_f32 v160, -v210, v163, v160
v_fma_f32 v161, v210, v162, v161
v_mfma_f32_16x16x32_bf16 v[116:119], a[232:235], a[180:183], 0
ds_read_b128 a[208:211], v201 offset:32768
v_fma_f32 v162, v209, v160, v154
v_mfma_f32_16x16x32_bf16 v[120:123], a[232:235], a[184:187], 0
buffer_load_dwordx4 v200, s[20:23], s38 offen offset:1024 sc1 lds
v_mfma_f32_16x16x32_bf16 v[124:127], a[232:235], a[188:191], 0
ds_read_b64_tr_b16 a[232:233], v203 offset:28672
v_fma_f32 v163, v209, v161, v250
v_fma_f32 v162, -v210, v161, v162
v_mfma_f32_16x16x32_bf16 a[96:99], a[236:239], a[160:163], 0
ds_read_b64_tr_b16 a[234:235], v203 offset:30720
ds_read_b128 a[212:215], v201 offset:33792
v_mfma_f32_16x16x32_bf16 a[100:103], a[236:239], a[164:167], 0
buffer_load_dwordx4 v200, s[20:23], s38 offen offset:2048 sc1 lds
v_mfma_f32_16x16x32_bf16 a[104:107], a[236:239], a[168:171], 0
v_fma_f32 v163, v210, v160, v163
v_fma_f32 v160, v209, v162, v155
v_fma_f32 v161, v209, v163, v251
v_mfma_f32_16x16x32_bf16 a[108:111], a[236:239], a[172:175], 0
ds_read_b128 a[216:219], v201 offset:34816
v_fma_f32 v160, -v210, v163, v160
v_mfma_f32_16x16x32_bf16 a[112:115], a[236:239], a[176:179], 0
buffer_load_dwordx4 v200, s[20:23], s38 offen offset:3072 sc1 lds
v_mfma_f32_16x16x32_bf16 a[116:119], a[236:239], a[180:183], 0
s_sub_u32 s38, s38, 16384
v_fma_f32 v161, v210, v162, v161
v_fma_f32 v162, v209, v160, v156
v_fma_f32 v163, v209, v161, v252
v_mfma_f32_16x16x32_bf16 a[120:123], a[236:239], a[184:187], 0
ds_read_b128 a[220:223], v201 offset:35840
v_fma_f32 v162, -v210, v161, v162
v_fma_f32 v163, v210, v160, v163
v_mfma_f32_16x16x32_bf16 a[124:127], a[236:239], a[188:191], 0
s_waitcnt lgkmcnt(2)
ds_read_b64_tr_b16 a[236:237], v203 offset:32768
ds_read_b64_tr_b16 a[238:239], v203 offset:34816
v_mfma_f32_16x16x32_bf16 v[64:67], a[224:227], a[192:195], v[64:67]
v_fma_f32 v160, v209, v162, v157
v_fma_f32 v161, v209, v163, v253
v_mfma_f32_16x16x32_bf16 v[68:71], a[224:227], a[196:199], v[68:71]
v_add_u32 v201, 57344, v201
v_fma_f32 v160, -v210, v163, v160
v_fma_f32 v161, v210, v162, v161
v_mfma_f32_16x16x32_bf16 v[72:75], a[224:227], a[200:203], v[72:75]
v_fma_f32 v162, v209, v160, v158
v_fma_f32 v163, v209, v161, v254
v_mfma_f32_16x16x32_bf16 v[76:79], a[224:227], a[204:207], v[76:79]
v_add_u32 v202, 57344, v202
v_fma_f32 v162, -v210, v161, v162
v_fma_f32 v163, v210, v160, v163
v_mfma_f32_16x16x32_bf16 v[80:83], a[224:227], a[208:211], v[80:83]
v_fma_f32 v160, v209, v162, v159
v_fma_f32 v161, v209, v163, v255
v_mfma_f32_16x16x32_bf16 v[84:87], a[224:227], a[212:215], v[84:87]
s_waitcnt lgkmcnt(2)
v_add_u32 v203, 57344, v203
v_fma_f32 v160, -v210, v163, v160
v_mfma_f32_16x16x32_bf16 v[88:91], a[224:227], a[216:219], v[88:91]
v_fma_f32 v161, v210, v162, v161
v_mul_f32 v164, v211, v160
v_mul_f32 v168, v211, v161
v_mfma_f32_16x16x32_bf16 v[92:95], a[224:227], a[220:223], v[92:95]
s_waitcnt vmcnt(18) lgkmcnt(0)
s_barrier
ds_read_b64_tr_b16 a[224:225], v202 offset:0
v_mfma_f32_16x16x32_bf16 a[64:67], a[228:231], a[192:195], a[64:67]
ds_read_b64_tr_b16 a[226:227], v202 offset:2048
v_fma_f32 v164, -v212, v161, v164
v_fma_f32 v168, -v212, v160, -v168
v_mfma_f32_16x16x32_bf16 a[68:71], a[228:231], a[196:199], a[68:71]
s_add_u32 m0, s63, 102400
ds_read_b128 a[160:163], v201 offset:0
v_mov_b32 v166, v164
v_mfma_f32_16x16x32_bf16 a[72:75], a[228:231], a[200:203], a[72:75]
buffer_load_dwordx4 v207, s[24:27], s46 offen lds
v_mfma_f32_16x16x32_bf16 a[76:79], a[228:231], a[204:207], a[76:79]
v_mov_b32 v170, v168
v_permlane32_swap_b32 v164, v166
s_nop 0
v_permlane32_swap_b32 v168, v170
v_mfma_f32_16x16x32_bf16 a[80:83], a[228:231], a[208:211], a[80:83]
ds_read_b128 a[164:167], v201 offset:1024
v_mov_b32 v165, v164
v_mfma_f32_16x16x32_bf16 a[84:87], a[228:231], a[212:215], a[84:87]
buffer_load_dwordx4 v208, s[24:27], s46 offen offset:1024 lds
v_mfma_f32_16x16x32_bf16 a[88:91], a[228:231], a[216:219], a[88:91]
s_sub_u32 s46, s46, 294912
v_mov_b32 v167, v166
v_mov_b32 v169, v168
v_mov_b32 v171, v170
v_mfma_f32_16x16x32_bf16 a[92:95], a[228:231], a[220:223], a[92:95]
ds_read_b64_tr_b16 a[228:229], v202 offset:4096
ds_read_b128 a[168:171], v201 offset:2048
v_mfma_f32_16x16x32_bf16 v[96:99], a[232:235], a[192:195], v[96:99]
s_add_u32 m0, s43, 86016
ds_read_b64_tr_b16 a[230:231], v202 offset:6144
v_permlane16_swap_b32 v164, v165
v_permlane16_swap_b32 v166, v167
v_mfma_f32_16x16x32_bf16 v[100:103], a[232:235], a[196:199], v[100:103]
buffer_load_dwordx4 v200, s[20:23], s38 offen offset:0 sc1 lds
v_mfma_f32_16x16x32_bf16 v[104:107], a[232:235], a[200:203], v[104:107]
ds_read_b128 a[172:175], v201 offset:3072
v_permlane16_swap_b32 v168, v169
v_permlane16_swap_b32 v170, v171
v_mfma_f32_16x16x32_bf16 v[108:111], a[232:235], a[204:207], v[108:111]
v_fma_f32 v160, v213, v164, v165
v_fma_f32 v161, v213, v168, v169
v_mfma_f32_16x16x32_bf16 v[112:115], a[232:235], a[208:211], v[112:115]
v_fma_f32 v160, -v214, v168, v160
v_fma_f32 v161, v214, v164, v161
v_mfma_f32_16x16x32_bf16 v[116:119], a[232:235], a[212:215], v[116:119]
ds_read_b128 a[176:179], v201 offset:4096
v_fma_f32 v162, v213, v160, v166
v_fma_f32 v163, v213, v161, v170
v_mfma_f32_16x16x32_bf16 v[120:123], a[232:235], a[216:219], v[120:123]
buffer_load_dwordx4 v200, s[20:23], s38 offen offset:1024 sc1 lds
v_mfma_f32_16x16x32_bf16 v[124:127], a[232:235], a[220:223], v[124:127]
ds_read_b64_tr_b16 a[232:233], v203 offset:0
v_fma_f32 v162, -v214, v161, v162
v_fma_f32 v163, v214, v160, v163
v_mfma_f32_16x16x32_bf16 a[96:99], a[236:239], a[192:195], a[96:99]
ds_read_b64_tr_b16 a[234:235], v203 offset:2048
ds_read_b128 a[180:183], v201 offset:5120
v_mfma_f32_16x16x32_bf16 a[100:103], a[236:239], a[196:199], a[100:103]
buffer_load_dwordx4 v200, s[20:23], s38 offen offset:2048 sc1 lds
v_mfma_f32_16x16x32_bf16 a[104:107], a[236:239], a[200:203], a[104:107]
v_fma_f32 v172, v213, v162, v167
v_fma_f32 v174, v213, v163, v171
v_fma_f32 v172, -v214, v163, v172
v_mfma_f32_16x16x32_bf16 a[108:111], a[236:239], a[204:207], a[108:111]
ds_read_b128 a[184:187], v201 offset:6144
v_fma_f32 v174, v214, v162, v174
v_mfma_f32_16x16x32_bf16 a[112:115], a[236:239], a[208:211], a[112:115]
buffer_load_dwordx4 v200, s[20:23], s38 offen offset:3072 sc1 lds
v_mfma_f32_16x16x32_bf16 a[116:119], a[236:239], a[212:215], a[116:119]
s_sub_u32 s38, s38, 16384
buffer_store_dwordx4 v[172:175], v178, s[20:23], s36 offen sc1
v_mul_f32 v160, v211, v128
v_mul_f32 v161, v212, v128
v_mfma_f32_16x16x32_bf16 a[120:123], a[236:239], a[216:219], a[120:123]
ds_read_b128 a[188:191], v201 offset:7168
v_fma_f32 v128, -v212, v224, v160
v_mfma_f32_16x16x32_bf16 a[124:127], a[236:239], a[220:223], a[124:127]
s_waitcnt lgkmcnt(2)
ds_read_b64_tr_b16 a[236:237], v203 offset:4096
ds_read_b64_tr_b16 a[238:239], v203 offset:6144
v_fma_f32 v224, -v211, v224, -v161
v_mfma_f32_16x16x32_bf16 v[64:67], a[224:227], a[160:163], v[64:67]
v_mul_f32 v162, v211, v129
v_mul_f32 v163, v212, v129
v_mfma_f32_16x16x32_bf16 v[68:71], a[224:227], a[164:167], v[68:71]
v_add_u32 v201, 4294852608, v201
v_fma_f32 v129, -v212, v225, v162
v_fma_f32 v225, -v211, v225, -v163
v_mfma_f32_16x16x32_bf16 v[72:75], a[224:227], a[168:171], v[72:75]
v_mul_f32 v160, v211, v130
v_mul_f32 v161, v212, v130
v_mfma_f32_16x16x32_bf16 v[76:79], a[224:227], a[172:175], v[76:79]
v_add_u32 v202, 4294852608, v202
v_fma_f32 v130, -v212, v226, v160
v_mfma_f32_16x16x32_bf16 v[80:83], a[224:227], a[176:179], v[80:83]
v_fma_f32 v226, -v211, v226, -v161
v_mul_f32 v162, v211, v131
v_mul_f32 v163, v212, v131
v_mfma_f32_16x16x32_bf16 v[84:87], a[224:227], a[180:183], v[84:87]
s_waitcnt lgkmcnt(1)
v_add_u32 v203, 4294852608, v203
v_fma_f32 v131, -v212, v227, v162
v_mfma_f32_16x16x32_bf16 v[88:91], a[224:227], a[184:187], v[88:91]
v_fma_f32 v227, -v211, v227, -v163
v_mul_f32 v160, v211, v132
v_mul_f32 v161, v212, v132
v_mfma_f32_16x16x32_bf16 v[92:95], a[224:227], a[188:191], v[92:95]
s_waitcnt vmcnt(19) lgkmcnt(0)
s_barrier
ds_read_b64_tr_b16 a[224:225], v202 offset:0
v_mfma_f32_16x16x32_bf16 a[64:67], a[228:231], a[160:163], a[64:67]
ds_read_b64_tr_b16 a[226:227], v202 offset:2048
v_fma_f32 v132, -v212, v228, v160
v_mfma_f32_16x16x32_bf16 a[68:71], a[228:231], a[164:167], a[68:71]
s_add_u32 m0, s63, 131072
ds_read_b128 a[192:195], v201 offset:0
v_fma_f32 v228, -v211, v228, -v161
v_mul_f32 v162, v211, v133
v_mfma_f32_16x16x32_bf16 a[72:75], a[228:231], a[168:171], a[72:75]
buffer_load_dwordx4 v207, s[24:27], s46 offen lds
v_mfma_f32_16x16x32_bf16 a[76:79], a[228:231], a[172:175], a[76:79]
v_mul_f32 v163, v212, v133
v_fma_f32 v133, -v212, v229, v162
v_fma_f32 v229, -v211, v229, -v163
v_mfma_f32_16x16x32_bf16 a[80:83], a[228:231], a[176:179], a[80:83]
ds_read_b128 a[196:199], v201 offset:1024
v_mul_f32 v160, v211, v134
v_mfma_f32_16x16x32_bf16 a[84:87], a[228:231], a[180:183], a[84:87]
buffer_load_dwordx4 v208, s[24:27], s46 offen offset:1024 lds
v_mfma_f32_16x16x32_bf16 a[88:91], a[228:231], a[184:187], a[88:91]
s_sub_u32 s46, s46, 294912
v_mul_f32 v161, v212, v134
v_fma_f32 v134, -v212, v230, v160
v_fma_f32 v230, -v211, v230, -v161
v_mfma_f32_16x16x32_bf16 a[92:95], a[228:231], a[188:191], a[92:95]
ds_read_b64_tr_b16 a[228:229], v202 offset:4096
ds_read_b128 a[200:203], v201 offset:2048
v_mfma_f32_16x16x32_bf16 v[96:99], a[232:235], a[160:163], v[96:99]
s_add_u32 m0, s43, 114688
ds_read_b64_tr_b16 a[230:231], v202 offset:6144
v_mul_f32 v162, v211, v135
v_mul_f32 v163, v212, v135
v_mfma_f32_16x16x32_bf16 v[100:103], a[232:235], a[164:167], v[100:103]
buffer_load_dwordx4 v200, s[20:23], s38 offen offset:0 sc1 lds
v_mfma_f32_16x16x32_bf16 v[104:107], a[232:235], a[168:171], v[104:107]
ds_read_b128 a[204:207], v201 offset:3072
v_fma_f32 v135, -v212, v231, v162
v_mfma_f32_16x16x32_bf16 v[108:111], a[232:235], a[172:175], v[108:111]
v_fma_f32 v231, -v211, v231, -v163
v_mul_f32 v160, v211, v136
v_mul_f32 v161, v212, v136
v_mfma_f32_16x16x32_bf16 v[112:115], a[232:235], a[176:179], v[112:115]
v_fma_f32 v136, -v212, v232, v160
v_fma_f32 v232, -v211, v232, -v161
v_mfma_f32_16x16x32_bf16 v[116:119], a[232:235], a[180:183], v[116:119]
ds_read_b128 a[208:211], v201 offset:4096
v_mul_f32 v162, v211, v137
v_mul_f32 v163, v212, v137
v_mfma_f32_16x16x32_bf16 v[120:123], a[232:235], a[184:187], v[120:123]
buffer_load_dwordx4 v200, s[20:23], s38 offen offset:1024 sc1 lds
v_mfma_f32_16x16x32_bf16 v[124:127], a[232:235], a[188:191], v[124:127]
ds_read_b64_tr_b16 a[232:233], v203 offset:0
v_fma_f32 v137, -v212, v233, v162
v_mfma_f32_16x16x32_bf16 a[96:99], a[236:239], a[160:163], a[96:99]
ds_read_b64_tr_b16 a[234:235], v203 offset:2048
ds_read_b128 a[212:215], v201 offset:5120
v_fma_f32 v233, -v211, v233, -v163
v_mfma_f32_16x16x32_bf16 a[100:103], a[236:239], a[164:167], a[100:103]
buffer_load_dwordx4 v200, s[20:23], s38 offen offset:2048 sc1 lds
v_mfma_f32_16x16x32_bf16 a[104:107], a[236:239], a[168:171], a[104:107]
v_mul_f32 v160, v211, v138
v_mul_f32 v161, v212, v138
v_fma_f32 v138, -v212, v234, v160
v_mfma_f32_16x16x32_bf16 a[108:111], a[236:239], a[172:175], a[108:111]
ds_read_b128 a[216:219], v201 offset:6144
v_fma_f32 v234, -v211, v234, -v161
v_mfma_f32_16x16x32_bf16 a[112:115], a[236:239], a[176:179], a[112:115]
buffer_load_dwordx4 v200, s[20:23], s38 offen offset:3072 sc1 lds
v_mfma_f32_16x16x32_bf16 a[116:119], a[236:239], a[180:183], a[116:119]
s_sub_u32 s38, s38, 16384
v_mul_f32 v162, v211, v139
v_mul_f32 v163, v212, v139
v_fma_f32 v139, -v212, v235, v162
v_mfma_f32_16x16x32_bf16 a[120:123], a[236:239], a[184:187], a[120:123]
ds_read_b128 a[220:223], v201 offset:7168
v_fma_f32 v235, -v211, v235, -v163
v_mfma_f32_16x16x32_bf16 a[124:127], a[236:239], a[188:191], a[124:127]
s_waitcnt lgkmcnt(2)
ds_read_b64_tr_b16 a[236:237], v203 offset:4096
ds_read_b64_tr_b16 a[238:239], v203 offset:6144
v_mul_f32 v160, v211, v140
v_mfma_f32_16x16x32_bf16 v[64:67], a[224:227], a[192:195], v[64:67]
v_mul_f32 v161, v212, v140
v_fma_f32 v140, -v212, v236, v160
v_mfma_f32_16x16x32_bf16 v[68:71], a[224:227], a[196:199], v[68:71]
v_fma_f32 v236, -v211, v236, -v161
v_mul_f32 v162, v211, v141
v_mfma_f32_16x16x32_bf16 v[72:75], a[224:227], a[200:203], v[72:75]
v_mul_f32 v163, v212, v141
v_fma_f32 v141, -v212, v237, v162
v_fma_f32 v237, -v211, v237, -v163
v_mfma_f32_16x16x32_bf16 v[76:79], a[224:227], a[204:207], v[76:79]
v_mul_f32 v160, v211, v142
v_mul_f32 v161, v212, v142
v_mfma_f32_16x16x32_bf16 v[80:83], a[224:227], a[208:211], v[80:83]
v_fma_f32 v142, -v212, v238, v160
v_fma_f32 v238, -v211, v238, -v161
v_mul_f32 v162, v211, v143
v_mfma_f32_16x16x32_bf16 v[84:87], a[224:227], a[212:215], v[84:87]
s_waitcnt lgkmcnt(1)
v_mul_f32 v163, v212, v143
v_fma_f32 v143, -v212, v239, v162
v_mfma_f32_16x16x32_bf16 v[88:91], a[224:227], a[216:219], v[88:91]
v_fma_f32 v239, -v211, v239, -v163
v_mul_f32 v160, v211, v144
v_mfma_f32_16x16x32_bf16 v[92:95], a[224:227], a[220:223], v[92:95]
s_waitcnt vmcnt(19) lgkmcnt(0)
s_barrier
ds_read_b64_tr_b16 a[224:225], v202 offset:28672
v_mul_f32 v161, v212, v144
v_mfma_f32_16x16x32_bf16 a[64:67], a[228:231], a[192:195], a[64:67]
ds_read_b64_tr_b16 a[226:227], v202 offset:30720
v_fma_f32 v144, -v212, v240, v160
v_mfma_f32_16x16x32_bf16 a[68:71], a[228:231], a[196:199], a[68:71]
s_add_u32 m0, s63, 16384
ds_read_b128 a[160:163], v201 offset:28672
v_fma_f32 v240, -v211, v240, -v161
v_mul_f32 v162, v211, v145
v_mfma_f32_16x16x32_bf16 a[72:75], a[228:231], a[200:203], a[72:75]
buffer_load_dwordx4 v207, s[24:27], s46 offen lds
v_mfma_f32_16x16x32_bf16 a[76:79], a[228:231], a[204:207], a[76:79]
v_mul_f32 v163, v212, v145
v_fma_f32 v145, -v212, v241, v162
v_mfma_f32_16x16x32_bf16 a[80:83], a[228:231], a[208:211], a[80:83]
ds_read_b128 a[164:167], v201 offset:29696
v_fma_f32 v241, -v211, v241, -v163
v_mul_f32 v160, v211, v146
v_mfma_f32_16x16x32_bf16 a[84:87], a[228:231], a[212:215], a[84:87]
buffer_load_dwordx4 v208, s[24:27], s46 offen offset:1024 lds
v_mfma_f32_16x16x32_bf16 a[88:91], a[228:231], a[216:219], a[88:91]
s_sub_u32 s46, s46, 294912
v_mul_f32 v161, v212, v146
v_fma_f32 v146, -v212, v242, v160
v_fma_f32 v242, -v211, v242, -v161
v_mfma_f32_16x16x32_bf16 a[92:95], a[228:231], a[220:223], a[92:95]
ds_read_b64_tr_b16 a[228:229], v202 offset:32768
ds_read_b128 a[168:171], v201 offset:30720
v_mfma_f32_16x16x32_bf16 v[96:99], a[232:235], a[192:195], v[96:99]
s_add_u32 m0, s43, 0
ds_read_b64_tr_b16 a[230:231], v202 offset:34816
v_mul_f32 v162, v211, v147
v_mfma_f32_16x16x32_bf16 v[100:103], a[232:235], a[196:199], v[100:103]
buffer_load_dwordx4 v200, s[20:23], s38 offen offset:0 sc1 lds
v_mfma_f32_16x16x32_bf16 v[104:107], a[232:235], a[200:203], v[104:107]
ds_read_b128 a[172:175], v201 offset:31744
v_mul_f32 v163, v212, v147
v_fma_f32 v147, -v212, v243, v162
v_mfma_f32_16x16x32_bf16 v[108:111], a[232:235], a[204:207], v[108:111]
v_fma_f32 v243, -v211, v243, -v163
v_mul_f32 v160, v211, v148
v_mul_f32 v161, v212, v148
v_mfma_f32_16x16x32_bf16 v[112:115], a[232:235], a[208:211], v[112:115]
v_fma_f32 v148, -v212, v244, v160
v_fma_f32 v244, -v211, v244, -v161
v_mfma_f32_16x16x32_bf16 v[116:119], a[232:235], a[212:215], v[116:119]
ds_read_b128 a[176:179], v201 offset:32768
v_mul_f32 v162, v211, v149
v_mfma_f32_16x16x32_bf16 v[120:123], a[232:235], a[216:219], v[120:123]
buffer_load_dwordx4 v200, s[20:23], s38 offen offset:1024 sc1 lds
v_mfma_f32_16x16x32_bf16 v[124:127], a[232:235], a[220:223], v[124:127]
ds_read_b64_tr_b16 a[232:233], v203 offset:28672
v_mul_f32 v163, v212, v149
v_fma_f32 v149, -v212, v245, v162
v_mfma_f32_16x16x32_bf16 a[96:99], a[236:239], a[192:195], a[96:99]
ds_read_b64_tr_b16 a[234:235], v203 offset:30720
ds_read_b128 a[180:183], v201 offset:33792
v_fma_f32 v245, -v211, v245, -v163
v_mfma_f32_16x16x32_bf16 a[100:103], a[236:239], a[196:199], a[100:103]
buffer_load_dwordx4 v200, s[20:23], s38 offen offset:2048 sc1 lds
v_mfma_f32_16x16x32_bf16 a[104:107], a[236:239], a[200:203], a[104:107]
v_mul_f32 v160, v211, v150
v_mul_f32 v161, v212, v150
v_mfma_f32_16x16x32_bf16 a[108:111], a[236:239], a[204:207], a[108:111]
ds_read_b128 a[184:187], v201 offset:34816
v_fma_f32 v150, -v212, v246, v160
v_fma_f32 v246, -v211, v246, -v161
T_a_10:
s_cbranch_execz T_a_r
v_mfma_f32_16x16x32_bf16 a[112:115], a[236:239], a[208:211], a[112:115]
buffer_load_dwordx4 v200, s[20:23], s38 offen offset:3072 sc1 lds
v_mfma_f32_16x16x32_bf16 a[116:119], a[236:239], a[212:215], a[116:119]
s_sub_u32 s38, s38, 16384
v_mul_f32 v162, v211, v151
v_mul_f32 v163, v212, v151
v_fma_f32 v151, -v212, v247, v162
v_mfma_f32_16x16x32_bf16 a[120:123], a[236:239], a[216:219], a[120:123]
ds_read_b128 a[188:191], v201 offset:35840
v_fma_f32 v247, -v211, v247, -v163
v_mfma_f32_16x16x32_bf16 a[124:127], a[236:239], a[220:223], a[124:127]
s_waitcnt lgkmcnt(2)
ds_read_b64_tr_b16 a[236:237], v203 offset:32768
ds_read_b64_tr_b16 a[238:239], v203 offset:34816
v_mfma_f32_16x16x32_bf16 v[64:67], a[224:227], a[160:163], v[64:67]
v_mul_f32 v160, v211, v152
v_mul_f32 v161, v212, v152
v_fma_f32 v152, -v212, v248, v160
v_mfma_f32_16x16x32_bf16 v[68:71], a[224:227], a[164:167], v[68:71]
v_add_u32 v201, 57344, v201
v_fma_f32 v248, -v211, v248, -v161
v_mfma_f32_16x16x32_bf16 v[72:75], a[224:227], a[168:171], v[72:75]
v_mul_f32 v162, v211, v153
v_mul_f32 v163, v212, v153
v_fma_f32 v153, -v212, v249, v162
v_mfma_f32_16x16x32_bf16 v[76:79], a[224:227], a[172:175], v[76:79]
v_add_u32 v202, 57344, v202
v_fma_f32 v249, -v211, v249, -v163
v_mfma_f32_16x16x32_bf16 v[80:83], a[224:227], a[176:179], v[80:83]
v_mul_f32 v160, v211, v154
v_mul_f32 v161, v212, v154
v_mfma_f32_16x16x32_bf16 v[84:87], a[224:227], a[180:183], v[84:87]
s_waitcnt lgkmcnt(2)
v_add_u32 v203, 57344, v203
v_fma_f32 v154, -v212, v250, v160
v_fma_f32 v250, -v211, v250, -v161
v_mfma_f32_16x16x32_bf16 v[88:91], a[224:227], a[184:187], v[88:91]
v_mul_f32 v162, v211, v155
v_mul_f32 v163, v212, v155
v_mfma_f32_16x16x32_bf16 v[92:95], a[224:227], a[188:191], v[92:95]
s_waitcnt vmcnt(19) lgkmcnt(0)
s_barrier
ds_read_b64_tr_b16 a[224:225], v202 offset:0
v_fma_f32 v155, -v212, v251, v162
v_mfma_f32_16x16x32_bf16 a[64:67], a[228:231], a[160:163], a[64:67]
ds_read_b64_tr_b16 a[226:227], v202 offset:2048
v_fma_f32 v251, -v211, v251, -v163
v_mfma_f32_16x16x32_bf16 a[68:71], a[228:231], a[164:167], a[68:71]
s_add_u32 m0, s63, 45056
ds_read_b128 a[192:195], v201 offset:0
v_mul_f32 v160, v211, v156
v_mfma_f32_16x16x32_bf16 a[72:75], a[228:231], a[168:171], a[72:75]
buffer_load_dwordx4 v207, s[24:27], s46 offen lds
v_mfma_f32_16x16x32_bf16 a[76:79], a[228:231], a[172:175], a[76:79]
v_mul_f32 v161, v212, v156
v_fma_f32 v156, -v212, v252, v160
v_fma_f32 v252, -v211, v252, -v161
v_mfma_f32_16x16x32_bf16 a[80:83], a[228:231], a[176:179], a[80:83]
ds_read_b128 a[196:199], v201 offset:1024
v_mul_f32 v162, v211, v157
v_mul_f32 v163, v212, v157
v_mfma_f32_16x16x32_bf16 a[84:87], a[228:231], a[180:183], a[84:87]
buffer_load_dwordx4 v208, s[24:27], s46 offen offset:1024 lds
v_mfma_f32_16x16x32_bf16 a[88:91], a[228:231], a[184:187], a[88:91]
s_sub_u32 s46, s46, 294912
v_fma_f32 v157, -v212, v253, v162
v_fma_f32 v253, -v211, v253, -v163
v_mfma_f32_16x16x32_bf16 a[92:95], a[228:231], a[188:191], a[92:95]
ds_read_b64_tr_b16 a[228:229], v202 offset:4096
ds_read_b128 a[200:203], v201 offset:2048
v_mul_f32 v160, v211, v158
v_mfma_f32_16x16x32_bf16 v[96:99], a[232:235], a[160:163], v[96:99]
s_add_u32 m0, s43, 28672
ds_read_b64_tr_b16 a[230:231], v202 offset:6144
v_mul_f32 v161, v212, v158
v_mfma_f32_16x16x32_bf16 v[100:103], a[232:235], a[164:167], v[100:103]
buffer_load_dwordx4 v200, s[20:23], s38 offen offset:0 sc1 lds
v_mfma_f32_16x16x32_bf16 v[104:107], a[232:235], a[168:171], v[104:107]
ds_read_b128 a[204:207], v201 offset:3072
v_fma_f32 v158, -v212, v254, v160
v_fma_f32 v254, -v211, v254, -v161
v_mfma_f32_16x16x32_bf16 v[108:111], a[232:235], a[172:175], v[108:111]
v_mul_f32 v162, v211, v159
v_mul_f32 v163, v212, v159
v_mfma_f32_16x16x32_bf16 v[112:115], a[232:235], a[176:179], v[112:115]
v_fma_f32 v159, -v212, v255, v162
v_fma_f32 v255, -v211, v255, -v163
v_ashrrev_i32 v172, 31, v180
v_mfma_f32_16x16x32_bf16 v[116:119], a[232:235], a[180:183], v[116:119]
ds_read_b128 a[208:211], v201 offset:4096
v_bfi_b32 v172, v172, 0, s96
v_mfma_f32_16x16x32_bf16 v[120:123], a[232:235], a[184:187], v[120:123]
buffer_load_dwordx4 v200, s[20:23], s38 offen offset:1024 sc1 lds
v_mfma_f32_16x16x32_bf16 v[124:127], a[232:235], a[188:191], v[124:127]
ds_read_b64_tr_b16 a[232:233], v203 offset:0
v_ashrrev_i32 v173, 31, v181
v_bfi_b32 v173, v173, 0, s96
v_mfma_f32_16x16x32_bf16 a[96:99], a[236:239], a[160:163], a[96:99]
ds_read_b64_tr_b16 a[234:235], v203 offset:2048
ds_read_b128 a[212:215], v201 offset:5120
v_mfma_f32_16x16x32_bf16 a[100:103], a[236:239], a[164:167], a[100:103]
buffer_load_dwordx4 v200, s[20:23], s38 offen offset:2048 sc1 lds
v_mfma_f32_16x16x32_bf16 a[104:107], a[236:239], a[168:171], a[104:107]
v_ashrrev_i32 v174, 31, v182
v_bfi_b32 v174, v174, 0, s96
v_ashrrev_i32 v175, 31, v183
v_mfma_f32_16x16x32_bf16 a[108:111], a[236:239], a[172:175], a[108:111]
ds_read_b128 a[216:219], v201 offset:6144
v_bfi_b32 v175, v175, 0, s96
s_lshl_b32 s34, s17, 13
v_mfma_f32_16x16x32_bf16 a[112:115], a[236:239], a[176:179], a[112:115]
s_add_u32 s34, s34, 143360
buffer_load_dwordx4 v200, s[20:23], s38 offen offset:3072 sc1 lds
v_mfma_f32_16x16x32_bf16 a[116:119], a[236:239], a[180:183], a[116:119]
s_sub_u32 s38, s38, 16384
v_lshrrev_b32 v176, 8, v200
v_lshlrev_b32 v177, 11, v176
v_mfma_f32_16x16x32_bf16 a[120:123], a[236:239], a[184:187], a[120:123]
ds_read_b128 a[220:223], v201 offset:7168
v_bfe_u32 v178, v200, 4, 4
v_lshl_add_u32 v177, v178, 2, v177
v_mfma_f32_16x16x32_bf16 a[124:127], a[236:239], a[188:191], a[124:127]
s_waitcnt lgkmcnt(2)
ds_read_b64_tr_b16 a[236:237], v203 offset:4096
ds_read_b64_tr_b16 a[238:239], v203 offset:6144
v_mfma_f32_16x16x32_bf16 v[64:67], a[224:227], a[192:195], v[64:67]
v_add_u32 v177, s34, v177
v_lshrrev_b32 v179, 2, v178
v_lshlrev_b32 v179, 11, v179
v_mfma_f32_16x16x32_bf16 v[68:71], a[224:227], a[196:199], v[68:71]
v_and_b32 v178, 3, v178
v_lshl_add_u32 v178, v178, 6, v179
v_mfma_f32_16x16x32_bf16 v[72:75], a[224:227], a[200:203], v[72:75]
v_lshl_add_u32 v178, v176, 4, v178
v_add_u32 v178, s34, v178
v_mfma_f32_16x16x32_bf16 v[76:79], a[224:227], a[204:207], v[76:79]
v_add_u32 v179, 1024, v177
s_add_u32 s36, s62, 144
s_lshl_b32 s36, s36, 10
v_mfma_f32_16x16x32_bf16 v[80:83], a[224:227], a[208:211], v[80:83]
s_add_u32 s36, s36, s88
v_accvgpr_read_b32 v160, a0
v_accvgpr_read_b32 v161, a1
v_mfma_f32_16x16x32_bf16 v[84:87], a[224:227], a[212:215], v[84:87]
s_waitcnt lgkmcnt(1)
v_accvgpr_read_b32 v162, a2
v_accvgpr_read_b32 v163, a3
v_mul_f32 v0, v160, v0
v_mfma_f32_16x16x32_bf16 v[88:91], a[224:227], a[216:219], v[88:91]
v_mul_f32 v1, v161, v1
v_mul_f32 v2, v162, v2
v_mfma_f32_16x16x32_bf16 v[92:95], a[224:227], a[220:223], v[92:95]
s_waitcnt vmcnt(19) lgkmcnt(0)
s_barrier
ds_read_b64_tr_b16 a[224:225], v202 offset:28672
v_mfma_f32_16x16x32_bf16 a[64:67], a[228:231], a[192:195], a[64:67]
ds_read_b64_tr_b16 a[226:227], v202 offset:30720
v_mul_f32 v3, v163, v3
v_accvgpr_read_b32 v160, a32
v_mfma_f32_16x16x32_bf16 a[68:71], a[228:231], a[196:199], a[68:71]
ds_read_b128 a[160:163], v201 offset:28672
v_accvgpr_read_b32 v161, a33
v_mfma_f32_16x16x32_bf16 a[72:75], a[228:231], a[200:203], a[72:75]
v_accvgpr_read_b32 v162, a34
v_accvgpr_read_b32 v163, a35
v_mul_f32 v32, v160, v32
v_mfma_f32_16x16x32_bf16 a[76:79], a[228:231], a[204:207], a[76:79]
v_mul_f32 v33, v161, v33
v_mul_f32 v34, v162, v34
v_mfma_f32_16x16x32_bf16 a[80:83], a[228:231], a[208:211], a[80:83]
ds_read_b128 a[164:167], v201 offset:29696
v_mul_f32 v35, v163, v35
v_mfma_f32_16x16x32_bf16 a[84:87], a[228:231], a[212:215], a[84:87]
v_cvt_pk_bf16_f32 v0, v0, v1
v_cvt_pk_bf16_f32 v1, v2, v3
v_cvt_pk_bf16_f32 v2, v32, v33
v_mfma_f32_16x16x32_bf16 a[88:91], a[228:231], a[216:219], a[88:91]
v_cvt_pk_bf16_f32 v3, v34, v35
buffer_store_dwordx4 v[0:3], v200, s[20:23], s89 offen sc1
v_mfma_f32_16x16x32_bf16 a[92:95], a[228:231], a[220:223], a[92:95]
s_add_u32 s89, s89, 184320
ds_read_b64_tr_b16 a[228:229], v202 offset:32768
ds_read_b128 a[168:171], v201 offset:30720
v_mfma_f32_16x16x32_bf16 v[96:99], a[232:235], a[192:195], v[96:99]
ds_read_b64_tr_b16 a[230:231], v202 offset:34816
v_mfma_f32_16x16x32_bf16 v[100:103], a[232:235], a[196:199], v[100:103]
buffer_load_dwordx4 v[184:187], v180, s[20:23], s37 offen sc1
v_mfma_f32_16x16x32_bf16 v[104:107], a[232:235], a[200:203], v[104:107]
ds_read_b128 a[172:175], v201 offset:31744
v_mfma_f32_16x16x32_bf16 v[108:111], a[232:235], a[204:207], v[108:111]
buffer_load_dwordx4 v[188:191], v181, s[20:23], s37 offen sc1
v_mfma_f32_16x16x32_bf16 v[112:115], a[232:235], a[208:211], v[112:115]
buffer_load_dwordx4 v[192:195], v182, s[20:23], s37 offen sc1
v_mfma_f32_16x16x32_bf16 v[116:119], a[232:235], a[212:215], v[116:119]
ds_read_b128 a[176:179], v201 offset:32768
v_mfma_f32_16x16x32_bf16 v[120:123], a[232:235], a[216:219], v[120:123]
buffer_load_dwordx4 v[196:199], v183, s[20:23], s37 offen sc1
v_mfma_f32_16x16x32_bf16 v[124:127], a[232:235], a[220:223], v[124:127]
ds_read_b64_tr_b16 a[232:233], v203 offset:28672
v_accvgpr_read_b32 v160, a4
v_accvgpr_read_b32 v161, a5
v_mfma_f32_16x16x32_bf16 a[96:99], a[236:239], a[192:195], a[96:99]
ds_read_b64_tr_b16 a[234:235], v203 offset:30720
ds_read_b128 a[180:183], v201 offset:33792
v_mfma_f32_16x16x32_bf16 a[100:103], a[236:239], a[196:199], a[100:103]
v_accvgpr_read_b32 v162, a6
v_accvgpr_read_b32 v163, a7
v_mul_f32 v4, v160, v4
v_mfma_f32_16x16x32_bf16 a[104:107], a[236:239], a[200:203], a[104:107]
v_mul_f32 v5, v161, v5
v_mul_f32 v6, v162, v6
v_mfma_f32_16x16x32_bf16 a[108:111], a[236:239], a[204:207], a[108:111]
ds_read_b128 a[184:187], v201 offset:34816
v_mul_f32 v7, v163, v7
v_mfma_f32_16x16x32_bf16 a[112:115], a[236:239], a[208:211], a[112:115]
v_accvgpr_read_b32 v160, a36
v_accvgpr_read_b32 v161, a37
v_accvgpr_read_b32 v162, a38
v_mfma_f32_16x16x32_bf16 a[116:119], a[236:239], a[212:215], a[116:119]
v_accvgpr_read_b32 v163, a39
v_mul_f32 v36, v160, v36
v_mfma_f32_16x16x32_bf16 a[120:123], a[236:239], a[216:219], a[120:123]
ds_read_b128 a[188:191], v201 offset:35840
v_mul_f32 v37, v161, v37
v_mul_f32 v38, v162, v38
v_mfma_f32_16x16x32_bf16 a[124:127], a[236:239], a[220:223], a[124:127]
s_waitcnt lgkmcnt(2)
ds_read_b64_tr_b16 a[236:237], v203 offset:32768
ds_read_b64_tr_b16 a[238:239], v203 offset:34816
v_mfma_f32_16x16x32_bf16 v[64:67], a[224:227], a[160:163], v[64:67]
v_mul_f32 v39, v163, v39
v_cvt_pk_bf16_f32 v4, v4, v5
v_mfma_f32_16x16x32_bf16 v[68:71], a[224:227], a[164:167], v[68:71]
v_add_u32 v201, 57344, v201
v_cvt_pk_bf16_f32 v5, v6, v7
v_cvt_pk_bf16_f32 v6, v36, v37
v_mfma_f32_16x16x32_bf16 v[72:75], a[224:227], a[168:171], v[72:75]
v_cvt_pk_bf16_f32 v7, v38, v39
v_accvgpr_read_b32 v160, a8
v_mfma_f32_16x16x32_bf16 v[76:79], a[224:227], a[172:175], v[76:79]
v_add_u32 v202, 57344, v202
v_accvgpr_read_b32 v161, a9
v_accvgpr_read_b32 v162, a10
v_mfma_f32_16x16x32_bf16 v[80:83], a[224:227], a[176:179], v[80:83]
buffer_store_dwordx4 v[4:7], v200, s[20:23], s89 offen sc1
s_add_u32 s89, s89, 184320
v_mfma_f32_16x16x32_bf16 v[84:87], a[224:227], a[180:183], v[84:87]
s_waitcnt lgkmcnt(2)
v_add_u32 v203, 57344, v203
v_accvgpr_read_b32 v163, a11
v_mfma_f32_16x16x32_bf16 v[88:91], a[224:227], a[184:187], v[88:91]
v_mul_f32 v8, v160, v8
v_mul_f32 v9, v161, v9
v_mul_f32 v10, v162, v10
v_mfma_f32_16x16x32_bf16 v[92:95], a[224:227], a[188:191], v[92:95]
s_waitcnt vmcnt(18) lgkmcnt(0)
s_barrier
ds_read_b64_tr_b16 a[224:225], v202 offset:0
v_mfma_f32_16x16x32_bf16 a[64:67], a[228:231], a[160:163], a[64:67]
ds_read_b64_tr_b16 a[226:227], v202 offset:2048
v_mul_f32 v11, v163, v11
v_accvgpr_read_b32 v160, a40
v_mfma_f32_16x16x32_bf16 a[68:71], a[228:231], a[164:167], a[68:71]
ds_read_b128 a[192:195], v201 offset:0
v_accvgpr_read_b32 v161, a41
v_mfma_f32_16x16x32_bf16 a[72:75], a[228:231], a[168:171], a[72:75]
v_accvgpr_read_b32 v162, a42
v_accvgpr_read_b32 v163, a43
v_mfma_f32_16x16x32_bf16 a[76:79], a[228:231], a[172:175], a[76:79]
v_mul_f32 v40, v160, v40
v_mul_f32 v41, v161, v41
v_mul_f32 v42, v162, v42
v_mfma_f32_16x16x32_bf16 a[80:83], a[228:231], a[176:179], a[80:83]
ds_read_b128 a[196:199], v201 offset:1024
v_mul_f32 v43, v163, v43
v_mfma_f32_16x16x32_bf16 a[84:87], a[228:231], a[180:183], a[84:87]
v_cvt_pk_bf16_f32 v8, v8, v9
v_cvt_pk_bf16_f32 v9, v10, v11
v_cvt_pk_bf16_f32 v10, v40, v41
v_mfma_f32_16x16x32_bf16 a[88:91], a[228:231], a[184:187], a[88:91]
v_cvt_pk_bf16_f32 v11, v42, v43
v_accvgpr_read_b32 v160, a12
v_mfma_f32_16x16x32_bf16 a[92:95], a[228:231], a[188:191], a[92:95]
ds_read_b64_tr_b16 a[228:229], v202 offset:4096
ds_read_b128 a[200:203], v201 offset:2048
v_mfma_f32_16x16x32_bf16 v[96:99], a[232:235], a[160:163], v[96:99]
ds_read_b64_tr_b16 a[230:231], v202 offset:6144
v_accvgpr_read_b32 v161, a13
v_accvgpr_read_b32 v162, a14
v_mfma_f32_16x16x32_bf16 v[100:103], a[232:235], a[164:167], v[100:103]
buffer_store_dwordx4 v[8:11], v200, s[20:23], s89 offen sc1
s_add_u32 s89, s89, 184320
v_mfma_f32_16x16x32_bf16 v[104:107], a[232:235], a[168:171], v[104:107]
ds_read_b128 a[204:207], v201 offset:3072
v_accvgpr_read_b32 v163, a15
v_mul_f32 v12, v160, v12
v_mfma_f32_16x16x32_bf16 v[108:111], a[232:235], a[172:175], v[108:111]
v_mul_f32 v13, v161, v13
v_mul_f32 v14, v162, v14
v_mfma_f32_16x16x32_bf16 v[112:115], a[232:235], a[176:179], v[112:115]
v_mul_f32 v15, v163, v15
v_accvgpr_read_b32 v160, a44
v_mfma_f32_16x16x32_bf16 v[116:119], a[232:235], a[180:183], v[116:119]
ds_read_b128 a[208:211], v201 offset:4096
v_accvgpr_read_b32 v161, a45
v_accvgpr_read_b32 v162, a46
v_mfma_f32_16x16x32_bf16 v[120:123], a[232:235], a[184:187], v[120:123]
v_accvgpr_read_b32 v163, a47
v_mul_f32 v44, v160, v44
v_mfma_f32_16x16x32_bf16 v[124:127], a[232:235], a[188:191], v[124:127]
ds_read_b64_tr_b16 a[232:233], v203 offset:0
v_mul_f32 v45, v161, v45
v_mul_f32 v46, v162, v46
v_mfma_f32_16x16x32_bf16 a[96:99], a[236:239], a[160:163], a[96:99]
ds_read_b64_tr_b16 a[234:235], v203 offset:2048
ds_read_b128 a[212:215], v201 offset:5120
v_mfma_f32_16x16x32_bf16 a[100:103], a[236:239], a[164:167], a[100:103]
v_mul_f32 v47, v163, v47
v_cvt_pk_bf16_f32 v12, v12, v13
v_mfma_f32_16x16x32_bf16 a[104:107], a[236:239], a[168:171], a[104:107]
v_cvt_pk_bf16_f32 v13, v14, v15
v_cvt_pk_bf16_f32 v14, v44, v45
v_cvt_pk_bf16_f32 v15, v46, v47
v_mfma_f32_16x16x32_bf16 a[108:111], a[236:239], a[172:175], a[108:111]
ds_read_b128 a[216:219], v201 offset:6144
buffer_store_dwordx4 v[12:15], v200, s[20:23], s89 offen sc1
v_mfma_f32_16x16x32_bf16 a[112:115], a[236:239], a[176:179], a[112:115]
s_add_u32 s89, s89, 184320
s_waitcnt vmcnt(3)
v_xor_b32 v160, v185, v172
v_xor_b32 v161, v187, v172
v_mfma_f32_16x16x32_bf16 a[116:119], a[236:239], a[180:183], a[116:119]
v_or_b32 v160, v160, v161
v_xor_b32 v161, v189, v173
v_mfma_f32_16x16x32_bf16 a[120:123], a[236:239], a[184:187], a[120:123]
ds_read_b128 a[220:223], v201 offset:7168
v_xor_b32 v162, v191, v173
v_mfma_f32_16x16x32_bf16 a[124:127], a[236:239], a[188:191], a[124:127]
s_waitcnt lgkmcnt(2)
ds_read_b64_tr_b16 a[236:237], v203 offset:4096
ds_read_b64_tr_b16 a[238:239], v203 offset:6144
v_or3_b32 v160, v160, v161, v162
v_mfma_f32_16x16x32_bf16 v[64:67], a[224:227], a[192:195], v[64:67]
v_xor_b32 v161, v193, v174
v_xor_b32 v162, v195, v174
v_mfma_f32_16x16x32_bf16 v[68:71], a[224:227], a[196:199], v[68:71]
v_add_u32 v201, 4294852608, v201
v_or3_b32 v160, v160, v161, v162
v_xor_b32 v161, v197, v175
v_mfma_f32_16x16x32_bf16 v[72:75], a[224:227], a[200:203], v[72:75]
v_xor_b32 v162, v199, v175
v_or3_b32 v160, v160, v161, v162
v_mfma_f32_16x16x32_bf16 v[76:79], a[224:227], a[204:207], v[76:79]
v_add_u32 v202, 4294852608, v202
v_cmp_ne_u32 vcc, 0, v160
s_cbranch_vccnz lb_6
lb_6_r:
v_mfma_f32_16x16x32_bf16 v[80:83], a[224:227], a[208:211], v[80:83]
v_fma_f32 v160, v215, v184, v188
v_fma_f32 v161, v215, v186, v190
v_fma_f32 v160, -v216, v186, v160
v_mfma_f32_16x16x32_bf16 v[84:87], a[224:227], a[212:215], v[84:87]
s_waitcnt lgkmcnt(0)
v_add_u32 v203, 4294852608, v203
v_fma_f32 v161, v216, v184, v161
v_mfma_f32_16x16x32_bf16 v[88:91], a[224:227], a[216:219], v[88:91]
v_fma_f32 v162, v215, v160, v192
v_fma_f32 v163, v215, v161, v194
v_fma_f32 v162, -v216, v161, v162
v_mfma_f32_16x16x32_bf16 v[92:95], a[224:227], a[220:223], v[92:95]
s_barrier
ds_read_b64_tr_b16 a[224:225], v202 offset:0
v_fma_f32 v163, v216, v160, v163
v_mfma_f32_16x16x32_bf16 a[64:67], a[228:231], a[192:195], a[64:67]
ds_read_b64_tr_b16 a[226:227], v202 offset:2048
v_fma_f32 v172, v215, v162, v196
v_mfma_f32_16x16x32_bf16 a[68:71], a[228:231], a[196:199], a[68:71]
ds_read_b128 a[160:163], v201 offset:0
v_fma_f32 v180, v215, v163, v198
v_fma_f32 v172, -v216, v163, v172
v_mfma_f32_16x16x32_bf16 a[72:75], a[228:231], a[200:203], a[72:75]
v_fma_f32 v180, v216, v162, v180
v_mov_b32 v174, v172
v_mfma_f32_16x16x32_bf16 a[76:79], a[228:231], a[204:207], a[76:79]
v_mov_b32 v182, v180
v_permlane32_swap_b32 v172, v174
s_nop 0
v_permlane32_swap_b32 v180, v182
v_mfma_f32_16x16x32_bf16 a[80:83], a[228:231], a[208:211], a[80:83]
ds_read_b128 a[164:167], v201 offset:1024
v_mov_b32 v173, v172
v_mfma_f32_16x16x32_bf16 a[84:87], a[228:231], a[212:215], a[84:87]
v_mov_b32 v175, v174
v_mov_b32 v181, v180
v_mfma_f32_16x16x32_bf16 a[88:91], a[228:231], a[216:219], a[88:91]
v_mov_b32 v183, v182
v_permlane16_swap_b32 v172, v173
v_permlane16_swap_b32 v174, v175
v_mfma_f32_16x16x32_bf16 a[92:95], a[228:231], a[220:223], a[92:95]
ds_read_b64_tr_b16 a[228:229], v202 offset:4096
ds_read_b128 a[168:171], v201 offset:2048
v_mfma_f32_16x16x32_bf16 v[96:99], a[232:235], a[192:195], v[96:99]
ds_read_b64_tr_b16 a[230:231], v202 offset:6144
v_permlane16_swap_b32 v180, v181
v_permlane16_swap_b32 v182, v183
v_mfma_f32_16x16x32_bf16 v[100:103], a[232:235], a[196:199], v[100:103]
v_fma_f32 v160, v217, v172, v173
v_fma_f32 v161, v217, v180, v181
v_mfma_f32_16x16x32_bf16 v[104:107], a[232:235], a[200:203], v[104:107]
ds_read_b128 a[172:175], v201 offset:3072
v_fma_f32 v160, -v218, v180, v160
v_mfma_f32_16x16x32_bf16 v[108:111], a[232:235], a[204:207], v[108:111]
v_fma_f32 v161, v218, v172, v161
v_fma_f32 v162, v217, v160, v174
v_fma_f32 v163, v217, v161, v182
v_mfma_f32_16x16x32_bf16 v[112:115], a[232:235], a[208:211], v[112:115]
v_fma_f32 v162, -v218, v161, v162
v_fma_f32 v163, v218, v160, v163
v_mfma_f32_16x16x32_bf16 v[116:119], a[232:235], a[212:215], v[116:119]
ds_read_b128 a[176:179], v201 offset:4096
v_fma_f32 v184, v217, v162, v175
v_fma_f32 v185, v217, v163, v183
v_mfma_f32_16x16x32_bf16 v[120:123], a[232:235], a[216:219], v[120:123]
v_fma_f32 v184, -v218, v163, v184
v_fma_f32 v185, v218, v162, v185
v_mfma_f32_16x16x32_bf16 v[124:127], a[232:235], a[220:223], v[124:127]
ds_read_b64_tr_b16 a[232:233], v203 offset:0
v_mov_b32 v160, v184
v_mfma_f32_16x16x32_bf16 a[96:99], a[236:239], a[192:195], a[96:99]
ds_read_b64_tr_b16 a[234:235], v203 offset:2048
ds_read_b128 a[180:183], v201 offset:5120
v_mov_b32 v161, v185
v_mfma_f32_16x16x32_bf16 a[100:103], a[236:239], a[196:199], a[100:103]
v_cmp_eq_u32 vcc, 1, v176
v_fma_f32 v186, v213, v184, v164
v_mfma_f32_16x16x32_bf16 a[104:107], a[236:239], a[200:203], a[104:107]
v_fma_f32 v187, v213, v185, v168
v_fma_f32 v186, -v214, v185, v186
v_fma_f32 v187, v214, v184, v187
v_mfma_f32_16x16x32_bf16 a[108:111], a[236:239], a[204:207], a[108:111]
ds_read_b128 a[184:187], v201 offset:6144
v_cndmask_b32 v160, v160, v186, vcc
v_mfma_f32_16x16x32_bf16 a[112:115], a[236:239], a[208:211], a[112:115]
v_cndmask_b32 v161, v161, v187, vcc
v_cmp_eq_u32 vcc, 2, v176
v_mfma_f32_16x16x32_bf16 a[116:119], a[236:239], a[212:215], a[116:119]
v_fma_f32 v188, v213, v186, v165
v_fma_f32 v189, v213, v187, v169
v_fma_f32 v188, -v214, v187, v188
v_mfma_f32_16x16x32_bf16 a[120:123], a[236:239], a[216:219], a[120:123]
ds_read_b128 a[188:191], v201 offset:7168
v_fma_f32 v189, v214, v186, v189
v_mfma_f32_16x16x32_bf16 a[124:127], a[236:239], a[220:223], a[124:127]
s_waitcnt lgkmcnt(2)
ds_read_b64_tr_b16 a[236:237], v203 offset:4096
ds_read_b64_tr_b16 a[238:239], v203 offset:6144
v_cndmask_b32 v160, v160, v188, vcc
v_mfma_f32_16x16x32_bf16 v[64:67], a[224:227], a[160:163], v[64:67]
v_cndmask_b32 v161, v161, v189, vcc
v_cmp_eq_u32 vcc, 3, v176
v_mfma_f32_16x16x32_bf16 v[68:71], a[224:227], a[164:167], v[68:71]
v_fma_f32 v190, v213, v188, v166
v_fma_f32 v191, v213, v189, v170
v_mfma_f32_16x16x32_bf16 v[72:75], a[224:227], a[168:171], v[72:75]
v_fma_f32 v190, -v214, v189, v190
v_fma_f32 v191, v214, v188, v191
v_cndmask_b32 v160, v160, v190, vcc
v_mfma_f32_16x16x32_bf16 v[76:79], a[224:227], a[172:175], v[76:79]
v_cndmask_b32 v161, v161, v191, vcc
v_lshlrev_b32 v217, 22, v200
v_mfma_f32_16x16x32_bf16 v[80:83], a[224:227], a[176:179], v[80:83]
v_mov_b32 v218, s96
v_add_u32 v214, s51, v200
v_fmac_f32 v128, v209, v160
v_mfma_f32_16x16x32_bf16 v[84:87], a[224:227], a[180:183], v[84:87]
s_waitcnt lgkmcnt(1)
v_fmac_f32 v224, v209, v161
v_fmac_f32 v128, v210, v161
v_mfma_f32_16x16x32_bf16 v[88:91], a[224:227], a[184:187], v[88:91]
v_fma_f32 v224, -v210, v160, v224
v_cvt_pk_bf16_f32 v162, v128, v224
v_mfma_f32_16x16x32_bf16 v[92:95], a[224:227], a[188:191], v[92:95]
s_waitcnt lgkmcnt(0)
s_barrier
ds_read_b64_tr_b16 a[224:225], v202 offset:28672
v_fmac_f32 v129, v209, v128
v_mfma_f32_16x16x32_bf16 a[64:67], a[228:231], a[160:163], a[64:67]
ds_read_b64_tr_b16 a[226:227], v202 offset:30720
v_fmac_f32 v225, v209, v224
v_mfma_f32_16x16x32_bf16 a[68:71], a[228:231], a[164:167], a[68:71]
ds_read_b128 a[192:195], v201 offset:28672
v_fmac_f32 v129, v210, v224
v_fma_f32 v225, -v210, v128, v225
v_mfma_f32_16x16x32_bf16 a[72:75], a[228:231], a[168:171], a[72:75]
v_cvt_pk_bf16_f32 v163, v129, v225
v_fmac_f32 v130, v209, v129
v_mfma_f32_16x16x32_bf16 a[76:79], a[228:231], a[172:175], a[76:79]
v_fmac_f32 v226, v209, v225
v_fmac_f32 v130, v210, v225
v_mfma_f32_16x16x32_bf16 a[80:83], a[228:231], a[176:179], a[80:83]
ds_read_b128 a[196:199], v201 offset:29696
ds_write2_b32 v177, v162, v163 offset0:0 offset1:16
v_fma_f32 v226, -v210, v129, v226
v_mfma_f32_16x16x32_bf16 a[84:87], a[228:231], a[180:183], a[84:87]
v_cvt_pk_bf16_f32 v164, v130, v226
v_fmac_f32 v131, v209, v130
v_mfma_f32_16x16x32_bf16 a[88:91], a[228:231], a[184:187], a[88:91]
v_fmac_f32 v227, v209, v226
v_fmac_f32 v131, v210, v226
v_fma_f32 v227, -v210, v130, v227
v_mfma_f32_16x16x32_bf16 a[92:95], a[228:231], a[188:191], a[92:95]
ds_read_b64_tr_b16 a[228:229], v202 offset:32768
ds_read_b128 a[200:203], v201 offset:30720
v_mfma_f32_16x16x32_bf16 v[96:99], a[232:235], a[160:163], v[96:99]
ds_read_b64_tr_b16 a[230:231], v202 offset:34816
v_cvt_pk_bf16_f32 v165, v131, v227
v_mfma_f32_16x16x32_bf16 v[100:103], a[232:235], a[164:167], v[100:103]
v_fmac_f32 v132, v209, v131
v_fmac_f32 v228, v209, v227
v_fmac_f32 v132, v210, v227
v_mfma_f32_16x16x32_bf16 v[104:107], a[232:235], a[168:171], v[104:107]
ds_read_b128 a[204:207], v201 offset:31744
ds_write2_b32 v177, v164, v165 offset0:32 offset1:48
v_mfma_f32_16x16x32_bf16 v[108:111], a[232:235], a[172:175], v[108:111]
v_fma_f32 v228, -v210, v131, v228
v_cvt_pk_bf16_f32 v166, v132, v228
v_fmac_f32 v133, v209, v132
v_mfma_f32_16x16x32_bf16 v[112:115], a[232:235], a[176:179], v[112:115]
v_fmac_f32 v229, v209, v228
v_fmac_f32 v133, v210, v228
v_mfma_f32_16x16x32_bf16 v[116:119], a[232:235], a[180:183], v[116:119]
ds_read_b128 a[208:211], v201 offset:32768
v_fma_f32 v229, -v210, v132, v229
v_mfma_f32_16x16x32_bf16 v[120:123], a[232:235], a[184:187], v[120:123]
v_cvt_pk_bf16_f32 v167, v133, v229
ds_read_b128 v[128:131], v178 offset:0
v_fmac_f32 v134, v209, v133
v_mfma_f32_16x16x32_bf16 v[124:127], a[232:235], a[188:191], v[124:127]
ds_read_b64_tr_b16 a[232:233], v203 offset:28672
v_fmac_f32 v230, v209, v229
v_mfma_f32_16x16x32_bf16 a[96:99], a[236:239], a[160:163], a[96:99]
ds_read_b64_tr_b16 a[234:235], v203 offset:30720
ds_read_b128 a[212:215], v201 offset:33792
v_fmac_f32 v134, v210, v229
v_mfma_f32_16x16x32_bf16 a[100:103], a[236:239], a[164:167], a[100:103]
ds_write2_b32 v177, v166, v167 offset0:64 offset1:80
v_fma_f32 v230, -v210, v133, v230
v_mfma_f32_16x16x32_bf16 a[104:107], a[236:239], a[168:171], a[104:107]
v_cvt_pk_bf16_f32 v168, v134, v230
v_fmac_f32 v135, v209, v134
v_mfma_f32_16x16x32_bf16 a[108:111], a[236:239], a[172:175], a[108:111]
ds_read_b128 a[216:219], v201 offset:34816
v_fmac_f32 v231, v209, v230
v_fmac_f32 v135, v210, v230
v_mfma_f32_16x16x32_bf16 a[112:115], a[236:239], a[176:179], a[112:115]
v_fma_f32 v231, -v210, v134, v231
v_cvt_pk_bf16_f32 v169, v135, v231
v_mfma_f32_16x16x32_bf16 a[116:119], a[236:239], a[180:183], a[116:119]
v_fmac_f32 v136, v209, v135
v_fmac_f32 v232, v209, v231
v_fmac_f32 v136, v210, v231
v_mfma_f32_16x16x32_bf16 a[120:123], a[236:239], a[184:187], a[120:123]
ds_read_b128 a[220:223], v201 offset:35840
ds_write2_b32 v177, v168, v169 offset0:96 offset1:112
v_mfma_f32_16x16x32_bf16 a[124:127], a[236:239], a[188:191], a[124:127]
s_waitcnt lgkmcnt(4)
ds_read_b64_tr_b16 a[236:237], v203 offset:32768
ds_read_b64_tr_b16 a[238:239], v203 offset:34816
v_mfma_f32_16x16x32_bf16 v[64:67], a[224:227], a[192:195], v[64:67]
v_fma_f32 v232, -v210, v135, v232
v_cvt_pk_bf16_f32 v162, v136, v232
v_fmac_f32 v137, v209, v136
v_mfma_f32_16x16x32_bf16 v[68:71], a[224:227], a[196:199], v[68:71]
v_add_u32 v201, 57344, v201
v_fmac_f32 v233, v209, v232
v_mfma_f32_16x16x32_bf16 v[72:75], a[224:227], a[200:203], v[72:75]
v_fmac_f32 v137, v210, v232
v_fma_f32 v233, -v210, v136, v233
v_cvt_pk_bf16_f32 v163, v137, v233
v_mfma_f32_16x16x32_bf16 v[76:79], a[224:227], a[204:207], v[76:79]
v_add_u32 v202, 57344, v202
ds_read_b128 v[132:135], v178 offset:256
v_mfma_f32_16x16x32_bf16 v[80:83], a[224:227], a[208:211], v[80:83]
buffer_store_dwordx4 v[128:131], v200, s[20:23], s36 offen sc1
s_add_u32 s36, s36, 184320
v_mfma_f32_16x16x32_bf16 v[84:87], a[224:227], a[212:215], v[84:87]
s_waitcnt lgkmcnt(3)
v_add_u32 v203, 57344, v203
v_fmac_f32 v138, v209, v137
v_fmac_f32 v234, v209, v233
v_mfma_f32_16x16x32_bf16 v[88:91], a[224:227], a[216:219], v[88:91]
T_a_11:
s_cbranch_execz T_a_r
v_fmac_f32 v138, v210, v233
ds_write2_b32 v177, v162, v163 offset0:128 offset1:144
v_mfma_f32_16x16x32_bf16 v[92:95], a[224:227], a[220:223], v[92:95]
s_waitcnt lgkmcnt(2)
s_barrier
ds_read_b64_tr_b16 a[224:225], v202 offset:0
v_fma_f32 v234, -v210, v137, v234
v_mfma_f32_16x16x32_bf16 a[64:67], a[228:231], a[192:195], a[64:67]
ds_read_b64_tr_b16 a[226:227], v202 offset:2048
v_cvt_pk_bf16_f32 v164, v138, v234
v_mfma_f32_16x16x32_bf16 a[68:71], a[228:231], a[196:199], a[68:71]
ds_read_b128 a[160:163], v201 offset:0
v_fmac_f32 v139, v209, v138
v_mfma_f32_16x16x32_bf16 a[72:75], a[228:231], a[200:203], a[72:75]
v_fmac_f32 v235, v209, v234
v_fmac_f32 v139, v210, v234
v_fma_f32 v235, -v210, v138, v235
v_mfma_f32_16x16x32_bf16 a[76:79], a[228:231], a[204:207], a[76:79]
s_lshl_b32 s6, s13, 2
v_cvt_pk_bf16_f32 v165, v139, v235
v_fmac_f32 v140, v209, v139
v_mfma_f32_16x16x32_bf16 a[80:83], a[228:231], a[208:211], a[80:83]
s_add_u32 s6, s6, s3
ds_read_b128 a[164:167], v201 offset:1024
v_fmac_f32 v236, v209, v235
v_fmac_f32 v140, v210, v235
v_mfma_f32_16x16x32_bf16 a[84:87], a[228:231], a[212:215], a[84:87]
s_cmp_ge_u32 s6, 64
s_cselect_b32 s80, s10, s8
s_cselect_b32 s81, s11, s9
v_mfma_f32_16x16x32_bf16 a[88:91], a[228:231], a[216:219], a[88:91]
ds_write2_b32 v177, v164, v165 offset0:160 offset1:176
v_fma_f32 v236, -v210, v139, v236
v_mfma_f32_16x16x32_bf16 a[92:95], a[228:231], a[220:223], a[92:95]
s_and_b32 s6, s6, 63
ds_read_b64_tr_b16 a[228:229], v202 offset:4096
ds_read_b128 a[168:171], v201 offset:2048
v_cvt_pk_bf16_f32 v166, v140, v236
v_mfma_f32_16x16x32_bf16 v[96:99], a[232:235], a[192:195], v[96:99]
s_add_u32 s6, s6, 512
ds_read_b64_tr_b16 a[230:231], v202 offset:6144
v_fmac_f32 v141, v209, v140
v_mfma_f32_16x16x32_bf16 v[100:103], a[232:235], a[196:199], v[100:103]
s_mul_i32 s6, s6, 1152
v_fmac_f32 v237, v209, v236
v_fmac_f32 v141, v210, v236
v_fma_f32 v237, -v210, v140, v237
v_mfma_f32_16x16x32_bf16 v[104:107], a[232:235], a[200:203], v[104:107]
ds_read_b128 a[172:175], v201 offset:3072
v_cvt_pk_bf16_f32 v167, v141, v237
v_mfma_f32_16x16x32_bf16 v[108:111], a[232:235], a[204:207], v[108:111]
v_lshlrev_b32 v222, 3, v200
v_min_u32 v222, 1024, v222
buffer_load_dword a255, v222, s[80:83], s6 offen
v_mfma_f32_16x16x32_bf16 v[112:115], a[232:235], a[208:211], v[112:115]
ds_read_b128 v[136:139], v178 offset:512
s_waitcnt lgkmcnt(4)
buffer_store_dwordx4 v[132:135], v200, s[20:23], s36 offen sc1
v_mfma_f32_16x16x32_bf16 v[116:119], a[232:235], a[212:215], v[116:119]
s_add_u32 s36, s36, 184320
ds_read_b128 a[176:179], v201 offset:4096
v_fmac_f32 v142, v209, v141
v_mfma_f32_16x16x32_bf16 v[120:123], a[232:235], a[216:219], v[120:123]
v_fmac_f32 v238, v209, v237
v_fmac_f32 v142, v210, v237
ds_write2_b32 v177, v166, v167 offset0:192 offset1:208
v_mfma_f32_16x16x32_bf16 v[124:127], a[232:235], a[220:223], v[124:127]
ds_read_b64_tr_b16 a[232:233], v203 offset:0
v_fma_f32 v238, -v210, v141, v238
v_mfma_f32_16x16x32_bf16 a[96:99], a[236:239], a[192:195], a[96:99]
ds_read_b64_tr_b16 a[234:235], v203 offset:2048
ds_read_b128 a[180:183], v201 offset:5120
v_mfma_f32_16x16x32_bf16 a[100:103], a[236:239], a[196:199], a[100:103]
v_cvt_pk_bf16_f32 v168, v142, v238
v_fmac_f32 v143, v209, v142
v_fmac_f32 v239, v209, v238
v_mfma_f32_16x16x32_bf16 a[104:107], a[236:239], a[200:203], a[104:107]
v_fmac_f32 v143, v210, v238
v_fma_f32 v239, -v210, v142, v239
v_mfma_f32_16x16x32_bf16 a[108:111], a[236:239], a[204:207], a[108:111]
ds_read_b128 a[184:187], v201 offset:6144
v_cvt_pk_bf16_f32 v169, v143, v239
v_fmac_f32 v144, v209, v143
v_mfma_f32_16x16x32_bf16 a[112:115], a[236:239], a[208:211], a[112:115]
v_fmac_f32 v240, v209, v239
v_fmac_f32 v144, v210, v239
v_mfma_f32_16x16x32_bf16 a[116:119], a[236:239], a[212:215], a[116:119]
ds_write2_b32 v177, v168, v169 offset0:224 offset1:240
v_fma_f32 v240, -v210, v143, v240
v_mfma_f32_16x16x32_bf16 a[120:123], a[236:239], a[216:219], a[120:123]
ds_read_b128 a[188:191], v201 offset:7168
v_cvt_pk_bf16_f32 v162, v144, v240
v_fmac_f32 v145, v209, v144
v_mfma_f32_16x16x32_bf16 a[124:127], a[236:239], a[220:223], a[124:127]
ds_read_b64_tr_b16 a[236:237], v203 offset:4096
ds_read_b64_tr_b16 a[238:239], v203 offset:6144
v_mfma_f32_16x16x32_bf16 v[64:67], a[224:227], a[160:163], v[64:67]
v_fmac_f32 v241, v209, v240
v_fmac_f32 v145, v210, v240
v_fma_f32 v241, -v210, v144, v241
v_mfma_f32_16x16x32_bf16 v[68:71], a[224:227], a[164:167], v[68:71]
s_waitcnt lgkmcnt(4)
v_cvt_pk_bf16_f32 v163, v145, v241
ds_read_b128 v[140:143], v178 offset:768
v_mfma_f32_16x16x32_bf16 v[72:75], a[224:227], a[168:171], v[72:75]
buffer_store_dwordx4 v[136:139], v200, s[20:23], s36 offen sc1
s_add_u32 s36, s36, 184320
v_mfma_f32_16x16x32_bf16 v[76:79], a[224:227], a[172:175], v[76:79]
v_fmac_f32 v146, v209, v145
v_fmac_f32 v242, v209, v241
v_fmac_f32 v146, v210, v241
v_mfma_f32_16x16x32_bf16 v[80:83], a[224:227], a[176:179], v[80:83]
ds_write2_b32 v179, v162, v163 offset0:0 offset1:16
v_fma_f32 v242, -v210, v145, v242
v_mfma_f32_16x16x32_bf16 v[84:87], a[224:227], a[180:183], v[84:87]
v_cvt_pk_bf16_f32 v164, v146, v242
v_fmac_f32 v147, v209, v146
v_fmac_f32 v243, v209, v242
v_mfma_f32_16x16x32_bf16 v[88:91], a[224:227], a[184:187], v[88:91]
s_waitcnt lgkmcnt(2)
v_fmac_f32 v147, v210, v242
v_fma_f32 v243, -v210, v146, v243
v_mfma_f32_16x16x32_bf16 v[92:95], a[224:227], a[188:191], v[92:95]
s_barrier
ds_read_b64_tr_b16 a[224:225], v202 offset:28672
v_cvt_pk_bf16_f32 v165, v147, v243
v_mfma_f32_16x16x32_bf16 a[64:67], a[228:231], a[160:163], a[64:67]
ds_read_b64_tr_b16 a[226:227], v202 offset:30720
v_fmac_f32 v148, v209, v147
v_fmac_f32 v244, v209, v243
v_mfma_f32_16x16x32_bf16 a[68:71], a[228:231], a[164:167], a[68:71]
ds_read_b128 a[192:195], v201 offset:28672
v_fmac_f32 v148, v210, v243
v_mfma_f32_16x16x32_bf16 a[72:75], a[228:231], a[168:171], a[72:75]
ds_write2_b32 v179, v164, v165 offset0:32 offset1:48
v_fma_f32 v244, -v210, v147, v244
v_cvt_pk_bf16_f32 v166, v148, v244
v_mfma_f32_16x16x32_bf16 a[76:79], a[228:231], a[172:175], a[76:79]
v_fmac_f32 v149, v209, v148
v_fmac_f32 v245, v209, v244
v_mfma_f32_16x16x32_bf16 a[80:83], a[228:231], a[176:179], a[80:83]
ds_read_b128 a[196:199], v201 offset:29696
v_fmac_f32 v149, v210, v244
v_mfma_f32_16x16x32_bf16 a[84:87], a[228:231], a[180:183], a[84:87]
v_fma_f32 v245, -v210, v148, v245
v_cvt_pk_bf16_f32 v167, v149, v245
ds_read_b128 v[144:147], v178 offset:1024
v_mfma_f32_16x16x32_bf16 a[88:91], a[228:231], a[184:187], a[88:91]
s_waitcnt lgkmcnt(4)
buffer_store_dwordx4 v[140:143], v200, s[20:23], s36 offen sc1
v_mfma_f32_16x16x32_bf16 a[92:95], a[228:231], a[188:191], a[92:95]
s_add_u32 s36, s36, 184320
ds_read_b64_tr_b16 a[228:229], v202 offset:32768
ds_read_b128 a[200:203], v201 offset:30720
v_fmac_f32 v150, v209, v149
v_mfma_f32_16x16x32_bf16 v[96:99], a[232:235], a[160:163], v[96:99]
ds_read_b64_tr_b16 a[230:231], v202 offset:34816
v_fmac_f32 v246, v209, v245
v_mfma_f32_16x16x32_bf16 v[100:103], a[232:235], a[164:167], v[100:103]
v_fmac_f32 v150, v210, v245
ds_write2_b32 v179, v166, v167 offset0:64 offset1:80
v_mfma_f32_16x16x32_bf16 v[104:107], a[232:235], a[168:171], v[104:107]
ds_read_b128 a[204:207], v201 offset:31744
v_fma_f32 v246, -v210, v149, v246
v_cvt_pk_bf16_f32 v168, v150, v246
v_mfma_f32_16x16x32_bf16 v[108:111], a[232:235], a[172:175], v[108:111]
v_fmac_f32 v151, v209, v150
v_fmac_f32 v247, v209, v246
v_mfma_f32_16x16x32_bf16 v[112:115], a[232:235], a[176:179], v[112:115]
v_fmac_f32 v151, v210, v246
v_fma_f32 v247, -v210, v150, v247
v_cvt_pk_bf16_f32 v169, v151, v247
v_mfma_f32_16x16x32_bf16 v[116:119], a[232:235], a[180:183], v[116:119]
ds_read_b128 a[208:211], v201 offset:32768
v_fmac_f32 v152, v209, v151
v_mfma_f32_16x16x32_bf16 v[120:123], a[232:235], a[184:187], v[120:123]
v_fmac_f32 v248, v209, v247
v_fmac_f32 v152, v210, v247
v_mfma_f32_16x16x32_bf16 v[124:127], a[232:235], a[188:191], v[124:127]
ds_read_b64_tr_b16 a[232:233], v203 offset:28672
ds_write2_b32 v179, v168, v169 offset0:96 offset1:112
v_fma_f32 v248, -v210, v151, v248
v_mfma_f32_16x16x32_bf16 a[96:99], a[236:239], a[160:163], a[96:99]
ds_read_b64_tr_b16 a[234:235], v203 offset:30720
ds_read_b128 a[212:215], v201 offset:33792
v_mfma_f32_16x16x32_bf16 a[100:103], a[236:239], a[164:167], a[100:103]
v_cvt_pk_bf16_f32 v162, v152, v248
v_fmac_f32 v153, v209, v152
v_fmac_f32 v249, v209, v248
v_mfma_f32_16x16x32_bf16 a[104:107], a[236:239], a[168:171], a[104:107]
v_fmac_f32 v153, v210, v248
v_fma_f32 v249, -v210, v152, v249
v_mfma_f32_16x16x32_bf16 a[108:111], a[236:239], a[172:175], a[108:111]
ds_read_b128 a[216:219], v201 offset:34816
v_cvt_pk_bf16_f32 v163, v153, v249
v_mfma_f32_16x16x32_bf16 a[112:115], a[236:239], a[176:179], a[112:115]
ds_read_b128 v[148:151], v178 offset:1280
s_waitcnt lgkmcnt(6)
buffer_store_dwordx4 v[144:147], v200, s[20:23], s36 offen sc1
v_mfma_f32_16x16x32_bf16 a[116:119], a[236:239], a[180:183], a[116:119]
s_add_u32 s36, s36, 184320
v_fmac_f32 v154, v209, v153
v_fmac_f32 v250, v209, v249
v_mfma_f32_16x16x32_bf16 a[120:123], a[236:239], a[184:187], a[120:123]
ds_read_b128 a[220:223], v201 offset:35840
v_fmac_f32 v154, v210, v249
ds_write2_b32 v179, v162, v163 offset0:128 offset1:144
v_mfma_f32_16x16x32_bf16 a[124:127], a[236:239], a[188:191], a[124:127]
ds_read_b64_tr_b16 a[236:237], v203 offset:32768
ds_read_b64_tr_b16 a[238:239], v203 offset:34816
v_mfma_f32_16x16x32_bf16 v[64:67], a[224:227], a[192:195], v[64:67]
v_fma_f32 v250, -v210, v153, v250
v_cvt_pk_bf16_f32 v164, v154, v250
v_mfma_f32_16x16x32_bf16 v[68:71], a[224:227], a[196:199], v[68:71]
v_add_u32 v201, 57344, v201
v_fmac_f32 v155, v209, v154
v_fmac_f32 v251, v209, v250
v_mfma_f32_16x16x32_bf16 v[72:75], a[224:227], a[200:203], v[72:75]
v_fmac_f32 v155, v210, v250
v_fma_f32 v251, -v210, v154, v251
v_mfma_f32_16x16x32_bf16 v[76:79], a[224:227], a[204:207], v[76:79]
v_add_u32 v202, 57344, v202
v_cvt_pk_bf16_f32 v165, v155, v251
v_fmac_f32 v156, v209, v155
v_mfma_f32_16x16x32_bf16 v[80:83], a[224:227], a[208:211], v[80:83]
s_waitcnt lgkmcnt(3)
v_fmac_f32 v252, v209, v251
v_fmac_f32 v156, v210, v251
v_mfma_f32_16x16x32_bf16 v[84:87], a[224:227], a[212:215], v[84:87]
v_add_u32 v203, 57344, v203
ds_write2_b32 v179, v164, v165 offset0:160 offset1:176
v_mfma_f32_16x16x32_bf16 v[88:91], a[224:227], a[216:219], v[88:91]
v_fma_f32 v252, -v210, v155, v252
v_cvt_pk_bf16_f32 v166, v156, v252
v_fmac_f32 v157, v209, v156
v_mfma_f32_16x16x32_bf16 v[92:95], a[224:227], a[220:223], v[92:95]
s_waitcnt lgkmcnt(1)
s_barrier
ds_read_b64_tr_b16 a[224:225], v202 offset:0
v_mfma_f32_16x16x32_bf16 a[64:67], a[228:231], a[192:195], a[64:67]
ds_read_b64_tr_b16 a[226:227], v202 offset:2048
v_fmac_f32 v253, v209, v252
v_fmac_f32 v157, v210, v252
v_mfma_f32_16x16x32_bf16 a[68:71], a[228:231], a[196:199], a[68:71]
ds_read_b128 a[160:163], v201 offset:0
v_fma_f32 v253, -v210, v156, v253
v_mfma_f32_16x16x32_bf16 a[72:75], a[228:231], a[200:203], a[72:75]
v_cvt_pk_bf16_f32 v167, v157, v253
ds_read_b128 v[152:155], v178 offset:1536
v_mfma_f32_16x16x32_bf16 a[76:79], a[228:231], a[204:207], a[76:79]
buffer_store_dwordx4 v[148:151], v200, s[20:23], s36 offen sc1
s_add_u32 s36, s36, 184320
v_fmac_f32 v158, v209, v157
v_mfma_f32_16x16x32_bf16 a[80:83], a[228:231], a[208:211], a[80:83]
ds_read_b128 a[164:167], v201 offset:1024
v_fmac_f32 v254, v209, v253
v_mfma_f32_16x16x32_bf16 a[84:87], a[228:231], a[212:215], a[84:87]
v_fmac_f32 v158, v210, v253
ds_write2_b32 v179, v166, v167 offset0:192 offset1:208
v_fma_f32 v254, -v210, v157, v254
v_mfma_f32_16x16x32_bf16 a[88:91], a[228:231], a[216:219], a[88:91]
v_cvt_pk_bf16_f32 v168, v158, v254
v_fmac_f32 v159, v209, v158
v_mfma_f32_16x16x32_bf16 a[92:95], a[228:231], a[220:223], a[92:95]
ds_read_b64_tr_b16 a[228:229], v202 offset:4096
ds_read_b128 a[168:171], v201 offset:2048
v_mfma_f32_16x16x32_bf16 v[96:99], a[232:235], a[192:195], v[96:99]
ds_read_b64_tr_b16 a[230:231], v202 offset:6144
v_fmac_f32 v255, v209, v254
v_fmac_f32 v159, v210, v254
v_mfma_f32_16x16x32_bf16 v[100:103], a[232:235], a[196:199], v[100:103]
v_fma_f32 v255, -v210, v158, v255
v_cvt_pk_bf16_f32 v169, v159, v255
v_mfma_f32_16x16x32_bf16 v[104:107], a[232:235], a[200:203], v[104:107]
ds_read_b128 a[172:175], v201 offset:3072
ds_write2_b32 v179, v168, v169 offset0:224 offset1:240
ds_read_b128 v[156:159], v178 offset:1792
v_mfma_f32_16x16x32_bf16 v[108:111], a[232:235], a[204:207], v[108:111]
s_waitcnt lgkmcnt(7)
buffer_store_dwordx4 v[152:155], v200, s[20:23], s36 offen sc1
v_mfma_f32_16x16x32_bf16 v[112:115], a[232:235], a[208:211], v[112:115]
s_add_u32 s36, s36, 184320
s_waitcnt lgkmcnt(0)
buffer_store_dwordx4 v[156:159], v200, s[20:23], s36 offen sc1
v_mfma_f32_16x16x32_bf16 v[116:119], a[232:235], a[212:215], v[116:119]
s_add_u32 s36, s36, 184320
ds_read_b128 a[176:179], v201 offset:4096
v_accvgpr_read_b32 v160, a16
v_accvgpr_read_b32 v161, a17
v_mfma_f32_16x16x32_bf16 v[120:123], a[232:235], a[216:219], v[120:123]
v_accvgpr_read_b32 v162, a18
v_accvgpr_read_b32 v163, a19
v_mfma_f32_16x16x32_bf16 v[124:127], a[232:235], a[220:223], v[124:127]
ds_read_b64_tr_b16 a[232:233], v203 offset:0
v_mul_f32 v16, v160, v16
v_mul_f32 v17, v161, v17
v_mfma_f32_16x16x32_bf16 a[96:99], a[236:239], a[192:195], a[96:99]
ds_read_b64_tr_b16 a[234:235], v203 offset:2048
ds_read_b128 a[180:183], v201 offset:5120
v_mfma_f32_16x16x32_bf16 a[100:103], a[236:239], a[196:199], a[100:103]
v_mul_f32 v18, v162, v18
v_mul_f32 v19, v163, v19
v_mfma_f32_16x16x32_bf16 a[104:107], a[236:239], a[200:203], a[104:107]
v_accvgpr_read_b32 v160, a48
v_accvgpr_read_b32 v161, a49
v_accvgpr_read_b32 v162, a50
v_mfma_f32_16x16x32_bf16 a[108:111], a[236:239], a[204:207], a[108:111]
ds_read_b128 a[184:187], v201 offset:6144
v_accvgpr_read_b32 v163, a51
v_mfma_f32_16x16x32_bf16 a[112:115], a[236:239], a[208:211], a[112:115]
v_mul_f32 v48, v160, v48
v_mul_f32 v49, v161, v49
v_mul_f32 v50, v162, v50
v_mfma_f32_16x16x32_bf16 a[116:119], a[236:239], a[212:215], a[116:119]
v_mul_f32 v51, v163, v51
v_cvt_pk_bf16_f32 v16, v16, v17
v_mfma_f32_16x16x32_bf16 a[120:123], a[236:239], a[216:219], a[120:123]
ds_read_b128 a[188:191], v201 offset:7168
v_cvt_pk_bf16_f32 v17, v18, v19
v_mfma_f32_16x16x32_bf16 a[124:127], a[236:239], a[220:223], a[124:127]
ds_read_b64_tr_b16 a[236:237], v203 offset:4096
ds_read_b64_tr_b16 a[238:239], v203 offset:6144
v_cvt_pk_bf16_f32 v18, v48, v49
v_mfma_f32_16x16x32_bf16 v[64:67], a[224:227], a[160:163], v[64:67]
v_cvt_pk_bf16_f32 v19, v50, v51
v_accvgpr_read_b32 v160, a20
v_mfma_f32_16x16x32_bf16 v[68:71], a[224:227], a[164:167], v[68:71]
v_add_u32 v201, 4294852608, v201
v_accvgpr_read_b32 v161, a21
v_accvgpr_read_b32 v162, a22
v_mfma_f32_16x16x32_bf16 v[72:75], a[224:227], a[168:171], v[72:75]
buffer_store_dwordx4 v[16:19], v200, s[20:23], s89 offen sc1
s_add_u32 s89, s89, 184320
v_mfma_f32_16x16x32_bf16 v[76:79], a[224:227], a[172:175], v[76:79]
s_waitcnt lgkmcnt(3)
v_add_u32 v202, 4294852608, v202
v_accvgpr_read_b32 v163, a23
v_mfma_f32_16x16x32_bf16 v[80:83], a[224:227], a[176:179], v[80:83]
v_mul_f32 v20, v160, v20
v_mul_f32 v21, v161, v21
v_mul_f32 v22, v162, v22
v_mfma_f32_16x16x32_bf16 v[84:87], a[224:227], a[180:183], v[84:87]
v_add_u32 v203, 4294852608, v203
v_mul_f32 v23, v163, v23
v_mfma_f32_16x16x32_bf16 v[88:91], a[224:227], a[184:187], v[88:91]
s_waitcnt lgkmcnt(0)
v_accvgpr_read_b32 v160, a52
v_accvgpr_read_b32 v161, a53
v_accvgpr_read_b32 v162, a54
v_mfma_f32_16x16x32_bf16 v[92:95], a[224:227], a[188:191], v[92:95]
s_barrier
ds_read_b64_tr_b16 a[224:225], v202 offset:0
v_accvgpr_read_b32 v163, a55
v_mfma_f32_16x16x32_bf16 a[64:67], a[228:231], a[160:163], a[64:67]
ds_read_b64_tr_b16 a[226:227], v202 offset:2048
v_mul_f32 v52, v160, v52
v_mfma_f32_16x16x32_bf16 a[68:71], a[228:231], a[164:167], a[68:71]
ds_read_b128 a[192:195], v201 offset:0
v_mul_f32 v53, v161, v53
v_mul_f32 v54, v162, v54
v_mfma_f32_16x16x32_bf16 a[72:75], a[228:231], a[168:171], a[72:75]
v_mul_f32 v55, v163, v55
v_cvt_pk_bf16_f32 v20, v20, v21
v_mfma_f32_16x16x32_bf16 a[76:79], a[228:231], a[172:175], a[76:79]
v_cvt_pk_bf16_f32 v21, v22, v23
v_cvt_pk_bf16_f32 v22, v52, v53
v_cvt_pk_bf16_f32 v23, v54, v55
v_mfma_f32_16x16x32_bf16 a[80:83], a[228:231], a[176:179], a[80:83]
ds_read_b128 a[196:199], v201 offset:1024
v_accvgpr_read_b32 v160, a24
v_mfma_f32_16x16x32_bf16 a[84:87], a[228:231], a[180:183], a[84:87]
v_accvgpr_read_b32 v161, a25
v_accvgpr_read_b32 v162, a26
v_mfma_f32_16x16x32_bf16 a[88:91], a[228:231], a[184:187], a[88:91]
buffer_store_dwordx4 v[20:23], v200, s[20:23], s89 offen sc1
s_add_u32 s89, s89, 184320
v_accvgpr_read_b32 v163, a27
v_mfma_f32_16x16x32_bf16 a[92:95], a[228:231], a[188:191], a[92:95]
ds_read_b64_tr_b16 a[228:229], v202 offset:4096
ds_read_b128 a[200:203], v201 offset:2048
v_mfma_f32_16x16x32_bf16 v[96:99], a[232:235], a[160:163], v[96:99]
ds_read_b64_tr_b16 a[230:231], v202 offset:6144
v_mul_f32 v24, v160, v24
v_mul_f32 v25, v161, v25
v_mfma_f32_16x16x32_bf16 v[100:103], a[232:235], a[164:167], v[100:103]
v_mul_f32 v26, v162, v26
v_mul_f32 v27, v163, v27
v_mfma_f32_16x16x32_bf16 v[104:107], a[232:235], a[168:171], v[104:107]
ds_read_b128 a[204:207], v201 offset:3072
v_accvgpr_read_b32 v160, a56
v_mfma_f32_16x16x32_bf16 v[108:111], a[232:235], a[172:175], v[108:111]
v_accvgpr_read_b32 v161, a57
v_accvgpr_read_b32 v162, a58
v_accvgpr_read_b32 v163, a59
v_mfma_f32_16x16x32_bf16 v[112:115], a[232:235], a[176:179], v[112:115]
v_mul_f32 v56, v160, v56
v_mul_f32 v57, v161, v57
v_mfma_f32_16x16x32_bf16 v[116:119], a[232:235], a[180:183], v[116:119]
ds_read_b128 a[208:211], v201 offset:4096
v_mul_f32 v58, v162, v58
v_mul_f32 v59, v163, v59
v_mfma_f32_16x16x32_bf16 v[120:123], a[232:235], a[184:187], v[120:123]
v_cvt_pk_bf16_f32 v24, v24, v25
v_cvt_pk_bf16_f32 v25, v26, v27
v_mfma_f32_16x16x32_bf16 v[124:127], a[232:235], a[188:191], v[124:127]
ds_read_b64_tr_b16 a[232:233], v203 offset:0
v_cvt_pk_bf16_f32 v26, v56, v57
v_mfma_f32_16x16x32_bf16 a[96:99], a[236:239], a[160:163], a[96:99]
ds_read_b64_tr_b16 a[234:235], v203 offset:2048
ds_read_b128 a[212:215], v201 offset:5120
v_cvt_pk_bf16_f32 v27, v58, v59
v_mfma_f32_16x16x32_bf16 a[100:103], a[236:239], a[164:167], a[100:103]
v_accvgpr_read_b32 v160, a28
v_accvgpr_read_b32 v161, a29
v_mfma_f32_16x16x32_bf16 a[104:107], a[236:239], a[168:171], a[104:107]
v_accvgpr_read_b32 v162, a30
buffer_store_dwordx4 v[24:27], v200, s[20:23], s89 offen sc1
s_add_u32 s89, s89, 184320
v_mfma_f32_16x16x32_bf16 a[108:111], a[236:239], a[172:175], a[108:111]
ds_read_b128 a[216:219], v201 offset:6144
v_accvgpr_read_b32 v163, a31
v_mfma_f32_16x16x32_bf16 a[112:115], a[236:239], a[176:179], a[112:115]
v_mul_f32 v28, v160, v28
v_mul_f32 v29, v161, v29
v_mfma_f32_16x16x32_bf16 a[116:119], a[236:239], a[180:183], a[116:119]
v_mul_f32 v30, v162, v30
v_mul_f32 v31, v163, v31
v_accvgpr_read_b32 v160, a60
v_mfma_f32_16x16x32_bf16 a[120:123], a[236:239], a[184:187], a[120:123]
ds_read_b128 a[220:223], v201 offset:7168
v_accvgpr_read_b32 v161, a61
v_mfma_f32_16x16x32_bf16 a[124:127], a[236:239], a[188:191], a[124:127]
s_waitcnt lgkmcnt(2)
ds_read_b64_tr_b16 a[236:237], v203 offset:4096
ds_read_b64_tr_b16 a[238:239], v203 offset:6144
v_accvgpr_read_b32 v162, a62
v_mfma_f32_16x16x32_bf16 v[64:67], a[224:227], a[192:195], v[64:67]
v_accvgpr_read_b32 v163, a63
v_mul_f32 v60, v160, v60
v_mfma_f32_16x16x32_bf16 v[68:71], a[224:227], a[196:199], v[68:71]
v_mul_f32 v61, v161, v61
v_mul_f32 v62, v162, v62
v_mfma_f32_16x16x32_bf16 v[72:75], a[224:227], a[200:203], v[72:75]
v_mul_f32 v63, v163, v63
v_cvt_pk_bf16_f32 v28, v28, v29
v_cvt_pk_bf16_f32 v29, v30, v31
v_mfma_f32_16x16x32_bf16 v[76:79], a[224:227], a[204:207], v[76:79]
v_cvt_pk_bf16_f32 v30, v60, v61
v_cvt_pk_bf16_f32 v31, v62, v63
v_mfma_f32_16x16x32_bf16 v[80:83], a[224:227], a[208:211], v[80:83]
buffer_store_dwordx4 v[28:31], v200, s[20:23], s89 offen sc1
s_add_u32 s89, s89, 184320
v_mfma_f32_16x16x32_bf16 v[84:87], a[224:227], a[212:215], v[84:87]
s_waitcnt lgkmcnt(2)
v_mfma_f32_16x16x32_bf16 v[88:91], a[224:227], a[216:219], v[88:91]
v_mfma_f32_16x16x32_bf16 v[92:95], a[224:227], a[220:223], v[92:95]
s_waitcnt lgkmcnt(0)
s_barrier
ds_read_b64_tr_b16 a[224:225], v202 offset:28672
v_mfma_f32_16x16x32_bf16 a[64:67], a[228:231], a[192:195], a[64:67]
ds_read_b64_tr_b16 a[226:227], v202 offset:30720
v_mfma_f32_16x16x32_bf16 a[68:71], a[228:231], a[196:199], a[68:71]
s_add_u32 m0, s93, 8192
ds_read_b128 a[160:163], v201 offset:28672
v_mfma_f32_16x16x32_bf16 a[72:75], a[228:231], a[200:203], a[72:75]
buffer_load_dwordx4 v219, s[76:79], s54 offen sc1 lds
v_mfma_f32_16x16x32_bf16 a[76:79], a[228:231], a[204:207], a[76:79]
v_mfma_f32_16x16x32_bf16 a[80:83], a[228:231], a[208:211], a[80:83]
ds_read_b128 a[164:167], v201 offset:29696
v_mfma_f32_16x16x32_bf16 a[84:87], a[228:231], a[212:215], a[84:87]
v_mfma_f32_16x16x32_bf16 a[88:91], a[228:231], a[216:219], a[88:91]
buffer_load_dwordx4 v220, s[76:79], s54 offen offset:1024 sc1 lds
v_mfma_f32_16x16x32_bf16 a[92:95], a[228:231], a[220:223], a[92:95]
ds_read_b64_tr_b16 a[228:229], v202 offset:32768
ds_read_b128 a[168:171], v201 offset:30720
v_mfma_f32_16x16x32_bf16 v[96:99], a[232:235], a[192:195], v[96:99]
ds_read_b64_tr_b16 a[230:231], v202 offset:34816
v_mfma_f32_16x16x32_bf16 v[100:103], a[232:235], a[196:199], v[100:103]
v_mfma_f32_16x16x32_bf16 v[104:107], a[232:235], a[200:203], v[104:107]
ds_read_b128 a[172:175], v201 offset:31744
v_mfma_f32_16x16x32_bf16 v[108:111], a[232:235], a[204:207], v[108:111]
buffer_load_dwordx4 v221, s[76:79], s54 offen offset:2048 sc1 lds
v_mfma_f32_16x16x32_bf16 v[112:115], a[232:235], a[208:211], v[112:115]
s_add_u32 s54, s54, s92
v_mfma_f32_16x16x32_bf16 v[116:119], a[232:235], a[212:215], v[116:119]
ds_read_b128 a[176:179], v201 offset:32768
v_mfma_f32_16x16x32_bf16 v[120:123], a[232:235], a[216:219], v[120:123]
s_add_u32 m0, s63, 0
v_mfma_f32_16x16x32_bf16 v[124:127], a[232:235], a[220:223], v[124:127]
ds_read_b64_tr_b16 a[232:233], v203 offset:28672
v_mfma_f32_16x16x32_bf16 a[96:99], a[236:239], a[192:195], a[96:99]
buffer_load_dwordx4 v200, s[20:23], s67 offen sc1 lds
v_mfma_f32_16x16x32_bf16 a[100:103], a[236:239], a[196:199], a[100:103]
ds_read_b64_tr_b16 a[234:235], v203 offset:30720
ds_read_b128 a[180:183], v201 offset:33792
v_mfma_f32_16x16x32_bf16 a[104:107], a[236:239], a[200:203], a[104:107]
v_mfma_f32_16x16x32_bf16 a[108:111], a[236:239], a[204:207], a[108:111]
ds_read_b128 a[184:187], v201 offset:34816
v_mfma_f32_16x16x32_bf16 a[112:115], a[236:239], a[208:211], a[112:115]
buffer_load_dwordx4 v214, s[20:23], s67 offen offset:1024 sc1 lds
v_mfma_f32_16x16x32_bf16 a[116:119], a[236:239], a[212:215], a[116:119]
s_add_u32 s67, s67, s33
v_mfma_f32_16x16x32_bf16 a[120:123], a[236:239], a[216:219], a[120:123]
ds_read_b128 a[188:191], v201 offset:35840
v_mfma_f32_16x16x32_bf16 a[124:127], a[236:239], a[220:223], a[124:127]
s_waitcnt lgkmcnt(6)
ds_read_b64_tr_b16 a[236:237], v203 offset:32768
ds_read_b64_tr_b16 a[238:239], v203 offset:34816
v_mfma_f32_16x16x32_bf16 v[64:67], a[224:227], a[160:163], v[64:67]
v_mfma_f32_16x16x32_bf16 v[68:71], a[224:227], a[164:167], v[68:71]
v_add_u32 v201, 57344, v201
v_mfma_f32_16x16x32_bf16 v[72:75], a[224:227], a[168:171], v[72:75]
v_mfma_f32_16x16x32_bf16 v[76:79], a[224:227], a[172:175], v[76:79]
s_waitcnt lgkmcnt(6)
v_add_u32 v202, 57344, v202
v_mfma_f32_16x16x32_bf16 v[80:83], a[224:227], a[176:179], v[80:83]
s_waitcnt lgkmcnt(4)
v_mfma_f32_16x16x32_bf16 v[84:87], a[224:227], a[180:183], v[84:87]
s_waitcnt lgkmcnt(3)
v_add_u32 v203, 57344, v203
v_mfma_f32_16x16x32_bf16 v[88:91], a[224:227], a[184:187], v[88:91]
s_waitcnt lgkmcnt(2)
s_waitcnt vmcnt(9)
buffer_store_dword v218, v217, s[20:23], s45 offen offset:12 sc1
v_mfma_f32_16x16x32_bf16 v[92:95], a[224:227], a[188:191], v[92:95]
s_waitcnt lgkmcnt(0)
s_barrier
ds_read_b64_tr_b16 a[224:225], v202 offset:0
v_mfma_f32_16x16x32_bf16 a[64:67], a[228:231], a[160:163], a[64:67]
ds_read_b64_tr_b16 a[226:227], v202 offset:2048
v_mfma_f32_16x16x32_bf16 a[68:71], a[228:231], a[164:167], a[68:71]
s_add_u32 m0, s93, 28672
ds_read_b128 a[192:195], v201 offset:0
v_mfma_f32_16x16x32_bf16 a[72:75], a[228:231], a[168:171], a[72:75]
buffer_load_dwordx4 v219, s[76:79], s54 offen sc1 lds
v_mfma_f32_16x16x32_bf16 a[76:79], a[228:231], a[172:175], a[76:79]
v_mfma_f32_16x16x32_bf16 a[80:83], a[228:231], a[176:179], a[80:83]
ds_read_b128 a[196:199], v201 offset:1024
v_mfma_f32_16x16x32_bf16 a[84:87], a[228:231], a[180:183], a[84:87]
v_mfma_f32_16x16x32_bf16 a[88:91], a[228:231], a[184:187], a[88:91]
buffer_load_dwordx4 v220, s[76:79], s54 offen offset:1024 sc1 lds
v_mfma_f32_16x16x32_bf16 a[92:95], a[228:231], a[188:191], a[92:95]
ds_read_b64_tr_b16 a[228:229], v202 offset:4096
ds_read_b128 a[200:203], v201 offset:2048
v_mfma_f32_16x16x32_bf16 v[96:99], a[232:235], a[160:163], v[96:99]
ds_read_b64_tr_b16 a[230:231], v202 offset:6144
v_mfma_f32_16x16x32_bf16 v[100:103], a[232:235], a[164:167], v[100:103]
v_mfma_f32_16x16x32_bf16 v[104:107], a[232:235], a[168:171], v[104:107]
ds_read_b128 a[204:207], v201 offset:3072
v_mfma_f32_16x16x32_bf16 v[108:111], a[232:235], a[172:175], v[108:111]
buffer_load_dwordx4 v221, s[76:79], s54 offen offset:2048 sc1 lds
v_mfma_f32_16x16x32_bf16 v[112:115], a[232:235], a[176:179], v[112:115]
s_add_u32 s54, s54, s70
v_mfma_f32_16x16x32_bf16 v[116:119], a[232:235], a[180:183], v[116:119]
ds_read_b128 a[208:211], v201 offset:4096
v_mfma_f32_16x16x32_bf16 v[120:123], a[232:235], a[184:187], v[120:123]
s_add_u32 m0, s63, 20480
v_mfma_f32_16x16x32_bf16 v[124:127], a[232:235], a[188:191], v[124:127]
ds_read_b64_tr_b16 a[232:233], v203 offset:0
v_mfma_f32_16x16x32_bf16 a[96:99], a[236:239], a[160:163], a[96:99]
buffer_load_dwordx4 v200, s[20:23], s67 offen sc1 lds
v_mfma_f32_16x16x32_bf16 a[100:103], a[236:239], a[164:167], a[100:103]
ds_read_b64_tr_b16 a[234:235], v203 offset:2048
ds_read_b128 a[212:215], v201 offset:5120
v_mfma_f32_16x16x32_bf16 a[104:107], a[236:239], a[168:171], a[104:107]
v_mfma_f32_16x16x32_bf16 a[108:111], a[236:239], a[172:175], a[108:111]
ds_read_b128 a[216:219], v201 offset:6144
v_mfma_f32_16x16x32_bf16 a[112:115], a[236:239], a[176:179], a[112:115]
buffer_load_dwordx4 v214, s[20:23], s67 offen offset:1024 sc1 lds
v_mfma_f32_16x16x32_bf16 a[116:119], a[236:239], a[180:183], a[116:119]
s_add_u32 s67, s67, s33
v_mfma_f32_16x16x32_bf16 a[120:123], a[236:239], a[184:187], a[120:123]
ds_read_b128 a[220:223], v201 offset:7168
v_mfma_f32_16x16x32_bf16 a[124:127], a[236:239], a[188:191], a[124:127]
s_waitcnt lgkmcnt(6)
ds_read_b64_tr_b16 a[236:237], v203 offset:4096
ds_read_b64_tr_b16 a[238:239], v203 offset:6144
v_mfma_f32_16x16x32_bf16 v[64:67], a[224:227], a[192:195], v[64:67]
v_mfma_f32_16x16x32_bf16 v[68:71], a[224:227], a[196:199], v[68:71]
v_mfma_f32_16x16x32_bf16 v[72:75], a[224:227], a[200:203], v[72:75]
T_a_12:
s_cbranch_execz T_a_q
v_mfma_f32_16x16x32_bf16 v[76:79], a[224:227], a[204:207], v[76:79]
s_waitcnt lgkmcnt(6)
v_mfma_f32_16x16x32_bf16 v[80:83], a[224:227], a[208:211], v[80:83]
s_waitcnt lgkmcnt(4)
v_mfma_f32_16x16x32_bf16 v[84:87], a[224:227], a[212:215], v[84:87]
s_waitcnt lgkmcnt(3)
v_mfma_f32_16x16x32_bf16 v[88:91], a[224:227], a[216:219], v[88:91]
s_waitcnt lgkmcnt(2)
v_mfma_f32_16x16x32_bf16 v[92:95], a[224:227], a[220:223], v[92:95]
s_waitcnt lgkmcnt(0)
s_barrier
ds_read_b64_tr_b16 a[224:225], v202 offset:28672
v_mfma_f32_16x16x32_bf16 a[64:67], a[228:231], a[192:195], a[64:67]
ds_read_b64_tr_b16 a[226:227], v202 offset:30720
v_mfma_f32_16x16x32_bf16 a[68:71], a[228:231], a[196:199], a[68:71]
s_add_u32 m0, s93, 49152
ds_read_b128 a[160:163], v201 offset:28672
v_mfma_f32_16x16x32_bf16 a[72:75], a[228:231], a[200:203], a[72:75]
buffer_load_dwordx4 v219, s[76:79], s54 offen sc1 lds
v_mfma_f32_16x16x32_bf16 a[76:79], a[228:231], a[204:207], a[76:79]
v_mfma_f32_16x16x32_bf16 a[80:83], a[228:231], a[208:211], a[80:83]
ds_read_b128 a[164:167], v201 offset:29696
v_mfma_f32_16x16x32_bf16 a[84:87], a[228:231], a[212:215], a[84:87]
buffer_load_dwordx4 v220, s[76:79], s54 offen offset:1024 sc1 lds
v_mfma_f32_16x16x32_bf16 a[88:91], a[228:231], a[216:219], a[88:91]
buffer_load_dwordx4 v221, s[76:79], s54 offen offset:2048 sc1 lds
v_mfma_f32_16x16x32_bf16 a[92:95], a[228:231], a[220:223], a[92:95]
s_add_u32 s54, s54, s92
ds_read_b64_tr_b16 a[228:229], v202 offset:32768
ds_read_b128 a[168:171], v201 offset:30720
v_mfma_f32_16x16x32_bf16 v[96:99], a[232:235], a[192:195], v[96:99]
s_add_u32 m0, s63, 40960
ds_read_b64_tr_b16 a[230:231], v202 offset:34816
v_mfma_f32_16x16x32_bf16 v[100:103], a[232:235], a[196:199], v[100:103]
buffer_load_dwordx4 v200, s[20:23], s67 offen sc1 lds
v_mfma_f32_16x16x32_bf16 v[104:107], a[232:235], a[200:203], v[104:107]
ds_read_b128 a[172:175], v201 offset:31744
v_mfma_f32_16x16x32_bf16 v[108:111], a[232:235], a[204:207], v[108:111]
buffer_load_dwordx4 v214, s[20:23], s67 offen offset:1024 sc1 lds
v_mfma_f32_16x16x32_bf16 v[112:115], a[232:235], a[208:211], v[112:115]
s_add_u32 s67, s67, s33
s_add_u32 m0, s93, 69632
v_mfma_f32_16x16x32_bf16 v[116:119], a[232:235], a[212:215], v[116:119]
ds_read_b128 a[176:179], v201 offset:32768
v_mfma_f32_16x16x32_bf16 v[120:123], a[232:235], a[216:219], v[120:123]
buffer_load_dwordx4 v219, s[76:79], s54 offen sc1 lds
v_mfma_f32_16x16x32_bf16 v[124:127], a[232:235], a[220:223], v[124:127]
ds_read_b64_tr_b16 a[232:233], v203 offset:28672
v_mfma_f32_16x16x32_bf16 a[96:99], a[236:239], a[192:195], a[96:99]
buffer_load_dwordx4 v220, s[76:79], s54 offen offset:1024 sc1 lds
v_mfma_f32_16x16x32_bf16 a[100:103], a[236:239], a[196:199], a[100:103]
ds_read_b64_tr_b16 a[234:235], v203 offset:30720
ds_read_b128 a[180:183], v201 offset:33792
v_mfma_f32_16x16x32_bf16 a[104:107], a[236:239], a[200:203], a[104:107]
buffer_load_dwordx4 v221, s[76:79], s54 offen offset:2048 sc1 lds
v_mfma_f32_16x16x32_bf16 a[108:111], a[236:239], a[204:207], a[108:111]
s_add_u32 s54, s54, s91
s_add_u32 m0, s63, 61440
ds_read_b128 a[184:187], v201 offset:34816
v_mfma_f32_16x16x32_bf16 a[112:115], a[236:239], a[208:211], a[112:115]
buffer_load_dwordx4 v200, s[20:23], s67 offen sc1 lds
v_mfma_f32_16x16x32_bf16 a[116:119], a[236:239], a[212:215], a[116:119]
buffer_load_dwordx4 v214, s[20:23], s67 offen offset:1024 sc1 lds
v_mfma_f32_16x16x32_bf16 a[120:123], a[236:239], a[216:219], a[120:123]
s_add_u32 s67, s67, s33
ds_read_b128 a[188:191], v201 offset:35840
v_mfma_f32_16x16x32_bf16 a[124:127], a[236:239], a[220:223], a[124:127]
s_waitcnt lgkmcnt(5)
ds_read_b64_tr_b16 a[236:237], v203 offset:32768
ds_read_b64_tr_b16 a[238:239], v203 offset:34816
v_mfma_f32_16x16x32_bf16 v[64:67], a[224:227], a[160:163], v[64:67]
v_mfma_f32_16x16x32_bf16 v[68:71], a[224:227], a[164:167], v[68:71]
v_add_u32 v201, 57344, v201
v_mfma_f32_16x16x32_bf16 v[72:75], a[224:227], a[168:171], v[72:75]
v_mfma_f32_16x16x32_bf16 v[76:79], a[224:227], a[172:175], v[76:79]
v_add_u32 v202, 57344, v202
v_mfma_f32_16x16x32_bf16 v[80:83], a[224:227], a[176:179], v[80:83]
s_waitcnt lgkmcnt(4)
v_mfma_f32_16x16x32_bf16 v[84:87], a[224:227], a[180:183], v[84:87]
s_waitcnt lgkmcnt(3)
v_add_u32 v203, 57344, v203
v_mfma_f32_16x16x32_bf16 v[88:91], a[224:227], a[184:187], v[88:91]
s_waitcnt lgkmcnt(2)
s_waitcnt vmcnt(21)
buffer_store_dword v218, v217, s[20:23], s45 offen offset:4 sc1
v_mfma_f32_16x16x32_bf16 v[92:95], a[224:227], a[188:191], v[92:95]
s_waitcnt lgkmcnt(0)
s_barrier
ds_read_b64_tr_b16 a[224:225], v202 offset:0
v_mfma_f32_16x16x32_bf16 a[64:67], a[228:231], a[160:163], a[64:67]
ds_read_b64_tr_b16 a[226:227], v202 offset:2048
v_mfma_f32_16x16x32_bf16 a[68:71], a[228:231], a[164:167], a[68:71]
s_add_u32 m0, s93, 90112
ds_read_b128 a[192:195], v201 offset:0
v_mfma_f32_16x16x32_bf16 a[72:75], a[228:231], a[168:171], a[72:75]
buffer_load_dwordx4 v219, s[76:79], s54 offen sc1 lds
v_mfma_f32_16x16x32_bf16 a[76:79], a[228:231], a[172:175], a[76:79]
v_mfma_f32_16x16x32_bf16 a[80:83], a[228:231], a[176:179], a[80:83]
ds_read_b128 a[196:199], v201 offset:1024
v_mfma_f32_16x16x32_bf16 a[84:87], a[228:231], a[180:183], a[84:87]
v_mfma_f32_16x16x32_bf16 a[88:91], a[228:231], a[184:187], a[88:91]
buffer_load_dwordx4 v220, s[76:79], s54 offen offset:1024 sc1 lds
v_mfma_f32_16x16x32_bf16 a[92:95], a[228:231], a[188:191], a[92:95]
ds_read_b64_tr_b16 a[228:229], v202 offset:4096
ds_read_b128 a[200:203], v201 offset:2048
v_mfma_f32_16x16x32_bf16 v[96:99], a[232:235], a[160:163], v[96:99]
ds_read_b64_tr_b16 a[230:231], v202 offset:6144
v_mfma_f32_16x16x32_bf16 v[100:103], a[232:235], a[164:167], v[100:103]
v_mfma_f32_16x16x32_bf16 v[104:107], a[232:235], a[168:171], v[104:107]
ds_read_b128 a[204:207], v201 offset:3072
v_mfma_f32_16x16x32_bf16 v[108:111], a[232:235], a[172:175], v[108:111]
buffer_load_dwordx4 v221, s[76:79], s54 offen offset:2048 sc1 lds
v_mfma_f32_16x16x32_bf16 v[112:115], a[232:235], a[176:179], v[112:115]
s_add_u32 s54, s54, s71
v_mfma_f32_16x16x32_bf16 v[116:119], a[232:235], a[180:183], v[116:119]
ds_read_b128 a[208:211], v201 offset:4096
v_mfma_f32_16x16x32_bf16 v[120:123], a[232:235], a[184:187], v[120:123]
s_add_u32 m0, s63, 81920
v_mfma_f32_16x16x32_bf16 v[124:127], a[232:235], a[188:191], v[124:127]
ds_read_b64_tr_b16 a[232:233], v203 offset:0
v_mfma_f32_16x16x32_bf16 a[96:99], a[236:239], a[160:163], a[96:99]
buffer_load_dwordx4 v200, s[20:23], s67 offen sc1 lds
v_mfma_f32_16x16x32_bf16 a[100:103], a[236:239], a[164:167], a[100:103]
ds_read_b64_tr_b16 a[234:235], v203 offset:2048
ds_read_b128 a[212:215], v201 offset:5120
v_mfma_f32_16x16x32_bf16 a[104:107], a[236:239], a[168:171], a[104:107]
v_mfma_f32_16x16x32_bf16 a[108:111], a[236:239], a[172:175], a[108:111]
ds_read_b128 a[216:219], v201 offset:6144
v_mfma_f32_16x16x32_bf16 a[112:115], a[236:239], a[176:179], a[112:115]
buffer_load_dwordx4 v214, s[20:23], s67 offen offset:1024 sc1 lds
v_mfma_f32_16x16x32_bf16 a[116:119], a[236:239], a[180:183], a[116:119]
s_add_u32 s67, s67, s33
v_mfma_f32_16x16x32_bf16 a[120:123], a[236:239], a[184:187], a[120:123]
ds_read_b128 a[220:223], v201 offset:7168
v_mfma_f32_16x16x32_bf16 a[124:127], a[236:239], a[188:191], a[124:127]
s_waitcnt lgkmcnt(6)
ds_read_b64_tr_b16 a[236:237], v203 offset:4096
ds_read_b64_tr_b16 a[238:239], v203 offset:6144
v_mfma_f32_16x16x32_bf16 v[64:67], a[224:227], a[192:195], v[64:67]
v_mfma_f32_16x16x32_bf16 v[68:71], a[224:227], a[196:199], v[68:71]
v_mfma_f32_16x16x32_bf16 v[72:75], a[224:227], a[200:203], v[72:75]
v_mfma_f32_16x16x32_bf16 v[76:79], a[224:227], a[204:207], v[76:79]
s_waitcnt lgkmcnt(6)
v_mfma_f32_16x16x32_bf16 v[80:83], a[224:227], a[208:211], v[80:83]
s_waitcnt lgkmcnt(4)
v_mfma_f32_16x16x32_bf16 v[84:87], a[224:227], a[212:215], v[84:87]
s_waitcnt lgkmcnt(3)
v_mfma_f32_16x16x32_bf16 v[88:91], a[224:227], a[216:219], v[88:91]
s_waitcnt lgkmcnt(2)
v_mfma_f32_16x16x32_bf16 v[92:95], a[224:227], a[220:223], v[92:95]
s_waitcnt vmcnt(22) lgkmcnt(0)
s_barrier
v_mfma_f32_16x16x32_bf16 a[64:67], a[228:231], a[192:195], a[64:67]
ds_read_b64_tr_b16 a[16:17], v205 offset:0
v_mfma_f32_16x16x32_bf16 a[68:71], a[228:231], a[196:199], a[68:71]
s_add_u32 m0, s93, 110592
ds_read_b64_tr_b16 a[18:19], v205 offset:6144
v_mfma_f32_16x16x32_bf16 a[72:75], a[228:231], a[200:203], a[72:75]
ds_read_b128 a[0:3], v204 offset:0
v_mfma_f32_16x16x32_bf16 a[76:79], a[228:231], a[204:207], a[76:79]
buffer_load_dwordx4 v219, s[76:79], s54 offen sc1 lds
v_mfma_f32_16x16x32_bf16 a[80:83], a[228:231], a[208:211], a[80:83]
ds_read_b128 a[4:7], v204 offset:1024
v_mfma_f32_16x16x32_bf16 a[84:87], a[228:231], a[212:215], a[84:87]
buffer_load_dwordx4 v220, s[76:79], s54 offen offset:1024 sc1 lds
v_mfma_f32_16x16x32_bf16 a[88:91], a[228:231], a[216:219], a[88:91]
ds_read_b128 a[8:11], v204 offset:2048
ds_read_b128 a[12:15], v204 offset:3072
v_mfma_f32_16x16x32_bf16 a[92:95], a[228:231], a[220:223], a[92:95]
buffer_load_dwordx4 v221, s[76:79], s54 offen offset:2048 sc1 lds
v_mfma_f32_16x16x32_bf16 v[96:99], a[232:235], a[192:195], v[96:99]
s_add_u32 s54, s54, s71
s_add_u32 m0, s63, 102400
ds_read_b64_tr_b16 a[20:21], v205 offset:128
v_mfma_f32_16x16x32_bf16 v[100:103], a[232:235], a[196:199], v[100:103]
buffer_load_dwordx4 v200, s[20:23], s67 offen sc1 lds
v_mfma_f32_16x16x32_bf16 v[104:107], a[232:235], a[200:203], v[104:107]
ds_read_b64_tr_b16 a[22:23], v205 offset:6272
ds_read_b64_tr_b16 a[24:25], v205 offset:256
v_mfma_f32_16x16x32_bf16 v[108:111], a[232:235], a[204:207], v[108:111]
buffer_load_dwordx4 v214, s[20:23], s67 offen offset:1024 sc1 lds
v_mfma_f32_16x16x32_bf16 v[112:115], a[232:235], a[208:211], v[112:115]
s_add_u32 s67, s67, s33
s_cmp_ge_u32 s13, 30
s_cselect_b32 s76, s10, s76
s_cselect_b32 s77, s11, s77
s_cselect_b32 s54, 0, s54
v_mfma_f32_16x16x32_bf16 v[116:119], a[232:235], a[212:215], v[116:119]
s_add_u32 m0, s93, 131072
ds_read_b64_tr_b16 a[26:27], v205 offset:6400
ds_read_b64_tr_b16 a[28:29], v206 offset:0
v_mfma_f32_16x16x32_bf16 v[120:123], a[232:235], a[216:219], v[120:123]
buffer_load_dwordx4 v219, s[76:79], s54 offen sc1 lds
v_mfma_f32_16x16x32_bf16 v[124:127], a[232:235], a[220:223], v[124:127]
ds_read_b64_tr_b16 a[30:31], v206 offset:6144
v_mfma_f32_16x16x32_bf16 a[96:99], a[236:239], a[192:195], a[96:99]
buffer_load_dwordx4 v220, s[76:79], s54 offen offset:1024 sc1 lds
v_mfma_f32_16x16x32_bf16 a[100:103], a[236:239], a[196:199], a[100:103]
ds_read_b64_tr_b16 a[32:33], v206 offset:128
ds_read_b64_tr_b16 a[34:35], v206 offset:6272
v_mfma_f32_16x16x32_bf16 a[104:107], a[236:239], a[200:203], a[104:107]
buffer_load_dwordx4 v221, s[76:79], s54 offen offset:2048 sc1 lds
v_mfma_f32_16x16x32_bf16 a[108:111], a[236:239], a[204:207], a[108:111]
s_add_u32 s54, s54, s71
ds_read_b64_tr_b16 a[36:37], v206 offset:256
s_add_u32 m0, s63, 122880
v_mfma_f32_16x16x32_bf16 a[112:115], a[236:239], a[208:211], a[112:115]
buffer_load_dwordx4 v200, s[20:23], s67 offen sc1 lds
v_mfma_f32_16x16x32_bf16 a[116:119], a[236:239], a[212:215], a[116:119]
ds_read_b64_tr_b16 a[38:39], v206 offset:6400
v_mfma_f32_16x16x32_bf16 a[120:123], a[236:239], a[216:219], a[120:123]
buffer_load_dwordx4 v214, s[20:23], s67 offen offset:1024 sc1 lds
v_mfma_f32_16x16x32_bf16 a[124:127], a[236:239], a[220:223], a[124:127]
s_add_u32 s67, s67, s33
s_cmp_ge_u32 s13, 24
s_cbranch_scc1 P2_other
P2g_join:
s_waitcnt lgkmcnt(4)
v_mfma_f32_16x16x32_bf16 v[128:131], a[0:3], a[16:19], 0
v_lshlrev_b32 v215, 3, v200
v_and_b32 v215, 0x380, v215
v_mfma_f32_16x16x32_bf16 v[140:143], a[4:7], a[16:19], 0
v_bfe_u32 v203, v200, 7, 1
v_lshl_add_u32 v203, v203, 5, v215
v_add_u32 v207, 61440, v204
v_mfma_f32_16x16x32_bf16 v[152:155], a[8:11], a[16:19], 0
s_waitcnt vmcnt(25) lgkmcnt(0)
s_barrier
ds_read_b64_tr_b16 a[144:145], v205 offset:20480
v_mfma_f32_16x16x32_bf16 v[164:167], a[12:15], a[16:19], 0
s_add_u32 m0, s63, 143360
ds_read_b64_tr_b16 a[146:147], v205 offset:26624
v_add_u32 v201, 61440, v205
v_add_u32 v202, 61440, v206
v_mfma_f32_16x16x32_bf16 v[132:135], a[0:3], a[20:23], 0
ds_read_b128 a[128:131], v204 offset:20480
buffer_load_dwordx4 v200, s[20:23], s67 offen sc1 lds
v_mfma_f32_16x16x32_bf16 v[144:147], a[4:7], a[20:23], 0
ds_read_b128 a[132:135], v204 offset:21504
v_add_u32 v208, 122880, v204
v_add_u32 v209, 122880, v205
v_mfma_f32_16x16x32_bf16 v[156:159], a[8:11], a[20:23], 0
buffer_load_dwordx4 v214, s[20:23], s67 offen offset:1024 sc1 lds
v_add_u32 v210, 122880, v206
v_mfma_f32_16x16x32_bf16 v[168:171], a[12:15], a[20:23], 0
s_add_u32 s67, s67, s33
ds_read_b128 a[136:139], v204 offset:22528
v_accvgpr_read_b32 v196, a64
v_accvgpr_read_b32 v197, a65
v_mfma_f32_16x16x32_bf16 v[136:139], a[0:3], a[24:27], 0
s_add_u32 m0, s93, 151552
ds_read_b128 a[140:143], v204 offset:23552
buffer_load_dwordx4 v219, s[76:79], s54 offen offset:0 lds
v_mfma_f32_16x16x32_bf16 v[148:151], a[4:7], a[24:27], 0
ds_read_b64_tr_b16 a[148:149], v205 offset:20608
v_accvgpr_read_b32 v198, a66
v_accvgpr_read_b32 v199, a67
v_mfma_f32_16x16x32_bf16 v[160:163], a[8:11], a[24:27], 0
ds_read_b64_tr_b16 a[150:151], v205 offset:26752
buffer_load_dwordx4 v220, s[76:79], s54 offen offset:1024 lds
v_mfma_f32_16x16x32_bf16 v[172:175], a[12:15], a[24:27], 0
v_mul_f32 v64, v196, v64
v_mul_f32 v65, v197, v65
v_mul_f32 v66, v198, v66
v_mfma_f32_16x16x32_bf16 v[176:179], a[0:3], a[28:31], 0
ds_read_b64_tr_b16 a[152:153], v205 offset:20736
buffer_load_dwordx4 v221, s[76:79], s54 offen offset:2048 lds
v_mfma_f32_16x16x32_bf16 v[188:191], a[4:7], a[28:31], 0
s_add_u32 s54, s54, 387072
ds_read_b64_tr_b16 a[154:155], v205 offset:26880
v_mul_f32 v67, v199, v67
v_accvgpr_read_b32 v196, a96
v_mfma_f32_16x16x32_bf16 v[232:235], a[8:11], a[28:31], 0
s_add_u32 m0, s63, 0
ds_read_b64_tr_b16 a[156:157], v206 offset:20480
buffer_load_dwordx4 v200, s[20:23], s67 offen sc1 lds
v_mfma_f32_16x16x32_bf16 v[244:247], a[12:15], a[28:31], 0
ds_read_b64_tr_b16 a[158:159], v206 offset:26624
v_accvgpr_read_b32 v197, a97
v_accvgpr_read_b32 v198, a98
v_mfma_f32_16x16x32_bf16 v[180:183], a[0:3], a[32:35], 0
buffer_load_dwordx4 v214, s[20:23], s67 offen offset:1024 sc1 lds
v_accvgpr_read_b32 v199, a99
v_mfma_f32_16x16x32_bf16 v[224:227], a[4:7], a[32:35], 0
s_add_u32 s67, s67, s33
ds_read_b64_tr_b16 a[160:161], v206 offset:20608
v_mul_f32 v96, v196, v96
v_mul_f32 v97, v197, v97
v_mfma_f32_16x16x32_bf16 v[236:239], a[8:11], a[32:35], 0
s_add_u32 m0, s93, 8192
ds_read_b64_tr_b16 a[162:163], v206 offset:26752
buffer_load_dwordx4 v219, s[76:79], s54 offen offset:0 lds
v_mfma_f32_16x16x32_bf16 v[248:251], a[12:15], a[32:35], 0
ds_read_b64_tr_b16 a[164:165], v206 offset:20736
v_mul_f32 v98, v198, v98
v_mul_f32 v99, v199, v99
v_mfma_f32_16x16x32_bf16 v[184:187], a[0:3], a[36:39], 0
ds_read_b64_tr_b16 a[166:167], v206 offset:26880
buffer_load_dwordx4 v220, s[76:79], s54 offen offset:1024 lds
v_mfma_f32_16x16x32_bf16 v[228:231], a[4:7], a[36:39], 0
v_cvt_pk_bf16_f32 v64, v64, v65
v_cvt_pk_bf16_f32 v65, v66, v67
v_cvt_pk_bf16_f32 v66, v96, v97
v_mfma_f32_16x16x32_bf16 v[240:243], a[8:11], a[36:39], 0
buffer_load_dwordx4 v221, s[76:79], s54 offen offset:2048 lds
v_cvt_pk_bf16_f32 v67, v98, v99
v_mfma_f32_16x16x32_bf16 v[252:255], a[12:15], a[36:39], 0
s_waitcnt lgkmcnt(3)
s_add_u32 s54, s54, 92160
v_accvgpr_read_b32 v196, a68
v_accvgpr_read_b32 v197, a69
v_mfma_f32_16x16x32_bf16 v[128:131], a[128:131], a[144:147], v[128:131]
v_accvgpr_read_b32 v198, a70
buffer_store_dwordx4 v[64:67], v200, s[20:23], s94 offen sc1
v_mfma_f32_16x16x32_bf16 v[140:143], a[132:135], a[144:147], v[140:143]
s_add_u32 s94, s94, 184320
v_accvgpr_read_b32 v199, a71
v_mul_f32 v68, v196, v68
v_mul_f32 v69, v197, v69
v_mfma_f32_16x16x32_bf16 v[152:155], a[136:139], a[144:147], v[152:155]
s_waitcnt vmcnt(31) lgkmcnt(0)
s_barrier
ds_read_b64_tr_b16 a[16:17], v205 offset:40960
v_mfma_f32_16x16x32_bf16 v[164:167], a[140:143], a[144:147], v[164:167]
s_add_u32 m0, s63, 20480
ds_read_b64_tr_b16 a[18:19], v205 offset:47104
v_mul_f32 v70, v198, v70
v_mul_f32 v71, v199, v71
v_mfma_f32_16x16x32_bf16 v[132:135], a[128:131], a[148:151], v[132:135]
ds_read_b128 a[0:3], v204 offset:40960
buffer_load_dwordx4 v200, s[20:23], s67 offen sc1 lds
v_mfma_f32_16x16x32_bf16 v[144:147], a[132:135], a[148:151], v[144:147]
ds_read_b128 a[4:7], v204 offset:41984
v_accvgpr_read_b32 v196, a100
v_accvgpr_read_b32 v197, a101
v_mfma_f32_16x16x32_bf16 v[156:159], a[136:139], a[148:151], v[156:159]
v_accvgpr_read_b32 v198, a102
v_accvgpr_read_b32 v199, a103
v_mfma_f32_16x16x32_bf16 v[168:171], a[140:143], a[148:151], v[168:171]
ds_read_b128 a[8:11], v204 offset:43008
v_mul_f32 v100, v196, v100
v_mul_f32 v101, v197, v101
v_mfma_f32_16x16x32_bf16 v[136:139], a[128:131], a[152:155], v[136:139]
ds_read_b128 a[12:15], v204 offset:44032
buffer_load_dwordx4 v214, s[20:23], s67 offen offset:1024 sc1 lds
v_mfma_f32_16x16x32_bf16 v[148:151], a[132:135], a[152:155], v[148:151]
s_add_u32 s67, s67, s33
ds_read_b64_tr_b16 a[20:21], v205 offset:41088
v_mul_f32 v102, v198, v102
v_mul_f32 v103, v199, v103
v_mfma_f32_16x16x32_bf16 v[160:163], a[136:139], a[152:155], v[160:163]
ds_read_b64_tr_b16 a[22:23], v205 offset:47232
v_cvt_pk_bf16_f32 v68, v68, v69
v_mfma_f32_16x16x32_bf16 v[172:175], a[140:143], a[152:155], v[172:175]
s_add_u32 m0, s93, 28672
v_cvt_pk_bf16_f32 v69, v70, v71
v_cvt_pk_bf16_f32 v70, v100, v101
v_cvt_pk_bf16_f32 v71, v102, v103
v_mfma_f32_16x16x32_bf16 v[176:179], a[128:131], a[156:159], v[176:179]
ds_read_b64_tr_b16 a[24:25], v205 offset:41216
buffer_load_dwordx4 v219, s[76:79], s54 offen offset:0 lds
v_mfma_f32_16x16x32_bf16 v[188:191], a[132:135], a[156:159], v[188:191]
ds_read_b64_tr_b16 a[26:27], v205 offset:47360
v_accvgpr_read_b32 v196, a72
v_accvgpr_read_b32 v197, a73
v_mfma_f32_16x16x32_bf16 v[232:235], a[136:139], a[156:159], v[232:235]
ds_read_b64_tr_b16 a[28:29], v206 offset:40960
v_accvgpr_read_b32 v198, a74
v_mfma_f32_16x16x32_bf16 v[244:247], a[140:143], a[156:159], v[244:247]
ds_read_b64_tr_b16 a[30:31], v206 offset:47104
buffer_store_dwordx4 v[68:71], v200, s[20:23], s94 offen sc1
s_add_u32 s94, s94, 184320
v_mfma_f32_16x16x32_bf16 v[180:183], a[128:131], a[160:163], v[180:183]
buffer_load_dwordx4 v220, s[76:79], s54 offen offset:1024 lds
v_accvgpr_read_b32 v199, a75
v_mfma_f32_16x16x32_bf16 v[224:227], a[132:135], a[160:163], v[224:227]
ds_read_b64_tr_b16 a[32:33], v206 offset:41088
v_mul_f32 v72, v196, v72
v_mul_f32 v73, v197, v73
v_mfma_f32_16x16x32_bf16 v[236:239], a[136:139], a[160:163], v[236:239]
ds_read_b64_tr_b16 a[34:35], v206 offset:47232
v_mul_f32 v74, v198, v74
v_mfma_f32_16x16x32_bf16 v[248:251], a[140:143], a[160:163], v[248:251]
ds_read_b64_tr_b16 a[36:37], v206 offset:41216
v_mul_f32 v75, v199, v75
v_accvgpr_read_b32 v196, a104
v_mfma_f32_16x16x32_bf16 v[184:187], a[128:131], a[164:167], v[184:187]
ds_read_b64_tr_b16 a[38:39], v206 offset:47360
buffer_load_dwordx4 v221, s[76:79], s54 offen offset:2048 lds
v_mfma_f32_16x16x32_bf16 v[228:231], a[132:135], a[164:167], v[228:231]
s_add_u32 s54, s54, 92160
v_accvgpr_read_b32 v197, a105
v_accvgpr_read_b32 v198, a106
v_accvgpr_read_b32 v199, a107
v_mfma_f32_16x16x32_bf16 v[240:243], a[136:139], a[164:167], v[240:243]
v_mul_f32 v104, v196, v104
v_mul_f32 v105, v197, v105
v_mfma_f32_16x16x32_bf16 v[252:255], a[140:143], a[164:167], v[252:255]
s_waitcnt lgkmcnt(3)
v_mul_f32 v106, v198, v106
v_mul_f32 v107, v199, v107
v_cvt_pk_bf16_f32 v72, v72, v73
v_mfma_f32_16x16x32_bf16 v[128:131], a[0:3], a[16:19], v[128:131]
v_cvt_pk_bf16_f32 v73, v74, v75
v_cvt_pk_bf16_f32 v74, v104, v105
v_mfma_f32_16x16x32_bf16 v[140:143], a[4:7], a[16:19], v[140:143]
v_cvt_pk_bf16_f32 v75, v106, v107
v_accvgpr_read_b32 v196, a76
v_accvgpr_read_b32 v197, a77
v_mfma_f32_16x16x32_bf16 v[152:155], a[8:11], a[16:19], v[152:155]
s_waitcnt vmcnt(32) lgkmcnt(0)
s_barrier
ds_read_b64_tr_b16 a[144:145], v201 offset:0
v_mfma_f32_16x16x32_bf16 v[164:167], a[12:15], a[16:19], v[164:167]
s_add_u32 m0, s63, 40960
ds_read_b64_tr_b16 a[146:147], v201 offset:6144
v_accvgpr_read_b32 v198, a78
buffer_store_dwordx4 v[72:75], v200, s[20:23], s94 offen sc1
v_mfma_f32_16x16x32_bf16 v[132:135], a[0:3], a[20:23], v[132:135]
s_add_u32 s94, s94, 184320
ds_read_b128 a[128:131], v207 offset:0
buffer_load_dwordx4 v200, s[20:23], s67 offen sc1 lds
v_mfma_f32_16x16x32_bf16 v[144:147], a[4:7], a[20:23], v[144:147]
ds_read_b128 a[132:135], v207 offset:1024
v_accvgpr_read_b32 v199, a79
v_mul_f32 v76, v196, v76
v_mfma_f32_16x16x32_bf16 v[156:159], a[8:11], a[20:23], v[156:159]
v_mul_f32 v77, v197, v77
v_mul_f32 v78, v198, v78
v_mfma_f32_16x16x32_bf16 v[168:171], a[12:15], a[20:23], v[168:171]
ds_read_b128 a[136:139], v207 offset:2048
v_mul_f32 v79, v199, v79
v_accvgpr_read_b32 v196, a108
v_mfma_f32_16x16x32_bf16 v[136:139], a[0:3], a[24:27], v[136:139]
ds_read_b128 a[140:143], v207 offset:3072
buffer_load_dwordx4 v214, s[20:23], s67 offen offset:1024 sc1 lds
v_mfma_f32_16x16x32_bf16 v[148:151], a[4:7], a[24:27], v[148:151]
s_add_u32 s67, s67, s33
ds_read_b64_tr_b16 a[148:149], v201 offset:128
v_accvgpr_read_b32 v197, a109
v_accvgpr_read_b32 v198, a110
v_mfma_f32_16x16x32_bf16 v[160:163], a[8:11], a[24:27], v[160:163]
ds_read_b64_tr_b16 a[150:151], v201 offset:6272
v_accvgpr_read_b32 v199, a111
v_mfma_f32_16x16x32_bf16 v[172:175], a[12:15], a[24:27], v[172:175]
s_add_u32 m0, s93, 49152
v_mul_f32 v108, v196, v108
v_mul_f32 v109, v197, v109
v_mul_f32 v110, v198, v110
v_mfma_f32_16x16x32_bf16 v[176:179], a[0:3], a[28:31], v[176:179]
ds_read_b64_tr_b16 a[152:153], v201 offset:256
buffer_load_dwordx4 v219, s[76:79], s54 offen offset:0 lds
v_mfma_f32_16x16x32_bf16 v[188:191], a[4:7], a[28:31], v[188:191]
ds_read_b64_tr_b16 a[154:155], v201 offset:6400
v_mul_f32 v111, v199, v111
v_cvt_pk_bf16_f32 v76, v76, v77
v_mfma_f32_16x16x32_bf16 v[232:235], a[8:11], a[28:31], v[232:235]
ds_read_b64_tr_b16 a[156:157], v202 offset:0
v_cvt_pk_bf16_f32 v77, v78, v79
v_mfma_f32_16x16x32_bf16 v[244:247], a[12:15], a[28:31], v[244:247]
ds_read_b64_tr_b16 a[158:159], v202 offset:6144
v_cvt_pk_bf16_f32 v78, v108, v109
v_cvt_pk_bf16_f32 v79, v110, v111
v_mfma_f32_16x16x32_bf16 v[180:183], a[0:3], a[32:35], v[180:183]
buffer_load_dwordx4 v220, s[76:79], s54 offen offset:1024 lds
v_accvgpr_read_b32 v196, a80
v_mfma_f32_16x16x32_bf16 v[224:227], a[4:7], a[32:35], v[224:227]
ds_read_b64_tr_b16 a[160:161], v202 offset:128
v_accvgpr_read_b32 v197, a81
v_accvgpr_read_b32 v198, a82
v_mfma_f32_16x16x32_bf16 v[236:239], a[8:11], a[32:35], v[236:239]
ds_read_b64_tr_b16 a[162:163], v202 offset:6272
buffer_store_dwordx4 v[76:79], v200, s[20:23], s94 offen sc1
v_mfma_f32_16x16x32_bf16 v[248:251], a[12:15], a[32:35], v[248:251]
s_add_u32 s94, s94, 184320
ds_read_b64_tr_b16 a[164:165], v202 offset:256
v_accvgpr_read_b32 v199, a83
v_mul_f32 v80, v196, v80
v_mfma_f32_16x16x32_bf16 v[184:187], a[0:3], a[36:39], v[184:187]
ds_read_b64_tr_b16 a[166:167], v202 offset:6400
buffer_load_dwordx4 v221, s[76:79], s54 offen offset:2048 lds
v_mfma_f32_16x16x32_bf16 v[228:231], a[4:7], a[36:39], v[228:231]
s_add_u32 s54, s54, 92160
v_mul_f32 v81, v197, v81
v_mul_f32 v82, v198, v82
v_mul_f32 v83, v199, v83
v_mfma_f32_16x16x32_bf16 v[240:243], a[8:11], a[36:39], v[240:243]
v_accvgpr_read_b32 v196, a112
v_accvgpr_read_b32 v197, a113
v_mfma_f32_16x16x32_bf16 v[252:255], a[12:15], a[36:39], v[252:255]
s_waitcnt lgkmcnt(3)
v_accvgpr_read_b32 v198, a114
v_accvgpr_read_b32 v199, a115
v_mul_f32 v112, v196, v112
v_mfma_f32_16x16x32_bf16 v[128:131], a[128:131], a[144:147], v[128:131]
v_mul_f32 v113, v197, v113
v_mul_f32 v114, v198, v114
v_mfma_f32_16x16x32_bf16 v[140:143], a[132:135], a[144:147], v[140:143]
v_mul_f32 v115, v199, v115
v_cvt_pk_bf16_f32 v80, v80, v81
v_cvt_pk_bf16_f32 v81, v82, v83
v_mfma_f32_16x16x32_bf16 v[152:155], a[136:139], a[144:147], v[152:155]
s_waitcnt vmcnt(34) lgkmcnt(0)
s_barrier
ds_read_b64_tr_b16 a[16:17], v201 offset:20480
v_mfma_f32_16x16x32_bf16 v[164:167], a[140:143], a[144:147], v[164:167]
s_add_u32 m0, s63, 61440
ds_read_b64_tr_b16 a[18:19], v201 offset:26624
v_cvt_pk_bf16_f32 v82, v112, v113
v_cvt_pk_bf16_f32 v83, v114, v115
v_mfma_f32_16x16x32_bf16 v[132:135], a[128:131], a[148:151], v[132:135]
ds_read_b128 a[0:3], v207 offset:20480
buffer_load_dwordx4 v200, s[20:23], s67 offen sc1 lds
v_mfma_f32_16x16x32_bf16 v[144:147], a[132:135], a[148:151], v[144:147]
ds_read_b128 a[4:7], v207 offset:21504
v_accvgpr_read_b32 v196, a84
v_accvgpr_read_b32 v197, a85
v_mfma_f32_16x16x32_bf16 v[156:159], a[136:139], a[148:151], v[156:159]
v_accvgpr_read_b32 v198, a86
buffer_store_dwordx4 v[80:83], v200, s[20:23], s94 offen sc1
v_mfma_f32_16x16x32_bf16 v[168:171], a[140:143], a[148:151], v[168:171]
s_add_u32 s94, s94, 184320
ds_read_b128 a[8:11], v207 offset:22528
v_accvgpr_read_b32 v199, a87
v_mul_f32 v84, v196, v84
v_mfma_f32_16x16x32_bf16 v[136:139], a[128:131], a[152:155], v[136:139]
ds_read_b128 a[12:15], v207 offset:23552
buffer_load_dwordx4 v214, s[20:23], s67 offen offset:1024 sc1 lds
v_mfma_f32_16x16x32_bf16 v[148:151], a[132:135], a[152:155], v[148:151]
s_add_u32 s67, s67, s33
ds_read_b64_tr_b16 a[20:21], v201 offset:20608
v_mul_f32 v85, v197, v85
v_mul_f32 v86, v198, v86
v_mfma_f32_16x16x32_bf16 v[160:163], a[136:139], a[152:155], v[160:163]
ds_read_b64_tr_b16 a[22:23], v201 offset:26752
v_mul_f32 v87, v199, v87
v_mfma_f32_16x16x32_bf16 v[172:175], a[140:143], a[152:155], v[172:175]
s_add_u32 m0, s93, 69632
v_accvgpr_read_b32 v196, a116
v_accvgpr_read_b32 v197, a117
v_accvgpr_read_b32 v198, a118
v_mfma_f32_16x16x32_bf16 v[176:179], a[128:131], a[156:159], v[176:179]
ds_read_b64_tr_b16 a[24:25], v201 offset:20736
buffer_load_dwordx4 v219, s[76:79], s54 offen offset:0 lds
v_mfma_f32_16x16x32_bf16 v[188:191], a[132:135], a[156:159], v[188:191]
ds_read_b64_tr_b16 a[26:27], v201 offset:26880
v_accvgpr_read_b32 v199, a119
v_mul_f32 v116, v196, v116
v_mfma_f32_16x16x32_bf16 v[232:235], a[136:139], a[156:159], v[232:235]
ds_read_b64_tr_b16 a[28:29], v202 offset:20480
v_mul_f32 v117, v197, v117
v_mfma_f32_16x16x32_bf16 v[244:247], a[140:143], a[156:159], v[244:247]
ds_read_b64_tr_b16 a[30:31], v202 offset:26624
v_mul_f32 v118, v198, v118
v_mul_f32 v119, v199, v119
v_mfma_f32_16x16x32_bf16 v[180:183], a[128:131], a[160:163], v[180:183]
buffer_load_dwordx4 v220, s[76:79], s54 offen offset:1024 lds
v_cvt_pk_bf16_f32 v84, v84, v85
v_mfma_f32_16x16x32_bf16 v[224:227], a[132:135], a[160:163], v[224:227]
ds_read_b64_tr_b16 a[32:33], v202 offset:20608
v_cvt_pk_bf16_f32 v85, v86, v87
v_cvt_pk_bf16_f32 v86, v116, v117
v_mfma_f32_16x16x32_bf16 v[236:239], a[136:139], a[160:163], v[236:239]
ds_read_b64_tr_b16 a[34:35], v202 offset:26752
T_b_0:
s_cbranch_execz T_r0
v_cvt_pk_bf16_f32 v87, v118, v119
v_mfma_f32_16x16x32_bf16 v[248:251], a[140:143], a[160:163], v[248:251]
ds_read_b64_tr_b16 a[36:37], v202 offset:20736
v_accvgpr_read_b32 v196, a88
v_accvgpr_read_b32 v197, a89
v_mfma_f32_16x16x32_bf16 v[184:187], a[128:131], a[164:167], v[184:187]
ds_read_b64_tr_b16 a[38:39], v202 offset:26880
buffer_load_dwordx4 v221, s[76:79], s54 offen offset:2048 lds
v_mfma_f32_16x16x32_bf16 v[228:231], a[132:135], a[164:167], v[228:231]
s_add_u32 s54, s54, 4294064128
v_accvgpr_read_b32 v198, a90
buffer_store_dwordx4 v[84:87], v200, s[20:23], s94 offen sc1
s_add_u32 s94, s94, 184320
v_mfma_f32_16x16x32_bf16 v[240:243], a[136:139], a[164:167], v[240:243]
v_accvgpr_read_b32 v199, a91
v_mul_f32 v88, v196, v88
v_mfma_f32_16x16x32_bf16 v[252:255], a[140:143], a[164:167], v[252:255]
s_waitcnt lgkmcnt(3)
v_mul_f32 v89, v197, v89
v_mul_f32 v90, v198, v90
v_mul_f32 v91, v199, v91
P2g_m:
v_mfma_f32_16x16x32_bf16 v[128:131], a[0:3], a[16:19], v[128:131]
buffer_load_dword v216, v215, s[20:23], s68 offen offset:36 sc1
v_accvgpr_read_b32 v196, a120
v_mfma_f32_16x16x32_bf16 v[140:143], a[4:7], a[16:19], v[140:143]
v_accvgpr_read_b32 v197, a121
v_accvgpr_read_b32 v198, a122
v_accvgpr_read_b32 v199, a123
v_mfma_f32_16x16x32_bf16 v[152:155], a[8:11], a[16:19], v[152:155]
s_waitcnt vmcnt(37) lgkmcnt(0)
s_barrier
ds_read_b64_tr_b16 a[144:145], v201 offset:40960
v_mfma_f32_16x16x32_bf16 v[164:167], a[12:15], a[16:19], v[164:167]
s_add_u32 m0, s93, 90112
ds_read_b64_tr_b16 a[146:147], v201 offset:47104
v_mul_f32 v120, v196, v120
v_mul_f32 v121, v197, v121
v_mfma_f32_16x16x32_bf16 v[132:135], a[0:3], a[20:23], v[132:135]
ds_read_b128 a[128:131], v207 offset:40960
buffer_load_dwordx4 v219, s[76:79], s54 offen offset:0 lds
v_mfma_f32_16x16x32_bf16 v[144:147], a[4:7], a[20:23], v[144:147]
ds_read_b128 a[132:135], v207 offset:41984
v_mul_f32 v122, v198, v122
v_mul_f32 v123, v199, v123
v_mfma_f32_16x16x32_bf16 v[156:159], a[8:11], a[20:23], v[156:159]
v_cvt_pk_bf16_f32 v88, v88, v89
v_cvt_pk_bf16_f32 v89, v90, v91
v_mfma_f32_16x16x32_bf16 v[168:171], a[12:15], a[20:23], v[168:171]
ds_read_b128 a[136:139], v207 offset:43008
v_cvt_pk_bf16_f32 v90, v120, v121
v_cvt_pk_bf16_f32 v91, v122, v123
v_mfma_f32_16x16x32_bf16 v[136:139], a[0:3], a[24:27], v[136:139]
ds_read_b128 a[140:143], v207 offset:44032
v_accvgpr_read_b32 v196, a92
v_mfma_f32_16x16x32_bf16 v[148:151], a[4:7], a[24:27], v[148:151]
ds_read_b64_tr_b16 a[148:149], v201 offset:41088
v_accvgpr_read_b32 v197, a93
v_accvgpr_read_b32 v198, a94
v_mfma_f32_16x16x32_bf16 v[160:163], a[8:11], a[24:27], v[160:163]
ds_read_b64_tr_b16 a[150:151], v201 offset:47232
buffer_load_dwordx4 v220, s[76:79], s54 offen offset:1024 lds
v_mfma_f32_16x16x32_bf16 v[172:175], a[12:15], a[24:27], v[172:175]
buffer_store_dwordx4 v[88:91], v200, s[20:23], s94 offen sc1
s_add_u32 s94, s94, 184320
v_accvgpr_read_b32 v199, a95
v_mfma_f32_16x16x32_bf16 v[176:179], a[0:3], a[28:31], v[176:179]
ds_read_b64_tr_b16 a[152:153], v201 offset:41216
v_mul_f32 v92, v196, v92
v_mfma_f32_16x16x32_bf16 v[188:191], a[4:7], a[28:31], v[188:191]
ds_read_b64_tr_b16 a[154:155], v201 offset:47360
v_mul_f32 v93, v197, v93
v_mul_f32 v94, v198, v94
v_mfma_f32_16x16x32_bf16 v[232:235], a[8:11], a[28:31], v[232:235]
ds_read_b64_tr_b16 a[156:157], v202 offset:40960
v_mul_f32 v95, v199, v95
v_mfma_f32_16x16x32_bf16 v[244:247], a[12:15], a[28:31], v[244:247]
ds_read_b64_tr_b16 a[158:159], v202 offset:47104
v_accvgpr_read_b32 v196, a124
v_accvgpr_read_b32 v197, a125
v_mfma_f32_16x16x32_bf16 v[180:183], a[0:3], a[32:35], v[180:183]
v_accvgpr_read_b32 v198, a126
v_accvgpr_read_b32 v199, a127
v_mfma_f32_16x16x32_bf16 v[224:227], a[4:7], a[32:35], v[224:227]
ds_read_b64_tr_b16 a[160:161], v202 offset:41088
buffer_load_dwordx4 v221, s[76:79], s54 offen offset:2048 lds
v_mul_f32 v124, v196, v124
v_mfma_f32_16x16x32_bf16 v[236:239], a[8:11], a[32:35], v[236:239]
s_add_u32 s54, s54, 92160
ds_read_b64_tr_b16 a[162:163], v202 offset:47232
v_mul_f32 v125, v197, v125
v_mfma_f32_16x16x32_bf16 v[248:251], a[12:15], a[32:35], v[248:251]
ds_read_b64_tr_b16 a[164:165], v202 offset:41216
v_mul_f32 v126, v198, v126
v_mul_f32 v127, v199, v127
v_mfma_f32_16x16x32_bf16 v[184:187], a[0:3], a[36:39], v[184:187]
ds_read_b64_tr_b16 a[166:167], v202 offset:47360
v_cvt_pk_bf16_f32 v92, v92, v93
v_mfma_f32_16x16x32_bf16 v[228:231], a[4:7], a[36:39], v[228:231]
v_cvt_pk_bf16_f32 v93, v94, v95
v_cvt_pk_bf16_f32 v94, v124, v125
v_cvt_pk_bf16_f32 v95, v126, v127
v_mfma_f32_16x16x32_bf16 v[240:243], a[8:11], a[36:39], v[240:243]
buffer_store_dwordx4 v[92:95], v200, s[20:23], s94 offen sc1
s_add_u32 s94, s94, 184320
v_mfma_f32_16x16x32_bf16 v[252:255], a[12:15], a[36:39], v[252:255]
s_waitcnt lgkmcnt(3)
v_mfma_f32_16x16x32_bf16 v[128:131], a[128:131], a[144:147], v[128:131]
v_mfma_f32_16x16x32_bf16 v[140:143], a[132:135], a[144:147], v[140:143]
v_mfma_f32_16x16x32_bf16 v[152:155], a[136:139], a[144:147], v[152:155]
s_waitcnt vmcnt(37) lgkmcnt(0)
s_barrier
ds_read_b64_tr_b16 a[16:17], v209 offset:0
v_mfma_f32_16x16x32_bf16 v[164:167], a[140:143], a[144:147], v[164:167]
s_add_u32 m0, s93, 110592
ds_read_b64_tr_b16 a[18:19], v209 offset:6144
v_mfma_f32_16x16x32_bf16 v[132:135], a[128:131], a[148:151], v[132:135]
ds_read_b128 a[0:3], v208 offset:0
buffer_load_dwordx4 v219, s[76:79], s54 offen offset:0 lds
v_mfma_f32_16x16x32_bf16 v[144:147], a[132:135], a[148:151], v[144:147]
ds_read_b128 a[4:7], v208 offset:1024
v_mfma_f32_16x16x32_bf16 v[156:159], a[136:139], a[148:151], v[156:159]
v_mfma_f32_16x16x32_bf16 v[168:171], a[140:143], a[148:151], v[168:171]
ds_read_b128 a[8:11], v208 offset:2048
v_mfma_f32_16x16x32_bf16 v[136:139], a[128:131], a[152:155], v[136:139]
ds_read_b128 a[12:15], v208 offset:3072
v_mfma_f32_16x16x32_bf16 v[148:151], a[132:135], a[152:155], v[148:151]
ds_read_b64_tr_b16 a[20:21], v209 offset:128
v_mfma_f32_16x16x32_bf16 v[160:163], a[136:139], a[152:155], v[160:163]
ds_read_b64_tr_b16 a[22:23], v209 offset:6272
buffer_load_dwordx4 v220, s[76:79], s54 offen offset:1024 lds
v_mfma_f32_16x16x32_bf16 v[172:175], a[140:143], a[152:155], v[172:175]
v_mfma_f32_16x16x32_bf16 v[176:179], a[128:131], a[156:159], v[176:179]
ds_read_b64_tr_b16 a[24:25], v209 offset:256
v_mfma_f32_16x16x32_bf16 v[188:191], a[132:135], a[156:159], v[188:191]
ds_read_b64_tr_b16 a[26:27], v209 offset:6400
v_mfma_f32_16x16x32_bf16 v[232:235], a[136:139], a[156:159], v[232:235]
ds_read_b64_tr_b16 a[28:29], v210 offset:0
v_mfma_f32_16x16x32_bf16 v[244:247], a[140:143], a[156:159], v[244:247]
ds_read_b64_tr_b16 a[30:31], v210 offset:6144
v_mfma_f32_16x16x32_bf16 v[180:183], a[128:131], a[160:163], v[180:183]
v_mfma_f32_16x16x32_bf16 v[224:227], a[132:135], a[160:163], v[224:227]
ds_read_b64_tr_b16 a[32:33], v210 offset:128
buffer_load_dwordx4 v221, s[76:79], s54 offen offset:2048 lds
v_mfma_f32_16x16x32_bf16 v[236:239], a[136:139], a[160:163], v[236:239]
s_add_u32 s54, s54, 92160
ds_read_b64_tr_b16 a[34:35], v210 offset:6272
v_mfma_f32_16x16x32_bf16 v[248:251], a[140:143], a[160:163], v[248:251]
ds_read_b64_tr_b16 a[36:37], v210 offset:256
v_mfma_f32_16x16x32_bf16 v[184:187], a[128:131], a[164:167], v[184:187]
ds_read_b64_tr_b16 a[38:39], v210 offset:6400
v_mfma_f32_16x16x32_bf16 v[228:231], a[132:135], a[164:167], v[228:231]
v_mfma_f32_16x16x32_bf16 v[240:243], a[136:139], a[164:167], v[240:243]
v_mfma_f32_16x16x32_bf16 v[252:255], a[140:143], a[164:167], v[252:255]
s_waitcnt lgkmcnt(7)
v_mfma_f32_16x16x32_bf16 v[128:131], a[0:3], a[16:19], v[128:131]
v_mfma_f32_16x16x32_bf16 v[140:143], a[4:7], a[16:19], v[140:143]
v_mfma_f32_16x16x32_bf16 v[152:155], a[8:11], a[16:19], v[152:155]
s_waitcnt vmcnt(8)
v_cmp_ne_u32 vcc, s96, v216
s_cbranch_vccnz chk_8
chk_8_r:
v_mfma_f32_16x16x32_bf16 v[164:167], a[12:15], a[16:19], v[164:167]
s_waitcnt lgkmcnt(0)
s_barrier
ds_read_b64_tr_b16 a[144:145], v209 offset:20480
v_mfma_f32_16x16x32_bf16 v[132:135], a[0:3], a[20:23], v[132:135]
s_add_u32 m0, s63, 81920
ds_read_b64_tr_b16 a[146:147], v209 offset:26624
ds_read_b128 a[128:131], v208 offset:20480
v_mfma_f32_16x16x32_bf16 v[144:147], a[4:7], a[20:23], v[144:147]
buffer_load_dwordx4 v200, s[20:23], s67 offen sc1 lds
ds_read_b128 a[132:135], v208 offset:21504
v_mfma_f32_16x16x32_bf16 v[156:159], a[8:11], a[20:23], v[156:159]
buffer_load_dwordx4 v214, s[20:23], s67 offen offset:1024 sc1 lds
s_add_u32 s67, s67, s33
v_mfma_f32_16x16x32_bf16 v[168:171], a[12:15], a[20:23], v[168:171]
ds_read_b128 a[136:139], v208 offset:22528
v_mfma_f32_16x16x32_bf16 v[136:139], a[0:3], a[24:27], v[136:139]
s_add_u32 m0, s93, 131072
ds_read_b128 a[140:143], v208 offset:23552
v_mfma_f32_16x16x32_bf16 v[148:151], a[4:7], a[24:27], v[148:151]
ds_read_b64_tr_b16 a[148:149], v209 offset:20608
buffer_load_dwordx4 v219, s[76:79], s54 offen offset:0 lds
v_mfma_f32_16x16x32_bf16 v[160:163], a[8:11], a[24:27], v[160:163]
ds_read_b64_tr_b16 a[150:151], v209 offset:26752
v_mfma_f32_16x16x32_bf16 v[172:175], a[12:15], a[24:27], v[172:175]
v_mfma_f32_16x16x32_bf16 v[176:179], a[0:3], a[28:31], v[176:179]
ds_read_b64_tr_b16 a[152:153], v209 offset:20736
buffer_load_dwordx4 v220, s[76:79], s54 offen offset:1024 lds
v_mfma_f32_16x16x32_bf16 v[188:191], a[4:7], a[28:31], v[188:191]
ds_read_b64_tr_b16 a[154:155], v209 offset:26880
v_mfma_f32_16x16x32_bf16 v[232:235], a[8:11], a[28:31], v[232:235]
ds_read_b64_tr_b16 a[156:157], v210 offset:20480
v_mfma_f32_16x16x32_bf16 v[244:247], a[12:15], a[28:31], v[244:247]
ds_read_b64_tr_b16 a[158:159], v210 offset:26624
buffer_load_dwordx4 v221, s[76:79], s54 offen offset:2048 lds
v_mfma_f32_16x16x32_bf16 v[180:183], a[0:3], a[32:35], v[180:183]
s_add_u32 s54, s54, 92160
v_mfma_f32_16x16x32_bf16 v[224:227], a[4:7], a[32:35], v[224:227]
s_add_u32 m0, s63, 102400
ds_read_b64_tr_b16 a[160:161], v210 offset:20608
v_mfma_f32_16x16x32_bf16 v[236:239], a[8:11], a[32:35], v[236:239]
ds_read_b64_tr_b16 a[162:163], v210 offset:26752
buffer_load_dwordx4 v200, s[20:23], s67 offen sc1 lds
v_mfma_f32_16x16x32_bf16 v[248:251], a[12:15], a[32:35], v[248:251]
ds_read_b64_tr_b16 a[164:165], v210 offset:20736
v_mfma_f32_16x16x32_bf16 v[184:187], a[0:3], a[36:39], v[184:187]
ds_read_b64_tr_b16 a[166:167], v210 offset:26880
v_mfma_f32_16x16x32_bf16 v[228:231], a[4:7], a[36:39], v[228:231]
buffer_load_dwordx4 v214, s[20:23], s67 offen offset:1024 sc1 lds
s_add_u32 s67, s67, s33
v_mfma_f32_16x16x32_bf16 v[240:243], a[8:11], a[36:39], v[240:243]
v_mfma_f32_16x16x32_bf16 v[252:255], a[12:15], a[36:39], v[252:255]
s_waitcnt lgkmcnt(5)
v_mfma_f32_16x16x32_bf16 v[128:131], a[128:131], a[144:147], v[128:131]
v_mfma_f32_16x16x32_bf16 v[140:143], a[132:135], a[144:147], v[140:143]
v_mfma_f32_16x16x32_bf16 v[152:155], a[136:139], a[144:147], v[152:155]
s_waitcnt lgkmcnt(0)
s_barrier
ds_read_b64_tr_b16 a[16:17], v205 offset:0
v_mfma_f32_16x16x32_bf16 v[164:167], a[140:143], a[144:147], v[164:167]
s_waitcnt vmcnt(10)
buffer_store_dword v218, v217, s[20:23], s45 offen offset:8 sc1
ds_read_b64_tr_b16 a[18:19], v205 offset:6144
v_mfma_f32_16x16x32_bf16 v[132:135], a[128:131], a[148:151], v[132:135]
s_add_u32 m0, s63, 122880
ds_read_b128 a[0:3], v204 offset:0
buffer_load_dwordx4 v200, s[20:23], s67 offen sc1 lds
v_mfma_f32_16x16x32_bf16 v[144:147], a[132:135], a[148:151], v[144:147]
ds_read_b128 a[4:7], v204 offset:1024
v_mfma_f32_16x16x32_bf16 v[156:159], a[136:139], a[148:151], v[156:159]
buffer_load_dwordx4 v214, s[20:23], s67 offen offset:1024 sc1 lds
s_add_u32 s67, s67, s33
v_mfma_f32_16x16x32_bf16 v[168:171], a[140:143], a[148:151], v[168:171]
ds_read_b128 a[8:11], v204 offset:2048
v_mfma_f32_16x16x32_bf16 v[136:139], a[128:131], a[152:155], v[136:139]
s_add_u32 m0, s93, 151552
ds_read_b128 a[12:15], v204 offset:3072
v_mfma_f32_16x16x32_bf16 v[148:151], a[132:135], a[152:155], v[148:151]
ds_read_b64_tr_b16 a[20:21], v205 offset:128
buffer_load_dwordx4 v219, s[76:79], s54 offen offset:0 lds
v_mfma_f32_16x16x32_bf16 v[160:163], a[136:139], a[152:155], v[160:163]
ds_read_b64_tr_b16 a[22:23], v205 offset:6272
v_mfma_f32_16x16x32_bf16 v[172:175], a[140:143], a[152:155], v[172:175]
v_mfma_f32_16x16x32_bf16 v[176:179], a[128:131], a[156:159], v[176:179]
ds_read_b64_tr_b16 a[24:25], v205 offset:256
buffer_load_dwordx4 v220, s[76:79], s54 offen offset:1024 lds
v_mfma_f32_16x16x32_bf16 v[188:191], a[132:135], a[156:159], v[188:191]
ds_read_b64_tr_b16 a[26:27], v205 offset:6400
v_mfma_f32_16x16x32_bf16 v[232:235], a[136:139], a[156:159], v[232:235]
ds_read_b64_tr_b16 a[28:29], v206 offset:0
v_mfma_f32_16x16x32_bf16 v[244:247], a[140:143], a[156:159], v[244:247]
ds_read_b64_tr_b16 a[30:31], v206 offset:6144
buffer_load_dwordx4 v221, s[76:79], s54 offen offset:2048 lds
v_mfma_f32_16x16x32_bf16 v[180:183], a[128:131], a[160:163], v[180:183]
s_add_u32 s54, s54, 387072
v_mfma_f32_16x16x32_bf16 v[224:227], a[132:135], a[160:163], v[224:227]
s_add_u32 m0, s63, 143360
ds_read_b64_tr_b16 a[32:33], v206 offset:128
v_mfma_f32_16x16x32_bf16 v[236:239], a[136:139], a[160:163], v[236:239]
ds_read_b64_tr_b16 a[34:35], v206 offset:6272
buffer_load_dwordx4 v200, s[20:23], s67 offen sc1 lds
v_mfma_f32_16x16x32_bf16 v[248:251], a[140:143], a[160:163], v[248:251]
ds_read_b64_tr_b16 a[36:37], v206 offset:256
v_mfma_f32_16x16x32_bf16 v[184:187], a[128:131], a[164:167], v[184:187]
ds_read_b64_tr_b16 a[38:39], v206 offset:6400
v_mfma_f32_16x16x32_bf16 v[228:231], a[132:135], a[164:167], v[228:231]
buffer_load_dwordx4 v214, s[20:23], s67 offen offset:1024 sc1 lds
s_add_u32 s67, s67, s33
v_mfma_f32_16x16x32_bf16 v[240:243], a[136:139], a[164:167], v[240:243]
v_mfma_f32_16x16x32_bf16 v[252:255], a[140:143], a[164:167], v[252:255]
s_waitcnt lgkmcnt(5)
v_mfma_f32_16x16x32_bf16 v[128:131], a[0:3], a[16:19], v[128:131]
v_mfma_f32_16x16x32_bf16 v[140:143], a[4:7], a[16:19], v[140:143]
v_mfma_f32_16x16x32_bf16 v[152:155], a[8:11], a[16:19], v[152:155]
s_waitcnt lgkmcnt(0)
s_barrier
ds_read_b64_tr_b16 a[144:145], v205 offset:20480
v_mfma_f32_16x16x32_bf16 v[164:167], a[12:15], a[16:19], v[164:167]
s_add_u32 m0, s63, 0
ds_read_b64_tr_b16 a[146:147], v205 offset:26624
v_mfma_f32_16x16x32_bf16 v[132:135], a[0:3], a[20:23], v[132:135]
ds_read_b128 a[128:131], v204 offset:20480
buffer_load_dwordx4 v200, s[20:23], s67 offen sc1 lds
v_mfma_f32_16x16x32_bf16 v[144:147], a[4:7], a[20:23], v[144:147]
ds_read_b128 a[132:135], v204 offset:21504
v_mfma_f32_16x16x32_bf16 v[156:159], a[8:11], a[20:23], v[156:159]
v_mfma_f32_16x16x32_bf16 v[168:171], a[12:15], a[20:23], v[168:171]
ds_read_b128 a[136:139], v204 offset:22528
v_mfma_f32_16x16x32_bf16 v[136:139], a[0:3], a[24:27], v[136:139]
ds_read_b128 a[140:143], v204 offset:23552
buffer_load_dwordx4 v214, s[20:23], s67 offen offset:1024 sc1 lds
v_mfma_f32_16x16x32_bf16 v[148:151], a[4:7], a[24:27], v[148:151]
s_add_u32 s67, s67, s33
ds_read_b64_tr_b16 a[148:149], v205 offset:20608
v_mfma_f32_16x16x32_bf16 v[160:163], a[8:11], a[24:27], v[160:163]
ds_read_b64_tr_b16 a[150:151], v205 offset:26752
v_mfma_f32_16x16x32_bf16 v[172:175], a[12:15], a[24:27], v[172:175]
s_add_u32 m0, s93, 8192
v_mfma_f32_16x16x32_bf16 v[176:179], a[0:3], a[28:31], v[176:179]
ds_read_b64_tr_b16 a[152:153], v205 offset:20736
buffer_load_dwordx4 v219, s[76:79], s54 offen offset:0 lds
v_mfma_f32_16x16x32_bf16 v[188:191], a[4:7], a[28:31], v[188:191]
ds_read_b64_tr_b16 a[154:155], v205 offset:26880
v_mfma_f32_16x16x32_bf16 v[232:235], a[8:11], a[28:31], v[232:235]
ds_read_b64_tr_b16 a[156:157], v206 offset:20480
v_mfma_f32_16x16x32_bf16 v[244:247], a[12:15], a[28:31], v[244:247]
ds_read_b64_tr_b16 a[158:159], v206 offset:26624
v_mfma_f32_16x16x32_bf16 v[180:183], a[0:3], a[32:35], v[180:183]
buffer_load_dwordx4 v220, s[76:79], s54 offen offset:1024 lds
v_mfma_f32_16x16x32_bf16 v[224:227], a[4:7], a[32:35], v[224:227]
ds_read_b64_tr_b16 a[160:161], v206 offset:20608
v_mfma_f32_16x16x32_bf16 v[236:239], a[8:11], a[32:35], v[236:239]
ds_read_b64_tr_b16 a[162:163], v206 offset:26752
v_mfma_f32_16x16x32_bf16 v[248:251], a[12:15], a[32:35], v[248:251]
ds_read_b64_tr_b16 a[164:165], v206 offset:20736
v_mfma_f32_16x16x32_bf16 v[184:187], a[0:3], a[36:39], v[184:187]
ds_read_b64_tr_b16 a[166:167], v206 offset:26880
buffer_load_dwordx4 v221, s[76:79], s54 offen offset:2048 lds
v_mfma_f32_16x16x32_bf16 v[228:231], a[4:7], a[36:39], v[228:231]
s_add_u32 s54, s54, 92160
v_mfma_f32_16x16x32_bf16 v[240:243], a[8:11], a[36:39], v[240:243]
v_mfma_f32_16x16x32_bf16 v[252:255], a[12:15], a[36:39], v[252:255]
s_waitcnt lgkmcnt(7)
v_mfma_f32_16x16x32_bf16 v[128:131], a[128:131], a[144:147], v[128:131]
v_mfma_f32_16x16x32_bf16 v[140:143], a[132:135], a[144:147], v[140:143]
v_mfma_f32_16x16x32_bf16 v[152:155], a[136:139], a[144:147], v[152:155]
s_waitcnt lgkmcnt(0)
s_barrier
ds_read_b64_tr_b16 a[16:17], v205 offset:40960
v_mfma_f32_16x16x32_bf16 v[164:167], a[140:143], a[144:147], v[164:167]
s_add_u32 m0, s63, 20480
ds_read_b64_tr_b16 a[18:19], v205 offset:47104
s_load_dwordx2 s[56:57], s[0:1], 64
v_mfma_f32_16x16x32_bf16 v[132:135], a[128:131], a[148:151], v[132:135]
s_load_dwordx2 s[58:59], s[0:1], 104
ds_read_b128 a[0:3], v204 offset:40960
buffer_load_dwordx4 v200, s[20:23], s67 offen sc1 lds
v_mfma_f32_16x16x32_bf16 v[144:147], a[132:135], a[148:151], v[144:147]
ds_read_b128 a[4:7], v204 offset:41984
v_mfma_f32_16x16x32_bf16 v[156:159], a[136:139], a[148:151], v[156:159]
v_mfma_f32_16x16x32_bf16 v[168:171], a[140:143], a[148:151], v[168:171]
ds_read_b128 a[8:11], v204 offset:43008
v_mfma_f32_16x16x32_bf16 v[136:139], a[128:131], a[152:155], v[136:139]
ds_read_b128 a[12:15], v204 offset:44032
buffer_load_dwordx4 v214, s[20:23], s67 offen offset:1024 sc1 lds
v_mfma_f32_16x16x32_bf16 v[148:151], a[132:135], a[152:155], v[148:151]
s_add_u32 s67, s67, s33
ds_read_b64_tr_b16 a[20:21], v205 offset:41088
v_mfma_f32_16x16x32_bf16 v[160:163], a[136:139], a[152:155], v[160:163]
ds_read_b64_tr_b16 a[22:23], v205 offset:47232
v_mfma_f32_16x16x32_bf16 v[172:175], a[140:143], a[152:155], v[172:175]
s_add_u32 m0, s93, 28672
v_mfma_f32_16x16x32_bf16 v[176:179], a[128:131], a[156:159], v[176:179]
ds_read_b64_tr_b16 a[24:25], v205 offset:41216
buffer_load_dwordx4 v219, s[76:79], s54 offen offset:0 lds
v_mfma_f32_16x16x32_bf16 v[188:191], a[132:135], a[156:159], v[188:191]
ds_read_b64_tr_b16 a[26:27], v205 offset:47360
v_mfma_f32_16x16x32_bf16 v[232:235], a[136:139], a[156:159], v[232:235]
ds_read_b64_tr_b16 a[28:29], v206 offset:40960
v_mfma_f32_16x16x32_bf16 v[244:247], a[140:143], a[156:159], v[244:247]
ds_read_b64_tr_b16 a[30:31], v206 offset:47104
v_mfma_f32_16x16x32_bf16 v[180:183], a[128:131], a[160:163], v[180:183]
buffer_load_dwordx4 v220, s[76:79], s54 offen offset:1024 lds
v_mfma_f32_16x16x32_bf16 v[224:227], a[132:135], a[160:163], v[224:227]
ds_read_b64_tr_b16 a[32:33], v206 offset:41088
v_mfma_f32_16x16x32_bf16 v[236:239], a[136:139], a[160:163], v[236:239]
ds_read_b64_tr_b16 a[34:35], v206 offset:47232
v_mfma_f32_16x16x32_bf16 v[248:251], a[140:143], a[160:163], v[248:251]
ds_read_b64_tr_b16 a[36:37], v206 offset:41216
v_mfma_f32_16x16x32_bf16 v[184:187], a[128:131], a[164:167], v[184:187]
ds_read_b64_tr_b16 a[38:39], v206 offset:47360
buffer_load_dwordx4 v221, s[76:79], s54 offen offset:2048 lds
v_mfma_f32_16x16x32_bf16 v[228:231], a[132:135], a[164:167], v[228:231]
s_add_u32 s54, s54, 92160
v_mfma_f32_16x16x32_bf16 v[240:243], a[136:139], a[164:167], v[240:243]
v_mfma_f32_16x16x32_bf16 v[252:255], a[140:143], a[164:167], v[252:255]
s_waitcnt lgkmcnt(7)
v_mfma_f32_16x16x32_bf16 v[128:131], a[0:3], a[16:19], v[128:131]
v_mfma_f32_16x16x32_bf16 v[140:143], a[4:7], a[16:19], v[140:143]
v_mfma_f32_16x16x32_bf16 v[152:155], a[8:11], a[16:19], v[152:155]
s_waitcnt lgkmcnt(0)
s_barrier
ds_read_b64_tr_b16 a[144:145], v201 offset:0
v_mfma_f32_16x16x32_bf16 v[164:167], a[12:15], a[16:19], v[164:167]
s_add_u32 m0, s63, 40960
ds_read_b64_tr_b16 a[146:147], v201 offset:6144
v_mfma_f32_16x16x32_bf16 v[132:135], a[0:3], a[20:23], v[132:135]
ds_read_b128 a[128:131], v207 offset:0
buffer_load_dwordx4 v200, s[20:23], s67 offen sc1 lds
v_mfma_f32_16x16x32_bf16 v[144:147], a[4:7], a[20:23], v[144:147]
ds_read_b128 a[132:135], v207 offset:1024
v_mfma_f32_16x16x32_bf16 v[156:159], a[8:11], a[20:23], v[156:159]
v_mfma_f32_16x16x32_bf16 v[168:171], a[12:15], a[20:23], v[168:171]
ds_read_b128 a[136:139], v207 offset:2048
v_mfma_f32_16x16x32_bf16 v[136:139], a[0:3], a[24:27], v[136:139]
ds_read_b128 a[140:143], v207 offset:3072
buffer_load_dwordx4 v214, s[20:23], s67 offen offset:1024 sc1 lds
v_mfma_f32_16x16x32_bf16 v[148:151], a[4:7], a[24:27], v[148:151]
s_add_u32 s67, s67, s33
ds_read_b64_tr_b16 a[148:149], v201 offset:128
v_mfma_f32_16x16x32_bf16 v[160:163], a[8:11], a[24:27], v[160:163]
ds_read_b64_tr_b16 a[150:151], v201 offset:6272
v_mfma_f32_16x16x32_bf16 v[172:175], a[12:15], a[24:27], v[172:175]
s_add_u32 m0, s93, 49152
v_mfma_f32_16x16x32_bf16 v[176:179], a[0:3], a[28:31], v[176:179]
ds_read_b64_tr_b16 a[152:153], v201 offset:256
buffer_load_dwordx4 v219, s[76:79], s54 offen offset:0 lds
v_mfma_f32_16x16x32_bf16 v[188:191], a[4:7], a[28:31], v[188:191]
ds_read_b64_tr_b16 a[154:155], v201 offset:6400
v_mfma_f32_16x16x32_bf16 v[232:235], a[8:11], a[28:31], v[232:235]
ds_read_b64_tr_b16 a[156:157], v202 offset:0
v_mfma_f32_16x16x32_bf16 v[244:247], a[12:15], a[28:31], v[244:247]
ds_read_b64_tr_b16 a[158:159], v202 offset:6144
v_mfma_f32_16x16x32_bf16 v[180:183], a[0:3], a[32:35], v[180:183]
buffer_load_dwordx4 v220, s[76:79], s54 offen offset:1024 lds
v_mfma_f32_16x16x32_bf16 v[224:227], a[4:7], a[32:35], v[224:227]
ds_read_b64_tr_b16 a[160:161], v202 offset:128
v_mfma_f32_16x16x32_bf16 v[236:239], a[8:11], a[32:35], v[236:239]
ds_read_b64_tr_b16 a[162:163], v202 offset:6272
v_mfma_f32_16x16x32_bf16 v[248:251], a[12:15], a[32:35], v[248:251]
ds_read_b64_tr_b16 a[164:165], v202 offset:256
v_mfma_f32_16x16x32_bf16 v[184:187], a[0:3], a[36:39], v[184:187]
ds_read_b64_tr_b16 a[166:167], v202 offset:6400
buffer_load_dwordx4 v221, s[76:79], s54 offen offset:2048 lds
v_mfma_f32_16x16x32_bf16 v[228:231], a[4:7], a[36:39], v[228:231]
s_add_u32 s54, s54, 92160
v_mfma_f32_16x16x32_bf16 v[240:243], a[8:11], a[36:39], v[240:243]
v_mfma_f32_16x16x32_bf16 v[252:255], a[12:15], a[36:39], v[252:255]
s_waitcnt lgkmcnt(7)
v_mfma_f32_16x16x32_bf16 v[128:131], a[128:131], a[144:147], v[128:131]
v_mfma_f32_16x16x32_bf16 v[140:143], a[132:135], a[144:147], v[140:143]
v_mfma_f32_16x16x32_bf16 v[152:155], a[136:139], a[144:147], v[152:155]
s_waitcnt vmcnt(28) lgkmcnt(0)
s_barrier
ds_read_b64_tr_b16 a[16:17], v201 offset:20480
v_mfma_f32_16x16x32_bf16 v[164:167], a[140:143], a[144:147], v[164:167]
s_add_u32 m0, s63, 61440
ds_read_b64_tr_b16 a[18:19], v201 offset:26624
v_mfma_f32_16x16x32_bf16 v[132:135], a[128:131], a[148:151], v[132:135]
ds_read_b128 a[0:3], v207 offset:20480
buffer_load_dwordx4 v200, s[20:23], s67 offen sc1 lds
v_mfma_f32_16x16x32_bf16 v[144:147], a[132:135], a[148:151], v[144:147]
ds_read_b128 a[4:7], v207 offset:21504
v_mfma_f32_16x16x32_bf16 v[156:159], a[136:139], a[148:151], v[156:159]
v_mfma_f32_16x16x32_bf16 v[168:171], a[140:143], a[148:151], v[168:171]
ds_read_b128 a[8:11], v207 offset:22528
v_mfma_f32_16x16x32_bf16 v[136:139], a[128:131], a[152:155], v[136:139]
ds_read_b128 a[12:15], v207 offset:23552
buffer_load_dwordx4 v214, s[20:23], s67 offen offset:1024 sc1 lds
v_mfma_f32_16x16x32_bf16 v[148:151], a[132:135], a[152:155], v[148:151]
s_add_u32 s67, s67, s33
ds_read_b64_tr_b16 a[20:21], v201 offset:20608
v_mfma_f32_16x16x32_bf16 v[160:163], a[136:139], a[152:155], v[160:163]
ds_read_b64_tr_b16 a[22:23], v201 offset:26752
v_mfma_f32_16x16x32_bf16 v[172:175], a[140:143], a[152:155], v[172:175]
s_add_u32 m0, s93, 69632
v_mfma_f32_16x16x32_bf16 v[176:179], a[128:131], a[156:159], v[176:179]
ds_read_b64_tr_b16 a[24:25], v201 offset:20736
buffer_load_dwordx4 v219, s[76:79], s54 offen offset:0 lds
v_mfma_f32_16x16x32_bf16 v[188:191], a[132:135], a[156:159], v[188:191]
ds_read_b64_tr_b16 a[26:27], v201 offset:26880
v_mfma_f32_16x16x32_bf16 v[232:235], a[136:139], a[156:159], v[232:235]
ds_read_b64_tr_b16 a[28:29], v202 offset:20480
v_mfma_f32_16x16x32_bf16 v[244:247], a[140:143], a[156:159], v[244:247]
ds_read_b64_tr_b16 a[30:31], v202 offset:26624
v_mfma_f32_16x16x32_bf16 v[180:183], a[128:131], a[160:163], v[180:183]
buffer_load_dwordx4 v220, s[76:79], s54 offen offset:1024 lds
v_mfma_f32_16x16x32_bf16 v[224:227], a[132:135], a[160:163], v[224:227]
ds_read_b64_tr_b16 a[32:33], v202 offset:20608
v_mfma_f32_16x16x32_bf16 v[236:239], a[136:139], a[160:163], v[236:239]
ds_read_b64_tr_b16 a[34:35], v202 offset:26752
v_mfma_f32_16x16x32_bf16 v[248:251], a[140:143], a[160:163], v[248:251]
ds_read_b64_tr_b16 a[36:37], v202 offset:20736
v_mfma_f32_16x16x32_bf16 v[184:187], a[128:131], a[164:167], v[184:187]
ds_read_b64_tr_b16 a[38:39], v202 offset:26880
buffer_load_dwordx4 v221, s[76:79], s54 offen offset:2048 lds
v_mfma_f32_16x16x32_bf16 v[228:231], a[132:135], a[164:167], v[228:231]
s_add_u32 s54, s54, 4294359040
v_mfma_f32_16x16x32_bf16 v[240:243], a[136:139], a[164:167], v[240:243]
v_mfma_f32_16x16x32_bf16 v[252:255], a[140:143], a[164:167], v[252:255]
s_waitcnt lgkmcnt(7)
v_mfma_f32_16x16x32_bf16 v[128:131], a[0:3], a[16:19], v[128:131]
v_mfma_f32_16x16x32_bf16 v[140:143], a[4:7], a[16:19], v[140:143]
v_mfma_f32_16x16x32_bf16 v[152:155], a[8:11], a[16:19], v[152:155]
s_waitcnt vmcnt(28) lgkmcnt(0)
s_barrier
ds_read_b64_tr_b16 a[144:145], v201 offset:40960
v_mfma_f32_16x16x32_bf16 v[164:167], a[12:15], a[16:19], v[164:167]
s_add_u32 m0, s93, 90112
ds_read_b64_tr_b16 a[146:147], v201 offset:47104
v_mfma_f32_16x16x32_bf16 v[132:135], a[0:3], a[20:23], v[132:135]
ds_read_b128 a[128:131], v207 offset:40960
buffer_load_dwordx4 v219, s[76:79], s54 offen offset:0 lds
v_mfma_f32_16x16x32_bf16 v[144:147], a[4:7], a[20:23], v[144:147]
ds_read_b128 a[132:135], v207 offset:41984
v_mfma_f32_16x16x32_bf16 v[156:159], a[8:11], a[20:23], v[156:159]
v_mfma_f32_16x16x32_bf16 v[168:171], a[12:15], a[20:23], v[168:171]
ds_read_b128 a[136:139], v207 offset:43008
v_mfma_f32_16x16x32_bf16 v[136:139], a[0:3], a[24:27], v[136:139]
ds_read_b128 a[140:143], v207 offset:44032
v_mfma_f32_16x16x32_bf16 v[148:151], a[4:7], a[24:27], v[148:151]
ds_read_b64_tr_b16 a[148:149], v201 offset:41088
v_mfma_f32_16x16x32_bf16 v[160:163], a[8:11], a[24:27], v[160:163]
ds_read_b64_tr_b16 a[150:151], v201 offset:47232
buffer_load_dwordx4 v220, s[76:79], s54 offen offset:1024 lds
v_mfma_f32_16x16x32_bf16 v[172:175], a[12:15], a[24:27], v[172:175]
v_mfma_f32_16x16x32_bf16 v[176:179], a[0:3], a[28:31], v[176:179]
ds_read_b64_tr_b16 a[152:153], v201 offset:41216
v_mfma_f32_16x16x32_bf16 v[188:191], a[4:7], a[28:31], v[188:191]
ds_read_b64_tr_b16 a[154:155], v201 offset:47360
v_mfma_f32_16x16x32_bf16 v[232:235], a[8:11], a[28:31], v[232:235]
ds_read_b64_tr_b16 a[156:157], v202 offset:40960
v_mfma_f32_16x16x32_bf16 v[244:247], a[12:15], a[28:31], v[244:247]
ds_read_b64_tr_b16 a[158:159], v202 offset:47104
v_mfma_f32_16x16x32_bf16 v[180:183], a[0:3], a[32:35], v[180:183]
v_mfma_f32_16x16x32_bf16 v[224:227], a[4:7], a[32:35], v[224:227]
ds_read_b64_tr_b16 a[160:161], v202 offset:41088
buffer_load_dwordx4 v221, s[76:79], s54 offen offset:2048 lds
v_mfma_f32_16x16x32_bf16 v[236:239], a[8:11], a[32:35], v[236:239]
s_add_u32 s54, s54, 73728
ds_read_b64_tr_b16 a[162:163], v202 offset:47232
v_mfma_f32_16x16x32_bf16 v[248:251], a[12:15], a[32:35], v[248:251]
ds_read_b64_tr_b16 a[164:165], v202 offset:41216
v_mfma_f32_16x16x32_bf16 v[184:187], a[0:3], a[36:39], v[184:187]
ds_read_b64_tr_b16 a[166:167], v202 offset:47360
v_mfma_f32_16x16x32_bf16 v[228:231], a[4:7], a[36:39], v[228:231]
v_mfma_f32_16x16x32_bf16 v[240:243], a[8:11], a[36:39], v[240:243]
v_mfma_f32_16x16x32_bf16 v[252:255], a[12:15], a[36:39], v[252:255]
s_waitcnt lgkmcnt(7)
v_mfma_f32_16x16x32_bf16 v[128:131], a[128:131], a[144:147], v[128:131]
buffer_load_dword v216, v203, s[20:23], s68 offen offset:8 sc1
v_mfma_f32_16x16x32_bf16 v[140:143], a[132:135], a[144:147], v[140:143]
v_mfma_f32_16x16x32_bf16 v[152:155], a[136:139], a[144:147], v[152:155]
s_waitcnt vmcnt(29) lgkmcnt(0)
s_barrier
ds_read_b64_tr_b16 a[16:17], v209 offset:0
v_mfma_f32_16x16x32_bf16 v[164:167], a[140:143], a[144:147], v[164:167]
s_add_u32 m0, s93, 110592
ds_read_b64_tr_b16 a[18:19], v209 offset:6144
v_mfma_f32_16x16x32_bf16 v[132:135], a[128:131], a[148:151], v[132:135]
ds_read_b128 a[0:3], v208 offset:0
T_b_1:
s_cbranch_execz T_r0
buffer_load_dwordx4 v219, s[76:79], s54 offen offset:0 lds
v_mfma_f32_16x16x32_bf16 v[144:147], a[132:135], a[148:151], v[144:147]
ds_read_b128 a[4:7], v208 offset:1024
v_mfma_f32_16x16x32_bf16 v[156:159], a[136:139], a[148:151], v[156:159]
v_mfma_f32_16x16x32_bf16 v[168:171], a[140:143], a[148:151], v[168:171]
ds_read_b128 a[8:11], v208 offset:2048
v_mfma_f32_16x16x32_bf16 v[136:139], a[128:131], a[152:155], v[136:139]
ds_read_b128 a[12:15], v208 offset:3072
v_mfma_f32_16x16x32_bf16 v[148:151], a[132:135], a[152:155], v[148:151]
ds_read_b64_tr_b16 a[20:21], v209 offset:128
v_mfma_f32_16x16x32_bf16 v[160:163], a[136:139], a[152:155], v[160:163]
ds_read_b64_tr_b16 a[22:23], v209 offset:6272
buffer_load_dwordx4 v220, s[76:79], s54 offen offset:1024 lds
v_mfma_f32_16x16x32_bf16 v[172:175], a[140:143], a[152:155], v[172:175]
v_mfma_f32_16x16x32_bf16 v[176:179], a[128:131], a[156:159], v[176:179]
ds_read_b64_tr_b16 a[24:25], v209 offset:256
v_mfma_f32_16x16x32_bf16 v[188:191], a[132:135], a[156:159], v[188:191]
ds_read_b64_tr_b16 a[26:27], v209 offset:6400
v_mfma_f32_16x16x32_bf16 v[232:235], a[136:139], a[156:159], v[232:235]
ds_read_b64_tr_b16 a[28:29], v210 offset:0
v_mfma_f32_16x16x32_bf16 v[244:247], a[140:143], a[156:159], v[244:247]
ds_read_b64_tr_b16 a[30:31], v210 offset:6144
v_mfma_f32_16x16x32_bf16 v[180:183], a[128:131], a[160:163], v[180:183]
v_mfma_f32_16x16x32_bf16 v[224:227], a[132:135], a[160:163], v[224:227]
ds_read_b64_tr_b16 a[32:33], v210 offset:128
buffer_load_dwordx4 v221, s[76:79], s54 offen offset:2048 lds
v_mfma_f32_16x16x32_bf16 v[236:239], a[136:139], a[160:163], v[236:239]
s_add_u32 s54, s54, 73728
ds_read_b64_tr_b16 a[34:35], v210 offset:6272
v_mfma_f32_16x16x32_bf16 v[248:251], a[140:143], a[160:163], v[248:251]
ds_read_b64_tr_b16 a[36:37], v210 offset:256
v_mfma_f32_16x16x32_bf16 v[184:187], a[128:131], a[164:167], v[184:187]
ds_read_b64_tr_b16 a[38:39], v210 offset:6400
v_mfma_f32_16x16x32_bf16 v[228:231], a[132:135], a[164:167], v[228:231]
v_mfma_f32_16x16x32_bf16 v[240:243], a[136:139], a[164:167], v[240:243]
v_mfma_f32_16x16x32_bf16 v[252:255], a[140:143], a[164:167], v[252:255]
s_waitcnt lgkmcnt(7)
v_mfma_f32_16x16x32_bf16 v[128:131], a[0:3], a[16:19], v[128:131]
v_mfma_f32_16x16x32_bf16 v[140:143], a[4:7], a[16:19], v[140:143]
v_mfma_f32_16x16x32_bf16 v[152:155], a[8:11], a[16:19], v[152:155]
s_waitcnt vmcnt(27) lgkmcnt(0)
s_barrier
ds_read_b64_tr_b16 a[144:145], v209 offset:20480
v_mfma_f32_16x16x32_bf16 v[164:167], a[12:15], a[16:19], v[164:167]
s_add_u32 m0, s93, 131072
ds_read_b64_tr_b16 a[146:147], v209 offset:26624
v_mfma_f32_16x16x32_bf16 v[132:135], a[0:3], a[20:23], v[132:135]
ds_read_b128 a[128:131], v208 offset:20480
buffer_load_dwordx4 v219, s[76:79], s54 offen offset:0 lds
v_mfma_f32_16x16x32_bf16 v[144:147], a[4:7], a[20:23], v[144:147]
ds_read_b128 a[132:135], v208 offset:21504
v_mfma_f32_16x16x32_bf16 v[156:159], a[8:11], a[20:23], v[156:159]
v_mfma_f32_16x16x32_bf16 v[168:171], a[12:15], a[20:23], v[168:171]
ds_read_b128 a[136:139], v208 offset:22528
v_mfma_f32_16x16x32_bf16 v[136:139], a[0:3], a[24:27], v[136:139]
ds_read_b128 a[140:143], v208 offset:23552
v_mfma_f32_16x16x32_bf16 v[148:151], a[4:7], a[24:27], v[148:151]
ds_read_b64_tr_b16 a[148:149], v209 offset:20608
v_mfma_f32_16x16x32_bf16 v[160:163], a[8:11], a[24:27], v[160:163]
ds_read_b64_tr_b16 a[150:151], v209 offset:26752
buffer_load_dwordx4 v220, s[76:79], s54 offen offset:1024 lds
v_mfma_f32_16x16x32_bf16 v[172:175], a[12:15], a[24:27], v[172:175]
v_mfma_f32_16x16x32_bf16 v[176:179], a[0:3], a[28:31], v[176:179]
ds_read_b64_tr_b16 a[152:153], v209 offset:20736
v_mfma_f32_16x16x32_bf16 v[188:191], a[4:7], a[28:31], v[188:191]
ds_read_b64_tr_b16 a[154:155], v209 offset:26880
v_mfma_f32_16x16x32_bf16 v[232:235], a[8:11], a[28:31], v[232:235]
ds_read_b64_tr_b16 a[156:157], v210 offset:20480
v_mfma_f32_16x16x32_bf16 v[244:247], a[12:15], a[28:31], v[244:247]
ds_read_b64_tr_b16 a[158:159], v210 offset:26624
v_mfma_f32_16x16x32_bf16 v[180:183], a[0:3], a[32:35], v[180:183]
v_mfma_f32_16x16x32_bf16 v[224:227], a[4:7], a[32:35], v[224:227]
ds_read_b64_tr_b16 a[160:161], v210 offset:20608
buffer_load_dwordx4 v221, s[76:79], s54 offen offset:2048 lds
v_mfma_f32_16x16x32_bf16 v[236:239], a[8:11], a[32:35], v[236:239]
s_add_u32 s54, s54, 73728
ds_read_b64_tr_b16 a[162:163], v210 offset:26752
v_mfma_f32_16x16x32_bf16 v[248:251], a[12:15], a[32:35], v[248:251]
ds_read_b64_tr_b16 a[164:165], v210 offset:20736
v_mfma_f32_16x16x32_bf16 v[184:187], a[0:3], a[36:39], v[184:187]
ds_read_b64_tr_b16 a[166:167], v210 offset:26880
v_mfma_f32_16x16x32_bf16 v[228:231], a[4:7], a[36:39], v[228:231]
v_mfma_f32_16x16x32_bf16 v[240:243], a[8:11], a[36:39], v[240:243]
v_mfma_f32_16x16x32_bf16 v[252:255], a[12:15], a[36:39], v[252:255]
s_waitcnt lgkmcnt(7)
v_mfma_f32_16x16x32_bf16 v[128:131], a[128:131], a[144:147], v[128:131]
v_mfma_f32_16x16x32_bf16 v[140:143], a[132:135], a[144:147], v[140:143]
v_mfma_f32_16x16x32_bf16 v[152:155], a[136:139], a[144:147], v[152:155]
s_waitcnt vmcnt(6)
v_cmp_ne_u32 vcc, s96, v216
s_cbranch_vccnz chk_10
chk_10_r:
v_mfma_f32_16x16x32_bf16 v[164:167], a[140:143], a[144:147], v[164:167]
s_waitcnt lgkmcnt(0)
s_barrier
ds_read_b64_tr_b16 a[16:17], v205 offset:0
v_mfma_f32_16x16x32_bf16 v[132:135], a[128:131], a[148:151], v[132:135]
s_add_u32 m0, s63, 81920
ds_read_b64_tr_b16 a[18:19], v205 offset:6144
ds_read_b128 a[0:3], v204 offset:0
v_mfma_f32_16x16x32_bf16 v[144:147], a[132:135], a[148:151], v[144:147]
buffer_load_dwordx4 v200, s[20:23], s67 offen sc1 lds
ds_read_b128 a[4:7], v204 offset:1024
v_mfma_f32_16x16x32_bf16 v[156:159], a[136:139], a[148:151], v[156:159]
buffer_load_dwordx4 v214, s[20:23], s67 offen offset:1024 sc1 lds
s_add_u32 s67, s67, s33
v_mfma_f32_16x16x32_bf16 v[168:171], a[140:143], a[148:151], v[168:171]
ds_read_b128 a[8:11], v204 offset:2048
v_mfma_f32_16x16x32_bf16 v[136:139], a[128:131], a[152:155], v[136:139]
s_add_u32 m0, s93, 151552
ds_read_b128 a[12:15], v204 offset:3072
v_mfma_f32_16x16x32_bf16 v[148:151], a[132:135], a[152:155], v[148:151]
ds_read_b64_tr_b16 a[20:21], v205 offset:128
buffer_load_dwordx4 v219, s[76:79], s54 offen offset:0 lds
v_mfma_f32_16x16x32_bf16 v[160:163], a[136:139], a[152:155], v[160:163]
ds_read_b64_tr_b16 a[22:23], v205 offset:6272
v_mfma_f32_16x16x32_bf16 v[172:175], a[140:143], a[152:155], v[172:175]
v_mfma_f32_16x16x32_bf16 v[176:179], a[128:131], a[156:159], v[176:179]
ds_read_b64_tr_b16 a[24:25], v205 offset:256
buffer_load_dwordx4 v220, s[76:79], s54 offen offset:1024 lds
v_mfma_f32_16x16x32_bf16 v[188:191], a[132:135], a[156:159], v[188:191]
ds_read_b64_tr_b16 a[26:27], v205 offset:6400
v_mfma_f32_16x16x32_bf16 v[232:235], a[136:139], a[156:159], v[232:235]
ds_read_b64_tr_b16 a[28:29], v206 offset:0
v_mfma_f32_16x16x32_bf16 v[244:247], a[140:143], a[156:159], v[244:247]
ds_read_b64_tr_b16 a[30:31], v206 offset:6144
buffer_load_dwordx4 v221, s[76:79], s54 offen offset:2048 lds
v_mfma_f32_16x16x32_bf16 v[180:183], a[128:131], a[160:163], v[180:183]
s_add_u32 s54, s54, 442368
v_mfma_f32_16x16x32_bf16 v[224:227], a[132:135], a[160:163], v[224:227]
s_add_u32 m0, s63, 102400
ds_read_b64_tr_b16 a[32:33], v206 offset:128
v_mfma_f32_16x16x32_bf16 v[236:239], a[136:139], a[160:163], v[236:239]
ds_read_b64_tr_b16 a[34:35], v206 offset:6272
buffer_load_dwordx4 v200, s[20:23], s67 offen sc1 lds
v_mfma_f32_16x16x32_bf16 v[248:251], a[140:143], a[160:163], v[248:251]
ds_read_b64_tr_b16 a[36:37], v206 offset:256
v_mfma_f32_16x16x32_bf16 v[184:187], a[128:131], a[164:167], v[184:187]
ds_read_b64_tr_b16 a[38:39], v206 offset:6400
v_mfma_f32_16x16x32_bf16 v[228:231], a[132:135], a[164:167], v[228:231]
buffer_load_dwordx4 v214, s[20:23], s67 offen offset:1024 sc1 lds
s_add_u32 s67, s67, s33
v_mfma_f32_16x16x32_bf16 v[240:243], a[136:139], a[164:167], v[240:243]
v_mfma_f32_16x16x32_bf16 v[252:255], a[140:143], a[164:167], v[252:255]
s_waitcnt lgkmcnt(5)
v_mfma_f32_16x16x32_bf16 v[128:131], a[0:3], a[16:19], v[128:131]
v_lshrrev_b32 v111, 4, v200
s_and_b32 s19, s64, 1
v_mfma_f32_16x16x32_bf16 v[140:143], a[4:7], a[16:19], v[140:143]
s_add_u32 s18, s19, 30
s_lshl_b32 s18, s18, 3
s_lshr_b32 s34, s64, 1
v_mfma_f32_16x16x32_bf16 v[152:155], a[8:11], a[16:19], v[152:155]
s_waitcnt lgkmcnt(0)
s_barrier
ds_read_b64_tr_b16 a[144:145], v205 offset:20480
v_mfma_f32_16x16x32_bf16 v[164:167], a[12:15], a[16:19], v[164:167]
s_add_u32 m0, s63, 122880
ds_read_b64_tr_b16 a[146:147], v205 offset:26624
s_add_u32 s18, s18, s34
v_mfma_f32_16x16x32_bf16 v[132:135], a[0:3], a[20:23], v[132:135]
s_lshl_b32 s18, s18, 7
ds_read_b128 a[128:131], v204 offset:20480
buffer_load_dwordx4 v200, s[20:23], s67 offen sc1 lds
v_mfma_f32_16x16x32_bf16 v[144:147], a[4:7], a[20:23], v[144:147]
s_add_u32 s18, s18, 4554752
ds_read_b128 a[132:135], v204 offset:21504
v_and_b32 v96, 3, v111
v_mfma_f32_16x16x32_bf16 v[156:159], a[8:11], a[20:23], v[156:159]
buffer_load_dwordx4 v214, s[20:23], s67 offen offset:1024 sc1 lds
v_lshl_add_u32 v213, v96, 5, s18
v_mfma_f32_16x16x32_bf16 v[168:171], a[12:15], a[20:23], v[168:171]
s_add_u32 s67, s67, s33
ds_read_b128 a[136:139], v204 offset:22528
s_lshl_b32 s34, s34, 12
v_mfma_f32_16x16x32_bf16 v[136:139], a[0:3], a[24:27], v[136:139]
s_add_u32 m0, s93, 8192
ds_read_b128 a[140:143], v204 offset:23552
s_lshl_b32 s19, s19, 6
v_mfma_f32_16x16x32_bf16 v[148:151], a[4:7], a[24:27], v[148:151]
s_add_u32 s18, s34, s19
ds_read_b64_tr_b16 a[148:149], v205 offset:20608
buffer_load_dwordx4 v219, s[76:79], s54 offen offset:0 lds
v_mfma_f32_16x16x32_bf16 v[160:163], a[8:11], a[24:27], v[160:163]
s_add_u32 s18, s18, 4492588
ds_read_b64_tr_b16 a[150:151], v205 offset:26752
v_min_u32 v96, 5, v111
v_mfma_f32_16x16x32_bf16 v[172:175], a[12:15], a[24:27], v[172:175]
v_lshl_add_u32 v212, v96, 7, s18
s_lshl_b32 s18, s64, 3
v_mfma_f32_16x16x32_bf16 v[176:179], a[0:3], a[28:31], v[176:179]
s_add_u32 s18, s18, s50
ds_read_b64_tr_b16 a[152:153], v205 offset:20736
buffer_load_dwordx4 v220, s[76:79], s54 offen offset:1024 lds
v_mfma_f32_16x16x32_bf16 v[188:191], a[4:7], a[28:31], v[188:191]
s_add_u32 s18, s18, s16
ds_read_b64_tr_b16 a[154:155], v205 offset:26880
s_mul_i32 s47, s18, 184320
v_mfma_f32_16x16x32_bf16 v[232:235], a[8:11], a[28:31], v[232:235]
s_add_u32 s47, s47, 10659840
ds_read_b64_tr_b16 a[156:157], v206 offset:20480
s_lshl_b32 s18, s65, 1
v_mfma_f32_16x16x32_bf16 v[244:247], a[12:15], a[28:31], v[244:247]
s_add_u32 s18, s18, s16
ds_read_b64_tr_b16 a[158:159], v206 offset:26624
buffer_load_dwordx4 v221, s[76:79], s54 offen offset:2048 lds
v_mfma_f32_16x16x32_bf16 v[180:183], a[0:3], a[32:35], v[180:183]
s_add_u32 s54, s54, 73728
s_lshl_b32 s18, s18, 1
s_lshr_b32 s49, s66, 1
v_mfma_f32_16x16x32_bf16 v[224:227], a[4:7], a[32:35], v[224:227]
s_add_u32 m0, s63, 143360
ds_read_b64_tr_b16 a[160:161], v206 offset:20608
s_add_u32 s18, s18, s49
v_mfma_f32_16x16x32_bf16 v[236:239], a[8:11], a[32:35], v[236:239]
s_mul_i32 s51, s18, 3072
ds_read_b64_tr_b16 a[162:163], v206 offset:26752
buffer_load_dwordx4 v200, s[20:23], s67 offen sc1 lds
v_mfma_f32_16x16x32_bf16 v[248:251], a[12:15], a[32:35], v[248:251]
s_mul_i32 s48, s17, 36864
ds_read_b64_tr_b16 a[164:165], v206 offset:20736
s_add_u32 s48, s48, s51
v_mfma_f32_16x16x32_bf16 v[184:187], a[0:3], a[36:39], v[184:187]
s_add_u32 s48, s48, 3579904
ds_read_b64_tr_b16 a[166:167], v206 offset:26880
s_mul_i32 s18, s16, 3072
v_mfma_f32_16x16x32_bf16 v[228:231], a[4:7], a[36:39], v[228:231]
s_add_u32 s18, s18, 69632
buffer_load_dwordx4 v214, s[20:23], s67 offen offset:1024 sc1 lds
v_add_u32 v112, s18, v200
v_mfma_f32_16x16x32_bf16 v[240:243], a[8:11], a[36:39], v[240:243]
s_add_u32 s67, s67, s33
v_add_u32 v113, 61440, v112
v_and_b32 v96, 15, v111
v_mfma_f32_16x16x32_bf16 v[252:255], a[12:15], a[36:39], v[252:255]
s_waitcnt lgkmcnt(3)
s_mul_i32 s34, s65, 192
s_lshl_b32 s19, s49, 5
v_mfma_f32_16x16x32_bf16 v[128:131], a[128:131], a[144:147], v[128:131]
s_add_u32 s34, s34, s19
s_lshl_b32 s19, s16, 4
s_add_u32 s35, s34, s19
v_mfma_f32_16x16x32_bf16 v[140:143], a[132:135], a[144:147], v[140:143]
s_mov_b32 s84, s56
s_mov_b32 s85, s57
s_mov_b32 s86, 1152
v_mfma_f32_16x16x32_bf16 v[152:155], a[136:139], a[144:147], v[152:155]
s_waitcnt lgkmcnt(0)
s_barrier
ds_read_b64_tr_b16 a[16:17], v205 offset:40960
v_mfma_f32_16x16x32_bf16 v[164:167], a[140:143], a[144:147], v[164:167]
s_add_u32 m0, s63, 0
ds_read_b64_tr_b16 a[18:19], v205 offset:47104
s_mov_b32 s87, 0x20000
v_mfma_f32_16x16x32_bf16 v[132:135], a[128:131], a[148:151], v[132:135]
ds_read_b128 a[0:3], v204 offset:40960
buffer_load_dwordx4 v200, s[20:23], s67 offen sc1 lds
v_mfma_f32_16x16x32_bf16 v[144:147], a[132:135], a[148:151], v[144:147]
ds_read_b128 a[4:7], v204 offset:41984
v_add_u32 v99, s35, v96
v_mfma_f32_16x16x32_bf16 v[156:159], a[136:139], a[148:151], v[156:159]
buffer_load_dwordx4 v214, s[20:23], s67 offen offset:1024 sc1 lds
v_lshlrev_b32 v98, 1, v99
v_mfma_f32_16x16x32_bf16 v[168:171], a[140:143], a[148:151], v[168:171]
s_add_u32 s67, s67, s33
ds_read_b128 a[8:11], v204 offset:43008
buffer_load_ushort v88, v98, s[84:87], 0 offen offset:0
v_mfma_f32_16x16x32_bf16 v[136:139], a[128:131], a[152:155], v[136:139]
s_add_u32 m0, s93, 28672
ds_read_b128 a[12:15], v204 offset:44032
buffer_load_ushort v89, v98, s[84:87], 0 offen offset:128
v_mfma_f32_16x16x32_bf16 v[148:151], a[132:135], a[152:155], v[148:151]
ds_read_b64_tr_b16 a[20:21], v205 offset:41088
buffer_load_dwordx4 v219, s[76:79], s54 offen offset:0 lds
v_mfma_f32_16x16x32_bf16 v[160:163], a[136:139], a[152:155], v[160:163]
ds_read_b64_tr_b16 a[22:23], v205 offset:47232
buffer_load_ushort v90, v98, s[84:87], 0 offen offset:256
v_mfma_f32_16x16x32_bf16 v[172:175], a[140:143], a[152:155], v[172:175]
v_lshrrev_b32 v97, 4, v111
s_lshl_b32 s18, s64, 7
v_mfma_f32_16x16x32_bf16 v[176:179], a[128:131], a[156:159], v[176:179]
s_lshl_b32 s19, s50, 2
ds_read_b64_tr_b16 a[24:25], v205 offset:41216
buffer_load_dwordx4 v220, s[76:79], s54 offen offset:1024 lds
v_mfma_f32_16x16x32_bf16 v[188:191], a[132:135], a[156:159], v[188:191]
s_add_u32 s18, s18, s19
ds_read_b64_tr_b16 a[26:27], v205 offset:47360
v_lshl_add_u32 v100, v97, 5, s18
v_mfma_f32_16x16x32_bf16 v[232:235], a[136:139], a[156:159], v[232:235]
ds_read_b64_tr_b16 a[28:29], v206 offset:40960
v_mul_u32_u24 v126, 576, v100
v_mfma_f32_16x16x32_bf16 v[244:247], a[140:143], a[156:159], v[244:247]
ds_read_b64_tr_b16 a[30:31], v206 offset:47104
buffer_load_dwordx4 v221, s[76:79], s54 offen offset:2048 lds
v_mfma_f32_16x16x32_bf16 v[180:183], a[128:131], a[160:163], v[180:183]
s_add_u32 s54, s54, 73728
v_add_lshl_u32 v126, v126, v99, 2
v_bfe_u32 v99, v111, 2, 2
v_mfma_f32_16x16x32_bf16 v[224:227], a[132:135], a[160:163], v[224:227]
s_add_u32 m0, s63, 20480
ds_read_b64_tr_b16 a[32:33], v206 offset:41088
v_add_u32 v100, v100, v99
v_mfma_f32_16x16x32_bf16 v[236:239], a[136:139], a[160:163], v[236:239]
ds_read_b64_tr_b16 a[34:35], v206 offset:47232
buffer_load_dwordx4 v200, s[20:23], s67 offen sc1 lds
v_mfma_f32_16x16x32_bf16 v[248:251], a[140:143], a[160:163], v[248:251]
ds_read_b64_tr_b16 a[36:37], v206 offset:41216
v_mul_u32_u24 v120, 1152, v100
v_mfma_f32_16x16x32_bf16 v[184:187], a[128:131], a[164:167], v[184:187]
ds_read_b64_tr_b16 a[38:39], v206 offset:47360
v_sub_u32 v100, 4, v97
v_mfma_f32_16x16x32_bf16 v[228:231], a[132:135], a[164:167], v[228:231]
buffer_load_dwordx4 v214, s[20:23], s67 offen offset:1024 sc1 lds
v_xor_b32 v100, v100, v111
v_mfma_f32_16x16x32_bf16 v[240:243], a[136:139], a[164:167], v[240:243]
s_add_u32 s67, s67, s33
v_and_b32 v100, 3, v100
v_lshl_add_u32 v120, v100, 4, v120
v_mfma_f32_16x16x32_bf16 v[252:255], a[140:143], a[164:167], v[252:255]
s_waitcnt lgkmcnt(4)
s_mul_i32 s18, s16, 4608
s_lshl_b32 s19, s34, 1
v_mfma_f32_16x16x32_bf16 v[128:131], a[0:3], a[16:19], v[128:131]
s_add_u32 s32, s18, s19
s_mov_b32 s28, s52
s_mov_b32 s29, s53
v_mfma_f32_16x16x32_bf16 v[140:143], a[4:7], a[16:19], v[140:143]
s_mov_b32 s30, 2359296
s_mov_b32 s31, 0x20000
s_mov_b32 s43, 4608
v_mfma_f32_16x16x32_bf16 v[152:155], a[8:11], a[16:19], v[152:155]
s_waitcnt lgkmcnt(0)
s_barrier
ds_read_b64_tr_b16 a[144:145], v201 offset:0
v_mfma_f32_16x16x32_bf16 v[164:167], a[12:15], a[16:19], v[164:167]
s_add_u32 m0, s63, 40960
ds_read_b64_tr_b16 a[146:147], v201 offset:6144
s_mov_b32 s44, 9216
v_mfma_f32_16x16x32_bf16 v[132:135], a[0:3], a[20:23], v[132:135]
s_mov_b32 s46, 13824
ds_read_b128 a[128:131], v207 offset:0
buffer_load_dwordx4 v200, s[20:23], s67 offen sc1 lds
v_mfma_f32_16x16x32_bf16 v[144:147], a[4:7], a[20:23], v[144:147]
s_mov_b32 s80, s58
ds_read_b128 a[132:135], v207 offset:1024
s_mov_b32 s81, s59
v_mfma_f32_16x16x32_bf16 v[156:159], a[8:11], a[20:23], v[156:159]
s_mov_b32 s82, 4718592
s_mov_b32 s83, 0x20000
v_lshrrev_b32 v100, 2, v96
v_mfma_f32_16x16x32_bf16 v[168:171], a[12:15], a[20:23], v[168:171]
ds_read_b128 a[136:139], v207 offset:2048
v_sub_u32 v100, 4, v100
v_mfma_f32_16x16x32_bf16 v[136:139], a[0:3], a[24:27], v[136:139]
ds_read_b128 a[140:143], v207 offset:3072
buffer_load_dwordx4 v214, s[20:23], s67 offen offset:1024 sc1 lds
v_mfma_f32_16x16x32_bf16 v[148:151], a[4:7], a[24:27], v[148:151]
s_add_u32 s67, s67, s33
ds_read_b64_tr_b16 a[148:149], v201 offset:128
v_xor_b32 v100, v100, v97
v_mfma_f32_16x16x32_bf16 v[160:163], a[8:11], a[24:27], v[160:163]
ds_read_b64_tr_b16 a[150:151], v201 offset:6272
v_and_b32 v100, 3, v100
v_mfma_f32_16x16x32_bf16 v[172:175], a[12:15], a[24:27], v[172:175]
s_add_u32 m0, s93, 49152
v_lshl_add_u32 v100, v96, 2, v100
s_mul_i32 s18, s17, 6144
v_mfma_f32_16x16x32_bf16 v[176:179], a[0:3], a[28:31], v[176:179]
s_add_u32 s18, s18, 8192
ds_read_b64_tr_b16 a[152:153], v201 offset:256
buffer_load_dwordx4 v219, s[76:79], s54 offen offset:0 lds
v_mfma_f32_16x16x32_bf16 v[188:191], a[4:7], a[28:31], v[188:191]
ds_read_b64_tr_b16 a[154:155], v201 offset:6400
v_lshl_add_u32 v121, v100, 4, s18
v_mfma_f32_16x16x32_bf16 v[232:235], a[8:11], a[28:31], v[232:235]
ds_read_b64_tr_b16 a[156:157], v202 offset:0
v_add_u32 v122, 20480, v121
v_mfma_f32_16x16x32_bf16 v[244:247], a[12:15], a[28:31], v[244:247]
s_lshr_b32 s18, s64, 1
ds_read_b64_tr_b16 a[158:159], v202 offset:6144
s_mul_i32 s18, s18, 18
v_mfma_f32_16x16x32_bf16 v[180:183], a[0:3], a[32:35], v[180:183]
s_lshr_b32 s19, s35, 5
buffer_load_dwordx4 v220, s[76:79], s54 offen offset:1024 lds
s_add_u32 s18, s18, s19
v_mfma_f32_16x16x32_bf16 v[224:227], a[4:7], a[32:35], v[224:227]
s_lshl_b32 s18, s18, 4
ds_read_b64_tr_b16 a[160:161], v202 offset:128
s_and_b32 s19, s64, 1
v_mfma_f32_16x16x32_bf16 v[236:239], a[8:11], a[32:35], v[236:239]
s_lshl_b32 s19, s19, 3
ds_read_b64_tr_b16 a[162:163], v202 offset:6272
s_add_u32 s18, s18, s19
v_mfma_f32_16x16x32_bf16 v[248:251], a[12:15], a[32:35], v[248:251]
s_add_u32 s18, s18, s50
ds_read_b64_tr_b16 a[164:165], v202 offset:256
s_add_u32 s18, s18, s16
v_mfma_f32_16x16x32_bf16 v[184:187], a[0:3], a[36:39], v[184:187]
s_lshl_b32 s60, s18, 10
ds_read_b64_tr_b16 a[166:167], v202 offset:6400
buffer_load_dwordx4 v221, s[76:79], s54 offen offset:2048 lds
v_mfma_f32_16x16x32_bf16 v[228:231], a[4:7], a[36:39], v[228:231]
s_add_u32 s54, s54, 73728
s_add_u32 s61, s60, 31744
s_add_u32 s62, s60, 63488
v_mfma_f32_16x16x32_bf16 v[240:243], a[8:11], a[36:39], v[240:243]
s_lshl_b32 s18, s2, 2
s_add_u32 s18, s18, s3
s_mul_i32 s36, s18, 9216
v_mfma_f32_16x16x32_bf16 v[252:255], a[12:15], a[36:39], v[252:255]
s_waitcnt lgkmcnt(3)
s_add_u32 s36, s36, 34603008
s_xor_b32 s19, s18, 4
v_mfma_f32_16x16x32_bf16 v[128:131], a[128:131], a[144:147], v[128:131]
s_mul_i32 s19, s19, 9216
s_add_u32 s40, s19, 34603008
s_xor_b32 s19, s18, 12
v_mfma_f32_16x16x32_bf16 v[140:143], a[132:135], a[144:147], v[140:143]
s_mul_i32 s19, s19, 9216
s_add_u32 s41, s19, 34606080
s_xor_b32 s19, s18, 8
v_mfma_f32_16x16x32_bf16 v[152:155], a[136:139], a[144:147], v[152:155]
s_waitcnt vmcnt(27) lgkmcnt(0)
s_barrier
ds_read_b64_tr_b16 a[16:17], v201 offset:20480
v_mfma_f32_16x16x32_bf16 v[164:167], a[140:143], a[144:147], v[164:167]
s_add_u32 m0, s63, 61440
ds_read_b64_tr_b16 a[18:19], v201 offset:26624
s_mul_i32 s19, s19, 9216
v_mfma_f32_16x16x32_bf16 v[132:135], a[128:131], a[148:151], v[132:135]
s_add_u32 s42, s19, 34609152
ds_read_b128 a[0:3], v207 offset:20480
buffer_load_dwordx4 v200, s[20:23], s67 offen sc1 lds
v_mfma_f32_16x16x32_bf16 v[144:147], a[132:135], a[148:151], v[144:147]
s_and_b32 s18, s64, 1
ds_read_b128 a[4:7], v207 offset:21504
s_mul_i32 s18, s18, 3
v_mfma_f32_16x16x32_bf16 v[156:159], a[136:139], a[148:151], v[156:159]
s_add_u32 s18, s18, s65
s_add_u32 s18, s18, 24
s_lshl_b32 s18, s18, 3
v_mfma_f32_16x16x32_bf16 v[168:171], a[140:143], a[148:151], v[168:171]
s_lshr_b32 s19, s64, 1
ds_read_b128 a[8:11], v207 offset:22528
s_add_u32 s18, s18, s19
v_mfma_f32_16x16x32_bf16 v[136:139], a[128:131], a[152:155], v[136:139]
s_lshl_b32 s18, s18, 2
ds_read_b128 a[12:15], v207 offset:23552
buffer_load_dwordx4 v214, s[20:23], s67 offen offset:1024 sc1 lds
v_mfma_f32_16x16x32_bf16 v[148:151], a[132:135], a[152:155], v[148:151]
s_add_u32 s67, s67, s33
ds_read_b64_tr_b16 a[20:21], v201 offset:20608
s_add_u32 s18, s18, s3
v_mfma_f32_16x16x32_bf16 v[160:163], a[136:139], a[152:155], v[160:163]
s_lshl_b32 s18, s18, 5
ds_read_b64_tr_b16 a[22:23], v201 offset:26752
s_add_u32 s18, s18, 4554752
v_mfma_f32_16x16x32_bf16 v[172:175], a[140:143], a[152:155], v[172:175]
s_add_u32 m0, s93, 69632
v_mov_b32 v102, s18
v_and_b32 v101, 3, v111
v_mfma_f32_16x16x32_bf16 v[176:179], a[128:131], a[156:159], v[176:179]
ds_read_b64_tr_b16 a[24:25], v201 offset:20736
buffer_load_dwordx4 v219, s[76:79], s54 offen offset:0 lds
v_mfma_f32_16x16x32_bf16 v[188:191], a[132:135], a[156:159], v[188:191]
ds_read_b64_tr_b16 a[26:27], v201 offset:26880
v_max_u32 v101, 1, v101
v_mfma_f32_16x16x32_bf16 v[232:235], a[136:139], a[156:159], v[232:235]
ds_read_b64_tr_b16 a[28:29], v202 offset:20480
v_lshlrev_b32 v101, 7, v101
v_mfma_f32_16x16x32_bf16 v[244:247], a[140:143], a[156:159], v[244:247]
ds_read_b64_tr_b16 a[30:31], v202 offset:26624
v_xor_b32 v101, s90, v101
v_mfma_f32_16x16x32_bf16 v[180:183], a[128:131], a[160:163], v[180:183]
s_lshl_b32 s18, s64, 3
buffer_load_dwordx4 v220, s[76:79], s54 offen offset:1024 lds
s_add_u32 s18, s18, s50
v_mfma_f32_16x16x32_bf16 v[224:227], a[132:135], a[160:163], v[224:227]
s_mul_i32 s18, s18, 36864
ds_read_b64_tr_b16 a[32:33], v202 offset:20608
s_add_u32 s18, s18, s51
v_mfma_f32_16x16x32_bf16 v[236:239], a[136:139], a[160:163], v[236:239]
s_add_u32 s38, s18, 4718592
ds_read_b64_tr_b16 a[34:35], v202 offset:26752
s_add_u32 s39, s38, 36864
v_mfma_f32_16x16x32_bf16 v[248:251], a[140:143], a[160:163], v[248:251]
ds_read_b64_tr_b16 a[36:37], v202 offset:20736
v_lshlrev_b32 v97, 2, v97
v_mfma_f32_16x16x32_bf16 v[184:187], a[128:131], a[164:167], v[184:187]
ds_read_b64_tr_b16 a[38:39], v202 offset:26880
buffer_load_dwordx4 v221, s[76:79], s54 offen offset:2048 lds
v_mfma_f32_16x16x32_bf16 v[228:231], a[132:135], a[164:167], v[228:231]
s_add_u32 s54, s54, 4294119424
v_sub_u32 v96, v96, v97
v_mov_b32 v104, 0x3f80
v_mfma_f32_16x16x32_bf16 v[240:243], a[136:139], a[164:167], v[240:243]
v_mov_b32 v123, 0x3f80
v_mov_b32 v105, 0
v_mfma_f32_16x16x32_bf16 v[252:255], a[140:143], a[164:167], v[252:255]
s_waitcnt lgkmcnt(4)
v_lshlrev_b32 v97, 4, v96
v_lshlrev_b64 v[104:105], v97, v[104:105]
v_mfma_f32_16x16x32_bf16 v[128:131], a[0:3], a[16:19], v[128:131]
v_mov_b32 v114, 0
v_mov_b32 v115, 0
v_mfma_f32_16x16x32_bf16 v[140:143], a[4:7], a[16:19], v[140:143]
v_mov_b32 v118, 0
v_mov_b32 v119, 0
v_mfma_f32_16x16x32_bf16 v[152:155], a[8:11], a[16:19], v[152:155]
s_waitcnt vmcnt(27) lgkmcnt(0)
s_barrier
ds_read_b64_tr_b16 a[144:145], v201 offset:40960
v_mfma_f32_16x16x32_bf16 v[164:167], a[12:15], a[16:19], v[164:167]
s_add_u32 m0, s63, 81920
ds_read_b64_tr_b16 a[146:147], v201 offset:47104
v_cmp_gt_u32 vcc, 4, v96
s_nop 1
v_cndmask_b32 v116, 0, v104, vcc
v_cndmask_b32 v117, 0, v105, vcc
v_mfma_f32_16x16x32_bf16 v[132:135], a[0:3], a[20:23], v[132:135]
ds_read_b128 a[128:131], v207 offset:40960
buffer_load_dwordx4 v200, s[20:23], s67 offen sc1 lds
v_mfma_f32_16x16x32_bf16 v[144:147], a[4:7], a[20:23], v[144:147]
ds_read_b128 a[132:135], v207 offset:41984
v_mfma_f32_16x16x32_bf16 v[156:159], a[8:11], a[20:23], v[156:159]
v_mfma_f32_16x16x32_bf16 v[168:171], a[12:15], a[20:23], v[168:171]
ds_read_b128 a[136:139], v207 offset:43008
v_mfma_f32_16x16x32_bf16 v[136:139], a[0:3], a[24:27], v[136:139]
ds_read_b128 a[140:143], v207 offset:44032
buffer_load_dwordx4 v214, s[20:23], s67 offen offset:1024 sc1 lds
v_mfma_f32_16x16x32_bf16 v[148:151], a[4:7], a[24:27], v[148:151]
s_add_u32 s67, s67, s33
ds_read_b64_tr_b16 a[148:149], v201 offset:41088
v_mfma_f32_16x16x32_bf16 v[160:163], a[8:11], a[24:27], v[160:163]
ds_read_b64_tr_b16 a[150:151], v201 offset:47232
v_mfma_f32_16x16x32_bf16 v[172:175], a[12:15], a[24:27], v[172:175]
s_add_u32 m0, s93, 90112
v_mfma_f32_16x16x32_bf16 v[176:179], a[0:3], a[28:31], v[176:179]
ds_read_b64_tr_b16 a[152:153], v201 offset:41216
buffer_load_dwordx4 v219, s[76:79], s54 offen offset:0 lds
v_mfma_f32_16x16x32_bf16 v[188:191], a[4:7], a[28:31], v[188:191]
ds_read_b64_tr_b16 a[154:155], v201 offset:47360
v_mfma_f32_16x16x32_bf16 v[232:235], a[8:11], a[28:31], v[232:235]
ds_read_b64_tr_b16 a[156:157], v202 offset:40960
v_mfma_f32_16x16x32_bf16 v[244:247], a[12:15], a[28:31], v[244:247]
ds_read_b64_tr_b16 a[158:159], v202 offset:47104
v_mfma_f32_16x16x32_bf16 v[180:183], a[0:3], a[32:35], v[180:183]
buffer_load_dwordx4 v220, s[76:79], s54 offen offset:1024 lds
v_mfma_f32_16x16x32_bf16 v[224:227], a[4:7], a[32:35], v[224:227]
ds_read_b64_tr_b16 a[160:161], v202 offset:41088
v_mfma_f32_16x16x32_bf16 v[236:239], a[8:11], a[32:35], v[236:239]
ds_read_b64_tr_b16 a[162:163], v202 offset:47232
v_mfma_f32_16x16x32_bf16 v[248:251], a[12:15], a[32:35], v[248:251]
ds_read_b64_tr_b16 a[164:165], v202 offset:41216
v_mfma_f32_16x16x32_bf16 v[184:187], a[0:3], a[36:39], v[184:187]
ds_read_b64_tr_b16 a[166:167], v202 offset:47360
buffer_load_dwordx4 v221, s[76:79], s54 offen offset:2048 lds
v_mfma_f32_16x16x32_bf16 v[228:231], a[4:7], a[36:39], v[228:231]
s_add_u32 s54, s54, 73728
v_mfma_f32_16x16x32_bf16 v[240:243], a[8:11], a[36:39], v[240:243]
v_mfma_f32_16x16x32_bf16 v[252:255], a[12:15], a[36:39], v[252:255]
s_waitcnt lgkmcnt(7)
v_mfma_f32_16x16x32_bf16 v[128:131], a[128:131], a[144:147], v[128:131]
v_mfma_f32_16x16x32_bf16 v[140:143], a[132:135], a[144:147], v[140:143]
v_mfma_f32_16x16x32_bf16 v[152:155], a[136:139], a[144:147], v[152:155]
s_waitcnt vmcnt(30) lgkmcnt(0)
s_barrier
ds_read_b64_tr_b16 a[16:17], v209 offset:0
v_mfma_f32_16x16x32_bf16 v[164:167], a[140:143], a[144:147], v[164:167]
s_add_u32 m0, s63, 102400
ds_read_b64_tr_b16 a[18:19], v209 offset:6144
v_mfma_f32_16x16x32_bf16 v[132:135], a[128:131], a[148:151], v[132:135]
ds_read_b128 a[0:3], v208 offset:0
buffer_load_dwordx4 v200, s[20:23], s67 offen sc1 lds
v_mfma_f32_16x16x32_bf16 v[144:147], a[132:135], a[148:151], v[144:147]
ds_read_b128 a[4:7], v208 offset:1024
v_mfma_f32_16x16x32_bf16 v[156:159], a[136:139], a[148:151], v[156:159]
v_mfma_f32_16x16x32_bf16 v[168:171], a[140:143], a[148:151], v[168:171]
T_b_2:
s_cbranch_execz T_r1
ds_read_b128 a[8:11], v208 offset:2048
v_mfma_f32_16x16x32_bf16 v[136:139], a[128:131], a[152:155], v[136:139]
ds_read_b128 a[12:15], v208 offset:3072
buffer_load_dwordx4 v214, s[20:23], s67 offen offset:1024 sc1 lds
v_mfma_f32_16x16x32_bf16 v[148:151], a[132:135], a[152:155], v[148:151]
s_add_u32 s67, s67, s33
ds_read_b64_tr_b16 a[20:21], v209 offset:128
v_mfma_f32_16x16x32_bf16 v[160:163], a[136:139], a[152:155], v[160:163]
ds_read_b64_tr_b16 a[22:23], v209 offset:6272
v_mfma_f32_16x16x32_bf16 v[172:175], a[140:143], a[152:155], v[172:175]
s_add_u32 m0, s93, 110592
v_mfma_f32_16x16x32_bf16 v[176:179], a[128:131], a[156:159], v[176:179]
ds_read_b64_tr_b16 a[24:25], v209 offset:256
buffer_load_dwordx4 v219, s[76:79], s54 offen offset:0 lds
v_mfma_f32_16x16x32_bf16 v[188:191], a[132:135], a[156:159], v[188:191]
ds_read_b64_tr_b16 a[26:27], v209 offset:6400
v_mfma_f32_16x16x32_bf16 v[232:235], a[136:139], a[156:159], v[232:235]
ds_read_b64_tr_b16 a[28:29], v210 offset:0
v_mfma_f32_16x16x32_bf16 v[244:247], a[140:143], a[156:159], v[244:247]
ds_read_b64_tr_b16 a[30:31], v210 offset:6144
v_mfma_f32_16x16x32_bf16 v[180:183], a[128:131], a[160:163], v[180:183]
buffer_load_dwordx4 v220, s[76:79], s54 offen offset:1024 lds
v_mfma_f32_16x16x32_bf16 v[224:227], a[132:135], a[160:163], v[224:227]
ds_read_b64_tr_b16 a[32:33], v210 offset:128
v_mfma_f32_16x16x32_bf16 v[236:239], a[136:139], a[160:163], v[236:239]
ds_read_b64_tr_b16 a[34:35], v210 offset:6272
v_mfma_f32_16x16x32_bf16 v[248:251], a[140:143], a[160:163], v[248:251]
ds_read_b64_tr_b16 a[36:37], v210 offset:256
v_mfma_f32_16x16x32_bf16 v[184:187], a[128:131], a[164:167], v[184:187]
ds_read_b64_tr_b16 a[38:39], v210 offset:6400
buffer_load_dwordx4 v221, s[76:79], s54 offen offset:2048 lds
v_mfma_f32_16x16x32_bf16 v[228:231], a[132:135], a[164:167], v[228:231]
s_add_u32 s54, s54, 73728
v_mfma_f32_16x16x32_bf16 v[240:243], a[136:139], a[164:167], v[240:243]
v_mfma_f32_16x16x32_bf16 v[252:255], a[140:143], a[164:167], v[252:255]
s_waitcnt lgkmcnt(7)
v_mfma_f32_16x16x32_bf16 v[128:131], a[0:3], a[16:19], v[128:131]
v_mfma_f32_16x16x32_bf16 v[140:143], a[4:7], a[16:19], v[140:143]
v_mfma_f32_16x16x32_bf16 v[152:155], a[8:11], a[16:19], v[152:155]
s_waitcnt vmcnt(30) lgkmcnt(0)
s_barrier
ds_read_b64_tr_b16 a[144:145], v209 offset:20480
v_mfma_f32_16x16x32_bf16 v[164:167], a[12:15], a[16:19], v[164:167]
s_add_u32 m0, s63, 122880
ds_read_b64_tr_b16 a[146:147], v209 offset:26624
v_mfma_f32_16x16x32_bf16 v[132:135], a[0:3], a[20:23], v[132:135]
ds_read_b128 a[128:131], v208 offset:20480
buffer_load_dwordx4 v200, s[20:23], s67 offen sc1 lds
v_mfma_f32_16x16x32_bf16 v[144:147], a[4:7], a[20:23], v[144:147]
ds_read_b128 a[132:135], v208 offset:21504
v_mfma_f32_16x16x32_bf16 v[156:159], a[8:11], a[20:23], v[156:159]
v_mfma_f32_16x16x32_bf16 v[168:171], a[12:15], a[20:23], v[168:171]
ds_read_b128 a[136:139], v208 offset:22528
v_mfma_f32_16x16x32_bf16 v[136:139], a[0:3], a[24:27], v[136:139]
ds_read_b128 a[140:143], v208 offset:23552
buffer_load_dwordx4 v214, s[20:23], s67 offen offset:1024 sc1 lds
v_mfma_f32_16x16x32_bf16 v[148:151], a[4:7], a[24:27], v[148:151]
s_add_u32 s67, s67, s33
ds_read_b64_tr_b16 a[148:149], v209 offset:20608
v_mfma_f32_16x16x32_bf16 v[160:163], a[8:11], a[24:27], v[160:163]
ds_read_b64_tr_b16 a[150:151], v209 offset:26752
v_mfma_f32_16x16x32_bf16 v[172:175], a[12:15], a[24:27], v[172:175]
s_add_u32 m0, s93, 131072
v_mfma_f32_16x16x32_bf16 v[176:179], a[0:3], a[28:31], v[176:179]
ds_read_b64_tr_b16 a[152:153], v209 offset:20736
buffer_load_dwordx4 v219, s[76:79], s54 offen offset:0 lds
v_mfma_f32_16x16x32_bf16 v[188:191], a[4:7], a[28:31], v[188:191]
ds_read_b64_tr_b16 a[154:155], v209 offset:26880
v_mfma_f32_16x16x32_bf16 v[232:235], a[8:11], a[28:31], v[232:235]
ds_read_b64_tr_b16 a[156:157], v210 offset:20480
v_mfma_f32_16x16x32_bf16 v[244:247], a[12:15], a[28:31], v[244:247]
ds_read_b64_tr_b16 a[158:159], v210 offset:26624
v_mfma_f32_16x16x32_bf16 v[180:183], a[0:3], a[32:35], v[180:183]
buffer_load_dwordx4 v220, s[76:79], s54 offen offset:1024 lds
v_mfma_f32_16x16x32_bf16 v[224:227], a[4:7], a[32:35], v[224:227]
ds_read_b64_tr_b16 a[160:161], v210 offset:20608
v_mfma_f32_16x16x32_bf16 v[236:239], a[8:11], a[32:35], v[236:239]
ds_read_b64_tr_b16 a[162:163], v210 offset:26752
v_mfma_f32_16x16x32_bf16 v[248:251], a[12:15], a[32:35], v[248:251]
ds_read_b64_tr_b16 a[164:165], v210 offset:20736
v_mfma_f32_16x16x32_bf16 v[184:187], a[0:3], a[36:39], v[184:187]
ds_read_b64_tr_b16 a[166:167], v210 offset:26880
buffer_load_dwordx4 v221, s[76:79], s54 offen offset:2048 lds
v_mfma_f32_16x16x32_bf16 v[228:231], a[4:7], a[36:39], v[228:231]
s_add_u32 s54, s54, 73728
v_mfma_f32_16x16x32_bf16 v[240:243], a[8:11], a[36:39], v[240:243]
v_mfma_f32_16x16x32_bf16 v[252:255], a[12:15], a[36:39], v[252:255]
s_waitcnt lgkmcnt(7)
v_mfma_f32_16x16x32_bf16 v[128:131], a[128:131], a[144:147], v[128:131]
v_mfma_f32_16x16x32_bf16 v[140:143], a[132:135], a[144:147], v[140:143]
v_mfma_f32_16x16x32_bf16 v[152:155], a[136:139], a[144:147], v[152:155]
s_waitcnt vmcnt(33) lgkmcnt(0)
s_barrier
ds_read_b64_tr_b16 a[16:17], v205 offset:0
v_mfma_f32_16x16x32_bf16 v[164:167], a[140:143], a[144:147], v[164:167]
s_add_u32 m0, s63, 143360
ds_read_b64_tr_b16 a[18:19], v205 offset:6144
v_mfma_f32_16x16x32_bf16 v[132:135], a[128:131], a[148:151], v[132:135]
ds_read_b128 a[0:3], v204 offset:0
buffer_load_dwordx4 v200, s[20:23], s67 offen sc1 lds
v_mfma_f32_16x16x32_bf16 v[144:147], a[132:135], a[148:151], v[144:147]
ds_read_b128 a[4:7], v204 offset:1024
v_mfma_f32_16x16x32_bf16 v[156:159], a[136:139], a[148:151], v[156:159]
v_mfma_f32_16x16x32_bf16 v[168:171], a[140:143], a[148:151], v[168:171]
ds_read_b128 a[8:11], v204 offset:2048
v_mfma_f32_16x16x32_bf16 v[136:139], a[128:131], a[152:155], v[136:139]
ds_read_b128 a[12:15], v204 offset:3072
buffer_load_dwordx4 v214, s[20:23], s67 offen offset:1024 sc1 lds
v_mfma_f32_16x16x32_bf16 v[148:151], a[132:135], a[152:155], v[148:151]
s_add_u32 s67, s67, s33
ds_read_b64_tr_b16 a[20:21], v205 offset:128
v_mfma_f32_16x16x32_bf16 v[160:163], a[136:139], a[152:155], v[160:163]
ds_read_b64_tr_b16 a[22:23], v205 offset:6272
v_mfma_f32_16x16x32_bf16 v[172:175], a[140:143], a[152:155], v[172:175]
s_add_u32 m0, s93, 151552
v_mfma_f32_16x16x32_bf16 v[176:179], a[128:131], a[156:159], v[176:179]
ds_read_b64_tr_b16 a[24:25], v205 offset:256
buffer_load_dwordx4 v219, s[76:79], s54 offen offset:0 lds
v_mfma_f32_16x16x32_bf16 v[188:191], a[132:135], a[156:159], v[188:191]
ds_read_b64_tr_b16 a[26:27], v205 offset:6400
v_mfma_f32_16x16x32_bf16 v[232:235], a[136:139], a[156:159], v[232:235]
ds_read_b64_tr_b16 a[28:29], v206 offset:0
v_mfma_f32_16x16x32_bf16 v[244:247], a[140:143], a[156:159], v[244:247]
ds_read_b64_tr_b16 a[30:31], v206 offset:6144
v_mfma_f32_16x16x32_bf16 v[180:183], a[128:131], a[160:163], v[180:183]
buffer_load_dwordx4 v220, s[76:79], s54 offen offset:1024 lds
v_mfma_f32_16x16x32_bf16 v[224:227], a[132:135], a[160:163], v[224:227]
ds_read_b64_tr_b16 a[32:33], v206 offset:128
v_mfma_f32_16x16x32_bf16 v[236:239], a[136:139], a[160:163], v[236:239]
ds_read_b64_tr_b16 a[34:35], v206 offset:6272
v_mfma_f32_16x16x32_bf16 v[248:251], a[140:143], a[160:163], v[248:251]
ds_read_b64_tr_b16 a[36:37], v206 offset:256
v_mfma_f32_16x16x32_bf16 v[184:187], a[128:131], a[164:167], v[184:187]
ds_read_b64_tr_b16 a[38:39], v206 offset:6400
buffer_load_dwordx4 v221, s[76:79], s54 offen offset:2048 lds
v_mfma_f32_16x16x32_bf16 v[228:231], a[132:135], a[164:167], v[228:231]
s_add_u32 s54, s54, 442368
v_mfma_f32_16x16x32_bf16 v[240:243], a[136:139], a[164:167], v[240:243]
v_mfma_f32_16x16x32_bf16 v[252:255], a[140:143], a[164:167], v[252:255]
s_waitcnt lgkmcnt(7)
v_mfma_f32_16x16x32_bf16 v[128:131], a[0:3], a[16:19], v[128:131]
v_mfma_f32_16x16x32_bf16 v[140:143], a[4:7], a[16:19], v[140:143]
v_mfma_f32_16x16x32_bf16 v[152:155], a[8:11], a[16:19], v[152:155]
s_waitcnt vmcnt(30) lgkmcnt(0)
s_barrier
ds_read_b64_tr_b16 a[144:145], v205 offset:20480
v_mfma_f32_16x16x32_bf16 v[164:167], a[12:15], a[16:19], v[164:167]
s_add_u32 m0, s63, 0
ds_read_b64_tr_b16 a[146:147], v205 offset:26624
v_mfma_f32_16x16x32_bf16 v[132:135], a[0:3], a[20:23], v[132:135]
ds_read_b128 a[128:131], v204 offset:20480
buffer_load_dwordx4 v200, s[20:23], s67 offen sc1 lds
v_mfma_f32_16x16x32_bf16 v[144:147], a[4:7], a[20:23], v[144:147]
ds_read_b128 a[132:135], v204 offset:21504
v_mfma_f32_16x16x32_bf16 v[156:159], a[8:11], a[20:23], v[156:159]
v_mfma_f32_16x16x32_bf16 v[168:171], a[12:15], a[20:23], v[168:171]
ds_read_b128 a[136:139], v204 offset:22528
v_mfma_f32_16x16x32_bf16 v[136:139], a[0:3], a[24:27], v[136:139]
ds_read_b128 a[140:143], v204 offset:23552
buffer_load_dwordx4 v214, s[20:23], s67 offen offset:1024 sc1 lds
v_mfma_f32_16x16x32_bf16 v[148:151], a[4:7], a[24:27], v[148:151]
s_add_u32 s67, s67, s33
ds_read_b64_tr_b16 a[148:149], v205 offset:20608
v_mfma_f32_16x16x32_bf16 v[160:163], a[8:11], a[24:27], v[160:163]
ds_read_b64_tr_b16 a[150:151], v205 offset:26752
v_mfma_f32_16x16x32_bf16 v[172:175], a[12:15], a[24:27], v[172:175]
s_add_u32 m0, s93, 8192
v_mfma_f32_16x16x32_bf16 v[176:179], a[0:3], a[28:31], v[176:179]
ds_read_b64_tr_b16 a[152:153], v205 offset:20736
buffer_load_dwordx4 v219, s[76:79], s54 offen offset:0 lds
v_mfma_f32_16x16x32_bf16 v[188:191], a[4:7], a[28:31], v[188:191]
ds_read_b64_tr_b16 a[154:155], v205 offset:26880
v_mfma_f32_16x16x32_bf16 v[232:235], a[8:11], a[28:31], v[232:235]
ds_read_b64_tr_b16 a[156:157], v206 offset:20480
v_mfma_f32_16x16x32_bf16 v[244:247], a[12:15], a[28:31], v[244:247]
ds_read_b64_tr_b16 a[158:159], v206 offset:26624
v_mfma_f32_16x16x32_bf16 v[180:183], a[0:3], a[32:35], v[180:183]
buffer_load_dwordx4 v220, s[76:79], s54 offen offset:1024 lds
v_mfma_f32_16x16x32_bf16 v[224:227], a[4:7], a[32:35], v[224:227]
ds_read_b64_tr_b16 a[160:161], v206 offset:20608
v_mfma_f32_16x16x32_bf16 v[236:239], a[8:11], a[32:35], v[236:239]
ds_read_b64_tr_b16 a[162:163], v206 offset:26752
v_mfma_f32_16x16x32_bf16 v[248:251], a[12:15], a[32:35], v[248:251]
ds_read_b64_tr_b16 a[164:165], v206 offset:20736
v_mfma_f32_16x16x32_bf16 v[184:187], a[0:3], a[36:39], v[184:187]
ds_read_b64_tr_b16 a[166:167], v206 offset:26880
buffer_load_dwordx4 v221, s[76:79], s54 offen offset:2048 lds
v_mfma_f32_16x16x32_bf16 v[228:231], a[4:7], a[36:39], v[228:231]
s_add_u32 s54, s54, 73728
v_mfma_f32_16x16x32_bf16 v[240:243], a[8:11], a[36:39], v[240:243]
v_mfma_f32_16x16x32_bf16 v[252:255], a[12:15], a[36:39], v[252:255]
s_waitcnt lgkmcnt(7)
v_mfma_f32_16x16x32_bf16 v[128:131], a[128:131], a[144:147], v[128:131]
v_mfma_f32_16x16x32_bf16 v[140:143], a[132:135], a[144:147], v[140:143]
v_mfma_f32_16x16x32_bf16 v[152:155], a[136:139], a[144:147], v[152:155]
s_waitcnt vmcnt(30) lgkmcnt(0)
s_barrier
ds_read_b64_tr_b16 a[16:17], v205 offset:40960
v_mfma_f32_16x16x32_bf16 v[164:167], a[140:143], a[144:147], v[164:167]
s_add_u32 m0, s63, 20480
ds_read_b64_tr_b16 a[18:19], v205 offset:47104
v_mfma_f32_16x16x32_bf16 v[132:135], a[128:131], a[148:151], v[132:135]
ds_read_b128 a[0:3], v204 offset:40960
buffer_load_dwordx4 v200, s[20:23], s67 offen sc1 lds
v_mfma_f32_16x16x32_bf16 v[144:147], a[132:135], a[148:151], v[144:147]
ds_read_b128 a[4:7], v204 offset:41984
v_mfma_f32_16x16x32_bf16 v[156:159], a[136:139], a[148:151], v[156:159]
v_mfma_f32_16x16x32_bf16 v[168:171], a[140:143], a[148:151], v[168:171]
ds_read_b128 a[8:11], v204 offset:43008
v_mfma_f32_16x16x32_bf16 v[136:139], a[128:131], a[152:155], v[136:139]
ds_read_b128 a[12:15], v204 offset:44032
buffer_load_dwordx4 v214, s[20:23], s67 offen offset:1024 sc1 lds
v_mfma_f32_16x16x32_bf16 v[148:151], a[132:135], a[152:155], v[148:151]
s_add_u32 s67, s67, s33
ds_read_b64_tr_b16 a[20:21], v205 offset:41088
v_mfma_f32_16x16x32_bf16 v[160:163], a[136:139], a[152:155], v[160:163]
ds_read_b64_tr_b16 a[22:23], v205 offset:47232
v_mfma_f32_16x16x32_bf16 v[172:175], a[140:143], a[152:155], v[172:175]
s_add_u32 m0, s93, 28672
v_mfma_f32_16x16x32_bf16 v[176:179], a[128:131], a[156:159], v[176:179]
ds_read_b64_tr_b16 a[24:25], v205 offset:41216
buffer_load_dwordx4 v219, s[76:79], s54 offen offset:0 lds
v_mfma_f32_16x16x32_bf16 v[188:191], a[132:135], a[156:159], v[188:191]
ds_read_b64_tr_b16 a[26:27], v205 offset:47360
v_mfma_f32_16x16x32_bf16 v[232:235], a[136:139], a[156:159], v[232:235]
ds_read_b64_tr_b16 a[28:29], v206 offset:40960
v_mfma_f32_16x16x32_bf16 v[244:247], a[140:143], a[156:159], v[244:247]
ds_read_b64_tr_b16 a[30:31], v206 offset:47104
v_mfma_f32_16x16x32_bf16 v[180:183], a[128:131], a[160:163], v[180:183]
buffer_load_dwordx4 v220, s[76:79], s54 offen offset:1024 lds
v_mfma_f32_16x16x32_bf16 v[224:227], a[132:135], a[160:163], v[224:227]
ds_read_b64_tr_b16 a[32:33], v206 offset:41088
v_mfma_f32_16x16x32_bf16 v[236:239], a[136:139], a[160:163], v[236:239]
ds_read_b64_tr_b16 a[34:35], v206 offset:47232
v_mfma_f32_16x16x32_bf16 v[248:251], a[140:143], a[160:163], v[248:251]
ds_read_b64_tr_b16 a[36:37], v206 offset:41216
v_mfma_f32_16x16x32_bf16 v[184:187], a[128:131], a[164:167], v[184:187]
ds_read_b64_tr_b16 a[38:39], v206 offset:47360
buffer_load_dwordx4 v221, s[76:79], s54 offen offset:2048 lds
v_mfma_f32_16x16x32_bf16 v[228:231], a[132:135], a[164:167], v[228:231]
s_add_u32 s54, s54, 73728
v_mfma_f32_16x16x32_bf16 v[240:243], a[136:139], a[164:167], v[240:243]
v_mfma_f32_16x16x32_bf16 v[252:255], a[140:143], a[164:167], v[252:255]
s_waitcnt lgkmcnt(7)
v_mfma_f32_16x16x32_bf16 v[128:131], a[0:3], a[16:19], v[128:131]
buffer_load_dword v216, v212, s[20:23], 0 offen offset:0 sc1
v_mfma_f32_16x16x32_bf16 v[140:143], a[4:7], a[16:19], v[140:143]
v_mfma_f32_16x16x32_bf16 v[152:155], a[8:11], a[16:19], v[152:155]
s_waitcnt vmcnt(31) lgkmcnt(0)
s_barrier
ds_read_b64_tr_b16 a[144:145], v201 offset:0
v_mfma_f32_16x16x32_bf16 v[164:167], a[12:15], a[16:19], v[164:167]
s_add_u32 m0, s63, 40960
ds_read_b64_tr_b16 a[146:147], v201 offset:6144
v_mfma_f32_16x16x32_bf16 v[132:135], a[0:3], a[20:23], v[132:135]
ds_read_b128 a[128:131], v207 offset:0
buffer_load_dwordx4 v200, s[20:23], s67 offen sc1 lds
v_mfma_f32_16x16x32_bf16 v[144:147], a[4:7], a[20:23], v[144:147]
ds_read_b128 a[132:135], v207 offset:1024
v_mfma_f32_16x16x32_bf16 v[156:159], a[8:11], a[20:23], v[156:159]
v_mfma_f32_16x16x32_bf16 v[168:171], a[12:15], a[20:23], v[168:171]
ds_read_b128 a[136:139], v207 offset:2048
v_mfma_f32_16x16x32_bf16 v[136:139], a[0:3], a[24:27], v[136:139]
ds_read_b128 a[140:143], v207 offset:3072
buffer_load_dwordx4 v214, s[20:23], s67 offen offset:1024 sc1 lds
v_mfma_f32_16x16x32_bf16 v[148:151], a[4:7], a[24:27], v[148:151]
s_add_u32 s67, s67, s33
ds_read_b64_tr_b16 a[148:149], v201 offset:128
v_mfma_f32_16x16x32_bf16 v[160:163], a[8:11], a[24:27], v[160:163]
ds_read_b64_tr_b16 a[150:151], v201 offset:6272
v_mfma_f32_16x16x32_bf16 v[172:175], a[12:15], a[24:27], v[172:175]
s_add_u32 m0, s93, 49152
v_mfma_f32_16x16x32_bf16 v[176:179], a[0:3], a[28:31], v[176:179]
ds_read_b64_tr_b16 a[152:153], v201 offset:256
buffer_load_dwordx4 v219, s[76:79], s54 offen offset:0 lds
v_mfma_f32_16x16x32_bf16 v[188:191], a[4:7], a[28:31], v[188:191]
ds_read_b64_tr_b16 a[154:155], v201 offset:6400
v_mfma_f32_16x16x32_bf16 v[232:235], a[8:11], a[28:31], v[232:235]
ds_read_b64_tr_b16 a[156:157], v202 offset:0
v_mfma_f32_16x16x32_bf16 v[244:247], a[12:15], a[28:31], v[244:247]
ds_read_b64_tr_b16 a[158:159], v202 offset:6144
v_mfma_f32_16x16x32_bf16 v[180:183], a[0:3], a[32:35], v[180:183]
buffer_load_dwordx4 v220, s[76:79], s54 offen offset:1024 lds
v_mfma_f32_16x16x32_bf16 v[224:227], a[4:7], a[32:35], v[224:227]
ds_read_b64_tr_b16 a[160:161], v202 offset:128
v_mfma_f32_16x16x32_bf16 v[236:239], a[8:11], a[32:35], v[236:239]
ds_read_b64_tr_b16 a[162:163], v202 offset:6272
v_mfma_f32_16x16x32_bf16 v[248:251], a[12:15], a[32:35], v[248:251]
ds_read_b64_tr_b16 a[164:165], v202 offset:256
v_mfma_f32_16x16x32_bf16 v[184:187], a[0:3], a[36:39], v[184:187]
ds_read_b64_tr_b16 a[166:167], v202 offset:6400
buffer_load_dwordx4 v221, s[76:79], s54 offen offset:2048 lds
v_mfma_f32_16x16x32_bf16 v[228:231], a[4:7], a[36:39], v[228:231]
s_add_u32 s54, s54, 73728
v_mfma_f32_16x16x32_bf16 v[240:243], a[8:11], a[36:39], v[240:243]
v_mfma_f32_16x16x32_bf16 v[252:255], a[12:15], a[36:39], v[252:255]
s_waitcnt lgkmcnt(7)
v_mfma_f32_16x16x32_bf16 v[128:131], a[128:131], a[144:147], v[128:131]
v_bfe_u32 v104, v111, 3, 1
v_lshrrev_b32 v105, 4, v111
v_mfma_f32_16x16x32_bf16 v[140:143], a[132:135], a[144:147], v[140:143]
v_sub_u32 v104, v105, v104
s_lshl_b32 s18, s16, 1
v_mfma_f32_16x16x32_bf16 v[152:155], a[136:139], a[144:147], v[152:155]
s_waitcnt vmcnt(31) lgkmcnt(0)
s_barrier
ds_read_b64_tr_b16 a[16:17], v201 offset:20480
v_mfma_f32_16x16x32_bf16 v[164:167], a[140:143], a[144:147], v[164:167]
s_add_u32 m0, s63, 61440
ds_read_b64_tr_b16 a[18:19], v201 offset:26624
v_bfe_u32 v105, v111, 1, 2
v_mfma_f32_16x16x32_bf16 v[132:135], a[128:131], a[148:151], v[132:135]
ds_read_b128 a[0:3], v207 offset:20480
buffer_load_dwordx4 v200, s[20:23], s67 offen sc1 lds
v_mfma_f32_16x16x32_bf16 v[144:147], a[132:135], a[148:151], v[144:147]
ds_read_b128 a[4:7], v207 offset:21504
v_cmp_eq_u32 vcc, s18, v104
s_nop 1
v_cndmask_b32 v104, 7, v105, vcc
v_mfma_f32_16x16x32_bf16 v[156:159], a[136:139], a[148:151], v[156:159]
v_lshlrev_b32 v105, 4, v111
v_lshlrev_b32 v106, v105, v123
v_mfma_f32_16x16x32_bf16 v[168:171], a[140:143], a[148:151], v[168:171]
ds_read_b128 a[8:11], v207 offset:22528
v_lshlrev_b32 v88, v105, v88
v_mfma_f32_16x16x32_bf16 v[136:139], a[128:131], a[152:155], v[136:139]
ds_read_b128 a[12:15], v207 offset:23552
buffer_load_dwordx4 v214, s[20:23], s67 offen offset:1024 sc1 lds
v_mfma_f32_16x16x32_bf16 v[148:151], a[132:135], a[152:155], v[148:151]
s_add_u32 s67, s67, s33
ds_read_b64_tr_b16 a[20:21], v201 offset:20608
v_lshlrev_b32 v89, v105, v89
v_mfma_f32_16x16x32_bf16 v[160:163], a[136:139], a[152:155], v[160:163]
ds_read_b64_tr_b16 a[22:23], v201 offset:26752
v_lshlrev_b32 v90, v105, v90
v_mfma_f32_16x16x32_bf16 v[172:175], a[140:143], a[152:155], v[172:175]
s_add_u32 m0, s93, 69632
v_cmp_eq_u32 s[6:7], 0, v104
s_nop 1
v_cndmask_b32 v72, 0, v106, s[6:7]
v_mfma_f32_16x16x32_bf16 v[176:179], a[128:131], a[156:159], v[176:179]
ds_read_b64_tr_b16 a[24:25], v201 offset:20736
buffer_load_dwordx4 v219, s[76:79], s54 offen offset:0 lds
v_mfma_f32_16x16x32_bf16 v[188:191], a[132:135], a[156:159], v[188:191]
ds_read_b64_tr_b16 a[26:27], v201 offset:26880
v_cndmask_b32 v76, 0, v88, s[6:7]
v_mfma_f32_16x16x32_bf16 v[232:235], a[136:139], a[156:159], v[232:235]
ds_read_b64_tr_b16 a[28:29], v202 offset:20480
v_cndmask_b32 v80, 0, v89, s[6:7]
v_mfma_f32_16x16x32_bf16 v[244:247], a[140:143], a[156:159], v[244:247]
ds_read_b64_tr_b16 a[30:31], v202 offset:26624
v_cndmask_b32 v84, 0, v90, s[6:7]
v_mfma_f32_16x16x32_bf16 v[180:183], a[128:131], a[160:163], v[180:183]
buffer_load_dwordx4 v220, s[76:79], s54 offen offset:1024 lds
v_cmp_eq_u32 s[6:7], 1, v104
v_mfma_f32_16x16x32_bf16 v[224:227], a[132:135], a[160:163], v[224:227]
ds_read_b64_tr_b16 a[32:33], v202 offset:20608
v_cndmask_b32 v73, 0, v106, s[6:7]
v_mfma_f32_16x16x32_bf16 v[236:239], a[136:139], a[160:163], v[236:239]
ds_read_b64_tr_b16 a[34:35], v202 offset:26752
v_cndmask_b32 v77, 0, v88, s[6:7]
v_mfma_f32_16x16x32_bf16 v[248:251], a[140:143], a[160:163], v[248:251]
ds_read_b64_tr_b16 a[36:37], v202 offset:20736
v_cndmask_b32 v81, 0, v89, s[6:7]
v_mfma_f32_16x16x32_bf16 v[184:187], a[128:131], a[164:167], v[184:187]
ds_read_b64_tr_b16 a[38:39], v202 offset:26880
buffer_load_dwordx4 v221, s[76:79], s54 offen offset:2048 lds
v_mfma_f32_16x16x32_bf16 v[228:231], a[132:135], a[164:167], v[228:231]
v_cndmask_b32 v85, 0, v90, s[6:7]
v_cmp_eq_u32 s[6:7], 2, v104
v_mfma_f32_16x16x32_bf16 v[240:243], a[136:139], a[164:167], v[240:243]
s_nop 0
v_cndmask_b32 v74, 0, v106, s[6:7]
v_mfma_f32_16x16x32_bf16 v[252:255], a[140:143], a[164:167], v[252:255]
s_waitcnt lgkmcnt(4)
v_cndmask_b32 v78, 0, v88, s[6:7]
v_cndmask_b32 v82, 0, v89, s[6:7]
v_mfma_f32_16x16x32_bf16 v[128:131], a[0:3], a[16:19], v[128:131]
v_cndmask_b32 v86, 0, v90, s[6:7]
v_cmp_eq_u32 s[6:7], 3, v104
v_mfma_f32_16x16x32_bf16 v[140:143], a[4:7], a[16:19], v[140:143]
s_nop 0
v_cndmask_b32 v75, 0, v106, s[6:7]
v_mfma_f32_16x16x32_bf16 v[152:155], a[8:11], a[16:19], v[152:155]
s_waitcnt vmcnt(10)
v_cmp_ne_u32 vcc, s96, v216
s_cbranch_vccnz chk_12
chk_12_r:
v_mfma_f32_16x16x32_bf16 v[164:167], a[12:15], a[16:19], v[164:167]
s_waitcnt lgkmcnt(0)
s_barrier
ds_read_b64_tr_b16 a[144:145], v201 offset:40960
v_mfma_f32_16x16x32_bf16 v[132:135], a[0:3], a[20:23], v[132:135]
s_add_u32 m0, s63, 81920
ds_read_b64_tr_b16 a[146:147], v201 offset:47104
ds_read_b128 a[128:131], v207 offset:40960
v_mfma_f32_16x16x32_bf16 v[144:147], a[4:7], a[20:23], v[144:147]
buffer_load_dwordx4 v200, s[20:23], s47 offen sc1 lds
ds_read_b128 a[132:135], v207 offset:41984
v_mfma_f32_16x16x32_bf16 v[156:159], a[8:11], a[20:23], v[156:159]
v_cndmask_b32 v79, 0, v88, s[6:7]
v_cndmask_b32 v83, 0, v89, s[6:7]
v_mfma_f32_16x16x32_bf16 v[168:171], a[12:15], a[20:23], v[168:171]
ds_read_b128 a[136:139], v207 offset:43008
v_cndmask_b32 v87, 0, v90, s[6:7]
v_mfma_f32_16x16x32_bf16 v[136:139], a[0:3], a[24:27], v[136:139]
ds_read_b128 a[140:143], v207 offset:44032
buffer_load_dwordx4 v200, s[20:23], s47 offen offset:1024 sc1 lds
v_mfma_f32_16x16x32_bf16 v[148:151], a[4:7], a[24:27], v[148:151]
s_add_u32 s47, s47, 2048
ds_read_b64_tr_b16 a[148:149], v201 offset:41088
v_mfma_f32_16x16x32_bf16 v[160:163], a[8:11], a[24:27], v[160:163]
ds_read_b64_tr_b16 a[150:151], v201 offset:47232
v_mfma_f32_16x16x32_bf16 v[172:175], a[12:15], a[24:27], v[172:175]
s_add_u32 m0, s93, 90112
v_mfma_f32_16x16x32_bf16 v[176:179], a[0:3], a[28:31], v[176:179]
ds_read_b64_tr_b16 a[152:153], v201 offset:41216
buffer_load_dwordx4 v200, s[20:23], s48 offen offset:0 sc1 lds
v_mfma_f32_16x16x32_bf16 v[188:191], a[4:7], a[28:31], v[188:191]
ds_read_b64_tr_b16 a[154:155], v201 offset:47360
v_mfma_f32_16x16x32_bf16 v[232:235], a[8:11], a[28:31], v[232:235]
ds_read_b64_tr_b16 a[156:157], v202 offset:40960
v_mfma_f32_16x16x32_bf16 v[244:247], a[12:15], a[28:31], v[244:247]
ds_read_b64_tr_b16 a[158:159], v202 offset:47104
v_mfma_f32_16x16x32_bf16 v[180:183], a[0:3], a[32:35], v[180:183]
buffer_load_dwordx4 v200, s[20:23], s48 offen offset:1024 sc1 lds
v_mfma_f32_16x16x32_bf16 v[224:227], a[4:7], a[32:35], v[224:227]
ds_read_b64_tr_b16 a[160:161], v202 offset:41088
v_mfma_f32_16x16x32_bf16 v[236:239], a[8:11], a[32:35], v[236:239]
ds_read_b64_tr_b16 a[162:163], v202 offset:47232
v_mfma_f32_16x16x32_bf16 v[248:251], a[12:15], a[32:35], v[248:251]
ds_read_b64_tr_b16 a[164:165], v202 offset:41216
v_mfma_f32_16x16x32_bf16 v[184:187], a[0:3], a[36:39], v[184:187]
ds_read_b64_tr_b16 a[166:167], v202 offset:47360
buffer_load_dwordx4 v200, s[20:23], s48 offen offset:2048 sc1 lds
v_mfma_f32_16x16x32_bf16 v[228:231], a[4:7], a[36:39], v[228:231]
s_add_u32 s48, s48, 73728
v_mfma_f32_16x16x32_bf16 v[240:243], a[8:11], a[36:39], v[240:243]
v_mfma_f32_16x16x32_bf16 v[252:255], a[12:15], a[36:39], v[252:255]
s_waitcnt lgkmcnt(7)
v_mfma_f32_16x16x32_bf16 v[128:131], a[128:131], a[144:147], v[128:131]
v_mfma_f32_16x16x32_bf16 v[140:143], a[132:135], a[144:147], v[140:143]
v_mfma_f32_16x16x32_bf16 v[152:155], a[136:139], a[144:147], v[152:155]
s_waitcnt lgkmcnt(0)
s_barrier
ds_read_b64_tr_b16 a[16:17], v209 offset:0
v_mfma_f32_16x16x32_bf16 v[164:167], a[140:143], a[144:147], v[164:167]
s_add_u32 m0, s63, 102400
ds_read_b64_tr_b16 a[18:19], v209 offset:6144
v_mfma_f32_16x16x32_bf16 v[132:135], a[128:131], a[148:151], v[132:135]
ds_read_b128 a[0:3], v208 offset:0
buffer_load_dwordx4 v200, s[20:23], s47 offen sc1 lds
v_mfma_f32_16x16x32_bf16 v[144:147], a[132:135], a[148:151], v[144:147]
ds_read_b128 a[4:7], v208 offset:1024
v_mfma_f32_16x16x32_bf16 v[156:159], a[136:139], a[148:151], v[156:159]
v_mfma_f32_16x16x32_bf16 v[168:171], a[140:143], a[148:151], v[168:171]
ds_read_b128 a[8:11], v208 offset:2048
v_mfma_f32_16x16x32_bf16 v[136:139], a[128:131], a[152:155], v[136:139]
ds_read_b128 a[12:15], v208 offset:3072
buffer_load_dwordx4 v200, s[20:23], s47 offen offset:1024 sc1 lds
v_mfma_f32_16x16x32_bf16 v[148:151], a[132:135], a[152:155], v[148:151]
s_add_u32 s47, s47, 2048
ds_read_b64_tr_b16 a[20:21], v209 offset:128
v_mfma_f32_16x16x32_bf16 v[160:163], a[136:139], a[152:155], v[160:163]
ds_read_b64_tr_b16 a[22:23], v209 offset:6272
v_mfma_f32_16x16x32_bf16 v[172:175], a[140:143], a[152:155], v[172:175]
s_add_u32 m0, s93, 110592
v_mfma_f32_16x16x32_bf16 v[176:179], a[128:131], a[156:159], v[176:179]
ds_read_b64_tr_b16 a[24:25], v209 offset:256
buffer_load_dwordx4 v200, s[20:23], s48 offen offset:0 sc1 lds
v_mfma_f32_16x16x32_bf16 v[188:191], a[132:135], a[156:159], v[188:191]
ds_read_b64_tr_b16 a[26:27], v209 offset:6400
v_mfma_f32_16x16x32_bf16 v[232:235], a[136:139], a[156:159], v[232:235]
ds_read_b64_tr_b16 a[28:29], v210 offset:0
v_mfma_f32_16x16x32_bf16 v[244:247], a[140:143], a[156:159], v[244:247]
ds_read_b64_tr_b16 a[30:31], v210 offset:6144
v_mfma_f32_16x16x32_bf16 v[180:183], a[128:131], a[160:163], v[180:183]
buffer_load_dwordx4 v200, s[20:23], s48 offen offset:1024 sc1 lds
v_mfma_f32_16x16x32_bf16 v[224:227], a[132:135], a[160:163], v[224:227]
ds_read_b64_tr_b16 a[32:33], v210 offset:128
v_mfma_f32_16x16x32_bf16 v[236:239], a[136:139], a[160:163], v[236:239]
ds_read_b64_tr_b16 a[34:35], v210 offset:6272
v_mfma_f32_16x16x32_bf16 v[248:251], a[140:143], a[160:163], v[248:251]
ds_read_b64_tr_b16 a[36:37], v210 offset:256
v_mfma_f32_16x16x32_bf16 v[184:187], a[128:131], a[164:167], v[184:187]
ds_read_b64_tr_b16 a[38:39], v210 offset:6400
buffer_load_dwordx4 v200, s[20:23], s48 offen offset:2048 sc1 lds
v_mfma_f32_16x16x32_bf16 v[228:231], a[132:135], a[164:167], v[228:231]
s_add_u32 s48, s48, 73728
v_mfma_f32_16x16x32_bf16 v[240:243], a[136:139], a[164:167], v[240:243]
v_mfma_f32_16x16x32_bf16 v[252:255], a[140:143], a[164:167], v[252:255]
s_waitcnt lgkmcnt(7)
v_mfma_f32_16x16x32_bf16 v[128:131], a[0:3], a[16:19], v[128:131]
buffer_load_dword v216, v213, s[20:23], 0 offen sc1
v_mfma_f32_16x16x32_bf16 v[140:143], a[4:7], a[16:19], v[140:143]
v_mfma_f32_16x16x32_bf16 v[152:155], a[8:11], a[16:19], v[152:155]
s_waitcnt lgkmcnt(0)
s_barrier
ds_read_b64_tr_b16 a[144:145], v209 offset:20480
v_mfma_f32_16x16x32_bf16 v[164:167], a[12:15], a[16:19], v[164:167]
s_add_u32 m0, s63, 122880
ds_read_b64_tr_b16 a[146:147], v209 offset:26624
v_mfma_f32_16x16x32_bf16 v[132:135], a[0:3], a[20:23], v[132:135]
ds_read_b128 a[128:131], v208 offset:20480
buffer_load_dwordx4 v200, s[20:23], s47 offen sc1 lds
v_mfma_f32_16x16x32_bf16 v[144:147], a[4:7], a[20:23], v[144:147]
ds_read_b128 a[132:135], v208 offset:21504
v_mfma_f32_16x16x32_bf16 v[156:159], a[8:11], a[20:23], v[156:159]
v_mfma_f32_16x16x32_bf16 v[168:171], a[12:15], a[20:23], v[168:171]
ds_read_b128 a[136:139], v208 offset:22528
v_mfma_f32_16x16x32_bf16 v[136:139], a[0:3], a[24:27], v[136:139]
ds_read_b128 a[140:143], v208 offset:23552
buffer_load_dwordx4 v200, s[20:23], s47 offen offset:1024 sc1 lds
v_mfma_f32_16x16x32_bf16 v[148:151], a[4:7], a[24:27], v[148:151]
s_add_u32 s47, s47, 2048
ds_read_b64_tr_b16 a[148:149], v209 offset:20608
v_mfma_f32_16x16x32_bf16 v[160:163], a[8:11], a[24:27], v[160:163]
ds_read_b64_tr_b16 a[150:151], v209 offset:26752
v_mfma_f32_16x16x32_bf16 v[172:175], a[12:15], a[24:27], v[172:175]
s_add_u32 m0, s93, 131072
v_mfma_f32_16x16x32_bf16 v[176:179], a[0:3], a[28:31], v[176:179]
ds_read_b64_tr_b16 a[152:153], v209 offset:20736
buffer_load_dwordx4 v200, s[20:23], s48 offen offset:0 sc1 lds
v_mfma_f32_16x16x32_bf16 v[188:191], a[4:7], a[28:31], v[188:191]
ds_read_b64_tr_b16 a[154:155], v209 offset:26880
v_mfma_f32_16x16x32_bf16 v[232:235], a[8:11], a[28:31], v[232:235]
ds_read_b64_tr_b16 a[156:157], v210 offset:20480
v_mfma_f32_16x16x32_bf16 v[244:247], a[12:15], a[28:31], v[244:247]
ds_read_b64_tr_b16 a[158:159], v210 offset:26624
v_mfma_f32_16x16x32_bf16 v[180:183], a[0:3], a[32:35], v[180:183]
buffer_load_dwordx4 v200, s[20:23], s48 offen offset:1024 sc1 lds
v_mfma_f32_16x16x32_bf16 v[224:227], a[4:7], a[32:35], v[224:227]
ds_read_b64_tr_b16 a[160:161], v210 offset:20608
v_mfma_f32_16x16x32_bf16 v[236:239], a[8:11], a[32:35], v[236:239]
ds_read_b64_tr_b16 a[162:163], v210 offset:26752
v_mfma_f32_16x16x32_bf16 v[248:251], a[12:15], a[32:35], v[248:251]
ds_read_b64_tr_b16 a[164:165], v210 offset:20736
v_mfma_f32_16x16x32_bf16 v[184:187], a[0:3], a[36:39], v[184:187]
ds_read_b64_tr_b16 a[166:167], v210 offset:26880
T_b_3:
s_cbranch_execz T_r1
buffer_load_dwordx4 v200, s[20:23], s48 offen offset:2048 sc1 lds
v_mfma_f32_16x16x32_bf16 v[228:231], a[4:7], a[36:39], v[228:231]
s_add_u32 s48, s48, 73728
v_mfma_f32_16x16x32_bf16 v[240:243], a[8:11], a[36:39], v[240:243]
v_mfma_f32_16x16x32_bf16 v[252:255], a[12:15], a[36:39], v[252:255]
s_waitcnt lgkmcnt(7)
v_mfma_f32_16x16x32_bf16 v[128:131], a[128:131], a[144:147], v[128:131]
v_mfma_f32_16x16x32_bf16 v[140:143], a[132:135], a[144:147], v[140:143]
v_mfma_f32_16x16x32_bf16 v[152:155], a[136:139], a[144:147], v[152:155]
s_waitcnt lgkmcnt(0)
s_barrier
ds_read_b64_tr_b16 a[16:17], v205 offset:0
v_mfma_f32_16x16x32_bf16 v[164:167], a[140:143], a[144:147], v[164:167]
s_add_u32 m0, s93, 151552
ds_read_b64_tr_b16 a[18:19], v205 offset:6144
ds_read_b128 a[0:3], v204 offset:0
v_mfma_f32_16x16x32_bf16 v[132:135], a[128:131], a[148:151], v[132:135]
ds_read_b128 a[4:7], v204 offset:1024
ds_read_b128 a[8:11], v204 offset:2048
v_mfma_f32_16x16x32_bf16 v[144:147], a[132:135], a[148:151], v[144:147]
ds_read_b128 a[12:15], v204 offset:3072
buffer_load_dwordx4 v200, s[20:23], s48 offen offset:0 sc1 lds
v_mfma_f32_16x16x32_bf16 v[156:159], a[136:139], a[148:151], v[156:159]
ds_read_b64_tr_b16 a[20:21], v205 offset:128
ds_read_b64_tr_b16 a[22:23], v205 offset:6272
v_mfma_f32_16x16x32_bf16 v[168:171], a[140:143], a[148:151], v[168:171]
ds_read_b64_tr_b16 a[24:25], v205 offset:256
ds_read_b64_tr_b16 a[26:27], v205 offset:6400
v_mfma_f32_16x16x32_bf16 v[136:139], a[128:131], a[152:155], v[136:139]
ds_read_b64_tr_b16 a[28:29], v206 offset:0
ds_read_b64_tr_b16 a[30:31], v206 offset:6144
v_mfma_f32_16x16x32_bf16 v[148:151], a[132:135], a[152:155], v[148:151]
buffer_load_dwordx4 v200, s[20:23], s48 offen offset:1024 sc1 lds
ds_read_b64_tr_b16 a[32:33], v206 offset:128
v_mfma_f32_16x16x32_bf16 v[160:163], a[136:139], a[152:155], v[160:163]
ds_read_b64_tr_b16 a[34:35], v206 offset:6272
ds_read_b64_tr_b16 a[36:37], v206 offset:256
v_mfma_f32_16x16x32_bf16 v[172:175], a[140:143], a[152:155], v[172:175]
ds_read_b64_tr_b16 a[38:39], v206 offset:6400
buffer_load_dwordx4 v200, s[20:23], s48 offen offset:2048 sc1 lds
v_mfma_f32_16x16x32_bf16 v[176:179], a[128:131], a[156:159], v[176:179]
s_add_u32 s48, s48, 73728
s_waitcnt vmcnt(19) lgkmcnt(0)
s_barrier
v_mfma_f32_16x16x32_bf16 v[188:191], a[132:135], a[156:159], v[188:191]
ds_read_b64_tr_b16 a[56:57], v205 offset:20480
ds_read_b64_tr_b16 a[58:59], v205 offset:26624
v_mfma_f32_16x16x32_bf16 v[232:235], a[136:139], a[156:159], v[232:235]
ds_read_b128 a[48:51], v204 offset:22528
ds_read_b128 a[52:55], v204 offset:23552
v_mfma_f32_16x16x32_bf16 v[244:247], a[140:143], a[156:159], v[244:247]
s_add_u32 m0, s93, 8192
ds_read_b64_tr_b16 a[60:61], v205 offset:20608
ds_read_b64_tr_b16 a[62:63], v205 offset:26752
v_mfma_f32_16x16x32_bf16 v[180:183], a[128:131], a[160:163], v[180:183]
buffer_load_dwordx4 v120, s[28:31], s32 offen offset:0 lds
ds_read_b64_tr_b16 a[64:65], v205 offset:20736
v_mfma_f32_16x16x32_bf16 v[224:227], a[132:135], a[160:163], v[224:227]
ds_read_b64_tr_b16 a[66:67], v205 offset:26880
v_mfma_f32_16x16x32_bf16 v[236:239], a[136:139], a[160:163], v[236:239]
s_add_u32 m0, s93, 9088
ds_read_b64_tr_b16 a[96:97], v205 offset:40960
ds_read_b64_tr_b16 a[98:99], v205 offset:47104
v_mfma_f32_16x16x32_bf16 v[248:251], a[140:143], a[160:163], v[248:251]
buffer_load_dwordx4 v120, s[28:31], s32 offen offset:128 lds
ds_read_b128 a[88:91], v204 offset:43008
v_mfma_f32_16x16x32_bf16 v[184:187], a[128:131], a[164:167], v[184:187]
ds_read_b128 a[92:95], v204 offset:44032
v_mfma_f32_16x16x32_bf16 v[228:231], a[132:135], a[164:167], v[228:231]
s_add_u32 m0, s93, 9984
ds_read_b64_tr_b16 a[100:101], v205 offset:41088
ds_read_b64_tr_b16 a[102:103], v205 offset:47232
v_mfma_f32_16x16x32_bf16 v[240:243], a[136:139], a[164:167], v[240:243]
buffer_load_dwordx4 v120, s[28:31], s32 offen offset:256 lds
ds_read_b64_tr_b16 a[104:105], v205 offset:41216
v_mfma_f32_16x16x32_bf16 v[252:255], a[140:143], a[164:167], v[252:255]
ds_read_b64_tr_b16 a[106:107], v205 offset:47360
v_mfma_f32_16x16x32_bf16 v[152:155], a[8:11], a[16:19], v[152:155]
ds_read_b64_tr_b16 a[184:185], v201 offset:0
ds_read_b64_tr_b16 a[186:187], v201 offset:6144
v_mfma_f32_16x16x32_bf16 v[164:167], a[12:15], a[16:19], v[164:167]
ds_read_b128 a[176:179], v207 offset:2048
ds_read_b128 a[180:183], v207 offset:3072
v_mfma_f32_16x16x32_bf16 v[156:159], a[8:11], a[20:23], v[156:159]
ds_read_b64_tr_b16 a[188:189], v201 offset:128
ds_read_b64_tr_b16 a[190:191], v201 offset:6272
v_mfma_f32_16x16x32_bf16 v[168:171], a[12:15], a[20:23], v[168:171]
ds_read_b64_tr_b16 a[192:193], v201 offset:256
ds_read_b64_tr_b16 a[194:195], v201 offset:6400
v_mfma_f32_16x16x32_bf16 v[160:163], a[8:11], a[24:27], v[160:163]
ds_read_b64_tr_b16 a[68:69], v206 offset:20480
v_mfma_f32_16x16x32_bf16 v[172:175], a[12:15], a[24:27], v[172:175]
s_waitcnt lgkmcnt(11)
ds_read_b64_tr_b16 a[70:71], v206 offset:26624
ds_read_b64_tr_b16 a[72:73], v206 offset:20608
v_mfma_f32_16x16x32_bf16 v[152:155], a[48:51], a[56:59], v[152:155]
ds_read_b64_tr_b16 a[74:75], v206 offset:26752
ds_read_b64_tr_b16 a[76:77], v206 offset:20736
v_mfma_f32_16x16x32_bf16 v[164:167], a[52:55], a[56:59], v[164:167]
ds_read_b64_tr_b16 a[78:79], v206 offset:26880
ds_read_b64_tr_b16 a[108:109], v206 offset:40960
v_mfma_f32_16x16x32_bf16 v[156:159], a[48:51], a[60:63], v[156:159]
ds_read_b64_tr_b16 a[110:111], v206 offset:47104
ds_read_b64_tr_b16 a[112:113], v206 offset:41088
v_mfma_f32_16x16x32_bf16 v[168:171], a[52:55], a[60:63], v[168:171]
s_waitcnt vmcnt(11)
v_cmp_ne_u32 vcc, s96, v216
s_cbranch_vccnz chk_14
chk_14_r:
v_mfma_f32_16x16x32_bf16 v[160:163], a[48:51], a[64:67], v[160:163]
s_add_u32 m0, s63, 143360
ds_read_b64_tr_b16 a[114:115], v206 offset:47232
buffer_load_dwordx4 v200, s[20:23], s47 offen sc1 lds
v_mfma_f32_16x16x32_bf16 v[172:175], a[52:55], a[64:67], v[172:175]
ds_read_b64_tr_b16 a[116:117], v206 offset:41216
ds_read_b64_tr_b16 a[118:119], v206 offset:47360
v_mfma_f32_16x16x32_bf16 v[152:155], a[88:91], a[96:99], v[152:155]
buffer_load_dwordx4 v200, s[20:23], s47 offen offset:1024 sc1 lds
s_add_u32 s47, s47, 2048
v_mfma_f32_16x16x32_bf16 v[164:167], a[92:95], a[96:99], v[164:167]
ds_read_b64_tr_b16 a[196:197], v202 offset:0
ds_read_b64_tr_b16 a[198:199], v202 offset:6144
v_mfma_f32_16x16x32_bf16 v[156:159], a[88:91], a[100:103], v[156:159]
ds_read_b64_tr_b16 a[200:201], v202 offset:128
ds_read_b64_tr_b16 a[202:203], v202 offset:6272
v_mfma_f32_16x16x32_bf16 v[168:171], a[92:95], a[100:103], v[168:171]
s_waitcnt lgkmcnt(7)
ds_read_b64_tr_b16 a[204:205], v202 offset:256
ds_read_b64_tr_b16 a[206:207], v202 offset:6400
v_mfma_f32_16x16x32_bf16 v[160:163], a[88:91], a[104:107], v[160:163]
ds_read_b128 a[40:43], v204 offset:20480
ds_read_b128 a[44:47], v204 offset:21504
v_mfma_f32_16x16x32_bf16 v[172:175], a[92:95], a[104:107], v[172:175]
ds_read_b128 a[80:83], v204 offset:40960
ds_read_b128 a[84:87], v204 offset:41984
v_mfma_f32_16x16x32_bf16 v[152:155], a[176:179], a[184:187], v[152:155]
ds_read_b128 a[168:171], v207 offset:0
ds_read_b128 a[172:175], v207 offset:1024
v_mfma_f32_16x16x32_bf16 v[164:167], a[180:183], a[184:187], v[164:167]
v_mfma_f32_16x16x32_bf16 v[156:159], a[176:179], a[188:191], v[156:159]
s_waitcnt lgkmcnt(0)
s_barrier
v_mfma_f32_16x16x32_bf16 v[168:171], a[180:183], a[188:191], v[168:171]
s_add_u32 m0, s63, 61440
v_mfma_f32_16x16x32_bf16 v[160:163], a[176:179], a[192:195], v[160:163]
buffer_load_dwordx4 v200, s[20:23], s47 offen sc1 lds
v_mfma_f32_16x16x32_bf16 v[172:175], a[180:183], a[192:195], v[172:175]
buffer_load_dwordx4 v200, s[20:23], s47 offen offset:1024 sc1 lds
s_add_u32 s47, s47, 2048
v_mfma_f32_16x16x32_bf16 v[232:235], a[8:11], a[28:31], v[232:235]
s_add_u32 m0, s93, 69632
v_mfma_f32_16x16x32_bf16 v[244:247], a[12:15], a[28:31], v[244:247]
buffer_load_dwordx4 v200, s[20:23], s48 offen offset:0 sc1 lds
v_mfma_f32_16x16x32_bf16 v[236:239], a[8:11], a[32:35], v[236:239]
buffer_load_dwordx4 v200, s[20:23], s48 offen offset:1024 sc1 lds
v_cvt_pk_bf16_f32 v152, v152, v153
v_mfma_f32_16x16x32_bf16 v[248:251], a[12:15], a[32:35], v[248:251]
v_cvt_pk_bf16_f32 v153, v154, v155
v_cvt_pk_bf16_f32 v154, v164, v165
v_mfma_f32_16x16x32_bf16 v[240:243], a[8:11], a[36:39], v[240:243]
v_cvt_pk_bf16_f32 v155, v166, v167
buffer_load_dwordx4 v200, s[20:23], s48 offen offset:2048 sc1 lds
v_mfma_f32_16x16x32_bf16 v[252:255], a[12:15], a[36:39], v[252:255]
s_add_u32 s48, s48, 73728
s_add_u32 m0, s93, 28672
buffer_store_dwordx4 v[152:155], v200, s[20:23], s36 offen offset:0 sc1
v_mfma_f32_16x16x32_bf16 v[232:235], a[48:51], a[68:71], v[232:235]
buffer_load_dwordx4 v200, s[20:23], s60 offen offset:0 sc1 lds
v_cvt_pk_bf16_f32 v156, v156, v157
v_mfma_f32_16x16x32_bf16 v[244:247], a[52:55], a[68:71], v[244:247]
v_cvt_pk_bf16_f32 v157, v158, v159
buffer_load_dwordx4 v200, s[20:23], s61 offen offset:1024 sc1 lds
v_mfma_f32_16x16x32_bf16 v[236:239], a[48:51], a[72:75], v[236:239]
v_cvt_pk_bf16_f32 v158, v168, v169
v_cvt_pk_bf16_f32 v159, v170, v171
v_mfma_f32_16x16x32_bf16 v[248:251], a[52:55], a[72:75], v[248:251]
buffer_load_dwordx4 v200, s[20:23], s62 offen offset:2048 sc1 lds
buffer_store_dwordx4 v[156:159], v200, s[20:23], s36 offen offset:1024 sc1
v_mfma_f32_16x16x32_bf16 v[240:243], a[48:51], a[76:79], v[240:243]
v_cvt_pk_bf16_f32 v160, v160, v161
v_cvt_pk_bf16_f32 v161, v162, v163
v_mfma_f32_16x16x32_bf16 v[252:255], a[52:55], a[76:79], v[252:255]
v_cvt_pk_bf16_f32 v162, v172, v173
v_cvt_pk_bf16_f32 v163, v174, v175
v_mfma_f32_16x16x32_bf16 v[232:235], a[88:91], a[108:111], v[232:235]
buffer_store_dwordx4 v[160:163], v200, s[20:23], s36 offen offset:2048 sc1
v_mfma_f32_16x16x32_bf16 v[244:247], a[92:95], a[108:111], v[244:247]
v_mfma_f32_16x16x32_bf16 v[236:239], a[88:91], a[112:115], v[236:239]
s_add_u32 s36, s36, 3072
v_mfma_f32_16x16x32_bf16 v[248:251], a[92:95], a[112:115], v[248:251]
v_mfma_f32_16x16x32_bf16 v[240:243], a[88:91], a[116:119], v[240:243]
v_mfma_f32_16x16x32_bf16 v[252:255], a[92:95], a[116:119], v[252:255]
v_mfma_f32_16x16x32_bf16 v[232:235], a[176:179], a[196:199], v[232:235]
v_mfma_f32_16x16x32_bf16 v[244:247], a[180:183], a[196:199], v[244:247]
v_mfma_f32_16x16x32_bf16 v[236:239], a[176:179], a[200:203], v[236:239]
v_mfma_f32_16x16x32_bf16 v[248:251], a[180:183], a[200:203], v[248:251]
v_mfma_f32_16x16x32_bf16 v[240:243], a[176:179], a[204:207], v[240:243]
v_mfma_f32_16x16x32_bf16 v[252:255], a[180:183], a[204:207], v[252:255]
v_mfma_f32_16x16x32_bf16 v[176:179], a[0:3], a[28:31], v[176:179]
v_mfma_f32_16x16x32_bf16 v[188:191], a[4:7], a[28:31], v[188:191]
v_mfma_f32_16x16x32_bf16 v[180:183], a[0:3], a[32:35], v[180:183]
v_cvt_pk_bf16_f32 v232, v232, v233
v_cvt_pk_bf16_f32 v233, v234, v235
v_mfma_f32_16x16x32_bf16 v[224:227], a[4:7], a[32:35], v[224:227]
v_cvt_pk_bf16_f32 v234, v244, v245
v_cvt_pk_bf16_f32 v235, v246, v247
v_mfma_f32_16x16x32_bf16 v[184:187], a[0:3], a[36:39], v[184:187]
buffer_store_dwordx4 v[232:235], v200, s[20:23], s36 offen offset:0 sc1
v_mfma_f32_16x16x32_bf16 v[228:231], a[4:7], a[36:39], v[228:231]
v_mfma_f32_16x16x32_bf16 v[176:179], a[40:43], a[68:71], v[176:179]
v_cvt_pk_bf16_f32 v236, v236, v237
v_cvt_pk_bf16_f32 v237, v238, v239
v_mfma_f32_16x16x32_bf16 v[188:191], a[44:47], a[68:71], v[188:191]
v_cvt_pk_bf16_f32 v238, v248, v249
v_cvt_pk_bf16_f32 v239, v250, v251
v_mfma_f32_16x16x32_bf16 v[180:183], a[40:43], a[72:75], v[180:183]
buffer_store_dwordx4 v[236:239], v200, s[20:23], s36 offen offset:1024 sc1
v_mfma_f32_16x16x32_bf16 v[224:227], a[44:47], a[72:75], v[224:227]
v_mfma_f32_16x16x32_bf16 v[184:187], a[40:43], a[76:79], v[184:187]
v_cvt_pk_bf16_f32 v240, v240, v241
v_cvt_pk_bf16_f32 v241, v242, v243
v_mfma_f32_16x16x32_bf16 v[228:231], a[44:47], a[76:79], v[228:231]
v_cvt_pk_bf16_f32 v242, v252, v253
v_cvt_pk_bf16_f32 v243, v254, v255
v_mfma_f32_16x16x32_bf16 v[176:179], a[80:83], a[108:111], v[176:179]
buffer_store_dwordx4 v[240:243], v200, s[20:23], s36 offen offset:2048 sc1
v_mfma_f32_16x16x32_bf16 v[188:191], a[84:87], a[108:111], v[188:191]
v_mfma_f32_16x16x32_bf16 v[180:183], a[80:83], a[112:115], v[180:183]
s_add_u32 s36, s36, 3072
v_mfma_f32_16x16x32_bf16 v[224:227], a[84:87], a[112:115], v[224:227]
v_mfma_f32_16x16x32_bf16 v[184:187], a[80:83], a[116:119], v[184:187]
v_mfma_f32_16x16x32_bf16 v[228:231], a[84:87], a[116:119], v[228:231]
v_mfma_f32_16x16x32_bf16 v[176:179], a[168:171], a[196:199], v[176:179]
v_mfma_f32_16x16x32_bf16 v[188:191], a[172:175], a[196:199], v[188:191]
v_mfma_f32_16x16x32_bf16 v[180:183], a[168:171], a[200:203], v[180:183]
v_mfma_f32_16x16x32_bf16 v[224:227], a[172:175], a[200:203], v[224:227]
v_mfma_f32_16x16x32_bf16 v[184:187], a[168:171], a[204:207], v[184:187]
s_barrier
v_mfma_f32_16x16x32_bf16 v[228:231], a[172:175], a[204:207], v[228:231]
v_mfma_f32_16x16x32_bf16 v[128:131], a[0:3], a[16:19], v[128:131]
ds_read_b128 a[208:211], v207 offset:20480
v_mfma_f32_16x16x32_bf16 v[140:143], a[4:7], a[16:19], v[140:143]
ds_read_b128 a[216:219], v207 offset:22528
v_mfma_f32_16x16x32_bf16 v[132:135], a[0:3], a[20:23], v[132:135]
v_cvt_pk_bf16_f32 v176, v176, v177
v_cvt_pk_bf16_f32 v177, v178, v179
v_mfma_f32_16x16x32_bf16 v[144:147], a[4:7], a[20:23], v[144:147]
ds_read_b128 a[224:227], v112 offset:20480
v_cvt_pk_bf16_f32 v178, v188, v189
v_mfma_f32_16x16x32_bf16 v[136:139], a[0:3], a[24:27], v[136:139]
v_cvt_pk_bf16_f32 v179, v190, v191
ds_read_b128 a[228:231], v112 offset:21504
v_mfma_f32_16x16x32_bf16 v[148:151], a[4:7], a[24:27], v[148:151]
buffer_store_dwordx4 v[176:179], v200, s[20:23], s36 offen offset:0 sc1
ds_read_b128 a[232:235], v112 offset:22528
v_mfma_f32_16x16x32_bf16 v[128:131], a[40:43], a[56:59], v[128:131]
ds_read_b128 a[212:215], v207 offset:21504
v_cvt_pk_bf16_f32 v180, v180, v181
v_mfma_f32_16x16x32_bf16 v[140:143], a[44:47], a[56:59], v[140:143]
v_cvt_pk_bf16_f32 v181, v182, v183
ds_read_b128 a[220:223], v207 offset:23552
v_mfma_f32_16x16x32_bf16 v[132:135], a[40:43], a[60:63], v[132:135]
v_cvt_pk_bf16_f32 v182, v224, v225
v_cvt_pk_bf16_f32 v183, v226, v227
v_mfma_f32_16x16x32_bf16 v[144:147], a[44:47], a[60:63], v[144:147]
ds_read_b128 a[236:239], v112 offset:26624
buffer_store_dwordx4 v[180:183], v200, s[20:23], s36 offen offset:1024 sc1
v_mfma_f32_16x16x32_bf16 v[136:139], a[40:43], a[64:67], v[136:139]
ds_read_b128 a[240:243], v112 offset:27648
ds_read_b128 a[244:247], v112 offset:28672
v_mfma_f32_16x16x32_bf16 v[148:151], a[44:47], a[64:67], v[148:151]
v_cvt_pk_bf16_f32 v184, v184, v185
v_cvt_pk_bf16_f32 v185, v186, v187
v_mfma_f32_16x16x32_bf16 v[128:131], a[80:83], a[96:99], v[128:131]
ds_read_b128 a[128:131], v207 offset:40960
v_cvt_pk_bf16_f32 v186, v228, v229
v_mfma_f32_16x16x32_bf16 v[140:143], a[84:87], a[96:99], v[140:143]
v_cvt_pk_bf16_f32 v187, v230, v231
ds_read_b128 a[136:139], v207 offset:43008
v_mfma_f32_16x16x32_bf16 v[132:135], a[80:83], a[100:103], v[132:135]
buffer_store_dwordx4 v[184:187], v200, s[20:23], s36 offen offset:2048 sc1
ds_read_b128 a[144:147], v112 offset:40960
v_mfma_f32_16x16x32_bf16 v[144:147], a[84:87], a[100:103], v[144:147]
s_add_u32 s36, s36, 3072
ds_read_b128 a[148:151], v112 offset:41984
ds_read_b128 a[152:155], v112 offset:43008
v_mfma_f32_16x16x32_bf16 v[136:139], a[80:83], a[104:107], v[136:139]
ds_read_b128 a[132:135], v207 offset:41984
buffer_load_dword v216, v102, s[20:23], 0 offen sc1
v_mfma_f32_16x16x32_bf16 v[148:151], a[84:87], a[104:107], v[148:151]
ds_read_b128 a[140:143], v207 offset:44032
ds_read_b128 a[156:159], v112 offset:47104
v_mfma_f32_16x16x32_bf16 v[128:131], a[168:171], a[184:187], v[128:131]
ds_read_b128 a[160:163], v112 offset:48128
v_mfma_f32_16x16x32_bf16 v[140:143], a[172:175], a[184:187], v[140:143]
ds_read_b128 a[164:167], v112 offset:49152
v_mfma_f32_16x16x32_bf16 v[132:135], a[168:171], a[188:191], v[132:135]
v_mfma_f32_16x16x32_bf16 v[144:147], a[172:175], a[188:191], v[144:147]
v_mfma_f32_16x16x32_bf16 v[136:139], a[168:171], a[192:195], v[136:139]
v_mfma_f32_16x16x32_bf16 v[148:151], a[172:175], a[192:195], v[148:151]
s_waitcnt lgkmcnt(8)
v_mfma_f32_16x16x32_bf16 v[48:51], a[208:211], a[224:227], 0
v_mfma_f32_16x16x32_bf16 v[60:63], a[216:219], a[224:227], 0
v_mfma_f32_16x16x32_bf16 v[52:55], a[208:211], a[228:231], 0
v_mfma_f32_16x16x32_bf16 v[64:67], a[216:219], a[228:231], 0
v_mfma_f32_16x16x32_bf16 v[56:59], a[208:211], a[232:235], 0
s_waitcnt vmcnt(9)
s_barrier
v_mfma_f32_16x16x32_bf16 v[68:71], a[216:219], a[232:235], 0
ds_read_b128 a[108:111], v122 offset:0
v_mfma_f32_16x16x32_bf16 v[48:51], a[212:215], a[236:239], v[48:51]
ds_read_b128 a[112:115], v122 offset:1024
v_mfma_f32_16x16x32_bf16 v[60:63], a[220:223], a[236:239], v[60:63]
ds_read_b128 a[116:119], v122 offset:2048
v_mfma_f32_16x16x32_bf16 v[52:55], a[212:215], a[240:243], v[52:55]
ds_read_b128 a[196:199], v122 offset:3072
v_mfma_f32_16x16x32_bf16 v[64:67], a[220:223], a[240:243], v[64:67]
ds_read_b128 a[200:203], v122 offset:4096
v_mfma_f32_16x16x32_bf16 v[56:59], a[212:215], a[244:247], v[56:59]
ds_read_b128 a[204:207], v122 offset:5120
v_mfma_f32_16x16x32_bf16 v[68:71], a[220:223], a[244:247], v[68:71]
s_waitcnt lgkmcnt(6)
ds_read_b128 a[28:31], v121 offset:0
v_mfma_f32_16x16x32_bf16 v[48:51], a[128:131], a[144:147], v[48:51]
ds_read_b128 a[32:35], v121 offset:1024
ds_read_b128 a[208:211], v208 offset:0
v_mfma_f32_16x16x32_bf16 v[60:63], a[136:139], a[144:147], v[60:63]
ds_read_b128 a[36:39], v121 offset:2048
ds_read_b128 a[216:219], v208 offset:2048
v_mfma_f32_16x16x32_bf16 v[52:55], a[128:131], a[148:151], v[52:55]
ds_read_b128 a[68:71], v121 offset:3072
ds_read_b128 a[224:227], v113 offset:0
v_mfma_f32_16x16x32_bf16 v[64:67], a[136:139], a[148:151], v[64:67]
ds_read_b128 a[72:75], v121 offset:4096
ds_read_b128 a[228:231], v113 offset:1024
v_mfma_f32_16x16x32_bf16 v[56:59], a[128:131], a[152:155], v[56:59]
ds_read_b128 a[76:79], v121 offset:5120
ds_read_b128 a[232:235], v113 offset:2048
v_mfma_f32_16x16x32_bf16 v[68:71], a[136:139], a[152:155], v[68:71]
ds_read_b128 a[212:215], v208 offset:1024
v_mfma_f32_16x16x32_bf16 v[48:51], a[132:135], a[156:159], v[48:51]
ds_read_b128 a[220:223], v208 offset:3072
v_mfma_f32_16x16x32_bf16 v[60:63], a[140:143], a[156:159], v[60:63]
ds_read_b128 a[236:239], v113 offset:6144
v_mfma_f32_16x16x32_bf16 v[52:55], a[132:135], a[160:163], v[52:55]
ds_read_b128 a[240:243], v113 offset:7168
v_mfma_f32_16x16x32_bf16 v[64:67], a[140:143], a[160:163], v[64:67]
ds_read_b128 a[244:247], v113 offset:8192
v_mfma_f32_16x16x32_bf16 v[56:59], a[132:135], a[164:167], v[56:59]
v_mfma_f32_16x16x32_bf16 v[68:71], a[140:143], a[164:167], v[68:71]
s_waitcnt lgkmcnt(9)
v_mfma_f32_16x16x32_bf16 v[48:51], a[208:211], a[224:227], v[48:51]
ds_read_b128 a[128:131], v208 offset:20480
v_mfma_f32_16x16x32_bf16 v[60:63], a[216:219], a[224:227], v[60:63]
s_waitcnt lgkmcnt(8)
ds_read_b128 a[136:139], v208 offset:22528
v_mfma_f32_16x16x32_bf16 v[52:55], a[208:211], a[228:231], v[52:55]
ds_read_b128 a[144:147], v113 offset:20480
v_mfma_f32_16x16x32_bf16 v[64:67], a[216:219], a[228:231], v[64:67]
s_waitcnt lgkmcnt(8)
ds_read_b128 a[148:151], v113 offset:21504
v_mfma_f32_16x16x32_bf16 v[56:59], a[208:211], a[232:235], v[56:59]
ds_read_b128 a[152:155], v113 offset:22528
v_mfma_f32_16x16x32_bf16 v[68:71], a[216:219], a[232:235], v[68:71]
s_waitcnt lgkmcnt(7)
ds_read_b128 a[132:135], v208 offset:21504
v_mfma_f32_16x16x32_bf16 v[48:51], a[212:215], a[236:239], v[48:51]
ds_read_b128 a[140:143], v208 offset:23552
v_mfma_f32_16x16x32_bf16 v[60:63], a[220:223], a[236:239], v[60:63]
s_waitcnt lgkmcnt(7)
ds_read_b128 a[156:159], v113 offset:26624
v_mfma_f32_16x16x32_bf16 v[52:55], a[212:215], a[240:243], v[52:55]
ds_read_b128 a[160:163], v113 offset:27648
s_waitcnt vmcnt(1)
v_mfma_f32_16x16x32_bf16 v[64:67], a[220:223], a[240:243], v[64:67]
buffer_store_dword v218, v217, s[20:23], s90 offen offset:0 sc1
s_waitcnt vmcnt(1)
v_mfma_f32_16x16x32_bf16 v[56:59], a[212:215], a[244:247], v[56:59]
v_cmp_ne_u32 vcc, s96, v216
s_cbranch_vccnz chk_16
chk_16_r:
v_mfma_f32_16x16x32_bf16 v[68:71], a[220:223], a[244:247], v[68:71]
s_waitcnt lgkmcnt(5)
ds_read_b128 a[164:167], v113 offset:28672
buffer_load_dword v98, v101, s[20:23], 0 offen sc1
v_mfma_f32_16x16x32_bf16 v[48:51], a[128:131], a[144:147], v[48:51]
buffer_load_dwordx4 v[232:235], v200, s[20:23], s38 offen offset:0 sc1
buffer_load_dwordx4 v[236:239], v200, s[20:23], s38 offen offset:1024 sc1
v_mfma_f32_16x16x32_bf16 v[60:63], a[136:139], a[144:147], v[60:63]
ds_read_b128 a[208:211], v207 offset:0
buffer_load_dwordx4 v[240:243], v200, s[20:23], s38 offen offset:2048 sc1
v_mfma_f32_16x16x32_bf16 v[52:55], a[128:131], a[148:151], v[52:55]
ds_read_b128 a[216:219], v207 offset:2048
buffer_load_dwordx4 v[244:247], v200, s[20:23], s39 offen offset:0 sc1
v_mfma_f32_16x16x32_bf16 v[64:67], a[136:139], a[148:151], v[64:67]
s_waitcnt lgkmcnt(3)
ds_read_b128 a[224:227], v112 offset:0
buffer_load_dwordx4 v[248:251], v200, s[20:23], s39 offen offset:1024 sc1
v_mfma_f32_16x16x32_bf16 v[56:59], a[128:131], a[152:155], v[56:59]
ds_read_b128 a[228:231], v112 offset:1024
buffer_load_dwordx4 v[252:255], v200, s[20:23], s39 offen offset:2048 sc1
v_mfma_f32_16x16x32_bf16 v[68:71], a[136:139], a[152:155], v[68:71]
ds_read_b128 a[232:235], v112 offset:2048
ds_read_b128 a[212:215], v207 offset:1024
v_mfma_f32_16x16x32_bf16 v[48:51], a[132:135], a[156:159], v[48:51]
ds_read_b128 a[220:223], v207 offset:3072
v_mfma_f32_16x16x32_bf16 v[60:63], a[140:143], a[156:159], v[60:63]
ds_read_b128 a[236:239], v112 offset:6144
v_mfma_f32_16x16x32_bf16 v[52:55], a[132:135], a[160:163], v[52:55]
ds_read_b128 a[240:243], v112 offset:7168
v_mfma_f32_16x16x32_bf16 v[64:67], a[140:143], a[160:163], v[64:67]
s_waitcnt lgkmcnt(8)
ds_read_b128 a[244:247], v112 offset:8192
v_mfma_f32_16x16x32_bf16 v[56:59], a[132:135], a[164:167], v[56:59]
v_mfma_f32_16x16x32_bf16 v[68:71], a[140:143], a[164:167], v[68:71]
v_mfma_f32_16x16x32_bf16 v[0:3], a[108:111], v[76:79], 0
v_mfma_f32_16x16x32_bf16 v[4:7], a[112:115], v[80:83], 0
v_mfma_f32_16x16x32_bf16 v[8:11], a[116:119], v[84:87], 0
v_mfma_f32_16x16x32_bf16 v[12:15], a[196:199], v[76:79], 0
s_nop 4
v_cvt_pk_bf16_f32 v0, 0, v0
v_mfma_f32_16x16x32_bf16 v[16:19], a[200:203], v[80:83], 0
v_cvt_pk_bf16_f32 v1, 0, v1
v_cvt_pk_bf16_f32 v2, 0, v2
v_mfma_f32_16x16x32_bf16 v[20:23], a[204:207], v[84:87], 0
v_cvt_pk_bf16_f32 v3, 0, v3
v_cvt_pk_bf16_f32 v4, 0, v4
v_mfma_f32_16x16x32_bf16 v[24:27], a[28:31], v[72:75], 0
v_cvt_pk_bf16_f32 v5, 0, v5
v_cvt_pk_bf16_f32 v6, 0, v6
v_mfma_f32_16x16x32_bf16 v[28:31], a[32:35], v[72:75], 0
v_cvt_pk_bf16_f32 v7, 0, v7
v_cvt_pk_bf16_f32 v8, 0, v8
v_mfma_f32_16x16x32_bf16 v[32:35], a[36:39], v[72:75], 0
v_cvt_pk_bf16_f32 v9, 0, v9
v_cvt_pk_bf16_f32 v10, 0, v10
v_mfma_f32_16x16x32_bf16 v[36:39], a[68:71], v[72:75], 0
v_cvt_pk_bf16_f32 v11, 0, v11
v_cvt_pk_bf16_f32 v12, 0, v12
v_mfma_f32_16x16x32_bf16 v[40:43], a[72:75], v[72:75], 0
v_cvt_pk_bf16_f32 v13, 0, v13
v_cvt_pk_bf16_f32 v14, 0, v14
v_mfma_f32_16x16x32_bf16 v[44:47], a[76:79], v[72:75], 0
s_waitcnt lgkmcnt(0)
v_cvt_pk_bf16_f32 v15, 0, v15
v_cvt_pk_bf16_f32 v16, 0, v16
v_mfma_f32_16x16x32_bf16 v[48:51], a[208:211], a[224:227], v[48:51]
s_waitcnt vmcnt(6)
v_cmp_ne_u32 vcc, s96, v98
v_cvt_pk_bf16_f32 v17, 0, v17
v_mfma_f32_16x16x32_bf16 v[60:63], a[216:219], a[224:227], v[60:63]
s_bitcmp0_b32 vcc_lo, 1
s_cselect_b32 s33, s40, 1073741824
s_bitcmp0_b32 vcc_lo, 3
s_cselect_b32 s34, s41, 1073741824
s_bitcmp0_b32 vcc_lo, 2
s_cselect_b32 s35, s42, 1073741824
v_mfma_f32_16x16x32_bf16 v[52:55], a[208:211], a[228:231], v[52:55]
buffer_load_dwordx4 v[152:155], v200, s[20:23], s33 offen offset:0 sc1 nt
v_cvt_pk_bf16_f32 v18, 0, v18
v_mfma_f32_16x16x32_bf16 v[64:67], a[216:219], a[228:231], v[64:67]
buffer_load_dwordx4 v[164:167], v200, s[20:23], s34 offen offset:0 sc1 nt
v_cvt_pk_bf16_f32 v19, 0, v19
v_mfma_f32_16x16x32_bf16 v[56:59], a[208:211], a[232:235], v[56:59]
buffer_load_dwordx4 v[176:179], v200, s[20:23], s35 offen offset:0 sc1 nt
v_cvt_pk_bf16_f32 v20, 0, v20
v_mfma_f32_16x16x32_bf16 v[68:71], a[216:219], a[232:235], v[68:71]
buffer_load_dwordx4 v[156:159], v200, s[20:23], s33 offen offset:1024 sc1 nt
v_cvt_pk_bf16_f32 v21, 0, v21
v_mfma_f32_16x16x32_bf16 v[48:51], a[212:215], a[236:239], v[48:51]
buffer_load_dwordx4 v[168:171], v200, s[20:23], s34 offen offset:1024 sc1 nt
v_cvt_pk_bf16_f32 v22, 0, v22
v_mfma_f32_16x16x32_bf16 v[60:63], a[220:223], a[236:239], v[60:63]
buffer_load_dwordx4 v[180:183], v200, s[20:23], s35 offen offset:1024 sc1 nt
v_cvt_pk_bf16_f32 v23, 0, v23
v_mfma_f32_16x16x32_bf16 v[52:55], a[212:215], a[240:243], v[52:55]
buffer_load_dwordx4 v[160:163], v200, s[20:23], s33 offen offset:2048 sc1 nt
v_mfma_f32_16x16x32_bf16 v[64:67], a[220:223], a[240:243], v[64:67]
buffer_load_dwordx4 v[172:175], v200, s[20:23], s34 offen offset:2048 sc1 nt
v_mfma_f32_16x16x32_bf16 v[56:59], a[212:215], a[244:247], v[56:59]
buffer_load_dwordx4 v[184:187], v200, s[20:23], s35 offen offset:2048 sc1 nt
v_mfma_f32_16x16x32_bf16 v[68:71], a[220:223], a[244:247], v[68:71]
s_mov_b32 s6, 3216550459
s_mov_b32 s7, s6
s_waitcnt vmcnt(9)
v_pk_add_f32 v[232:233], v[232:233], v[0:1]
v_pk_add_f32 v[234:235], v[234:235], v[2:3]
v_pk_add_f32 v[244:245], v[244:245], v[12:13]
v_pk_add_f32 v[246:247], v[246:247], v[14:15]
v_pk_add_f32 v[236:237], v[236:237], v[4:5]
v_pk_add_f32 v[238:239], v[238:239], v[6:7]
v_pk_add_f32 v[248:249], v[248:249], v[16:17]
v_pk_add_f32 v[250:251], v[250:251], v[18:19]
v_pk_add_f32 v[240:241], v[240:241], v[8:9]
v_pk_add_f32 v[242:243], v[242:243], v[10:11]
v_pk_add_f32 v[252:253], v[252:253], v[20:21]
v_pk_add_f32 v[254:255], v[254:255], v[22:23]
s_or_b32 s18, s33, s34
s_or_b32 s18, s18, s35
s_bitcmp1_b32 s18, 30
s_cbranch_scc1 P2g_w
P2g_r:
s_waitcnt vmcnt(6)
v_mfma_f32_16x16x32_bf16 v[128:131], v[116:119], v[152:155], v[128:131]
v_pk_add_f32 v[232:233], v[232:233], v[48:49]
v_pk_add_f32 v[234:235], v[234:235], v[50:51]
v_pk_add_f32 v[244:245], v[244:245], v[60:61]
v_mfma_f32_16x16x32_bf16 v[140:143], v[114:117], v[152:155], v[140:143]
v_pk_add_f32 v[246:247], v[246:247], v[62:63]
v_pk_add_f32 v[236:237], v[236:237], v[52:53]
v_pk_add_f32 v[238:239], v[238:239], v[54:55]
v_mfma_f32_16x16x32_bf16 v[128:131], v[116:119], v[164:167], v[128:131]
v_pk_add_f32 v[248:249], v[248:249], v[64:65]
v_pk_add_f32 v[250:251], v[250:251], v[66:67]
v_pk_add_f32 v[240:241], v[240:241], v[56:57]
v_mfma_f32_16x16x32_bf16 v[140:143], v[114:117], v[164:167], v[140:143]
v_pk_add_f32 v[242:243], v[242:243], v[58:59]
v_pk_add_f32 v[252:253], v[252:253], v[68:69]
v_pk_add_f32 v[254:255], v[254:255], v[70:71]
v_mfma_f32_16x16x32_bf16 v[128:131], v[116:119], v[176:179], v[128:131]
v_mfma_f32_16x16x32_bf16 v[140:143], v[114:117], v[176:179], v[140:143]
s_waitcnt vmcnt(3)
v_mfma_f32_16x16x32_bf16 v[132:135], v[116:119], v[156:159], v[132:135]
v_mfma_f32_16x16x32_bf16 v[144:147], v[114:117], v[156:159], v[144:147]
s_nop 3
v_cvt_pk_bf16_f32 v128, 0, v128
v_cvt_pk_bf16_f32 v129, 0, v129
v_mfma_f32_16x16x32_bf16 v[132:135], v[116:119], v[168:171], v[132:135]
v_cvt_pk_bf16_f32 v130, 0, v130
v_cvt_pk_bf16_f32 v131, 0, v131
v_pk_mul_f32 v[0:1], s[6:7], v[128:129]
v_mfma_f32_16x16x32_bf16 v[144:147], v[114:117], v[168:171], v[144:147]
v_pk_mul_f32 v[2:3], s[6:7], v[130:131]
v_exp_f32 v0, v0
v_exp_f32 v1, v1
v_mfma_f32_16x16x32_bf16 v[132:135], v[116:119], v[180:183], v[132:135]
v_exp_f32 v2, v2
v_exp_f32 v3, v3
v_pk_add_f32 v[0:1], 1.0, v[0:1] op_sel_hi:[0,1]
v_mfma_f32_16x16x32_bf16 v[144:147], v[114:117], v[180:183], v[144:147]
T_b_4:
s_cbranch_execz T_r2
s_waitcnt vmcnt(0)
v_pk_add_f32 v[2:3], 1.0, v[2:3] op_sel_hi:[0,1]
v_rcp_f32 v0, v0
v_rcp_f32 v1, v1
v_mfma_f32_16x16x32_bf16 v[136:139], v[116:119], v[160:163], v[136:139]
v_rcp_f32 v2, v2
v_rcp_f32 v3, v3
v_pk_mul_f32 v[128:129], v[128:129], v[0:1]
v_mfma_f32_16x16x32_bf16 v[148:151], v[114:117], v[160:163], v[148:151]
v_pk_mul_f32 v[130:131], v[130:131], v[2:3]
v_cvt_pk_bf16_f32 v128, 0, v128
v_cvt_pk_bf16_f32 v129, 0, v129
v_mfma_f32_16x16x32_bf16 v[136:139], v[116:119], v[172:175], v[136:139]
v_cvt_pk_bf16_f32 v130, 0, v130
v_cvt_pk_bf16_f32 v131, 0, v131
v_pk_fma_f32 v[232:233], v[232:233], v[128:129], v[24:25]
v_mfma_f32_16x16x32_bf16 v[148:151], v[114:117], v[172:175], v[148:151]
v_pk_fma_f32 v[234:235], v[234:235], v[130:131], v[26:27]
buffer_store_dword v232, v126, s[80:83], 0 offen offset:0 sc1 nt
buffer_store_dword v233, v126, s[80:83], 0 offen offset:2304 sc1 nt
v_mfma_f32_16x16x32_bf16 v[136:139], v[116:119], v[184:187], v[136:139]
buffer_store_dword v234, v126, s[80:83], s43 offen offset:0 sc1 nt
buffer_store_dword v235, v126, s[80:83], s43 offen offset:2304 sc1 nt
v_cvt_pk_bf16_f32 v140, 0, v140
v_mfma_f32_16x16x32_bf16 v[148:151], v[114:117], v[184:187], v[148:151]
v_cvt_pk_bf16_f32 v141, 0, v141
v_cvt_pk_bf16_f32 v142, 0, v142
v_cvt_pk_bf16_f32 v143, 0, v143
v_pk_mul_f32 v[12:13], s[6:7], v[140:141]
v_pk_mul_f32 v[14:15], s[6:7], v[142:143]
v_exp_f32 v12, v12
v_exp_f32 v13, v13
v_exp_f32 v14, v14
v_exp_f32 v15, v15
v_pk_add_f32 v[12:13], 1.0, v[12:13] op_sel_hi:[0,1]
v_pk_add_f32 v[14:15], 1.0, v[14:15] op_sel_hi:[0,1]
v_rcp_f32 v12, v12
v_rcp_f32 v13, v13
v_rcp_f32 v14, v14
v_rcp_f32 v15, v15
v_pk_mul_f32 v[140:141], v[140:141], v[12:13]
v_pk_mul_f32 v[142:143], v[142:143], v[14:15]
v_cvt_pk_bf16_f32 v140, 0, v140
v_cvt_pk_bf16_f32 v141, 0, v141
v_cvt_pk_bf16_f32 v142, 0, v142
v_cvt_pk_bf16_f32 v143, 0, v143
v_pk_fma_f32 v[244:245], v[244:245], v[140:141], v[36:37]
v_pk_fma_f32 v[246:247], v[246:247], v[142:143], v[38:39]
buffer_store_dword v244, v126, s[80:83], s44 offen offset:0 sc1 nt
buffer_store_dword v245, v126, s[80:83], s44 offen offset:2304 sc1 nt
buffer_store_dword v246, v126, s[80:83], s46 offen offset:0 sc1 nt
buffer_store_dword v247, v126, s[80:83], s46 offen offset:2304 sc1 nt
v_cvt_pk_bf16_f32 v132, 0, v132
v_cvt_pk_bf16_f32 v133, 0, v133
v_cvt_pk_bf16_f32 v134, 0, v134
v_cvt_pk_bf16_f32 v135, 0, v135
v_pk_mul_f32 v[4:5], s[6:7], v[132:133]
v_pk_mul_f32 v[6:7], s[6:7], v[134:135]
v_exp_f32 v4, v4
v_exp_f32 v5, v5
v_exp_f32 v6, v6
v_exp_f32 v7, v7
v_pk_add_f32 v[4:5], 1.0, v[4:5] op_sel_hi:[0,1]
v_pk_add_f32 v[6:7], 1.0, v[6:7] op_sel_hi:[0,1]
v_rcp_f32 v4, v4
v_rcp_f32 v5, v5
v_rcp_f32 v6, v6
v_rcp_f32 v7, v7
v_pk_mul_f32 v[132:133], v[132:133], v[4:5]
v_pk_mul_f32 v[134:135], v[134:135], v[6:7]
v_cvt_pk_bf16_f32 v132, 0, v132
v_cvt_pk_bf16_f32 v133, 0, v133
v_cvt_pk_bf16_f32 v134, 0, v134
v_cvt_pk_bf16_f32 v135, 0, v135
v_pk_fma_f32 v[236:237], v[236:237], v[132:133], v[28:29]
v_pk_fma_f32 v[238:239], v[238:239], v[134:135], v[30:31]
buffer_store_dword v236, v126, s[80:83], 0 offen offset:256 sc1 nt
buffer_store_dword v237, v126, s[80:83], 0 offen offset:2560 sc1 nt
buffer_store_dword v238, v126, s[80:83], s43 offen offset:256 sc1 nt
buffer_store_dword v239, v126, s[80:83], s43 offen offset:2560 sc1 nt
v_cvt_pk_bf16_f32 v144, 0, v144
v_cvt_pk_bf16_f32 v145, 0, v145
v_cvt_pk_bf16_f32 v146, 0, v146
v_cvt_pk_bf16_f32 v147, 0, v147
v_pk_mul_f32 v[16:17], s[6:7], v[144:145]
v_pk_mul_f32 v[18:19], s[6:7], v[146:147]
v_exp_f32 v16, v16
v_exp_f32 v17, v17
v_exp_f32 v18, v18
v_exp_f32 v19, v19
v_pk_add_f32 v[16:17], 1.0, v[16:17] op_sel_hi:[0,1]
v_pk_add_f32 v[18:19], 1.0, v[18:19] op_sel_hi:[0,1]
v_rcp_f32 v16, v16
v_rcp_f32 v17, v17
v_rcp_f32 v18, v18
v_rcp_f32 v19, v19
v_pk_mul_f32 v[144:145], v[144:145], v[16:17]
v_pk_mul_f32 v[146:147], v[146:147], v[18:19]
v_cvt_pk_bf16_f32 v144, 0, v144
v_cvt_pk_bf16_f32 v145, 0, v145
v_cvt_pk_bf16_f32 v146, 0, v146
v_cvt_pk_bf16_f32 v147, 0, v147
v_pk_fma_f32 v[248:249], v[248:249], v[144:145], v[40:41]
v_pk_fma_f32 v[250:251], v[250:251], v[146:147], v[42:43]
buffer_store_dword v248, v126, s[80:83], s44 offen offset:256 sc1 nt
buffer_store_dword v249, v126, s[80:83], s44 offen offset:2560 sc1 nt
buffer_store_dword v250, v126, s[80:83], s46 offen offset:256 sc1 nt
buffer_store_dword v251, v126, s[80:83], s46 offen offset:2560 sc1 nt
v_cvt_pk_bf16_f32 v136, 0, v136
v_cvt_pk_bf16_f32 v137, 0, v137
v_cvt_pk_bf16_f32 v138, 0, v138
v_cvt_pk_bf16_f32 v139, 0, v139
v_pk_mul_f32 v[8:9], s[6:7], v[136:137]
v_pk_mul_f32 v[10:11], s[6:7], v[138:139]
v_exp_f32 v8, v8
v_exp_f32 v9, v9
v_exp_f32 v10, v10
v_exp_f32 v11, v11
v_pk_add_f32 v[8:9], 1.0, v[8:9] op_sel_hi:[0,1]
v_pk_add_f32 v[10:11], 1.0, v[10:11] op_sel_hi:[0,1]
v_rcp_f32 v8, v8
v_rcp_f32 v9, v9
v_rcp_f32 v10, v10
v_rcp_f32 v11, v11
v_pk_mul_f32 v[136:137], v[136:137], v[8:9]
v_pk_mul_f32 v[138:139], v[138:139], v[10:11]
v_cvt_pk_bf16_f32 v136, 0, v136
v_cvt_pk_bf16_f32 v137, 0, v137
v_cvt_pk_bf16_f32 v138, 0, v138
v_cvt_pk_bf16_f32 v139, 0, v139
v_pk_fma_f32 v[240:241], v[240:241], v[136:137], v[32:33]
v_pk_fma_f32 v[242:243], v[242:243], v[138:139], v[34:35]
buffer_store_dword v240, v126, s[80:83], 0 offen offset:512 sc1 nt
buffer_store_dword v241, v126, s[80:83], 0 offen offset:2816 sc1 nt
buffer_store_dword v242, v126, s[80:83], s43 offen offset:512 sc1 nt
buffer_store_dword v243, v126, s[80:83], s43 offen offset:2816 sc1 nt
v_cvt_pk_bf16_f32 v148, 0, v148
v_cvt_pk_bf16_f32 v149, 0, v149
v_cvt_pk_bf16_f32 v150, 0, v150
v_cvt_pk_bf16_f32 v151, 0, v151
v_pk_mul_f32 v[20:21], s[6:7], v[148:149]
v_pk_mul_f32 v[22:23], s[6:7], v[150:151]
v_exp_f32 v20, v20
v_exp_f32 v21, v21
v_exp_f32 v22, v22
v_exp_f32 v23, v23
v_pk_add_f32 v[20:21], 1.0, v[20:21] op_sel_hi:[0,1]
v_pk_add_f32 v[22:23], 1.0, v[22:23] op_sel_hi:[0,1]
v_rcp_f32 v20, v20
v_rcp_f32 v21, v21
v_rcp_f32 v22, v22
v_rcp_f32 v23, v23
v_pk_mul_f32 v[148:149], v[148:149], v[20:21]
v_pk_mul_f32 v[150:151], v[150:151], v[22:23]
v_cvt_pk_bf16_f32 v148, 0, v148
v_cvt_pk_bf16_f32 v149, 0, v149
v_cvt_pk_bf16_f32 v150, 0, v150
v_cvt_pk_bf16_f32 v151, 0, v151
v_pk_fma_f32 v[252:253], v[252:253], v[148:149], v[44:45]
v_pk_fma_f32 v[254:255], v[254:255], v[150:151], v[46:47]
buffer_store_dword v252, v126, s[80:83], s44 offen offset:512 sc1 nt
buffer_store_dword v253, v126, s[80:83], s44 offen offset:2816 sc1 nt
buffer_store_dword v254, v126, s[80:83], s46 offen offset:512 sc1 nt
buffer_store_dword v255, v126, s[80:83], s46 offen offset:2816 sc1 nt
s_endpgm
P2g_e:
lb_6:
s_mov_b32 s97, 0
spoll_7:
buffer_load_dwordx4 v[184:187], v180, s[20:23], s37 offen sc1
buffer_load_dwordx4 v[188:191], v181, s[20:23], s37 offen sc1
buffer_load_dwordx4 v[192:195], v182, s[20:23], s37 offen sc1
buffer_load_dwordx4 v[196:199], v183, s[20:23], s37 offen sc1
s_waitcnt vmcnt(0)
v_xor_b32 v160, v185, v172
v_xor_b32 v161, v187, v172
v_or_b32 v160, v160, v161
v_xor_b32 v161, v189, v173
v_xor_b32 v162, v191, v173
v_or3_b32 v160, v160, v161, v162
v_xor_b32 v161, v193, v174
v_xor_b32 v162, v195, v174
v_or3_b32 v160, v160, v161, v162
v_xor_b32 v161, v197, v175
v_xor_b32 v162, v199, v175
v_or3_b32 v160, v160, v161, v162
v_cmp_ne_u32 vcc, 0, v160
s_add_u32 s97, s97, 1
s_cmp_ge_u32 s97, 32768
s_cbranch_scc1 spoll_7_x
s_cbranch_vccnz spoll_7
spoll_7_x:
s_branch lb_6_r
chk_8:
s_mov_b32 s97, 0
poll_9:
buffer_load_dword v216, v215, s[20:23], s68 offen offset:36 sc1
s_waitcnt vmcnt(0)
v_cmp_ne_u32 vcc, s96, v216
s_add_u32 s97, s97, 1
s_cmp_ge_u32 s97, 32768
s_cbranch_scc1 poll_9_x
s_cbranch_vccnz poll_9
poll_9_x:
s_branch chk_8_r
chk_10:
s_mov_b32 s97, 0
poll_11:
buffer_load_dword v216, v203, s[20:23], s68 offen offset:8 sc1
s_waitcnt vmcnt(0)
v_cmp_ne_u32 vcc, s96, v216
s_add_u32 s97, s97, 1
s_cmp_ge_u32 s97, 32768
s_cbranch_scc1 poll_11_x
s_cbranch_vccnz poll_11
poll_11_x:
s_branch chk_10_r
chk_12:
s_mov_b32 s97, 0
poll_13:
buffer_load_dword v216, v212, s[20:23], 0 offen offset:0 sc1
s_waitcnt vmcnt(0)
v_cmp_ne_u32 vcc, s96, v216
s_add_u32 s97, s97, 1
s_cmp_ge_u32 s97, 32768
s_cbranch_scc1 poll_13_x
s_cbranch_vccnz poll_13
poll_13_x:
s_branch chk_12_r
chk_14:
s_mov_b32 s97, 0
poll_15:
buffer_load_dword v216, v213, s[20:23], 0 offen offset:0 sc1
s_waitcnt vmcnt(0)
v_cmp_ne_u32 vcc, s96, v216
s_add_u32 s97, s97, 1
s_cmp_ge_u32 s97, 32768
s_cbranch_scc1 poll_15_x
s_cbranch_vccnz poll_15
poll_15_x:
s_branch chk_14_r
chk_16:
s_mov_b32 s97, 0
poll_17:
buffer_load_dword v216, v102, s[20:23], 0 offen offset:0 sc1
s_waitcnt vmcnt(0)
v_cmp_ne_u32 vcc, s96, v216
s_add_u32 s97, s97, 1
s_cmp_ge_u32 s97, 32768
s_cbranch_scc1 poll_17_x
s_cbranch_vccnz poll_17
poll_17_x:
s_branch chk_16_r
P2g_w:
s_mov_b32 s97, 0
P2g_l:
buffer_load_dword v98, v101, s[20:23], 0 offen sc1
s_add_u32 s97, s97, 1
s_waitcnt vmcnt(0)
v_cmp_ne_u32 vcc, s96, v98
s_cmp_ge_u32 s97, 32768
s_cbranch_scc1 P2g_x
s_bitcmp1_b32 vcc_lo, 1
s_cbranch_scc1 P2g_n0
s_cmp_eq_u32 s33, s40
s_cbranch_scc1 P2g_n0
s_mov_b32 s33, s40
buffer_load_dwordx4 v[152:155], v200, s[20:23], s33 offen offset:0 sc1 nt
buffer_load_dwordx4 v[156:159], v200, s[20:23], s33 offen offset:1024 sc1 nt
buffer_load_dwordx4 v[160:163], v200, s[20:23], s33 offen offset:2048 sc1 nt
P2g_n0:
s_bitcmp1_b32 vcc_lo, 3
s_cbranch_scc1 P2g_n1
s_cmp_eq_u32 s34, s41
s_cbranch_scc1 P2g_n1
s_mov_b32 s34, s41
buffer_load_dwordx4 v[164:167], v200, s[20:23], s34 offen offset:0 sc1 nt
buffer_load_dwordx4 v[168:171], v200, s[20:23], s34 offen offset:1024 sc1 nt
buffer_load_dwordx4 v[172:175], v200, s[20:23], s34 offen offset:2048 sc1 nt
P2g_n1:
s_bitcmp1_b32 vcc_lo, 2
s_cbranch_scc1 P2g_n2
s_cmp_eq_u32 s35, s42
s_cbranch_scc1 P2g_n2
s_mov_b32 s35, s42
buffer_load_dwordx4 v[176:179], v200, s[20:23], s35 offen offset:0 sc1 nt
buffer_load_dwordx4 v[180:183], v200, s[20:23], s35 offen offset:1024 sc1 nt
buffer_load_dwordx4 v[184:187], v200, s[20:23], s35 offen offset:2048 sc1 nt
P2g_n2:
s_or_b32 s18, s33, s34
s_or_b32 s18, s18, s35
s_bitcmp1_b32 s18, 30
s_cbranch_scc1 P2g_l
P2g_x:
s_waitcnt vmcnt(0)
s_branch P2g_r
P2_other:
T_c_0:
s_cbranch_execz T_r0
s_waitcnt lgkmcnt(0)
v_lshrrev_b32 v213, 4, v200
s_cmp_ge_u32 s13, 30
s_cbranch_scc1 P2_left
s_mov_b32 s67, s69
v_min_u32 v222, 25, v213
v_lshlrev_b32 v222, 7, v222
buffer_load_dword v223, v222, s[20:23], s68 offen offset:44 sc1
s_add_u32 m0, s93, 151552
s_nop 0
buffer_load_dwordx4 v219, s[76:79], s54 offen sc1 lds
buffer_load_dwordx4 v220, s[76:79], s54 offen offset:1024 sc1 lds
buffer_load_dwordx4 v221, s[76:79], s54 offen offset:2048 sc1 lds
s_add_u32 s54, s54, s71
s_mul_i32 s18, s16, 6144
s_add_u32 s18, s18, 8192
v_add_u32 v205, s18, v200
v_add_u32 v207, 61440, v204
v_add_u32 v206, 61440, v205
v_add_u32 v208, 122880, v204
v_add_u32 v201, 122880, v205
s_lshl_b32 s18, s64, 1
s_add_u32 s18, s18, s17
s_mul_i32 s18, s18, 144
s_lshl_b32 s19, s65, 1
s_add_u32 s19, s19, s16
s_mul_i32 s19, s19, 6
s_add_u32 s18, s18, s19
s_lshl_b32 s18, s18, 10
s_add_u32 s36, s18, 4718592
s_add_u32 s37, s36, 3072
v_accvgpr_read_b32 v196, a64
v_accvgpr_read_b32 v197, a65
v_accvgpr_read_b32 v198, a66
v_accvgpr_read_b32 v199, a67
v_mul_f32 v64, v196, v64
v_mul_f32 v65, v197, v65
v_mul_f32 v66, v198, v66
v_mul_f32 v67, v199, v67
v_accvgpr_read_b32 v196, a96
v_accvgpr_read_b32 v197, a97
v_accvgpr_read_b32 v198, a98
v_accvgpr_read_b32 v199, a99
v_mul_f32 v96, v196, v96
v_mul_f32 v97, v197, v97
v_mul_f32 v98, v198, v98
v_mul_f32 v99, v199, v99
v_cvt_pk_bf16_f32 v64, v64, v65
v_cvt_pk_bf16_f32 v65, v66, v67
v_cvt_pk_bf16_f32 v66, v96, v97
v_cvt_pk_bf16_f32 v67, v98, v99
v_accvgpr_read_b32 v196, a68
v_accvgpr_read_b32 v197, a69
v_accvgpr_read_b32 v198, a70
v_accvgpr_read_b32 v199, a71
v_mul_f32 v68, v196, v68
v_mul_f32 v69, v197, v69
v_mul_f32 v70, v198, v70
v_mul_f32 v71, v199, v71
v_accvgpr_read_b32 v196, a100
v_accvgpr_read_b32 v197, a101
v_accvgpr_read_b32 v198, a102
v_accvgpr_read_b32 v199, a103
v_mul_f32 v100, v196, v100
v_mul_f32 v101, v197, v101
v_mul_f32 v102, v198, v102
v_mul_f32 v103, v199, v103
v_cvt_pk_bf16_f32 v68, v68, v69
v_cvt_pk_bf16_f32 v69, v70, v71
v_cvt_pk_bf16_f32 v70, v100, v101
v_cvt_pk_bf16_f32 v71, v102, v103
v_accvgpr_read_b32 v196, a72
v_accvgpr_read_b32 v197, a73
v_accvgpr_read_b32 v198, a74
v_accvgpr_read_b32 v199, a75
v_mul_f32 v72, v196, v72
v_mul_f32 v73, v197, v73
v_mul_f32 v74, v198, v74
v_mul_f32 v75, v199, v75
v_accvgpr_read_b32 v196, a104
v_accvgpr_read_b32 v197, a105
v_accvgpr_read_b32 v198, a106
v_accvgpr_read_b32 v199, a107
v_mul_f32 v104, v196, v104
v_mul_f32 v105, v197, v105
v_mul_f32 v106, v198, v106
v_mul_f32 v107, v199, v107
v_cvt_pk_bf16_f32 v72, v72, v73
v_cvt_pk_bf16_f32 v73, v74, v75
v_cvt_pk_bf16_f32 v74, v104, v105
v_cvt_pk_bf16_f32 v75, v106, v107
v_accvgpr_read_b32 v196, a76
v_accvgpr_read_b32 v197, a77
v_accvgpr_read_b32 v198, a78
v_accvgpr_read_b32 v199, a79
v_mul_f32 v76, v196, v76
v_mul_f32 v77, v197, v77
v_mul_f32 v78, v198, v78
v_mul_f32 v79, v199, v79
v_accvgpr_read_b32 v196, a108
v_accvgpr_read_b32 v197, a109
v_accvgpr_read_b32 v198, a110
v_accvgpr_read_b32 v199, a111
v_mul_f32 v108, v196, v108
v_mul_f32 v109, v197, v109
v_mul_f32 v110, v198, v110
v_mul_f32 v111, v199, v111
v_cvt_pk_bf16_f32 v76, v76, v77
v_cvt_pk_bf16_f32 v77, v78, v79
v_cvt_pk_bf16_f32 v78, v108, v109
v_cvt_pk_bf16_f32 v79, v110, v111
v_accvgpr_read_b32 v196, a80
v_accvgpr_read_b32 v197, a81
v_accvgpr_read_b32 v198, a82
v_accvgpr_read_b32 v199, a83
v_mul_f32 v80, v196, v80
v_mul_f32 v81, v197, v81
v_mul_f32 v82, v198, v82
v_mul_f32 v83, v199, v83
v_accvgpr_read_b32 v196, a112
v_accvgpr_read_b32 v197, a113
v_accvgpr_read_b32 v198, a114
v_accvgpr_read_b32 v199, a115
v_mul_f32 v112, v196, v112
v_mul_f32 v113, v197, v113
v_mul_f32 v114, v198, v114
v_mul_f32 v115, v199, v115
v_cvt_pk_bf16_f32 v80, v80, v81
v_cvt_pk_bf16_f32 v81, v82, v83
v_cvt_pk_bf16_f32 v82, v112, v113
v_cvt_pk_bf16_f32 v83, v114, v115
v_accvgpr_read_b32 v196, a84
v_accvgpr_read_b32 v197, a85
v_accvgpr_read_b32 v198, a86
v_accvgpr_read_b32 v199, a87
v_mul_f32 v84, v196, v84
v_mul_f32 v85, v197, v85
v_mul_f32 v86, v198, v86
v_mul_f32 v87, v199, v87
v_accvgpr_read_b32 v196, a116
v_accvgpr_read_b32 v197, a117
v_accvgpr_read_b32 v198, a118
v_accvgpr_read_b32 v199, a119
v_mul_f32 v116, v196, v116
v_mul_f32 v117, v197, v117
v_mul_f32 v118, v198, v118
v_mul_f32 v119, v199, v119
v_cvt_pk_bf16_f32 v84, v84, v85
v_cvt_pk_bf16_f32 v85, v86, v87
v_cvt_pk_bf16_f32 v86, v116, v117
v_cvt_pk_bf16_f32 v87, v118, v119
s_waitcnt vmcnt(3)
v_cmp_ne_u32 vcc, s96, v223
s_cbranch_vccnz chk_18
chk_18_r:
s_add_u32 m0, s63, 0
s_nop 0
buffer_load_dwordx4 v200, s[20:23], s67 offen sc1 lds
buffer_load_dwordx4 v214, s[20:23], s67 offen offset:1024 sc1 lds
s_add_u32 s67, s67, s33
s_add_u32 m0, s63, 20480
s_nop 0
buffer_load_dwordx4 v200, s[20:23], s67 offen sc1 lds
buffer_load_dwordx4 v214, s[20:23], s67 offen offset:1024 sc1 lds
s_add_u32 s67, s67, s33
s_add_u32 m0, s63, 40960
s_nop 0
buffer_load_dwordx4 v200, s[20:23], s67 offen sc1 lds
buffer_load_dwordx4 v214, s[20:23], s67 offen offset:1024 sc1 lds
s_add_u32 s67, s67, s33
s_add_u32 m0, s63, 61440
s_nop 0
buffer_load_dwordx4 v200, s[20:23], s67 offen sc1 lds
buffer_load_dwordx4 v214, s[20:23], s67 offen offset:1024 sc1 lds
s_add_u32 s67, s67, s33
v_accvgpr_read_b32 v196, a88
v_accvgpr_read_b32 v197, a89
v_accvgpr_read_b32 v198, a90
v_accvgpr_read_b32 v199, a91
v_mul_f32 v88, v196, v88
v_mul_f32 v89, v197, v89
v_mul_f32 v90, v198, v90
v_mul_f32 v91, v199, v91
v_accvgpr_read_b32 v196, a120
v_accvgpr_read_b32 v197, a121
v_accvgpr_read_b32 v198, a122
v_accvgpr_read_b32 v199, a123
v_mul_f32 v120, v196, v120
v_mul_f32 v121, v197, v121
v_mul_f32 v122, v198, v122
v_mul_f32 v123, v199, v123
v_cvt_pk_bf16_f32 v88, v88, v89
v_cvt_pk_bf16_f32 v89, v90, v91
v_cvt_pk_bf16_f32 v90, v120, v121
v_cvt_pk_bf16_f32 v91, v122, v123
v_accvgpr_read_b32 v196, a92
v_accvgpr_read_b32 v197, a93
v_accvgpr_read_b32 v198, a94
v_accvgpr_read_b32 v199, a95
v_mul_f32 v92, v196, v92
v_mul_f32 v93, v197, v93
v_mul_f32 v94, v198, v94
v_mul_f32 v95, v199, v95
v_accvgpr_read_b32 v196, a124
v_accvgpr_read_b32 v197, a125
v_accvgpr_read_b32 v198, a126
v_accvgpr_read_b32 v199, a127
v_mul_f32 v124, v196, v124
v_mul_f32 v125, v197, v125
v_mul_f32 v126, v198, v126
v_mul_f32 v127, v199, v127
v_cvt_pk_bf16_f32 v92, v92, v93
v_cvt_pk_bf16_f32 v93, v94, v95
v_cvt_pk_bf16_f32 v94, v124, v125
v_cvt_pk_bf16_f32 v95, v126, v127
s_add_u32 m0, s63, 81920
s_nop 0
buffer_load_dwordx4 v200, s[20:23], s67 offen sc1 lds
buffer_load_dwordx4 v214, s[20:23], s67 offen offset:1024 sc1 lds
s_add_u32 s67, s67, s33
s_add_u32 m0, s63, 102400
s_nop 0
buffer_load_dwordx4 v200, s[20:23], s67 offen sc1 lds
buffer_load_dwordx4 v214, s[20:23], s67 offen offset:1024 sc1 lds
s_add_u32 s67, s67, s33
s_add_u32 m0, s63, 122880
s_nop 0
buffer_load_dwordx4 v200, s[20:23], s67 offen sc1 lds
buffer_load_dwordx4 v214, s[20:23], s67 offen offset:1024 sc1 lds
s_add_u32 s67, s67, s33
s_add_u32 m0, s63, 143360
s_nop 0
buffer_load_dwordx4 v200, s[20:23], s67 offen sc1 lds
buffer_load_dwordx4 v214, s[20:23], s67 offen offset:1024 sc1 lds
s_add_u32 s67, s67, s33
P2s_c:
s_waitcnt vmcnt(14)
s_barrier
ds_read_b128 a[0:3], v204 offset:0
ds_read_b128 a[4:7], v204 offset:1024
ds_read_b128 a[8:11], v204 offset:2048
ds_read_b128 a[12:15], v204 offset:3072
ds_read_b128 a[16:19], v205 offset:0
ds_read_b128 a[20:23], v205 offset:1024
ds_read_b128 a[24:27], v205 offset:2048
ds_read_b128 a[28:31], v205 offset:3072
ds_read_b128 a[32:35], v205 offset:4096
ds_read_b128 a[36:39], v205 offset:5120
s_waitcnt lgkmcnt(5)
v_mfma_f32_16x16x32_bf16 v[128:131], a[0:3], a[16:19], 0
v_mfma_f32_16x16x32_bf16 v[152:155], a[4:7], a[16:19], 0
v_mfma_f32_16x16x32_bf16 v[176:179], a[8:11], a[16:19], 0
s_waitcnt vmcnt(12) lgkmcnt(0)
s_barrier
ds_read_b128 a[40:43], v204 offset:20480
v_mfma_f32_16x16x32_bf16 v[232:235], a[12:15], a[16:19], 0
s_add_u32 m0, s93, 8192
ds_read_b128 a[44:47], v204 offset:21504
v_mfma_f32_16x16x32_bf16 v[132:135], a[0:3], a[20:23], 0
buffer_load_dwordx4 v219, s[76:79], s54 offen sc1 lds
v_mfma_f32_16x16x32_bf16 v[156:159], a[4:7], a[20:23], 0
ds_read_b128 a[48:51], v204 offset:22528
v_mfma_f32_16x16x32_bf16 v[180:183], a[8:11], a[20:23], 0
buffer_store_dwordx4 v[64:67], v200, s[20:23], s94 offen sc1
s_add_u32 s94, s94, 184320
v_mfma_f32_16x16x32_bf16 v[236:239], a[12:15], a[20:23], 0
ds_read_b128 a[52:55], v204 offset:23552
v_mfma_f32_16x16x32_bf16 v[136:139], a[0:3], a[24:27], 0
ds_read_b128 a[56:59], v205 offset:20480
buffer_load_dwordx4 v220, s[76:79], s54 offen offset:1024 sc1 lds
v_mfma_f32_16x16x32_bf16 v[160:163], a[4:7], a[24:27], 0
ds_read_b128 a[60:63], v205 offset:21504
v_mfma_f32_16x16x32_bf16 v[184:187], a[8:11], a[24:27], 0
buffer_store_dwordx4 v[68:71], v200, s[20:23], s94 offen sc1
s_add_u32 s94, s94, 184320
v_mfma_f32_16x16x32_bf16 v[240:243], a[12:15], a[24:27], 0
ds_read_b128 a[64:67], v205 offset:22528
v_mfma_f32_16x16x32_bf16 v[140:143], a[0:3], a[28:31], 0
ds_read_b128 a[68:71], v205 offset:23552
buffer_load_dwordx4 v221, s[76:79], s54 offen offset:2048 sc1 lds
v_mfma_f32_16x16x32_bf16 v[164:167], a[4:7], a[28:31], 0
s_add_u32 s54, s54, s71
v_mfma_f32_16x16x32_bf16 v[188:191], a[8:11], a[28:31], 0
buffer_store_dwordx4 v[72:75], v200, s[20:23], s94 offen sc1
s_add_u32 s94, s94, 184320
v_mfma_f32_16x16x32_bf16 v[244:247], a[12:15], a[28:31], 0
s_add_u32 m0, s63, 0
ds_read_b128 a[72:75], v205 offset:24576
ds_read_b128 a[76:79], v205 offset:25600
v_mfma_f32_16x16x32_bf16 v[144:147], a[0:3], a[32:35], 0
buffer_load_dwordx4 v200, s[20:23], s67 offen sc1 lds
v_mfma_f32_16x16x32_bf16 v[168:171], a[4:7], a[32:35], 0
v_mfma_f32_16x16x32_bf16 v[224:227], a[8:11], a[32:35], 0
buffer_store_dwordx4 v[76:79], v200, s[20:23], s94 offen sc1
s_add_u32 s94, s94, 184320
v_mfma_f32_16x16x32_bf16 v[248:251], a[12:15], a[32:35], 0
v_mfma_f32_16x16x32_bf16 v[148:151], a[0:3], a[36:39], 0
buffer_load_dwordx4 v214, s[20:23], s67 offen offset:1024 sc1 lds
s_add_u32 s67, s67, s33
v_mfma_f32_16x16x32_bf16 v[172:175], a[4:7], a[36:39], 0
v_mfma_f32_16x16x32_bf16 v[228:231], a[8:11], a[36:39], 0
v_mfma_f32_16x16x32_bf16 v[252:255], a[12:15], a[36:39], 0
s_waitcnt lgkmcnt(2)
v_mfma_f32_16x16x32_bf16 v[128:131], a[40:43], a[56:59], v[128:131]
v_mfma_f32_16x16x32_bf16 v[152:155], a[44:47], a[56:59], v[152:155]
v_mfma_f32_16x16x32_bf16 v[176:179], a[48:51], a[56:59], v[176:179]
s_waitcnt vmcnt(19) lgkmcnt(0)
s_barrier
ds_read_b128 a[0:3], v204 offset:40960
v_mfma_f32_16x16x32_bf16 v[232:235], a[52:55], a[56:59], v[232:235]
s_add_u32 m0, s93, 28672
ds_read_b128 a[4:7], v204 offset:41984
v_mfma_f32_16x16x32_bf16 v[132:135], a[40:43], a[60:63], v[132:135]
buffer_load_dwordx4 v219, s[76:79], s54 offen sc1 lds
v_mfma_f32_16x16x32_bf16 v[156:159], a[44:47], a[60:63], v[156:159]
ds_read_b128 a[8:11], v204 offset:43008
v_mfma_f32_16x16x32_bf16 v[180:183], a[48:51], a[60:63], v[180:183]
buffer_store_dwordx4 v[80:83], v200, s[20:23], s94 offen sc1
s_add_u32 s94, s94, 184320
v_mfma_f32_16x16x32_bf16 v[236:239], a[52:55], a[60:63], v[236:239]
ds_read_b128 a[12:15], v204 offset:44032
v_mfma_f32_16x16x32_bf16 v[136:139], a[40:43], a[64:67], v[136:139]
ds_read_b128 a[16:19], v205 offset:40960
buffer_load_dwordx4 v220, s[76:79], s54 offen offset:1024 sc1 lds
v_mfma_f32_16x16x32_bf16 v[160:163], a[44:47], a[64:67], v[160:163]
ds_read_b128 a[20:23], v205 offset:41984
v_mfma_f32_16x16x32_bf16 v[184:187], a[48:51], a[64:67], v[184:187]
buffer_store_dwordx4 v[84:87], v200, s[20:23], s94 offen sc1
s_add_u32 s94, s94, 184320
v_mfma_f32_16x16x32_bf16 v[240:243], a[52:55], a[64:67], v[240:243]
ds_read_b128 a[24:27], v205 offset:43008
v_mfma_f32_16x16x32_bf16 v[140:143], a[40:43], a[68:71], v[140:143]
ds_read_b128 a[28:31], v205 offset:44032
buffer_load_dwordx4 v221, s[76:79], s54 offen offset:2048 sc1 lds
v_mfma_f32_16x16x32_bf16 v[164:167], a[44:47], a[68:71], v[164:167]
s_add_u32 s54, s54, s71
v_mfma_f32_16x16x32_bf16 v[188:191], a[48:51], a[68:71], v[188:191]
buffer_store_dwordx4 v[88:91], v200, s[20:23], s94 offen sc1
s_add_u32 s94, s94, 184320
v_mfma_f32_16x16x32_bf16 v[244:247], a[52:55], a[68:71], v[244:247]
s_add_u32 m0, s63, 20480
ds_read_b128 a[32:35], v205 offset:45056
ds_read_b128 a[36:39], v205 offset:46080
v_mfma_f32_16x16x32_bf16 v[144:147], a[40:43], a[72:75], v[144:147]
buffer_load_dwordx4 v200, s[20:23], s67 offen sc1 lds
v_mfma_f32_16x16x32_bf16 v[168:171], a[44:47], a[72:75], v[168:171]
v_mfma_f32_16x16x32_bf16 v[224:227], a[48:51], a[72:75], v[224:227]
buffer_store_dwordx4 v[92:95], v200, s[20:23], s94 offen sc1
s_add_u32 s94, s94, 184320
v_mfma_f32_16x16x32_bf16 v[248:251], a[52:55], a[72:75], v[248:251]
v_mfma_f32_16x16x32_bf16 v[148:151], a[40:43], a[76:79], v[148:151]
buffer_load_dwordx4 v214, s[20:23], s67 offen offset:1024 sc1 lds
s_add_u32 s67, s67, s33
v_mfma_f32_16x16x32_bf16 v[172:175], a[44:47], a[76:79], v[172:175]
v_mfma_f32_16x16x32_bf16 v[228:231], a[48:51], a[76:79], v[228:231]
v_mfma_f32_16x16x32_bf16 v[252:255], a[52:55], a[76:79], v[252:255]
s_waitcnt lgkmcnt(2)
v_mfma_f32_16x16x32_bf16 v[128:131], a[0:3], a[16:19], v[128:131]
v_mfma_f32_16x16x32_bf16 v[152:155], a[4:7], a[16:19], v[152:155]
v_mfma_f32_16x16x32_bf16 v[176:179], a[8:11], a[16:19], v[176:179]
s_waitcnt vmcnt(26) lgkmcnt(0)
s_barrier
T_c_1:
s_cbranch_execz T_r0
ds_read_b128 a[40:43], v207 offset:0
v_mfma_f32_16x16x32_bf16 v[232:235], a[12:15], a[16:19], v[232:235]
s_add_u32 m0, s93, 49152
ds_read_b128 a[44:47], v207 offset:1024
v_mfma_f32_16x16x32_bf16 v[132:135], a[0:3], a[20:23], v[132:135]
buffer_load_dwordx4 v219, s[76:79], s54 offen sc1 lds
v_mfma_f32_16x16x32_bf16 v[156:159], a[4:7], a[20:23], v[156:159]
ds_read_b128 a[48:51], v207 offset:2048
v_mfma_f32_16x16x32_bf16 v[180:183], a[8:11], a[20:23], v[180:183]
ds_read_b128 a[52:55], v207 offset:3072
v_mfma_f32_16x16x32_bf16 v[236:239], a[12:15], a[20:23], v[236:239]
v_mfma_f32_16x16x32_bf16 v[136:139], a[0:3], a[24:27], v[136:139]
ds_read_b128 a[56:59], v206 offset:0
buffer_load_dwordx4 v220, s[76:79], s54 offen offset:1024 sc1 lds
v_mfma_f32_16x16x32_bf16 v[160:163], a[4:7], a[24:27], v[160:163]
ds_read_b128 a[60:63], v206 offset:1024
v_mfma_f32_16x16x32_bf16 v[184:187], a[8:11], a[24:27], v[184:187]
v_mfma_f32_16x16x32_bf16 v[240:243], a[12:15], a[24:27], v[240:243]
ds_read_b128 a[64:67], v206 offset:2048
v_mfma_f32_16x16x32_bf16 v[140:143], a[0:3], a[28:31], v[140:143]
ds_read_b128 a[68:71], v206 offset:3072
buffer_load_dwordx4 v221, s[76:79], s54 offen offset:2048 sc1 lds
v_mfma_f32_16x16x32_bf16 v[164:167], a[4:7], a[28:31], v[164:167]
s_add_u32 s54, s54, s71
v_mfma_f32_16x16x32_bf16 v[188:191], a[8:11], a[28:31], v[188:191]
ds_read_b128 a[72:75], v206 offset:4096
v_mfma_f32_16x16x32_bf16 v[244:247], a[12:15], a[28:31], v[244:247]
s_add_u32 m0, s63, 40960
ds_read_b128 a[76:79], v206 offset:5120
v_mfma_f32_16x16x32_bf16 v[144:147], a[0:3], a[32:35], v[144:147]
buffer_load_dwordx4 v200, s[20:23], s67 offen sc1 lds
v_mfma_f32_16x16x32_bf16 v[168:171], a[4:7], a[32:35], v[168:171]
v_mfma_f32_16x16x32_bf16 v[224:227], a[8:11], a[32:35], v[224:227]
v_mfma_f32_16x16x32_bf16 v[248:251], a[12:15], a[32:35], v[248:251]
v_mfma_f32_16x16x32_bf16 v[148:151], a[0:3], a[36:39], v[148:151]
buffer_load_dwordx4 v214, s[20:23], s67 offen offset:1024 sc1 lds
s_add_u32 s67, s67, s33
v_mfma_f32_16x16x32_bf16 v[172:175], a[4:7], a[36:39], v[172:175]
v_mfma_f32_16x16x32_bf16 v[228:231], a[8:11], a[36:39], v[228:231]
v_mfma_f32_16x16x32_bf16 v[252:255], a[12:15], a[36:39], v[252:255]
s_waitcnt lgkmcnt(3)
v_mfma_f32_16x16x32_bf16 v[128:131], a[40:43], a[56:59], v[128:131]
v_mfma_f32_16x16x32_bf16 v[152:155], a[44:47], a[56:59], v[152:155]
v_mfma_f32_16x16x32_bf16 v[176:179], a[48:51], a[56:59], v[176:179]
s_waitcnt vmcnt(29) lgkmcnt(0)
s_barrier
ds_read_b128 a[0:3], v207 offset:20480
v_mfma_f32_16x16x32_bf16 v[232:235], a[52:55], a[56:59], v[232:235]
s_add_u32 m0, s93, 69632
ds_read_b128 a[4:7], v207 offset:21504
v_mfma_f32_16x16x32_bf16 v[132:135], a[40:43], a[60:63], v[132:135]
buffer_load_dwordx4 v219, s[76:79], s54 offen sc1 lds
v_mfma_f32_16x16x32_bf16 v[156:159], a[44:47], a[60:63], v[156:159]
ds_read_b128 a[8:11], v207 offset:22528
v_mfma_f32_16x16x32_bf16 v[180:183], a[48:51], a[60:63], v[180:183]
ds_read_b128 a[12:15], v207 offset:23552
v_mfma_f32_16x16x32_bf16 v[236:239], a[52:55], a[60:63], v[236:239]
v_mfma_f32_16x16x32_bf16 v[136:139], a[40:43], a[64:67], v[136:139]
ds_read_b128 a[16:19], v206 offset:20480
buffer_load_dwordx4 v220, s[76:79], s54 offen offset:1024 sc1 lds
v_mfma_f32_16x16x32_bf16 v[160:163], a[44:47], a[64:67], v[160:163]
ds_read_b128 a[20:23], v206 offset:21504
v_mfma_f32_16x16x32_bf16 v[184:187], a[48:51], a[64:67], v[184:187]
v_mfma_f32_16x16x32_bf16 v[240:243], a[52:55], a[64:67], v[240:243]
ds_read_b128 a[24:27], v206 offset:22528
v_mfma_f32_16x16x32_bf16 v[140:143], a[40:43], a[68:71], v[140:143]
ds_read_b128 a[28:31], v206 offset:23552
buffer_load_dwordx4 v221, s[76:79], s54 offen offset:2048 sc1 lds
v_mfma_f32_16x16x32_bf16 v[164:167], a[44:47], a[68:71], v[164:167]
s_add_u32 s54, s54, s71
v_mfma_f32_16x16x32_bf16 v[188:191], a[48:51], a[68:71], v[188:191]
ds_read_b128 a[32:35], v206 offset:24576
v_mfma_f32_16x16x32_bf16 v[244:247], a[52:55], a[68:71], v[244:247]
s_add_u32 m0, s63, 61440
ds_read_b128 a[36:39], v206 offset:25600
v_mfma_f32_16x16x32_bf16 v[144:147], a[40:43], a[72:75], v[144:147]
buffer_load_dwordx4 v200, s[20:23], s67 offen sc1 lds
v_mfma_f32_16x16x32_bf16 v[168:171], a[44:47], a[72:75], v[168:171]
v_mfma_f32_16x16x32_bf16 v[224:227], a[48:51], a[72:75], v[224:227]
v_mfma_f32_16x16x32_bf16 v[248:251], a[52:55], a[72:75], v[248:251]
v_mfma_f32_16x16x32_bf16 v[148:151], a[40:43], a[76:79], v[148:151]
buffer_load_dwordx4 v214, s[20:23], s67 offen offset:1024 sc1 lds
s_add_u32 s67, s67, s33
v_mfma_f32_16x16x32_bf16 v[172:175], a[44:47], a[76:79], v[172:175]
v_mfma_f32_16x16x32_bf16 v[228:231], a[48:51], a[76:79], v[228:231]
v_mfma_f32_16x16x32_bf16 v[252:255], a[52:55], a[76:79], v[252:255]
s_waitcnt lgkmcnt(3)
v_mfma_f32_16x16x32_bf16 v[128:131], a[0:3], a[16:19], v[128:131]
v_mfma_f32_16x16x32_bf16 v[152:155], a[4:7], a[16:19], v[152:155]
v_mfma_f32_16x16x32_bf16 v[176:179], a[8:11], a[16:19], v[176:179]
s_waitcnt vmcnt(32) lgkmcnt(0)
s_barrier
ds_read_b128 a[40:43], v207 offset:40960
v_mfma_f32_16x16x32_bf16 v[232:235], a[12:15], a[16:19], v[232:235]
s_add_u32 m0, s93, 90112
ds_read_b128 a[44:47], v207 offset:41984
v_mfma_f32_16x16x32_bf16 v[132:135], a[0:3], a[20:23], v[132:135]
buffer_load_dwordx4 v219, s[76:79], s54 offen sc1 lds
v_mfma_f32_16x16x32_bf16 v[156:159], a[4:7], a[20:23], v[156:159]
ds_read_b128 a[48:51], v207 offset:43008
v_mfma_f32_16x16x32_bf16 v[180:183], a[8:11], a[20:23], v[180:183]
ds_read_b128 a[52:55], v207 offset:44032
v_mfma_f32_16x16x32_bf16 v[236:239], a[12:15], a[20:23], v[236:239]
v_mfma_f32_16x16x32_bf16 v[136:139], a[0:3], a[24:27], v[136:139]
ds_read_b128 a[56:59], v206 offset:40960
buffer_load_dwordx4 v220, s[76:79], s54 offen offset:1024 sc1 lds
v_mfma_f32_16x16x32_bf16 v[160:163], a[4:7], a[24:27], v[160:163]
ds_read_b128 a[60:63], v206 offset:41984
v_mfma_f32_16x16x32_bf16 v[184:187], a[8:11], a[24:27], v[184:187]
v_mfma_f32_16x16x32_bf16 v[240:243], a[12:15], a[24:27], v[240:243]
ds_read_b128 a[64:67], v206 offset:43008
v_mfma_f32_16x16x32_bf16 v[140:143], a[0:3], a[28:31], v[140:143]
ds_read_b128 a[68:71], v206 offset:44032
buffer_load_dwordx4 v221, s[76:79], s54 offen offset:2048 sc1 lds
v_mfma_f32_16x16x32_bf16 v[164:167], a[4:7], a[28:31], v[164:167]
s_add_u32 s54, s54, s71
v_mfma_f32_16x16x32_bf16 v[188:191], a[8:11], a[28:31], v[188:191]
ds_read_b128 a[72:75], v206 offset:45056
v_mfma_f32_16x16x32_bf16 v[244:247], a[12:15], a[28:31], v[244:247]
s_add_u32 m0, s63, 81920
ds_read_b128 a[76:79], v206 offset:46080
v_mfma_f32_16x16x32_bf16 v[144:147], a[0:3], a[32:35], v[144:147]
buffer_load_dwordx4 v200, s[20:23], s67 offen sc1 lds
v_mfma_f32_16x16x32_bf16 v[168:171], a[4:7], a[32:35], v[168:171]
v_mfma_f32_16x16x32_bf16 v[224:227], a[8:11], a[32:35], v[224:227]
v_mfma_f32_16x16x32_bf16 v[248:251], a[12:15], a[32:35], v[248:251]
v_mfma_f32_16x16x32_bf16 v[148:151], a[0:3], a[36:39], v[148:151]
buffer_load_dwordx4 v214, s[20:23], s67 offen offset:1024 sc1 lds
s_add_u32 s67, s67, s33
v_mfma_f32_16x16x32_bf16 v[172:175], a[4:7], a[36:39], v[172:175]
v_mfma_f32_16x16x32_bf16 v[228:231], a[8:11], a[36:39], v[228:231]
v_mfma_f32_16x16x32_bf16 v[252:255], a[12:15], a[36:39], v[252:255]
s_waitcnt lgkmcnt(3)
v_mfma_f32_16x16x32_bf16 v[128:131], a[40:43], a[56:59], v[128:131]
v_mfma_f32_16x16x32_bf16 v[152:155], a[44:47], a[56:59], v[152:155]
v_mfma_f32_16x16x32_bf16 v[176:179], a[48:51], a[56:59], v[176:179]
s_waitcnt vmcnt(35) lgkmcnt(0)
s_barrier
s_waitcnt vmcnt(16)
v_mfma_f32_16x16x32_bf16 v[232:235], a[52:55], a[56:59], v[232:235]
buffer_store_dword v218, v217, s[20:23], s45 offen offset:8 sc1
ds_read_b128 a[0:3], v208 offset:0
v_mfma_f32_16x16x32_bf16 v[132:135], a[40:43], a[60:63], v[132:135]
s_add_u32 m0, s93, 110592
ds_read_b128 a[4:7], v208 offset:1024
buffer_load_dwordx4 v219, s[76:79], s54 offen sc1 lds
v_mfma_f32_16x16x32_bf16 v[156:159], a[44:47], a[60:63], v[156:159]
ds_read_b128 a[8:11], v208 offset:2048
v_mfma_f32_16x16x32_bf16 v[180:183], a[48:51], a[60:63], v[180:183]
ds_read_b128 a[12:15], v208 offset:3072
v_mfma_f32_16x16x32_bf16 v[236:239], a[52:55], a[60:63], v[236:239]
v_mfma_f32_16x16x32_bf16 v[136:139], a[40:43], a[64:67], v[136:139]
ds_read_b128 a[16:19], v201 offset:0
buffer_load_dwordx4 v220, s[76:79], s54 offen offset:1024 sc1 lds
v_mfma_f32_16x16x32_bf16 v[160:163], a[44:47], a[64:67], v[160:163]
ds_read_b128 a[20:23], v201 offset:1024
v_mfma_f32_16x16x32_bf16 v[184:187], a[48:51], a[64:67], v[184:187]
v_mfma_f32_16x16x32_bf16 v[240:243], a[52:55], a[64:67], v[240:243]
ds_read_b128 a[24:27], v201 offset:2048
v_mfma_f32_16x16x32_bf16 v[140:143], a[40:43], a[68:71], v[140:143]
ds_read_b128 a[28:31], v201 offset:3072
buffer_load_dwordx4 v221, s[76:79], s54 offen offset:2048 sc1 lds
v_mfma_f32_16x16x32_bf16 v[164:167], a[44:47], a[68:71], v[164:167]
s_add_u32 s54, s54, s71
v_mfma_f32_16x16x32_bf16 v[188:191], a[48:51], a[68:71], v[188:191]
ds_read_b128 a[32:35], v201 offset:4096
v_mfma_f32_16x16x32_bf16 v[244:247], a[52:55], a[68:71], v[244:247]
s_add_u32 m0, s63, 102400
ds_read_b128 a[36:39], v201 offset:5120
v_mfma_f32_16x16x32_bf16 v[144:147], a[40:43], a[72:75], v[144:147]
buffer_load_dwordx4 v200, s[20:23], s67 offen sc1 lds
v_mfma_f32_16x16x32_bf16 v[168:171], a[44:47], a[72:75], v[168:171]
v_mfma_f32_16x16x32_bf16 v[224:227], a[48:51], a[72:75], v[224:227]
v_mfma_f32_16x16x32_bf16 v[248:251], a[52:55], a[72:75], v[248:251]
v_mfma_f32_16x16x32_bf16 v[148:151], a[40:43], a[76:79], v[148:151]
buffer_load_dwordx4 v214, s[20:23], s67 offen offset:1024 sc1 lds
s_add_u32 s67, s67, s33
v_mfma_f32_16x16x32_bf16 v[172:175], a[44:47], a[76:79], v[172:175]
v_mfma_f32_16x16x32_bf16 v[228:231], a[48:51], a[76:79], v[228:231]
v_mfma_f32_16x16x32_bf16 v[252:255], a[52:55], a[76:79], v[252:255]
s_waitcnt lgkmcnt(3)
v_mfma_f32_16x16x32_bf16 v[128:131], a[0:3], a[16:19], v[128:131]
v_mfma_f32_16x16x32_bf16 v[152:155], a[4:7], a[16:19], v[152:155]
v_mfma_f32_16x16x32_bf16 v[176:179], a[8:11], a[16:19], v[176:179]
s_waitcnt lgkmcnt(0)
s_barrier
ds_read_b128 a[40:43], v208 offset:20480
v_mfma_f32_16x16x32_bf16 v[232:235], a[12:15], a[16:19], v[232:235]
s_add_u32 m0, s93, 131072
ds_read_b128 a[44:47], v208 offset:21504
v_mfma_f32_16x16x32_bf16 v[132:135], a[0:3], a[20:23], v[132:135]
buffer_load_dwordx4 v219, s[76:79], s54 offen sc1 lds
v_mfma_f32_16x16x32_bf16 v[156:159], a[4:7], a[20:23], v[156:159]
ds_read_b128 a[48:51], v208 offset:22528
v_mfma_f32_16x16x32_bf16 v[180:183], a[8:11], a[20:23], v[180:183]
ds_read_b128 a[52:55], v208 offset:23552
v_mfma_f32_16x16x32_bf16 v[236:239], a[12:15], a[20:23], v[236:239]
v_mfma_f32_16x16x32_bf16 v[136:139], a[0:3], a[24:27], v[136:139]
ds_read_b128 a[56:59], v201 offset:20480
buffer_load_dwordx4 v220, s[76:79], s54 offen offset:1024 sc1 lds
v_mfma_f32_16x16x32_bf16 v[160:163], a[4:7], a[24:27], v[160:163]
ds_read_b128 a[60:63], v201 offset:21504
v_mfma_f32_16x16x32_bf16 v[184:187], a[8:11], a[24:27], v[184:187]
v_mfma_f32_16x16x32_bf16 v[240:243], a[12:15], a[24:27], v[240:243]
ds_read_b128 a[64:67], v201 offset:22528
v_mfma_f32_16x16x32_bf16 v[140:143], a[0:3], a[28:31], v[140:143]
ds_read_b128 a[68:71], v201 offset:23552
buffer_load_dwordx4 v221, s[76:79], s54 offen offset:2048 sc1 lds
v_mfma_f32_16x16x32_bf16 v[164:167], a[4:7], a[28:31], v[164:167]
s_add_u32 s54, s54, s71
v_mfma_f32_16x16x32_bf16 v[188:191], a[8:11], a[28:31], v[188:191]
ds_read_b128 a[72:75], v201 offset:24576
v_mfma_f32_16x16x32_bf16 v[244:247], a[12:15], a[28:31], v[244:247]
s_add_u32 m0, s63, 122880
ds_read_b128 a[76:79], v201 offset:25600
v_mfma_f32_16x16x32_bf16 v[144:147], a[0:3], a[32:35], v[144:147]
buffer_load_dwordx4 v200, s[20:23], s67 offen sc1 lds
v_mfma_f32_16x16x32_bf16 v[168:171], a[4:7], a[32:35], v[168:171]
v_mfma_f32_16x16x32_bf16 v[224:227], a[8:11], a[32:35], v[224:227]
v_mfma_f32_16x16x32_bf16 v[248:251], a[12:15], a[32:35], v[248:251]
v_mfma_f32_16x16x32_bf16 v[148:151], a[0:3], a[36:39], v[148:151]
buffer_load_dwordx4 v214, s[20:23], s67 offen offset:1024 sc1 lds
s_add_u32 s67, s67, s33
v_mfma_f32_16x16x32_bf16 v[172:175], a[4:7], a[36:39], v[172:175]
v_mfma_f32_16x16x32_bf16 v[228:231], a[8:11], a[36:39], v[228:231]
v_mfma_f32_16x16x32_bf16 v[252:255], a[12:15], a[36:39], v[252:255]
s_waitcnt lgkmcnt(3)
v_mfma_f32_16x16x32_bf16 v[128:131], a[40:43], a[56:59], v[128:131]
v_mfma_f32_16x16x32_bf16 v[152:155], a[44:47], a[56:59], v[152:155]
v_mfma_f32_16x16x32_bf16 v[176:179], a[48:51], a[56:59], v[176:179]
s_waitcnt lgkmcnt(0)
s_barrier
ds_read_b128 a[0:3], v204 offset:0
v_mfma_f32_16x16x32_bf16 v[232:235], a[52:55], a[56:59], v[232:235]
s_add_u32 m0, s93, 151552
ds_read_b128 a[4:7], v204 offset:1024
v_mfma_f32_16x16x32_bf16 v[132:135], a[40:43], a[60:63], v[132:135]
buffer_load_dwordx4 v219, s[76:79], s54 offen sc1 lds
v_mfma_f32_16x16x32_bf16 v[156:159], a[44:47], a[60:63], v[156:159]
ds_read_b128 a[8:11], v204 offset:2048
v_mfma_f32_16x16x32_bf16 v[180:183], a[48:51], a[60:63], v[180:183]
ds_read_b128 a[12:15], v204 offset:3072
v_mfma_f32_16x16x32_bf16 v[236:239], a[52:55], a[60:63], v[236:239]
v_mfma_f32_16x16x32_bf16 v[136:139], a[40:43], a[64:67], v[136:139]
ds_read_b128 a[16:19], v205 offset:0
buffer_load_dwordx4 v220, s[76:79], s54 offen offset:1024 sc1 lds
v_mfma_f32_16x16x32_bf16 v[160:163], a[44:47], a[64:67], v[160:163]
ds_read_b128 a[20:23], v205 offset:1024
v_mfma_f32_16x16x32_bf16 v[184:187], a[48:51], a[64:67], v[184:187]
v_mfma_f32_16x16x32_bf16 v[240:243], a[52:55], a[64:67], v[240:243]
ds_read_b128 a[24:27], v205 offset:2048
v_mfma_f32_16x16x32_bf16 v[140:143], a[40:43], a[68:71], v[140:143]
ds_read_b128 a[28:31], v205 offset:3072
buffer_load_dwordx4 v221, s[76:79], s54 offen offset:2048 sc1 lds
v_mfma_f32_16x16x32_bf16 v[164:167], a[44:47], a[68:71], v[164:167]
s_add_u32 s54, s54, s71
v_mfma_f32_16x16x32_bf16 v[188:191], a[48:51], a[68:71], v[188:191]
ds_read_b128 a[32:35], v205 offset:4096
v_mfma_f32_16x16x32_bf16 v[244:247], a[52:55], a[68:71], v[244:247]
s_add_u32 m0, s63, 143360
ds_read_b128 a[36:39], v205 offset:5120
v_mfma_f32_16x16x32_bf16 v[144:147], a[40:43], a[72:75], v[144:147]
buffer_load_dwordx4 v200, s[20:23], s67 offen sc1 lds
v_mfma_f32_16x16x32_bf16 v[168:171], a[44:47], a[72:75], v[168:171]
v_mfma_f32_16x16x32_bf16 v[224:227], a[48:51], a[72:75], v[224:227]
v_mfma_f32_16x16x32_bf16 v[248:251], a[52:55], a[72:75], v[248:251]
v_mfma_f32_16x16x32_bf16 v[148:151], a[40:43], a[76:79], v[148:151]
buffer_load_dwordx4 v214, s[20:23], s67 offen offset:1024 sc1 lds
s_add_u32 s67, s67, s33
v_mfma_f32_16x16x32_bf16 v[172:175], a[44:47], a[76:79], v[172:175]
v_mfma_f32_16x16x32_bf16 v[228:231], a[48:51], a[76:79], v[228:231]
v_mfma_f32_16x16x32_bf16 v[252:255], a[52:55], a[76:79], v[252:255]
s_waitcnt lgkmcnt(3)
v_mfma_f32_16x16x32_bf16 v[128:131], a[0:3], a[16:19], v[128:131]
v_mfma_f32_16x16x32_bf16 v[152:155], a[4:7], a[16:19], v[152:155]
v_mfma_f32_16x16x32_bf16 v[176:179], a[8:11], a[16:19], v[176:179]
s_waitcnt vmcnt(31) lgkmcnt(0)
s_barrier
ds_read_b128 a[40:43], v204 offset:20480
v_mfma_f32_16x16x32_bf16 v[232:235], a[12:15], a[16:19], v[232:235]
s_add_u32 m0, s93, 8192
ds_read_b128 a[44:47], v204 offset:21504
v_mfma_f32_16x16x32_bf16 v[132:135], a[0:3], a[20:23], v[132:135]
buffer_load_dwordx4 v219, s[76:79], s54 offen sc1 lds
v_mfma_f32_16x16x32_bf16 v[156:159], a[4:7], a[20:23], v[156:159]
ds_read_b128 a[48:51], v204 offset:22528
v_mfma_f32_16x16x32_bf16 v[180:183], a[8:11], a[20:23], v[180:183]
ds_read_b128 a[52:55], v204 offset:23552
v_mfma_f32_16x16x32_bf16 v[236:239], a[12:15], a[20:23], v[236:239]
v_mfma_f32_16x16x32_bf16 v[136:139], a[0:3], a[24:27], v[136:139]
ds_read_b128 a[56:59], v205 offset:20480
buffer_load_dwordx4 v220, s[76:79], s54 offen offset:1024 sc1 lds
v_mfma_f32_16x16x32_bf16 v[160:163], a[4:7], a[24:27], v[160:163]
ds_read_b128 a[60:63], v205 offset:21504
v_mfma_f32_16x16x32_bf16 v[184:187], a[8:11], a[24:27], v[184:187]
v_mfma_f32_16x16x32_bf16 v[240:243], a[12:15], a[24:27], v[240:243]
ds_read_b128 a[64:67], v205 offset:22528
v_mfma_f32_16x16x32_bf16 v[140:143], a[0:3], a[28:31], v[140:143]
ds_read_b128 a[68:71], v205 offset:23552
buffer_load_dwordx4 v221, s[76:79], s54 offen offset:2048 sc1 lds
v_mfma_f32_16x16x32_bf16 v[164:167], a[4:7], a[28:31], v[164:167]
s_add_u32 s54, s54, s71
v_mfma_f32_16x16x32_bf16 v[188:191], a[8:11], a[28:31], v[188:191]
ds_read_b128 a[72:75], v205 offset:24576
v_mfma_f32_16x16x32_bf16 v[244:247], a[12:15], a[28:31], v[244:247]
s_add_u32 m0, s63, 0
ds_read_b128 a[76:79], v205 offset:25600
v_mfma_f32_16x16x32_bf16 v[144:147], a[0:3], a[32:35], v[144:147]
buffer_load_dwordx4 v200, s[20:23], s67 offen sc1 lds
v_mfma_f32_16x16x32_bf16 v[168:171], a[4:7], a[32:35], v[168:171]
v_mfma_f32_16x16x32_bf16 v[224:227], a[8:11], a[32:35], v[224:227]
v_mfma_f32_16x16x32_bf16 v[248:251], a[12:15], a[32:35], v[248:251]
v_mfma_f32_16x16x32_bf16 v[148:151], a[0:3], a[36:39], v[148:151]
buffer_load_dwordx4 v214, s[20:23], s67 offen offset:1024 sc1 lds
s_add_u32 s67, s67, s33
v_mfma_f32_16x16x32_bf16 v[172:175], a[4:7], a[36:39], v[172:175]
v_mfma_f32_16x16x32_bf16 v[228:231], a[8:11], a[36:39], v[228:231]
v_mfma_f32_16x16x32_bf16 v[252:255], a[12:15], a[36:39], v[252:255]
s_waitcnt lgkmcnt(3)
v_mfma_f32_16x16x32_bf16 v[128:131], a[40:43], a[56:59], v[128:131]
v_mfma_f32_16x16x32_bf16 v[152:155], a[44:47], a[56:59], v[152:155]
v_mfma_f32_16x16x32_bf16 v[176:179], a[48:51], a[56:59], v[176:179]
s_waitcnt vmcnt(31) lgkmcnt(0)
s_barrier
ds_read_b128 a[0:3], v204 offset:40960
v_mfma_f32_16x16x32_bf16 v[232:235], a[52:55], a[56:59], v[232:235]
s_add_u32 m0, s93, 28672
ds_read_b128 a[4:7], v204 offset:41984
v_mfma_f32_16x16x32_bf16 v[132:135], a[40:43], a[60:63], v[132:135]
buffer_load_dwordx4 v219, s[76:79], s54 offen sc1 lds
v_mfma_f32_16x16x32_bf16 v[156:159], a[44:47], a[60:63], v[156:159]
ds_read_b128 a[8:11], v204 offset:43008
v_mfma_f32_16x16x32_bf16 v[180:183], a[48:51], a[60:63], v[180:183]
ds_read_b128 a[12:15], v204 offset:44032
v_mfma_f32_16x16x32_bf16 v[236:239], a[52:55], a[60:63], v[236:239]
v_mfma_f32_16x16x32_bf16 v[136:139], a[40:43], a[64:67], v[136:139]
ds_read_b128 a[16:19], v205 offset:40960
buffer_load_dwordx4 v220, s[76:79], s54 offen offset:1024 sc1 lds
v_mfma_f32_16x16x32_bf16 v[160:163], a[44:47], a[64:67], v[160:163]
ds_read_b128 a[20:23], v205 offset:41984
v_mfma_f32_16x16x32_bf16 v[184:187], a[48:51], a[64:67], v[184:187]
v_mfma_f32_16x16x32_bf16 v[240:243], a[52:55], a[64:67], v[240:243]
ds_read_b128 a[24:27], v205 offset:43008
v_mfma_f32_16x16x32_bf16 v[140:143], a[40:43], a[68:71], v[140:143]
ds_read_b128 a[28:31], v205 offset:44032
buffer_load_dwordx4 v221, s[76:79], s54 offen offset:2048 sc1 lds
v_mfma_f32_16x16x32_bf16 v[164:167], a[44:47], a[68:71], v[164:167]
s_add_u32 s54, s54, s71
v_mfma_f32_16x16x32_bf16 v[188:191], a[48:51], a[68:71], v[188:191]
ds_read_b128 a[32:35], v205 offset:45056
v_mfma_f32_16x16x32_bf16 v[244:247], a[52:55], a[68:71], v[244:247]
s_add_u32 m0, s63, 20480
ds_read_b128 a[36:39], v205 offset:46080
v_mfma_f32_16x16x32_bf16 v[144:147], a[40:43], a[72:75], v[144:147]
buffer_load_dwordx4 v200, s[20:23], s67 offen sc1 lds
v_mfma_f32_16x16x32_bf16 v[168:171], a[44:47], a[72:75], v[168:171]
v_mfma_f32_16x16x32_bf16 v[224:227], a[48:51], a[72:75], v[224:227]
v_mfma_f32_16x16x32_bf16 v[248:251], a[52:55], a[72:75], v[248:251]
v_mfma_f32_16x16x32_bf16 v[148:151], a[40:43], a[76:79], v[148:151]
buffer_load_dwordx4 v214, s[20:23], s67 offen offset:1024 sc1 lds
s_add_u32 s67, s67, s33
v_mfma_f32_16x16x32_bf16 v[172:175], a[44:47], a[76:79], v[172:175]
v_mfma_f32_16x16x32_bf16 v[228:231], a[48:51], a[76:79], v[228:231]
v_mfma_f32_16x16x32_bf16 v[252:255], a[52:55], a[76:79], v[252:255]
s_waitcnt lgkmcnt(3)
v_mfma_f32_16x16x32_bf16 v[128:131], a[0:3], a[16:19], v[128:131]
v_mfma_f32_16x16x32_bf16 v[152:155], a[4:7], a[16:19], v[152:155]
v_mfma_f32_16x16x32_bf16 v[176:179], a[8:11], a[16:19], v[176:179]
s_waitcnt vmcnt(31) lgkmcnt(0)
s_barrier
ds_read_b128 a[40:43], v207 offset:0
v_mfma_f32_16x16x32_bf16 v[232:235], a[12:15], a[16:19], v[232:235]
s_add_u32 m0, s93, 49152
ds_read_b128 a[44:47], v207 offset:1024
v_mfma_f32_16x16x32_bf16 v[132:135], a[0:3], a[20:23], v[132:135]
buffer_load_dwordx4 v219, s[76:79], s54 offen sc1 lds
v_mfma_f32_16x16x32_bf16 v[156:159], a[4:7], a[20:23], v[156:159]
ds_read_b128 a[48:51], v207 offset:2048
v_mfma_f32_16x16x32_bf16 v[180:183], a[8:11], a[20:23], v[180:183]
ds_read_b128 a[52:55], v207 offset:3072
v_mfma_f32_16x16x32_bf16 v[236:239], a[12:15], a[20:23], v[236:239]
v_mfma_f32_16x16x32_bf16 v[136:139], a[0:3], a[24:27], v[136:139]
ds_read_b128 a[56:59], v206 offset:0
buffer_load_dwordx4 v220, s[76:79], s54 offen offset:1024 sc1 lds
v_mfma_f32_16x16x32_bf16 v[160:163], a[4:7], a[24:27], v[160:163]
ds_read_b128 a[60:63], v206 offset:1024
v_mfma_f32_16x16x32_bf16 v[184:187], a[8:11], a[24:27], v[184:187]
v_mfma_f32_16x16x32_bf16 v[240:243], a[12:15], a[24:27], v[240:243]
ds_read_b128 a[64:67], v206 offset:2048
v_mfma_f32_16x16x32_bf16 v[140:143], a[0:3], a[28:31], v[140:143]
ds_read_b128 a[68:71], v206 offset:3072
buffer_load_dwordx4 v221, s[76:79], s54 offen offset:2048 sc1 lds
v_mfma_f32_16x16x32_bf16 v[164:167], a[4:7], a[28:31], v[164:167]
s_add_u32 s54, s54, s71
v_mfma_f32_16x16x32_bf16 v[188:191], a[8:11], a[28:31], v[188:191]
ds_read_b128 a[72:75], v206 offset:4096
v_mfma_f32_16x16x32_bf16 v[244:247], a[12:15], a[28:31], v[244:247]
s_add_u32 m0, s63, 40960
ds_read_b128 a[76:79], v206 offset:5120
v_mfma_f32_16x16x32_bf16 v[144:147], a[0:3], a[32:35], v[144:147]
buffer_load_dwordx4 v200, s[20:23], s67 offen sc1 lds
v_mfma_f32_16x16x32_bf16 v[168:171], a[4:7], a[32:35], v[168:171]
v_mfma_f32_16x16x32_bf16 v[224:227], a[8:11], a[32:35], v[224:227]
v_mfma_f32_16x16x32_bf16 v[248:251], a[12:15], a[32:35], v[248:251]
v_mfma_f32_16x16x32_bf16 v[148:151], a[0:3], a[36:39], v[148:151]
buffer_load_dwordx4 v214, s[20:23], s67 offen offset:1024 sc1 lds
s_add_u32 s67, s67, s33
v_mfma_f32_16x16x32_bf16 v[172:175], a[4:7], a[36:39], v[172:175]
v_mfma_f32_16x16x32_bf16 v[228:231], a[8:11], a[36:39], v[228:231]
v_mfma_f32_16x16x32_bf16 v[252:255], a[12:15], a[36:39], v[252:255]
s_waitcnt lgkmcnt(3)
v_mfma_f32_16x16x32_bf16 v[128:131], a[40:43], a[56:59], v[128:131]
v_mfma_f32_16x16x32_bf16 v[152:155], a[44:47], a[56:59], v[152:155]
v_mfma_f32_16x16x32_bf16 v[176:179], a[48:51], a[56:59], v[176:179]
s_waitcnt vmcnt(31) lgkmcnt(0)
s_barrier
ds_read_b128 a[0:3], v207 offset:20480
v_mfma_f32_16x16x32_bf16 v[232:235], a[52:55], a[56:59], v[232:235]
s_add_u32 m0, s93, 69632
ds_read_b128 a[4:7], v207 offset:21504
v_mfma_f32_16x16x32_bf16 v[132:135], a[40:43], a[60:63], v[132:135]
buffer_load_dwordx4 v219, s[76:79], s54 offen sc1 lds
v_mfma_f32_16x16x32_bf16 v[156:159], a[44:47], a[60:63], v[156:159]
ds_read_b128 a[8:11], v207 offset:22528
v_mfma_f32_16x16x32_bf16 v[180:183], a[48:51], a[60:63], v[180:183]
ds_read_b128 a[12:15], v207 offset:23552
v_mfma_f32_16x16x32_bf16 v[236:239], a[52:55], a[60:63], v[236:239]
v_mfma_f32_16x16x32_bf16 v[136:139], a[40:43], a[64:67], v[136:139]
ds_read_b128 a[16:19], v206 offset:20480
buffer_load_dwordx4 v220, s[76:79], s54 offen offset:1024 sc1 lds
v_mfma_f32_16x16x32_bf16 v[160:163], a[44:47], a[64:67], v[160:163]
ds_read_b128 a[20:23], v206 offset:21504
v_mfma_f32_16x16x32_bf16 v[184:187], a[48:51], a[64:67], v[184:187]
v_mfma_f32_16x16x32_bf16 v[240:243], a[52:55], a[64:67], v[240:243]
ds_read_b128 a[24:27], v206 offset:22528
v_mfma_f32_16x16x32_bf16 v[140:143], a[40:43], a[68:71], v[140:143]
ds_read_b128 a[28:31], v206 offset:23552
buffer_load_dwordx4 v221, s[76:79], s54 offen offset:2048 sc1 lds
v_mfma_f32_16x16x32_bf16 v[164:167], a[44:47], a[68:71], v[164:167]
s_add_u32 s54, s54, s71
v_mfma_f32_16x16x32_bf16 v[188:191], a[48:51], a[68:71], v[188:191]
ds_read_b128 a[32:35], v206 offset:24576
v_mfma_f32_16x16x32_bf16 v[244:247], a[52:55], a[68:71], v[244:247]
s_add_u32 m0, s63, 61440
ds_read_b128 a[36:39], v206 offset:25600
v_mfma_f32_16x16x32_bf16 v[144:147], a[40:43], a[72:75], v[144:147]
buffer_load_dwordx4 v200, s[20:23], s67 offen sc1 lds
v_mfma_f32_16x16x32_bf16 v[168:171], a[44:47], a[72:75], v[168:171]
v_mfma_f32_16x16x32_bf16 v[224:227], a[48:51], a[72:75], v[224:227]
v_mfma_f32_16x16x32_bf16 v[248:251], a[52:55], a[72:75], v[248:251]
v_mfma_f32_16x16x32_bf16 v[148:151], a[40:43], a[76:79], v[148:151]
buffer_load_dwordx4 v214, s[20:23], s67 offen offset:1024 sc1 lds
s_add_u32 s67, s67, s33
v_mfma_f32_16x16x32_bf16 v[172:175], a[44:47], a[76:79], v[172:175]
v_mfma_f32_16x16x32_bf16 v[228:231], a[48:51], a[76:79], v[228:231]
v_mfma_f32_16x16x32_bf16 v[252:255], a[52:55], a[76:79], v[252:255]
s_waitcnt lgkmcnt(3)
v_mfma_f32_16x16x32_bf16 v[128:131], a[0:3], a[16:19], v[128:131]
v_mfma_f32_16x16x32_bf16 v[152:155], a[4:7], a[16:19], v[152:155]
v_mfma_f32_16x16x32_bf16 v[176:179], a[8:11], a[16:19], v[176:179]
s_waitcnt vmcnt(30) lgkmcnt(0)
s_barrier
ds_read_b128 a[40:43], v207 offset:40960
v_mfma_f32_16x16x32_bf16 v[232:235], a[12:15], a[16:19], v[232:235]
s_add_u32 m0, s93, 90112
ds_read_b128 a[44:47], v207 offset:41984
v_mfma_f32_16x16x32_bf16 v[132:135], a[0:3], a[20:23], v[132:135]
buffer_load_dwordx4 v219, s[76:79], s54 offen sc1 lds
v_mfma_f32_16x16x32_bf16 v[156:159], a[4:7], a[20:23], v[156:159]
ds_read_b128 a[48:51], v207 offset:43008
v_mfma_f32_16x16x32_bf16 v[180:183], a[8:11], a[20:23], v[180:183]
ds_read_b128 a[52:55], v207 offset:44032
v_mfma_f32_16x16x32_bf16 v[236:239], a[12:15], a[20:23], v[236:239]
v_mfma_f32_16x16x32_bf16 v[136:139], a[0:3], a[24:27], v[136:139]
ds_read_b128 a[56:59], v206 offset:40960
buffer_load_dwordx4 v220, s[76:79], s54 offen offset:1024 sc1 lds
v_mfma_f32_16x16x32_bf16 v[160:163], a[4:7], a[24:27], v[160:163]
ds_read_b128 a[60:63], v206 offset:41984
v_mfma_f32_16x16x32_bf16 v[184:187], a[8:11], a[24:27], v[184:187]
v_mfma_f32_16x16x32_bf16 v[240:243], a[12:15], a[24:27], v[240:243]
ds_read_b128 a[64:67], v206 offset:43008
v_mfma_f32_16x16x32_bf16 v[140:143], a[0:3], a[28:31], v[140:143]
ds_read_b128 a[68:71], v206 offset:44032
buffer_load_dwordx4 v221, s[76:79], s54 offen offset:2048 sc1 lds
v_mfma_f32_16x16x32_bf16 v[164:167], a[4:7], a[28:31], v[164:167]
s_add_u32 s54, s54, s71
v_mfma_f32_16x16x32_bf16 v[188:191], a[8:11], a[28:31], v[188:191]
ds_read_b128 a[72:75], v206 offset:45056
v_mfma_f32_16x16x32_bf16 v[244:247], a[12:15], a[28:31], v[244:247]
s_add_u32 m0, s63, 81920
ds_read_b128 a[76:79], v206 offset:46080
v_mfma_f32_16x16x32_bf16 v[144:147], a[0:3], a[32:35], v[144:147]
buffer_load_dwordx4 v200, s[20:23], s67 offen sc1 lds
v_mfma_f32_16x16x32_bf16 v[168:171], a[4:7], a[32:35], v[168:171]
v_mfma_f32_16x16x32_bf16 v[224:227], a[8:11], a[32:35], v[224:227]
v_mfma_f32_16x16x32_bf16 v[248:251], a[12:15], a[32:35], v[248:251]
v_mfma_f32_16x16x32_bf16 v[148:151], a[0:3], a[36:39], v[148:151]
buffer_load_dwordx4 v214, s[20:23], s67 offen offset:1024 sc1 lds
s_add_u32 s67, s67, s33
v_mfma_f32_16x16x32_bf16 v[172:175], a[4:7], a[36:39], v[172:175]
v_mfma_f32_16x16x32_bf16 v[228:231], a[8:11], a[36:39], v[228:231]
v_mfma_f32_16x16x32_bf16 v[252:255], a[12:15], a[36:39], v[252:255]
s_waitcnt lgkmcnt(3)
v_mfma_f32_16x16x32_bf16 v[128:131], a[40:43], a[56:59], v[128:131]
v_mfma_f32_16x16x32_bf16 v[152:155], a[44:47], a[56:59], v[152:155]
v_mfma_f32_16x16x32_bf16 v[176:179], a[48:51], a[56:59], v[176:179]
s_waitcnt vmcnt(30) lgkmcnt(0)
s_barrier
ds_read_b128 a[0:3], v208 offset:0
v_mfma_f32_16x16x32_bf16 v[232:235], a[52:55], a[56:59], v[232:235]
s_add_u32 m0, s93, 110592
ds_read_b128 a[4:7], v208 offset:1024
v_mfma_f32_16x16x32_bf16 v[132:135], a[40:43], a[60:63], v[132:135]
buffer_load_dwordx4 v219, s[76:79], s54 offen sc1 lds
v_mfma_f32_16x16x32_bf16 v[156:159], a[44:47], a[60:63], v[156:159]
ds_read_b128 a[8:11], v208 offset:2048
v_mfma_f32_16x16x32_bf16 v[180:183], a[48:51], a[60:63], v[180:183]
ds_read_b128 a[12:15], v208 offset:3072
v_mfma_f32_16x16x32_bf16 v[236:239], a[52:55], a[60:63], v[236:239]
v_mfma_f32_16x16x32_bf16 v[136:139], a[40:43], a[64:67], v[136:139]
ds_read_b128 a[16:19], v201 offset:0
buffer_load_dwordx4 v220, s[76:79], s54 offen offset:1024 sc1 lds
v_mfma_f32_16x16x32_bf16 v[160:163], a[44:47], a[64:67], v[160:163]
ds_read_b128 a[20:23], v201 offset:1024
v_mfma_f32_16x16x32_bf16 v[184:187], a[48:51], a[64:67], v[184:187]
v_mfma_f32_16x16x32_bf16 v[240:243], a[52:55], a[64:67], v[240:243]
ds_read_b128 a[24:27], v201 offset:2048
v_mfma_f32_16x16x32_bf16 v[140:143], a[40:43], a[68:71], v[140:143]
ds_read_b128 a[28:31], v201 offset:3072
buffer_load_dwordx4 v221, s[76:79], s54 offen offset:2048 sc1 lds
v_mfma_f32_16x16x32_bf16 v[164:167], a[44:47], a[68:71], v[164:167]
s_add_u32 s54, s54, s71
v_mfma_f32_16x16x32_bf16 v[188:191], a[48:51], a[68:71], v[188:191]
ds_read_b128 a[32:35], v201 offset:4096
v_mfma_f32_16x16x32_bf16 v[244:247], a[52:55], a[68:71], v[244:247]
s_add_u32 m0, s63, 102400
ds_read_b128 a[36:39], v201 offset:5120
v_mfma_f32_16x16x32_bf16 v[144:147], a[40:43], a[72:75], v[144:147]
buffer_load_dwordx4 v200, s[20:23], s67 offen sc1 lds
v_mfma_f32_16x16x32_bf16 v[168:171], a[44:47], a[72:75], v[168:171]
v_mfma_f32_16x16x32_bf16 v[224:227], a[48:51], a[72:75], v[224:227]
T_c_2:
s_cbranch_execz T_r1
v_mfma_f32_16x16x32_bf16 v[248:251], a[52:55], a[72:75], v[248:251]
v_mfma_f32_16x16x32_bf16 v[148:151], a[40:43], a[76:79], v[148:151]
buffer_load_dwordx4 v214, s[20:23], s67 offen offset:1024 sc1 lds
s_add_u32 s67, s67, s33
v_mfma_f32_16x16x32_bf16 v[172:175], a[44:47], a[76:79], v[172:175]
v_mfma_f32_16x16x32_bf16 v[228:231], a[48:51], a[76:79], v[228:231]
v_mfma_f32_16x16x32_bf16 v[252:255], a[52:55], a[76:79], v[252:255]
s_waitcnt lgkmcnt(3)
v_mfma_f32_16x16x32_bf16 v[128:131], a[0:3], a[16:19], v[128:131]
v_mfma_f32_16x16x32_bf16 v[152:155], a[4:7], a[16:19], v[152:155]
v_mfma_f32_16x16x32_bf16 v[176:179], a[8:11], a[16:19], v[176:179]
s_waitcnt vmcnt(30) lgkmcnt(0)
s_barrier
ds_read_b128 a[40:43], v208 offset:20480
v_mfma_f32_16x16x32_bf16 v[232:235], a[12:15], a[16:19], v[232:235]
s_add_u32 m0, s93, 131072
ds_read_b128 a[44:47], v208 offset:21504
v_mfma_f32_16x16x32_bf16 v[132:135], a[0:3], a[20:23], v[132:135]
buffer_load_dwordx4 v219, s[76:79], s54 offen sc1 lds
v_mfma_f32_16x16x32_bf16 v[156:159], a[4:7], a[20:23], v[156:159]
ds_read_b128 a[48:51], v208 offset:22528
v_mfma_f32_16x16x32_bf16 v[180:183], a[8:11], a[20:23], v[180:183]
ds_read_b128 a[52:55], v208 offset:23552
v_mfma_f32_16x16x32_bf16 v[236:239], a[12:15], a[20:23], v[236:239]
v_mfma_f32_16x16x32_bf16 v[136:139], a[0:3], a[24:27], v[136:139]
ds_read_b128 a[56:59], v201 offset:20480
buffer_load_dwordx4 v220, s[76:79], s54 offen offset:1024 sc1 lds
v_mfma_f32_16x16x32_bf16 v[160:163], a[4:7], a[24:27], v[160:163]
ds_read_b128 a[60:63], v201 offset:21504
v_mfma_f32_16x16x32_bf16 v[184:187], a[8:11], a[24:27], v[184:187]
v_mfma_f32_16x16x32_bf16 v[240:243], a[12:15], a[24:27], v[240:243]
ds_read_b128 a[64:67], v201 offset:22528
v_mfma_f32_16x16x32_bf16 v[140:143], a[0:3], a[28:31], v[140:143]
ds_read_b128 a[68:71], v201 offset:23552
buffer_load_dwordx4 v221, s[76:79], s54 offen offset:2048 sc1 lds
v_mfma_f32_16x16x32_bf16 v[164:167], a[4:7], a[28:31], v[164:167]
s_add_u32 s54, s54, s71
v_mfma_f32_16x16x32_bf16 v[188:191], a[8:11], a[28:31], v[188:191]
ds_read_b128 a[72:75], v201 offset:24576
v_mfma_f32_16x16x32_bf16 v[244:247], a[12:15], a[28:31], v[244:247]
s_add_u32 m0, s63, 122880
ds_read_b128 a[76:79], v201 offset:25600
v_mfma_f32_16x16x32_bf16 v[144:147], a[0:3], a[32:35], v[144:147]
buffer_load_dwordx4 v200, s[20:23], s67 offen sc1 lds
v_mfma_f32_16x16x32_bf16 v[168:171], a[4:7], a[32:35], v[168:171]
v_mfma_f32_16x16x32_bf16 v[224:227], a[8:11], a[32:35], v[224:227]
v_mfma_f32_16x16x32_bf16 v[248:251], a[12:15], a[32:35], v[248:251]
v_mfma_f32_16x16x32_bf16 v[148:151], a[0:3], a[36:39], v[148:151]
buffer_load_dwordx4 v214, s[20:23], s67 offen offset:1024 sc1 lds
s_add_u32 s67, s67, s33
v_mfma_f32_16x16x32_bf16 v[172:175], a[4:7], a[36:39], v[172:175]
v_mfma_f32_16x16x32_bf16 v[228:231], a[8:11], a[36:39], v[228:231]
v_mfma_f32_16x16x32_bf16 v[252:255], a[12:15], a[36:39], v[252:255]
s_waitcnt lgkmcnt(3)
v_mfma_f32_16x16x32_bf16 v[128:131], a[40:43], a[56:59], v[128:131]
v_mfma_f32_16x16x32_bf16 v[152:155], a[44:47], a[56:59], v[152:155]
v_mfma_f32_16x16x32_bf16 v[176:179], a[48:51], a[56:59], v[176:179]
s_waitcnt vmcnt(30) lgkmcnt(0)
s_barrier
ds_read_b128 a[0:3], v204 offset:0
v_mfma_f32_16x16x32_bf16 v[232:235], a[52:55], a[56:59], v[232:235]
s_add_u32 m0, s93, 151552
ds_read_b128 a[4:7], v204 offset:1024
v_mfma_f32_16x16x32_bf16 v[132:135], a[40:43], a[60:63], v[132:135]
buffer_load_dwordx4 v219, s[76:79], s54 offen sc1 lds
v_mfma_f32_16x16x32_bf16 v[156:159], a[44:47], a[60:63], v[156:159]
ds_read_b128 a[8:11], v204 offset:2048
v_mfma_f32_16x16x32_bf16 v[180:183], a[48:51], a[60:63], v[180:183]
ds_read_b128 a[12:15], v204 offset:3072
v_mfma_f32_16x16x32_bf16 v[236:239], a[52:55], a[60:63], v[236:239]
v_mfma_f32_16x16x32_bf16 v[136:139], a[40:43], a[64:67], v[136:139]
ds_read_b128 a[16:19], v205 offset:0
buffer_load_dwordx4 v220, s[76:79], s54 offen offset:1024 sc1 lds
v_mfma_f32_16x16x32_bf16 v[160:163], a[44:47], a[64:67], v[160:163]
ds_read_b128 a[20:23], v205 offset:1024
v_mfma_f32_16x16x32_bf16 v[184:187], a[48:51], a[64:67], v[184:187]
v_mfma_f32_16x16x32_bf16 v[240:243], a[52:55], a[64:67], v[240:243]
ds_read_b128 a[24:27], v205 offset:2048
v_mfma_f32_16x16x32_bf16 v[140:143], a[40:43], a[68:71], v[140:143]
ds_read_b128 a[28:31], v205 offset:3072
buffer_load_dwordx4 v221, s[76:79], s54 offen offset:2048 sc1 lds
v_mfma_f32_16x16x32_bf16 v[164:167], a[44:47], a[68:71], v[164:167]
s_add_u32 s54, s54, s71
v_mfma_f32_16x16x32_bf16 v[188:191], a[48:51], a[68:71], v[188:191]
ds_read_b128 a[32:35], v205 offset:4096
v_mfma_f32_16x16x32_bf16 v[244:247], a[52:55], a[68:71], v[244:247]
s_add_u32 m0, s63, 143360
ds_read_b128 a[36:39], v205 offset:5120
v_mfma_f32_16x16x32_bf16 v[144:147], a[40:43], a[72:75], v[144:147]
buffer_load_dwordx4 v200, s[20:23], s67 offen sc1 lds
v_mfma_f32_16x16x32_bf16 v[168:171], a[44:47], a[72:75], v[168:171]
v_mfma_f32_16x16x32_bf16 v[224:227], a[48:51], a[72:75], v[224:227]
v_mfma_f32_16x16x32_bf16 v[248:251], a[52:55], a[72:75], v[248:251]
v_mfma_f32_16x16x32_bf16 v[148:151], a[40:43], a[76:79], v[148:151]
buffer_load_dwordx4 v214, s[20:23], s67 offen offset:1024 sc1 lds
s_add_u32 s67, s67, s33
v_mfma_f32_16x16x32_bf16 v[172:175], a[44:47], a[76:79], v[172:175]
v_mfma_f32_16x16x32_bf16 v[228:231], a[48:51], a[76:79], v[228:231]
v_mfma_f32_16x16x32_bf16 v[252:255], a[52:55], a[76:79], v[252:255]
s_waitcnt lgkmcnt(3)
v_mfma_f32_16x16x32_bf16 v[128:131], a[0:3], a[16:19], v[128:131]
v_mfma_f32_16x16x32_bf16 v[152:155], a[4:7], a[16:19], v[152:155]
v_mfma_f32_16x16x32_bf16 v[176:179], a[8:11], a[16:19], v[176:179]
s_waitcnt vmcnt(30) lgkmcnt(0)
s_barrier
ds_read_b128 a[40:43], v204 offset:20480
v_mfma_f32_16x16x32_bf16 v[232:235], a[12:15], a[16:19], v[232:235]
s_add_u32 m0, s93, 8192
ds_read_b128 a[44:47], v204 offset:21504
v_mfma_f32_16x16x32_bf16 v[132:135], a[0:3], a[20:23], v[132:135]
buffer_load_dwordx4 v219, s[76:79], s54 offen sc1 lds
v_mfma_f32_16x16x32_bf16 v[156:159], a[4:7], a[20:23], v[156:159]
ds_read_b128 a[48:51], v204 offset:22528
v_mfma_f32_16x16x32_bf16 v[180:183], a[8:11], a[20:23], v[180:183]
ds_read_b128 a[52:55], v204 offset:23552
v_mfma_f32_16x16x32_bf16 v[236:239], a[12:15], a[20:23], v[236:239]
v_mfma_f32_16x16x32_bf16 v[136:139], a[0:3], a[24:27], v[136:139]
ds_read_b128 a[56:59], v205 offset:20480
buffer_load_dwordx4 v220, s[76:79], s54 offen offset:1024 sc1 lds
v_mfma_f32_16x16x32_bf16 v[160:163], a[4:7], a[24:27], v[160:163]
ds_read_b128 a[60:63], v205 offset:21504
v_mfma_f32_16x16x32_bf16 v[184:187], a[8:11], a[24:27], v[184:187]
v_mfma_f32_16x16x32_bf16 v[240:243], a[12:15], a[24:27], v[240:243]
ds_read_b128 a[64:67], v205 offset:22528
v_mfma_f32_16x16x32_bf16 v[140:143], a[0:3], a[28:31], v[140:143]
ds_read_b128 a[68:71], v205 offset:23552
buffer_load_dwordx4 v221, s[76:79], s54 offen offset:2048 sc1 lds
v_mfma_f32_16x16x32_bf16 v[164:167], a[4:7], a[28:31], v[164:167]
s_add_u32 s54, s54, s71
v_mfma_f32_16x16x32_bf16 v[188:191], a[8:11], a[28:31], v[188:191]
ds_read_b128 a[72:75], v205 offset:24576
v_mfma_f32_16x16x32_bf16 v[244:247], a[12:15], a[28:31], v[244:247]
s_add_u32 m0, s63, 0
ds_read_b128 a[76:79], v205 offset:25600
v_mfma_f32_16x16x32_bf16 v[144:147], a[0:3], a[32:35], v[144:147]
buffer_load_dwordx4 v200, s[20:23], s67 offen sc1 lds
v_mfma_f32_16x16x32_bf16 v[168:171], a[4:7], a[32:35], v[168:171]
v_mfma_f32_16x16x32_bf16 v[224:227], a[8:11], a[32:35], v[224:227]
v_mfma_f32_16x16x32_bf16 v[248:251], a[12:15], a[32:35], v[248:251]
v_mfma_f32_16x16x32_bf16 v[148:151], a[0:3], a[36:39], v[148:151]
buffer_load_dwordx4 v214, s[20:23], s67 offen offset:1024 sc1 lds
s_add_u32 s67, s67, s33
v_mfma_f32_16x16x32_bf16 v[172:175], a[4:7], a[36:39], v[172:175]
v_mfma_f32_16x16x32_bf16 v[228:231], a[8:11], a[36:39], v[228:231]
v_mfma_f32_16x16x32_bf16 v[252:255], a[12:15], a[36:39], v[252:255]
s_waitcnt lgkmcnt(3)
v_mfma_f32_16x16x32_bf16 v[128:131], a[40:43], a[56:59], v[128:131]
v_mfma_f32_16x16x32_bf16 v[152:155], a[44:47], a[56:59], v[152:155]
v_mfma_f32_16x16x32_bf16 v[176:179], a[48:51], a[56:59], v[176:179]
s_waitcnt vmcnt(30) lgkmcnt(0)
s_barrier
ds_read_b128 a[0:3], v204 offset:40960
v_mfma_f32_16x16x32_bf16 v[232:235], a[52:55], a[56:59], v[232:235]
s_add_u32 m0, s93, 28672
ds_read_b128 a[4:7], v204 offset:41984
v_mfma_f32_16x16x32_bf16 v[132:135], a[40:43], a[60:63], v[132:135]
buffer_load_dwordx4 v219, s[76:79], s54 offen sc1 lds
v_mfma_f32_16x16x32_bf16 v[156:159], a[44:47], a[60:63], v[156:159]
ds_read_b128 a[8:11], v204 offset:43008
v_mfma_f32_16x16x32_bf16 v[180:183], a[48:51], a[60:63], v[180:183]
ds_read_b128 a[12:15], v204 offset:44032
v_mfma_f32_16x16x32_bf16 v[236:239], a[52:55], a[60:63], v[236:239]
v_mfma_f32_16x16x32_bf16 v[136:139], a[40:43], a[64:67], v[136:139]
ds_read_b128 a[16:19], v205 offset:40960
buffer_load_dwordx4 v220, s[76:79], s54 offen offset:1024 sc1 lds
v_mfma_f32_16x16x32_bf16 v[160:163], a[44:47], a[64:67], v[160:163]
ds_read_b128 a[20:23], v205 offset:41984
v_mfma_f32_16x16x32_bf16 v[184:187], a[48:51], a[64:67], v[184:187]
v_mfma_f32_16x16x32_bf16 v[240:243], a[52:55], a[64:67], v[240:243]
ds_read_b128 a[24:27], v205 offset:43008
v_mfma_f32_16x16x32_bf16 v[140:143], a[40:43], a[68:71], v[140:143]
ds_read_b128 a[28:31], v205 offset:44032
buffer_load_dwordx4 v221, s[76:79], s54 offen offset:2048 sc1 lds
v_mfma_f32_16x16x32_bf16 v[164:167], a[44:47], a[68:71], v[164:167]
s_add_u32 s54, s54, s71
v_mfma_f32_16x16x32_bf16 v[188:191], a[48:51], a[68:71], v[188:191]
ds_read_b128 a[32:35], v205 offset:45056
v_mfma_f32_16x16x32_bf16 v[244:247], a[52:55], a[68:71], v[244:247]
s_add_u32 m0, s63, 20480
ds_read_b128 a[36:39], v205 offset:46080
v_mfma_f32_16x16x32_bf16 v[144:147], a[40:43], a[72:75], v[144:147]
buffer_load_dwordx4 v200, s[20:23], s67 offen sc1 lds
v_mfma_f32_16x16x32_bf16 v[168:171], a[44:47], a[72:75], v[168:171]
v_mfma_f32_16x16x32_bf16 v[224:227], a[48:51], a[72:75], v[224:227]
v_mfma_f32_16x16x32_bf16 v[248:251], a[52:55], a[72:75], v[248:251]
v_mfma_f32_16x16x32_bf16 v[148:151], a[40:43], a[76:79], v[148:151]
buffer_load_dwordx4 v214, s[20:23], s67 offen offset:1024 sc1 lds
s_add_u32 s67, s67, s33
v_mfma_f32_16x16x32_bf16 v[172:175], a[44:47], a[76:79], v[172:175]
v_mfma_f32_16x16x32_bf16 v[228:231], a[48:51], a[76:79], v[228:231]
v_mfma_f32_16x16x32_bf16 v[252:255], a[52:55], a[76:79], v[252:255]
s_waitcnt lgkmcnt(3)
v_mfma_f32_16x16x32_bf16 v[128:131], a[0:3], a[16:19], v[128:131]
v_mfma_f32_16x16x32_bf16 v[152:155], a[4:7], a[16:19], v[152:155]
v_mfma_f32_16x16x32_bf16 v[176:179], a[8:11], a[16:19], v[176:179]
s_waitcnt vmcnt(30) lgkmcnt(0)
s_barrier
ds_read_b128 a[40:43], v207 offset:0
v_mfma_f32_16x16x32_bf16 v[232:235], a[12:15], a[16:19], v[232:235]
ds_read_b128 a[44:47], v207 offset:1024
v_mfma_f32_16x16x32_bf16 v[132:135], a[0:3], a[20:23], v[132:135]
v_mfma_f32_16x16x32_bf16 v[156:159], a[4:7], a[20:23], v[156:159]
ds_read_b128 a[48:51], v207 offset:2048
v_mfma_f32_16x16x32_bf16 v[180:183], a[8:11], a[20:23], v[180:183]
ds_read_b128 a[52:55], v207 offset:3072
v_mfma_f32_16x16x32_bf16 v[236:239], a[12:15], a[20:23], v[236:239]
v_mfma_f32_16x16x32_bf16 v[136:139], a[0:3], a[24:27], v[136:139]
ds_read_b128 a[56:59], v206 offset:0
v_mfma_f32_16x16x32_bf16 v[160:163], a[4:7], a[24:27], v[160:163]
ds_read_b128 a[60:63], v206 offset:1024
v_mfma_f32_16x16x32_bf16 v[184:187], a[8:11], a[24:27], v[184:187]
v_mfma_f32_16x16x32_bf16 v[240:243], a[12:15], a[24:27], v[240:243]
ds_read_b128 a[64:67], v206 offset:2048
v_mfma_f32_16x16x32_bf16 v[140:143], a[0:3], a[28:31], v[140:143]
ds_read_b128 a[68:71], v206 offset:3072
v_mfma_f32_16x16x32_bf16 v[164:167], a[4:7], a[28:31], v[164:167]
v_mfma_f32_16x16x32_bf16 v[188:191], a[8:11], a[28:31], v[188:191]
ds_read_b128 a[72:75], v206 offset:4096
v_mfma_f32_16x16x32_bf16 v[244:247], a[12:15], a[28:31], v[244:247]
ds_read_b128 a[76:79], v206 offset:5120
v_mfma_f32_16x16x32_bf16 v[144:147], a[0:3], a[32:35], v[144:147]
v_mfma_f32_16x16x32_bf16 v[168:171], a[4:7], a[32:35], v[168:171]
v_mfma_f32_16x16x32_bf16 v[224:227], a[8:11], a[32:35], v[224:227]
v_mfma_f32_16x16x32_bf16 v[248:251], a[12:15], a[32:35], v[248:251]
v_mfma_f32_16x16x32_bf16 v[148:151], a[0:3], a[36:39], v[148:151]
v_mfma_f32_16x16x32_bf16 v[172:175], a[4:7], a[36:39], v[172:175]
v_mfma_f32_16x16x32_bf16 v[228:231], a[8:11], a[36:39], v[228:231]
v_mfma_f32_16x16x32_bf16 v[252:255], a[12:15], a[36:39], v[252:255]
s_waitcnt lgkmcnt(5)
v_mfma_f32_16x16x32_bf16 v[128:131], a[40:43], a[56:59], v[128:131]
v_mfma_f32_16x16x32_bf16 v[152:155], a[44:47], a[56:59], v[152:155]
v_mfma_f32_16x16x32_bf16 v[176:179], a[48:51], a[56:59], v[176:179]
s_waitcnt vmcnt(25) lgkmcnt(0)
s_barrier
ds_read_b128 a[0:3], v207 offset:20480
v_mfma_f32_16x16x32_bf16 v[232:235], a[52:55], a[56:59], v[232:235]
ds_read_b128 a[4:7], v207 offset:21504
v_mfma_f32_16x16x32_bf16 v[132:135], a[40:43], a[60:63], v[132:135]
v_mfma_f32_16x16x32_bf16 v[156:159], a[44:47], a[60:63], v[156:159]
ds_read_b128 a[8:11], v207 offset:22528
v_mfma_f32_16x16x32_bf16 v[180:183], a[48:51], a[60:63], v[180:183]
ds_read_b128 a[12:15], v207 offset:23552
v_mfma_f32_16x16x32_bf16 v[236:239], a[52:55], a[60:63], v[236:239]
v_mfma_f32_16x16x32_bf16 v[136:139], a[40:43], a[64:67], v[136:139]
ds_read_b128 a[16:19], v206 offset:20480
v_mfma_f32_16x16x32_bf16 v[160:163], a[44:47], a[64:67], v[160:163]
ds_read_b128 a[20:23], v206 offset:21504
v_mfma_f32_16x16x32_bf16 v[184:187], a[48:51], a[64:67], v[184:187]
v_mfma_f32_16x16x32_bf16 v[240:243], a[52:55], a[64:67], v[240:243]
ds_read_b128 a[24:27], v206 offset:22528
v_mfma_f32_16x16x32_bf16 v[140:143], a[40:43], a[68:71], v[140:143]
ds_read_b128 a[28:31], v206 offset:23552
v_mfma_f32_16x16x32_bf16 v[164:167], a[44:47], a[68:71], v[164:167]
v_mfma_f32_16x16x32_bf16 v[188:191], a[48:51], a[68:71], v[188:191]
ds_read_b128 a[32:35], v206 offset:24576
v_mfma_f32_16x16x32_bf16 v[244:247], a[52:55], a[68:71], v[244:247]
ds_read_b128 a[36:39], v206 offset:25600
v_mfma_f32_16x16x32_bf16 v[144:147], a[40:43], a[72:75], v[144:147]
v_mfma_f32_16x16x32_bf16 v[168:171], a[44:47], a[72:75], v[168:171]
v_mfma_f32_16x16x32_bf16 v[224:227], a[48:51], a[72:75], v[224:227]
v_mfma_f32_16x16x32_bf16 v[248:251], a[52:55], a[72:75], v[248:251]
v_mfma_f32_16x16x32_bf16 v[148:151], a[40:43], a[76:79], v[148:151]
v_mfma_f32_16x16x32_bf16 v[172:175], a[44:47], a[76:79], v[172:175]
v_mfma_f32_16x16x32_bf16 v[228:231], a[48:51], a[76:79], v[228:231]
v_mfma_f32_16x16x32_bf16 v[252:255], a[52:55], a[76:79], v[252:255]
s_waitcnt lgkmcnt(5)
v_mfma_f32_16x16x32_bf16 v[128:131], a[0:3], a[16:19], v[128:131]
v_mfma_f32_16x16x32_bf16 v[152:155], a[4:7], a[16:19], v[152:155]
v_mfma_f32_16x16x32_bf16 v[176:179], a[8:11], a[16:19], v[176:179]
s_waitcnt vmcnt(20) lgkmcnt(0)
s_barrier
ds_read_b128 a[40:43], v207 offset:40960
v_mfma_f32_16x16x32_bf16 v[232:235], a[12:15], a[16:19], v[232:235]
ds_read_b128 a[44:47], v207 offset:41984
v_mfma_f32_16x16x32_bf16 v[132:135], a[0:3], a[20:23], v[132:135]
v_mfma_f32_16x16x32_bf16 v[156:159], a[4:7], a[20:23], v[156:159]
ds_read_b128 a[48:51], v207 offset:43008
v_mfma_f32_16x16x32_bf16 v[180:183], a[8:11], a[20:23], v[180:183]
ds_read_b128 a[52:55], v207 offset:44032
v_mfma_f32_16x16x32_bf16 v[236:239], a[12:15], a[20:23], v[236:239]
v_mfma_f32_16x16x32_bf16 v[136:139], a[0:3], a[24:27], v[136:139]
ds_read_b128 a[56:59], v206 offset:40960
v_mfma_f32_16x16x32_bf16 v[160:163], a[4:7], a[24:27], v[160:163]
ds_read_b128 a[60:63], v206 offset:41984
v_mfma_f32_16x16x32_bf16 v[184:187], a[8:11], a[24:27], v[184:187]
v_mfma_f32_16x16x32_bf16 v[240:243], a[12:15], a[24:27], v[240:243]
ds_read_b128 a[64:67], v206 offset:43008
v_mfma_f32_16x16x32_bf16 v[140:143], a[0:3], a[28:31], v[140:143]
ds_read_b128 a[68:71], v206 offset:44032
v_mfma_f32_16x16x32_bf16 v[164:167], a[4:7], a[28:31], v[164:167]
v_mfma_f32_16x16x32_bf16 v[188:191], a[8:11], a[28:31], v[188:191]
ds_read_b128 a[72:75], v206 offset:45056
v_mfma_f32_16x16x32_bf16 v[244:247], a[12:15], a[28:31], v[244:247]
ds_read_b128 a[76:79], v206 offset:46080
v_mfma_f32_16x16x32_bf16 v[144:147], a[0:3], a[32:35], v[144:147]
v_mfma_f32_16x16x32_bf16 v[168:171], a[4:7], a[32:35], v[168:171]
v_mfma_f32_16x16x32_bf16 v[224:227], a[8:11], a[32:35], v[224:227]
v_mfma_f32_16x16x32_bf16 v[248:251], a[12:15], a[32:35], v[248:251]
v_mfma_f32_16x16x32_bf16 v[148:151], a[0:3], a[36:39], v[148:151]
v_mfma_f32_16x16x32_bf16 v[172:175], a[4:7], a[36:39], v[172:175]
v_mfma_f32_16x16x32_bf16 v[228:231], a[8:11], a[36:39], v[228:231]
v_mfma_f32_16x16x32_bf16 v[252:255], a[12:15], a[36:39], v[252:255]
s_waitcnt lgkmcnt(5)
v_mfma_f32_16x16x32_bf16 v[128:131], a[40:43], a[56:59], v[128:131]
v_mfma_f32_16x16x32_bf16 v[152:155], a[44:47], a[56:59], v[152:155]
v_mfma_f32_16x16x32_bf16 v[176:179], a[48:51], a[56:59], v[176:179]
s_waitcnt vmcnt(15) lgkmcnt(0)
s_barrier
ds_read_b128 a[0:3], v208 offset:0
v_mfma_f32_16x16x32_bf16 v[232:235], a[52:55], a[56:59], v[232:235]
ds_read_b128 a[4:7], v208 offset:1024
v_mfma_f32_16x16x32_bf16 v[132:135], a[40:43], a[60:63], v[132:135]
ds_read_b128 a[8:11], v208 offset:2048
v_mfma_f32_16x16x32_bf16 v[156:159], a[44:47], a[60:63], v[156:159]
ds_read_b128 a[12:15], v208 offset:3072
v_mfma_f32_16x16x32_bf16 v[180:183], a[48:51], a[60:63], v[180:183]
ds_read_b128 a[16:19], v201 offset:0
v_mfma_f32_16x16x32_bf16 v[236:239], a[52:55], a[60:63], v[236:239]
ds_read_b128 a[20:23], v201 offset:1024
v_mfma_f32_16x16x32_bf16 v[136:139], a[40:43], a[64:67], v[136:139]
ds_read_b128 a[24:27], v201 offset:2048
v_mfma_f32_16x16x32_bf16 v[160:163], a[44:47], a[64:67], v[160:163]
ds_read_b128 a[28:31], v201 offset:3072
v_mfma_f32_16x16x32_bf16 v[184:187], a[48:51], a[64:67], v[184:187]
ds_read_b128 a[32:35], v201 offset:4096
v_mfma_f32_16x16x32_bf16 v[240:243], a[52:55], a[64:67], v[240:243]
ds_read_b128 a[36:39], v201 offset:5120
v_mfma_f32_16x16x32_bf16 v[140:143], a[40:43], a[68:71], v[140:143]
s_waitcnt vmcnt(0)
s_barrier
v_mfma_f32_16x16x32_bf16 v[164:167], a[44:47], a[68:71], v[164:167]
ds_read_b128 a[80:83], v208 offset:20480
ds_read_b128 a[96:99], v201 offset:20480
v_mfma_f32_16x16x32_bf16 v[188:191], a[48:51], a[68:71], v[188:191]
ds_read_b128 a[100:103], v201 offset:21504
ds_read_b128 a[104:107], v201 offset:22528
v_mfma_f32_16x16x32_bf16 v[244:247], a[52:55], a[68:71], v[244:247]
ds_read_b128 a[108:111], v201 offset:23552
ds_read_b128 a[112:115], v201 offset:24576
v_mfma_f32_16x16x32_bf16 v[144:147], a[40:43], a[72:75], v[144:147]
ds_read_b128 a[116:119], v201 offset:25600
ds_read_b128 a[120:123], v204 offset:0
v_mfma_f32_16x16x32_bf16 v[168:171], a[44:47], a[72:75], v[168:171]
ds_read_b128 a[136:139], v205 offset:0
ds_read_b128 a[140:143], v205 offset:1024
v_mfma_f32_16x16x32_bf16 v[224:227], a[48:51], a[72:75], v[224:227]
ds_read_b128 a[144:147], v205 offset:2048
ds_read_b128 a[148:151], v205 offset:3072
v_mfma_f32_16x16x32_bf16 v[248:251], a[52:55], a[72:75], v[248:251]
ds_read_b128 a[152:155], v205 offset:4096
ds_read_b128 a[156:159], v205 offset:5120
v_mfma_f32_16x16x32_bf16 v[148:151], a[40:43], a[76:79], v[148:151]
ds_read_b128 a[160:163], v204 offset:20480
ds_read_b128 a[176:179], v205 offset:20480
v_mfma_f32_16x16x32_bf16 v[172:175], a[44:47], a[76:79], v[172:175]
ds_read_b128 a[180:183], v205 offset:21504
ds_read_b128 a[184:187], v205 offset:22528
v_mfma_f32_16x16x32_bf16 v[228:231], a[48:51], a[76:79], v[228:231]
ds_read_b128 a[188:191], v205 offset:23552
ds_read_b128 a[192:195], v205 offset:24576
v_mfma_f32_16x16x32_bf16 v[252:255], a[52:55], a[76:79], v[252:255]
s_waitcnt lgkmcnt(13)
ds_read_b128 a[196:199], v205 offset:25600
ds_read_b128 a[84:87], v208 offset:21504
v_mfma_f32_16x16x32_bf16 v[128:131], a[0:3], a[16:19], v[128:131]
ds_read_b128 a[124:127], v204 offset:1024
v_mfma_f32_16x16x32_bf16 v[132:135], a[0:3], a[20:23], v[132:135]
ds_read_b128 a[164:167], v204 offset:21504
v_mfma_f32_16x16x32_bf16 v[136:139], a[0:3], a[24:27], v[136:139]
ds_read_b128 a[88:91], v208 offset:22528
v_mfma_f32_16x16x32_bf16 v[140:143], a[0:3], a[28:31], v[140:143]
ds_read_b128 a[128:131], v204 offset:2048
v_mfma_f32_16x16x32_bf16 v[144:147], a[0:3], a[32:35], v[144:147]
ds_read_b128 a[168:171], v204 offset:22528
v_mfma_f32_16x16x32_bf16 v[148:151], a[0:3], a[36:39], v[148:151]
ds_read_b128 a[92:95], v208 offset:23552
v_mfma_f32_16x16x32_bf16 v[128:131], a[80:83], a[96:99], v[128:131]
ds_read_b128 a[132:135], v204 offset:3072
v_mfma_f32_16x16x32_bf16 v[132:135], a[80:83], a[100:103], v[132:135]
ds_read_b128 a[172:175], v204 offset:23552
v_mfma_f32_16x16x32_bf16 v[136:139], a[80:83], a[104:107], v[136:139]
v_mfma_f32_16x16x32_bf16 v[140:143], a[80:83], a[108:111], v[140:143]
v_mfma_f32_16x16x32_bf16 v[144:147], a[80:83], a[112:115], v[144:147]
v_mfma_f32_16x16x32_bf16 v[148:151], a[80:83], a[116:119], v[148:151]
s_waitcnt lgkmcnt(8)
v_mfma_f32_16x16x32_bf16 v[128:131], a[120:123], a[136:139], v[128:131]
v_mfma_f32_16x16x32_bf16 v[132:135], a[120:123], a[140:143], v[132:135]
v_mfma_f32_16x16x32_bf16 v[136:139], a[120:123], a[144:147], v[136:139]
v_mfma_f32_16x16x32_bf16 v[140:143], a[120:123], a[148:151], v[140:143]
v_mfma_f32_16x16x32_bf16 v[144:147], a[120:123], a[152:155], v[144:147]
v_mfma_f32_16x16x32_bf16 v[148:151], a[120:123], a[156:159], v[148:151]
v_mfma_f32_16x16x32_bf16 v[128:131], a[160:163], a[176:179], v[128:131]
v_mfma_f32_16x16x32_bf16 v[132:135], a[160:163], a[180:183], v[132:135]
v_mfma_f32_16x16x32_bf16 v[136:139], a[160:163], a[184:187], v[136:139]
v_mfma_f32_16x16x32_bf16 v[140:143], a[160:163], a[188:191], v[140:143]
v_mfma_f32_16x16x32_bf16 v[144:147], a[160:163], a[192:195], v[144:147]
v_mfma_f32_16x16x32_bf16 v[148:151], a[160:163], a[196:199], v[148:151]
v_mfma_f32_16x16x32_bf16 v[152:155], a[4:7], a[16:19], v[152:155]
s_nop 1
buffer_store_dwordx4 v[128:131], v200, s[20:23], s36 offen offset:0 sc1
v_mfma_f32_16x16x32_bf16 v[156:159], a[4:7], a[20:23], v[156:159]
v_mfma_f32_16x16x32_bf16 v[160:163], a[4:7], a[24:27], v[160:163]
v_mfma_f32_16x16x32_bf16 v[164:167], a[4:7], a[28:31], v[164:167]
buffer_store_dwordx4 v[132:135], v200, s[20:23], s36 offen offset:1024 sc1
v_mfma_f32_16x16x32_bf16 v[168:171], a[4:7], a[32:35], v[168:171]
v_mfma_f32_16x16x32_bf16 v[172:175], a[4:7], a[36:39], v[172:175]
v_mfma_f32_16x16x32_bf16 v[152:155], a[84:87], a[96:99], v[152:155]
buffer_store_dwordx4 v[136:139], v200, s[20:23], s36 offen offset:2048 sc1
v_mfma_f32_16x16x32_bf16 v[156:159], a[84:87], a[100:103], v[156:159]
v_mfma_f32_16x16x32_bf16 v[160:163], a[84:87], a[104:107], v[160:163]
v_mfma_f32_16x16x32_bf16 v[164:167], a[84:87], a[108:111], v[164:167]
buffer_store_dwordx4 v[140:143], v200, s[20:23], s37 offen offset:0 sc1
v_mfma_f32_16x16x32_bf16 v[168:171], a[84:87], a[112:115], v[168:171]
v_mfma_f32_16x16x32_bf16 v[172:175], a[84:87], a[116:119], v[172:175]
s_waitcnt lgkmcnt(0)
v_mfma_f32_16x16x32_bf16 v[152:155], a[124:127], a[136:139], v[152:155]
buffer_store_dwordx4 v[144:147], v200, s[20:23], s37 offen offset:1024 sc1
v_mfma_f32_16x16x32_bf16 v[156:159], a[124:127], a[140:143], v[156:159]
v_mfma_f32_16x16x32_bf16 v[160:163], a[124:127], a[144:147], v[160:163]
v_mfma_f32_16x16x32_bf16 v[164:167], a[124:127], a[148:151], v[164:167]
buffer_store_dwordx4 v[148:151], v200, s[20:23], s37 offen offset:2048 sc1
s_add_u32 s36, s36, 36864
v_mfma_f32_16x16x32_bf16 v[168:171], a[124:127], a[152:155], v[168:171]
s_add_u32 s37, s37, 36864
v_mfma_f32_16x16x32_bf16 v[172:175], a[124:127], a[156:159], v[172:175]
v_mfma_f32_16x16x32_bf16 v[152:155], a[164:167], a[176:179], v[152:155]
v_mfma_f32_16x16x32_bf16 v[156:159], a[164:167], a[180:183], v[156:159]
v_mfma_f32_16x16x32_bf16 v[160:163], a[164:167], a[184:187], v[160:163]
v_mfma_f32_16x16x32_bf16 v[164:167], a[164:167], a[188:191], v[164:167]
v_mfma_f32_16x16x32_bf16 v[168:171], a[164:167], a[192:195], v[168:171]
v_mfma_f32_16x16x32_bf16 v[172:175], a[164:167], a[196:199], v[172:175]
v_mfma_f32_16x16x32_bf16 v[176:179], a[8:11], a[16:19], v[176:179]
s_nop 1
buffer_store_dwordx4 v[152:155], v200, s[20:23], s36 offen offset:0 sc1
v_mfma_f32_16x16x32_bf16 v[180:183], a[8:11], a[20:23], v[180:183]
v_mfma_f32_16x16x32_bf16 v[184:187], a[8:11], a[24:27], v[184:187]
v_mfma_f32_16x16x32_bf16 v[188:191], a[8:11], a[28:31], v[188:191]
buffer_store_dwordx4 v[156:159], v200, s[20:23], s36 offen offset:1024 sc1
v_mfma_f32_16x16x32_bf16 v[224:227], a[8:11], a[32:35], v[224:227]
v_mfma_f32_16x16x32_bf16 v[228:231], a[8:11], a[36:39], v[228:231]
v_mfma_f32_16x16x32_bf16 v[176:179], a[88:91], a[96:99], v[176:179]
buffer_store_dwordx4 v[160:163], v200, s[20:23], s36 offen offset:2048 sc1
v_mfma_f32_16x16x32_bf16 v[180:183], a[88:91], a[100:103], v[180:183]
v_mfma_f32_16x16x32_bf16 v[184:187], a[88:91], a[104:107], v[184:187]
v_mfma_f32_16x16x32_bf16 v[188:191], a[88:91], a[108:111], v[188:191]
buffer_store_dwordx4 v[164:167], v200, s[20:23], s37 offen offset:0 sc1
v_mfma_f32_16x16x32_bf16 v[224:227], a[88:91], a[112:115], v[224:227]
v_mfma_f32_16x16x32_bf16 v[228:231], a[88:91], a[116:119], v[228:231]
v_mfma_f32_16x16x32_bf16 v[176:179], a[128:131], a[136:139], v[176:179]
buffer_store_dwordx4 v[168:171], v200, s[20:23], s37 offen offset:1024 sc1
v_mfma_f32_16x16x32_bf16 v[180:183], a[128:131], a[140:143], v[180:183]
v_mfma_f32_16x16x32_bf16 v[184:187], a[128:131], a[144:147], v[184:187]
v_mfma_f32_16x16x32_bf16 v[188:191], a[128:131], a[148:151], v[188:191]
buffer_store_dwordx4 v[172:175], v200, s[20:23], s37 offen offset:2048 sc1
s_add_u32 s36, s36, 36864
v_mfma_f32_16x16x32_bf16 v[224:227], a[128:131], a[152:155], v[224:227]
s_add_u32 s37, s37, 36864
v_mfma_f32_16x16x32_bf16 v[228:231], a[128:131], a[156:159], v[228:231]
v_mfma_f32_16x16x32_bf16 v[176:179], a[168:171], a[176:179], v[176:179]
v_mfma_f32_16x16x32_bf16 v[180:183], a[168:171], a[180:183], v[180:183]
v_mfma_f32_16x16x32_bf16 v[184:187], a[168:171], a[184:187], v[184:187]
v_mfma_f32_16x16x32_bf16 v[188:191], a[168:171], a[188:191], v[188:191]
v_mfma_f32_16x16x32_bf16 v[224:227], a[168:171], a[192:195], v[224:227]
v_mfma_f32_16x16x32_bf16 v[228:231], a[168:171], a[196:199], v[228:231]
v_mfma_f32_16x16x32_bf16 v[232:235], a[12:15], a[16:19], v[232:235]
s_nop 1
buffer_store_dwordx4 v[176:179], v200, s[20:23], s36 offen offset:0 sc1
v_mfma_f32_16x16x32_bf16 v[236:239], a[12:15], a[20:23], v[236:239]
v_mfma_f32_16x16x32_bf16 v[240:243], a[12:15], a[24:27], v[240:243]
v_mfma_f32_16x16x32_bf16 v[244:247], a[12:15], a[28:31], v[244:247]
buffer_store_dwordx4 v[180:183], v200, s[20:23], s36 offen offset:1024 sc1
v_mfma_f32_16x16x32_bf16 v[248:251], a[12:15], a[32:35], v[248:251]
v_mfma_f32_16x16x32_bf16 v[252:255], a[12:15], a[36:39], v[252:255]
v_mfma_f32_16x16x32_bf16 v[232:235], a[92:95], a[96:99], v[232:235]
buffer_store_dwordx4 v[184:187], v200, s[20:23], s36 offen offset:2048 sc1
v_mfma_f32_16x16x32_bf16 v[236:239], a[92:95], a[100:103], v[236:239]
v_mfma_f32_16x16x32_bf16 v[240:243], a[92:95], a[104:107], v[240:243]
v_mfma_f32_16x16x32_bf16 v[244:247], a[92:95], a[108:111], v[244:247]
buffer_store_dwordx4 v[188:191], v200, s[20:23], s37 offen offset:0 sc1
v_mfma_f32_16x16x32_bf16 v[248:251], a[92:95], a[112:115], v[248:251]
v_mfma_f32_16x16x32_bf16 v[252:255], a[92:95], a[116:119], v[252:255]
v_mfma_f32_16x16x32_bf16 v[232:235], a[132:135], a[136:139], v[232:235]
buffer_store_dwordx4 v[224:227], v200, s[20:23], s37 offen offset:1024 sc1
v_mfma_f32_16x16x32_bf16 v[236:239], a[132:135], a[140:143], v[236:239]
v_mfma_f32_16x16x32_bf16 v[240:243], a[132:135], a[144:147], v[240:243]
v_mfma_f32_16x16x32_bf16 v[244:247], a[132:135], a[148:151], v[244:247]
buffer_store_dwordx4 v[228:231], v200, s[20:23], s37 offen offset:2048 sc1
s_add_u32 s36, s36, 36864
v_mfma_f32_16x16x32_bf16 v[248:251], a[132:135], a[152:155], v[248:251]
s_add_u32 s37, s37, 36864
v_mfma_f32_16x16x32_bf16 v[252:255], a[132:135], a[156:159], v[252:255]
v_mfma_f32_16x16x32_bf16 v[232:235], a[172:175], a[176:179], v[232:235]
v_mfma_f32_16x16x32_bf16 v[236:239], a[172:175], a[180:183], v[236:239]
v_mfma_f32_16x16x32_bf16 v[240:243], a[172:175], a[184:187], v[240:243]
v_mfma_f32_16x16x32_bf16 v[244:247], a[172:175], a[188:191], v[244:247]
v_mfma_f32_16x16x32_bf16 v[248:251], a[172:175], a[192:195], v[248:251]
v_mfma_f32_16x16x32_bf16 v[252:255], a[172:175], a[196:199], v[252:255]
s_nop 2
buffer_store_dwordx4 v[232:235], v200, s[20:23], s36 offen offset:0 sc1
buffer_store_dwordx4 v[236:239], v200, s[20:23], s36 offen offset:1024 sc1
buffer_store_dwordx4 v[240:243], v200, s[20:23], s36 offen offset:2048 sc1
buffer_store_dwordx4 v[244:247], v200, s[20:23], s37 offen offset:0 sc1
buffer_store_dwordx4 v[248:251], v200, s[20:23], s37 offen offset:1024 sc1
buffer_store_dwordx4 v[252:255], v200, s[20:23], s37 offen offset:2048 sc1
s_add_u32 s36, s36, 36864
s_add_u32 s37, s37, 36864
s_waitcnt vmcnt(0)
buffer_store_dword v218, v217, s[20:23], s90 offen offset:0 sc1
s_endpgm
P2s_e:
chk_18:
s_mov_b32 s97, 0
poll_19:
buffer_load_dword v223, v222, s[20:23], s68 offen offset:44 sc1
s_waitcnt vmcnt(0)
v_cmp_ne_u32 vcc, s96, v223
s_add_u32 s97, s97, 1
s_cmp_ge_u32 s97, 32768
s_cbranch_scc1 poll_19_x
s_cbranch_vccnz poll_19
poll_19_x:
s_branch chk_18_r
P2_left:
T_d_0:
s_cbranch_execz T_r0
s_sub_u32 s18, s13, 30
s_lshl_b32 s55, s12, 1
s_add_u32 s55, s55, s18
s_add_u32 s62, s3, 32
s_mov_b32 s28, s10
s_mov_b32 s29, s11
s_mov_b32 s30, 663552
s_mov_b32 s31, 0x20000
s_add_u32 m0, s93, 151360
s_nop 0
buffer_load_dwordx4 v219, s[28:31], 0 offen offset:192 lds
s_add_u32 m0, s93, 152320
s_nop 0
buffer_load_dwordx4 v219, s[28:31], 0 offen offset:256 lds
s_add_u32 m0, s93, 153280
s_nop 0
buffer_load_dwordx4 v219, s[28:31], 0 offen offset:320 lds
s_add_u32 m0, s63, 143360
s_nop 0
buffer_load_dwordx4 v200, s[20:23], s67 offen sc1 lds
buffer_load_dwordx4 v214, s[20:23], s67 offen offset:1024 sc1 lds
s_add_u32 s67, s67, s33
v_and_b32 v180, 15, v213
s_mov_b32 s76, s56
s_mov_b32 s77, s57
s_mov_b32 s78, 1152
T_d_1:
s_cbranch_execz T_r0
s_mov_b32 s79, 0x20000
s_mov_b32 s80, s58
s_mov_b32 s81, s59
s_mov_b32 s82, 1152
s_mov_b32 s83, 0x20000
s_mov_b32 s84, s60
s_mov_b32 s85, s61
s_mov_b32 s86, 1152
s_mov_b32 s87, 0x20000
s_lshl_b32 s18, s62, 4
v_add_lshl_u32 v180, v180, s18, 1
buffer_load_ushort v192, v180, s[76:79], 0 offen
buffer_load_ushort v193, v180, s[80:83], 0 offen
buffer_load_ushort v194, v180, s[84:87], 0 offen
v_and_b32 v204, 15, v213
v_lshrrev_b32 v182, 2, v204
v_sub_u32 v182, 4, v182
v_lshrrev_b32 v183, 4, v213
v_xor_b32 v182, v182, v183
v_and_b32 v182, 3, v182
v_lshl_add_u32 v204, v204, 2, v182
v_lshlrev_b32 v204, 4, v204
s_add_u32 s18, s93, 8192
v_add_u32 v205, s18, v204
v_add_u32 v206, 61440, v205
v_add_u32 v207, 61440, v204
v_add_u32 v208, 122880, v204
v_add_u32 v201, 122880, v205
v_accvgpr_read_b32 v196, a64
v_accvgpr_read_b32 v197, a65
v_accvgpr_read_b32 v198, a66
v_accvgpr_read_b32 v199, a67
v_mul_f32 v64, v196, v64
v_mul_f32 v65, v197, v65
v_mul_f32 v66, v198, v66
v_mul_f32 v67, v199, v67
v_accvgpr_read_b32 v196, a96
v_accvgpr_read_b32 v197, a97
v_accvgpr_read_b32 v198, a98
v_accvgpr_read_b32 v199, a99
v_mul_f32 v96, v196, v96
v_mul_f32 v97, v197, v97
v_mul_f32 v98, v198, v98
v_mul_f32 v99, v199, v99
v_cvt_pk_bf16_f32 v64, v64, v65
v_cvt_pk_bf16_f32 v65, v66, v67
v_cvt_pk_bf16_f32 v66, v96, v97
v_cvt_pk_bf16_f32 v67, v98, v99
v_accvgpr_read_b32 v196, a68
v_accvgpr_read_b32 v197, a69
v_accvgpr_read_b32 v198, a70
v_accvgpr_read_b32 v199, a71
v_mul_f32 v68, v196, v68
v_mul_f32 v69, v197, v69
v_mul_f32 v70, v198, v70
v_mul_f32 v71, v199, v71
v_accvgpr_read_b32 v196, a100
v_accvgpr_read_b32 v197, a101
v_accvgpr_read_b32 v198, a102
v_accvgpr_read_b32 v199, a103
v_mul_f32 v100, v196, v100
v_mul_f32 v101, v197, v101
v_mul_f32 v102, v198, v102
v_mul_f32 v103, v199, v103
v_cvt_pk_bf16_f32 v68, v68, v69
v_cvt_pk_bf16_f32 v69, v70, v71
v_cvt_pk_bf16_f32 v70, v100, v101
v_cvt_pk_bf16_f32 v71, v102, v103
P2l_m:
s_waitcnt vmcnt(8)
ds_read_b128 a[200:203], v205 offset:0
ds_read_b128 a[128:131], v201 offset:0
ds_read_b128 a[0:3], v204 offset:0
ds_read_b128 a[4:7], v204 offset:1024
ds_read_b128 a[8:11], v204 offset:2048
ds_read_b128 a[12:15], v204 offset:3072
ds_read_b128 a[16:19], v204 offset:4096
ds_read_b128 a[20:23], v204 offset:5120
ds_read_b128 a[24:27], v204 offset:6144
ds_read_b128 a[28:31], v204 offset:7168
v_mov_b32 v222, v217
v_mov_b32 v223, v218
s_waitcnt lgkmcnt(7)
v_mfma_f32_16x16x32_bf16 v[128:131], a[0:3], a[200:203], 0
v_accvgpr_read_b32 v196, a72
v_accvgpr_read_b32 v197, a73
v_mfma_f32_16x16x32_bf16 v[224:227], a[0:3], a[128:131], 0
s_waitcnt lgkmcnt(6)
v_accvgpr_read_b32 v198, a74
v_accvgpr_read_b32 v199, a75
v_mfma_f32_16x16x32_bf16 v[132:135], a[4:7], a[200:203], 0
s_waitcnt lgkmcnt(0)
s_barrier
ds_read_b128 a[204:207], v205 offset:1024
v_mfma_f32_16x16x32_bf16 v[228:231], a[4:7], a[128:131], 0
s_add_u32 m0, s63, 0
ds_read_b128 a[132:135], v201 offset:1024
v_mul_f32 v72, v196, v72
v_mfma_f32_16x16x32_bf16 v[136:139], a[8:11], a[200:203], 0
ds_read_b128 a[32:35], v204 offset:20480
buffer_load_dwordx4 v200, s[20:23], s67 offen sc1 lds
v_mul_f32 v73, v197, v73
v_mfma_f32_16x16x32_bf16 v[232:235], a[8:11], a[128:131], 0
ds_read_b128 a[36:39], v204 offset:21504
v_mul_f32 v74, v198, v74
v_mfma_f32_16x16x32_bf16 v[140:143], a[12:15], a[200:203], 0
ds_read_b128 a[40:43], v204 offset:22528
buffer_load_dwordx4 v200, s[20:23], s67 offen offset:1024 sc1 lds
v_mfma_f32_16x16x32_bf16 v[236:239], a[12:15], a[128:131], 0
s_add_u32 s67, s67, s33
ds_read_b128 a[44:47], v204 offset:23552
v_mul_f32 v75, v199, v75
v_mfma_f32_16x16x32_bf16 v[144:147], a[16:19], a[200:203], 0
s_add_u32 m0, s93, 130688
ds_read_b128 a[48:51], v204 offset:24576
v_accvgpr_read_b32 v196, a104
v_mfma_f32_16x16x32_bf16 v[240:243], a[16:19], a[128:131], 0
ds_read_b128 a[52:55], v204 offset:25600
buffer_load_dwordx4 v219, s[28:31], 0 offen offset:384 lds
v_accvgpr_read_b32 v197, a105
v_mfma_f32_16x16x32_bf16 v[148:151], a[20:23], a[200:203], 0
ds_read_b128 a[56:59], v204 offset:26624
v_accvgpr_read_b32 v198, a106
v_mfma_f32_16x16x32_bf16 v[244:247], a[20:23], a[128:131], 0
ds_read_b128 a[60:63], v204 offset:27648
v_accvgpr_read_b32 v199, a107
v_mfma_f32_16x16x32_bf16 v[152:155], a[24:27], a[200:203], 0
s_add_u32 m0, s93, 7424
v_mul_f32 v104, v196, v104
v_mul_f32 v105, v197, v105
v_mfma_f32_16x16x32_bf16 v[248:251], a[24:27], a[128:131], 0
buffer_load_dwordx4 v219, s[28:31], 0 offen offset:768 lds
v_mul_f32 v106, v198, v106
v_mfma_f32_16x16x32_bf16 v[156:159], a[28:31], a[200:203], 0
v_mul_f32 v107, v199, v107
v_cvt_pk_bf16_f32 v72, v72, v73
v_cvt_pk_bf16_f32 v73, v74, v75
v_mfma_f32_16x16x32_bf16 v[252:255], a[28:31], a[128:131], 0
s_waitcnt lgkmcnt(2)
v_cvt_pk_bf16_f32 v74, v104, v105
v_cvt_pk_bf16_f32 v75, v106, v107
v_mfma_f32_16x16x32_bf16 v[128:131], a[32:35], a[204:207], v[128:131]
v_accvgpr_read_b32 v196, a76
v_accvgpr_read_b32 v197, a77
v_mfma_f32_16x16x32_bf16 v[224:227], a[32:35], a[132:135], v[224:227]
v_accvgpr_read_b32 v198, a78
v_accvgpr_read_b32 v199, a79
v_mfma_f32_16x16x32_bf16 v[132:135], a[36:39], a[204:207], v[132:135]
s_waitcnt lgkmcnt(0)
s_barrier
ds_read_b128 a[200:203], v205 offset:2048
v_mfma_f32_16x16x32_bf16 v[228:231], a[36:39], a[132:135], v[228:231]
s_add_u32 m0, s63, 20480
ds_read_b128 a[128:131], v201 offset:2048
v_mul_f32 v76, v196, v76
v_mfma_f32_16x16x32_bf16 v[136:139], a[40:43], a[204:207], v[136:139]
ds_read_b128 a[0:3], v204 offset:40960
buffer_load_dwordx4 v200, s[20:23], s67 offen sc1 lds
v_mul_f32 v77, v197, v77
v_mfma_f32_16x16x32_bf16 v[232:235], a[40:43], a[132:135], v[232:235]
ds_read_b128 a[4:7], v204 offset:41984
v_mul_f32 v78, v198, v78
v_mfma_f32_16x16x32_bf16 v[140:143], a[44:47], a[204:207], v[140:143]
ds_read_b128 a[8:11], v204 offset:43008
buffer_load_dwordx4 v200, s[20:23], s67 offen offset:1024 sc1 lds
v_mfma_f32_16x16x32_bf16 v[236:239], a[44:47], a[132:135], v[236:239]
s_add_u32 s67, s67, s33
ds_read_b128 a[12:15], v204 offset:44032
v_mul_f32 v79, v199, v79
v_mfma_f32_16x16x32_bf16 v[144:147], a[48:51], a[204:207], v[144:147]
s_add_u32 m0, s93, 131648
ds_read_b128 a[16:19], v204 offset:45056
v_accvgpr_read_b32 v196, a108
v_mfma_f32_16x16x32_bf16 v[240:243], a[48:51], a[132:135], v[240:243]
ds_read_b128 a[20:23], v204 offset:46080
buffer_load_dwordx4 v219, s[28:31], 0 offen offset:448 lds
v_accvgpr_read_b32 v197, a109
v_mfma_f32_16x16x32_bf16 v[148:151], a[52:55], a[204:207], v[148:151]
ds_read_b128 a[24:27], v204 offset:47104
v_accvgpr_read_b32 v198, a110
v_mfma_f32_16x16x32_bf16 v[244:247], a[52:55], a[132:135], v[244:247]
ds_read_b128 a[28:31], v204 offset:48128
v_accvgpr_read_b32 v199, a111
v_mfma_f32_16x16x32_bf16 v[152:155], a[56:59], a[204:207], v[152:155]
s_add_u32 m0, s93, 8384
v_mul_f32 v108, v196, v108
v_mul_f32 v109, v197, v109
v_mfma_f32_16x16x32_bf16 v[248:251], a[56:59], a[132:135], v[248:251]
buffer_load_dwordx4 v219, s[28:31], 0 offen offset:832 lds
v_mul_f32 v110, v198, v110
v_mfma_f32_16x16x32_bf16 v[156:159], a[60:63], a[204:207], v[156:159]
v_mul_f32 v111, v199, v111
v_cvt_pk_bf16_f32 v76, v76, v77
v_cvt_pk_bf16_f32 v77, v78, v79
v_mfma_f32_16x16x32_bf16 v[252:255], a[60:63], a[132:135], v[252:255]
s_waitcnt lgkmcnt(2)
v_cvt_pk_bf16_f32 v78, v108, v109
v_cvt_pk_bf16_f32 v79, v110, v111
v_mfma_f32_16x16x32_bf16 v[128:131], a[0:3], a[200:203], v[128:131]
v_accvgpr_read_b32 v196, a80
v_accvgpr_read_b32 v197, a81
v_mfma_f32_16x16x32_bf16 v[224:227], a[0:3], a[128:131], v[224:227]
v_accvgpr_read_b32 v198, a82
v_accvgpr_read_b32 v199, a83
v_mfma_f32_16x16x32_bf16 v[132:135], a[4:7], a[200:203], v[132:135]
s_waitcnt vmcnt(15) lgkmcnt(0)
s_barrier
ds_read_b128 a[204:207], v205 offset:20480
v_mfma_f32_16x16x32_bf16 v[228:231], a[4:7], a[128:131], v[228:231]
s_add_u32 m0, s63, 40960
ds_read_b128 a[132:135], v201 offset:20480
v_mul_f32 v80, v196, v80
v_mfma_f32_16x16x32_bf16 v[136:139], a[8:11], a[200:203], v[136:139]
ds_read_b128 a[32:35], v207 offset:0
buffer_load_dwordx4 v200, s[20:23], s67 offen sc1 lds
v_mul_f32 v81, v197, v81
v_mfma_f32_16x16x32_bf16 v[232:235], a[8:11], a[128:131], v[232:235]
ds_read_b128 a[36:39], v207 offset:1024
v_mul_f32 v82, v198, v82
v_mfma_f32_16x16x32_bf16 v[140:143], a[12:15], a[200:203], v[140:143]
ds_read_b128 a[40:43], v207 offset:2048
buffer_load_dwordx4 v200, s[20:23], s67 offen offset:1024 sc1 lds
v_mfma_f32_16x16x32_bf16 v[236:239], a[12:15], a[128:131], v[236:239]
s_add_u32 s67, s67, s33
ds_read_b128 a[44:47], v207 offset:3072
v_mul_f32 v83, v199, v83
v_mfma_f32_16x16x32_bf16 v[144:147], a[16:19], a[200:203], v[144:147]
s_add_u32 m0, s93, 132608
ds_read_b128 a[48:51], v207 offset:4096
v_accvgpr_read_b32 v196, a112
v_mfma_f32_16x16x32_bf16 v[240:243], a[16:19], a[128:131], v[240:243]
ds_read_b128 a[52:55], v207 offset:5120
buffer_load_dwordx4 v219, s[28:31], 0 offen offset:512 lds
v_accvgpr_read_b32 v197, a113
v_mfma_f32_16x16x32_bf16 v[148:151], a[20:23], a[200:203], v[148:151]
ds_read_b128 a[56:59], v207 offset:6144
v_accvgpr_read_b32 v198, a114
v_mfma_f32_16x16x32_bf16 v[244:247], a[20:23], a[128:131], v[244:247]
ds_read_b128 a[60:63], v207 offset:7168
v_accvgpr_read_b32 v199, a115
v_mfma_f32_16x16x32_bf16 v[152:155], a[24:27], a[200:203], v[152:155]
s_add_u32 m0, s93, 9344
v_mul_f32 v112, v196, v112
v_mul_f32 v113, v197, v113
v_mfma_f32_16x16x32_bf16 v[248:251], a[24:27], a[128:131], v[248:251]
buffer_load_dwordx4 v219, s[28:31], 0 offen offset:896 lds
v_mul_f32 v114, v198, v114
v_mfma_f32_16x16x32_bf16 v[156:159], a[28:31], a[200:203], v[156:159]
v_mul_f32 v115, v199, v115
v_cvt_pk_bf16_f32 v80, v80, v81
v_cvt_pk_bf16_f32 v81, v82, v83
v_mfma_f32_16x16x32_bf16 v[252:255], a[28:31], a[128:131], v[252:255]
s_waitcnt lgkmcnt(2)
v_cvt_pk_bf16_f32 v82, v112, v113
v_cvt_pk_bf16_f32 v83, v114, v115
v_mfma_f32_16x16x32_bf16 v[128:131], a[32:35], a[204:207], v[128:131]
v_accvgpr_read_b32 v196, a84
v_accvgpr_read_b32 v197, a85
v_mfma_f32_16x16x32_bf16 v[224:227], a[32:35], a[132:135], v[224:227]
v_accvgpr_read_b32 v198, a86
v_accvgpr_read_b32 v199, a87
v_mfma_f32_16x16x32_bf16 v[132:135], a[36:39], a[204:207], v[132:135]
s_waitcnt vmcnt(18) lgkmcnt(0)
s_barrier
ds_read_b128 a[200:203], v205 offset:21504
v_mfma_f32_16x16x32_bf16 v[228:231], a[36:39], a[132:135], v[228:231]
s_add_u32 m0, s63, 61440
ds_read_b128 a[128:131], v201 offset:21504
v_mul_f32 v84, v196, v84
v_mfma_f32_16x16x32_bf16 v[136:139], a[40:43], a[204:207], v[136:139]
ds_read_b128 a[0:3], v207 offset:20480
buffer_load_dwordx4 v200, s[20:23], s67 offen sc1 lds
v_mul_f32 v85, v197, v85
v_mfma_f32_16x16x32_bf16 v[232:235], a[40:43], a[132:135], v[232:235]
ds_read_b128 a[4:7], v207 offset:21504
v_mul_f32 v86, v198, v86
v_mfma_f32_16x16x32_bf16 v[140:143], a[44:47], a[204:207], v[140:143]
ds_read_b128 a[8:11], v207 offset:22528
buffer_load_dwordx4 v200, s[20:23], s67 offen offset:1024 sc1 lds
v_mfma_f32_16x16x32_bf16 v[236:239], a[44:47], a[132:135], v[236:239]
s_add_u32 s67, s67, s33
ds_read_b128 a[12:15], v207 offset:23552
v_mul_f32 v87, v199, v87
v_mfma_f32_16x16x32_bf16 v[144:147], a[48:51], a[204:207], v[144:147]
s_add_u32 m0, s93, 150976
ds_read_b128 a[16:19], v207 offset:24576
v_accvgpr_read_b32 v196, a116
v_mfma_f32_16x16x32_bf16 v[240:243], a[48:51], a[132:135], v[240:243]
ds_read_b128 a[20:23], v207 offset:25600
buffer_load_dwordx4 v219, s[28:31], 0 offen offset:576 lds
v_accvgpr_read_b32 v197, a117
v_mfma_f32_16x16x32_bf16 v[148:151], a[52:55], a[204:207], v[148:151]
ds_read_b128 a[24:27], v207 offset:26624
v_accvgpr_read_b32 v198, a118
v_mfma_f32_16x16x32_bf16 v[244:247], a[52:55], a[132:135], v[244:247]
ds_read_b128 a[28:31], v207 offset:27648
v_accvgpr_read_b32 v199, a119
v_mfma_f32_16x16x32_bf16 v[152:155], a[56:59], a[204:207], v[152:155]
s_add_u32 m0, s93, 27712
v_mul_f32 v116, v196, v116
v_mul_f32 v117, v197, v117
v_mfma_f32_16x16x32_bf16 v[248:251], a[56:59], a[132:135], v[248:251]
buffer_load_dwordx4 v219, s[28:31], 0 offen offset:960 lds
v_mul_f32 v118, v198, v118
v_mfma_f32_16x16x32_bf16 v[156:159], a[60:63], a[204:207], v[156:159]
v_mul_f32 v119, v199, v119
v_cvt_pk_bf16_f32 v84, v84, v85
v_cvt_pk_bf16_f32 v85, v86, v87
v_mfma_f32_16x16x32_bf16 v[252:255], a[60:63], a[132:135], v[252:255]
s_waitcnt lgkmcnt(2)
v_cvt_pk_bf16_f32 v86, v116, v117
v_cvt_pk_bf16_f32 v87, v118, v119
v_mfma_f32_16x16x32_bf16 v[128:131], a[0:3], a[200:203], v[128:131]
v_accvgpr_read_b32 v196, a88
v_accvgpr_read_b32 v197, a89
v_mfma_f32_16x16x32_bf16 v[224:227], a[0:3], a[128:131], v[224:227]
v_accvgpr_read_b32 v198, a90
v_accvgpr_read_b32 v199, a91
v_mfma_f32_16x16x32_bf16 v[132:135], a[4:7], a[200:203], v[132:135]
s_waitcnt vmcnt(21) lgkmcnt(0)
s_barrier
ds_read_b128 a[204:207], v205 offset:22528
v_mfma_f32_16x16x32_bf16 v[228:231], a[4:7], a[128:131], v[228:231]
s_add_u32 m0, s63, 81920
ds_read_b128 a[132:135], v201 offset:22528
v_mul_f32 v88, v196, v88
v_mfma_f32_16x16x32_bf16 v[136:139], a[8:11], a[200:203], v[136:139]
ds_read_b128 a[32:35], v207 offset:40960
buffer_load_dwordx4 v200, s[20:23], s67 offen sc1 lds
v_mul_f32 v89, v197, v89
v_mfma_f32_16x16x32_bf16 v[232:235], a[8:11], a[128:131], v[232:235]
ds_read_b128 a[36:39], v207 offset:41984
v_mul_f32 v90, v198, v90
v_mfma_f32_16x16x32_bf16 v[140:143], a[12:15], a[200:203], v[140:143]
ds_read_b128 a[40:43], v207 offset:43008
buffer_load_dwordx4 v200, s[20:23], s67 offen offset:1024 sc1 lds
v_mfma_f32_16x16x32_bf16 v[236:239], a[12:15], a[128:131], v[236:239]
s_add_u32 s67, s67, s33
ds_read_b128 a[44:47], v207 offset:44032
v_mul_f32 v91, v199, v91
v_mfma_f32_16x16x32_bf16 v[144:147], a[16:19], a[200:203], v[144:147]
s_add_u32 m0, s93, 151936
ds_read_b128 a[48:51], v207 offset:45056
buffer_store_dwordx4 v[64:67], v200, s[20:23], s94 offen sc1
v_mfma_f32_16x16x32_bf16 v[240:243], a[16:19], a[128:131], v[240:243]
s_add_u32 s94, s94, 184320
ds_read_b128 a[52:55], v207 offset:46080
buffer_load_dwordx4 v219, s[28:31], 0 offen offset:640 lds
v_accvgpr_read_b32 v196, a120
v_mfma_f32_16x16x32_bf16 v[148:151], a[20:23], a[200:203], v[148:151]
ds_read_b128 a[56:59], v207 offset:47104
v_accvgpr_read_b32 v197, a121
v_mfma_f32_16x16x32_bf16 v[244:247], a[20:23], a[128:131], v[244:247]
ds_read_b128 a[60:63], v207 offset:48128
v_accvgpr_read_b32 v198, a122
v_mfma_f32_16x16x32_bf16 v[152:155], a[24:27], a[200:203], v[152:155]
s_add_u32 m0, s93, 28672
buffer_store_dwordx4 v[68:71], v200, s[20:23], s94 offen sc1
v_accvgpr_read_b32 v199, a123
v_mfma_f32_16x16x32_bf16 v[248:251], a[24:27], a[128:131], v[248:251]
s_add_u32 s94, s94, 184320
buffer_load_dwordx4 v219, s[28:31], 0 offen offset:1024 lds
v_mul_f32 v120, v196, v120
v_mfma_f32_16x16x32_bf16 v[156:159], a[28:31], a[200:203], v[156:159]
v_mul_f32 v121, v197, v121
v_mul_f32 v122, v198, v122
v_mul_f32 v123, v199, v123
v_mfma_f32_16x16x32_bf16 v[252:255], a[28:31], a[128:131], v[252:255]
s_waitcnt lgkmcnt(2)
v_cvt_pk_bf16_f32 v88, v88, v89
v_cvt_pk_bf16_f32 v89, v90, v91
v_mfma_f32_16x16x32_bf16 v[128:131], a[32:35], a[204:207], v[128:131]
v_cvt_pk_bf16_f32 v90, v120, v121
v_cvt_pk_bf16_f32 v91, v122, v123
v_mfma_f32_16x16x32_bf16 v[224:227], a[32:35], a[132:135], v[224:227]
v_accvgpr_read_b32 v196, a92
v_accvgpr_read_b32 v197, a93
v_mfma_f32_16x16x32_bf16 v[132:135], a[36:39], a[204:207], v[132:135]
s_waitcnt vmcnt(19) lgkmcnt(0)
s_barrier
ds_read_b128 a[200:203], v205 offset:40960
v_mfma_f32_16x16x32_bf16 v[228:231], a[36:39], a[132:135], v[228:231]
s_add_u32 m0, s63, 102400
ds_read_b128 a[128:131], v201 offset:0
v_accvgpr_read_b32 v198, a94
v_mfma_f32_16x16x32_bf16 v[136:139], a[40:43], a[204:207], v[136:139]
ds_read_b128 a[0:3], v208 offset:0
buffer_load_dwordx4 v200, s[20:23], s67 offen sc1 lds
v_accvgpr_read_b32 v199, a95
v_mfma_f32_16x16x32_bf16 v[232:235], a[40:43], a[132:135], v[232:235]
ds_read_b128 a[4:7], v208 offset:1024
v_mul_f32 v92, v196, v92
v_mfma_f32_16x16x32_bf16 v[140:143], a[44:47], a[204:207], v[140:143]
ds_read_b128 a[8:11], v208 offset:2048
buffer_load_dwordx4 v200, s[20:23], s67 offen offset:1024 sc1 lds
v_mfma_f32_16x16x32_bf16 v[236:239], a[44:47], a[132:135], v[236:239]
s_add_u32 s67, s67, s33
ds_read_b128 a[12:15], v208 offset:3072
v_mul_f32 v93, v197, v93
v_mfma_f32_16x16x32_bf16 v[144:147], a[48:51], a[204:207], v[144:147]
s_add_u32 m0, s93, 152896
ds_read_b128 a[16:19], v208 offset:4096
buffer_store_dwordx4 v[72:75], v200, s[20:23], s94 offen sc1
v_mfma_f32_16x16x32_bf16 v[240:243], a[48:51], a[132:135], v[240:243]
s_add_u32 s94, s94, 184320
ds_read_b128 a[20:23], v208 offset:5120
buffer_load_dwordx4 v219, s[28:31], 0 offen offset:704 lds
v_mul_f32 v94, v198, v94
v_mfma_f32_16x16x32_bf16 v[148:151], a[52:55], a[204:207], v[148:151]
ds_read_b128 a[24:27], v208 offset:6144
v_mul_f32 v95, v199, v95
v_mfma_f32_16x16x32_bf16 v[244:247], a[52:55], a[132:135], v[244:247]
ds_read_b128 a[28:31], v208 offset:7168
v_accvgpr_read_b32 v196, a124
v_mfma_f32_16x16x32_bf16 v[152:155], a[56:59], a[204:207], v[152:155]
s_add_u32 m0, s93, 29632
buffer_store_dwordx4 v[76:79], v200, s[20:23], s94 offen sc1
v_accvgpr_read_b32 v197, a125
v_mfma_f32_16x16x32_bf16 v[248:251], a[56:59], a[132:135], v[248:251]
s_add_u32 s94, s94, 184320
buffer_load_dwordx4 v219, s[28:31], 0 offen offset:1088 lds
v_accvgpr_read_b32 v198, a126
v_mfma_f32_16x16x32_bf16 v[156:159], a[60:63], a[204:207], v[156:159]
v_accvgpr_read_b32 v199, a127
v_mul_f32 v124, v196, v124
v_mul_f32 v125, v197, v125
v_mfma_f32_16x16x32_bf16 v[252:255], a[60:63], a[132:135], v[252:255]
s_waitcnt lgkmcnt(2)
v_mul_f32 v126, v198, v126
v_mul_f32 v127, v199, v127
v_mfma_f32_16x16x32_bf16 v[128:131], a[0:3], a[200:203], v[128:131]
v_cvt_pk_bf16_f32 v92, v92, v93
v_cvt_pk_bf16_f32 v93, v94, v95
v_mfma_f32_16x16x32_bf16 v[224:227], a[0:3], a[128:131], v[224:227]
v_cvt_pk_bf16_f32 v94, v124, v125
v_cvt_pk_bf16_f32 v95, v126, v127
v_mfma_f32_16x16x32_bf16 v[132:135], a[4:7], a[200:203], v[132:135]
s_waitcnt vmcnt(21) lgkmcnt(0)
s_barrier
ds_read_b128 a[204:207], v205 offset:41984
v_mfma_f32_16x16x32_bf16 v[228:231], a[4:7], a[128:131], v[228:231]
s_add_u32 m0, s63, 122880
ds_read_b128 a[132:135], v201 offset:1024
v_lshlrev_b32 v192, 16, v192
v_mfma_f32_16x16x32_bf16 v[136:139], a[8:11], a[200:203], v[136:139]
ds_read_b128 a[32:35], v208 offset:20480
buffer_load_dwordx4 v200, s[20:23], s67 offen sc1 lds
v_lshlrev_b32 v193, 16, v193
v_mfma_f32_16x16x32_bf16 v[232:235], a[8:11], a[128:131], v[232:235]
ds_read_b128 a[36:39], v208 offset:21504
v_lshlrev_b32 v194, 16, v194
v_mfma_f32_16x16x32_bf16 v[140:143], a[12:15], a[200:203], v[140:143]
ds_read_b128 a[40:43], v208 offset:22528
buffer_load_dwordx4 v200, s[20:23], s67 offen offset:1024 sc1 lds
v_mfma_f32_16x16x32_bf16 v[236:239], a[12:15], a[128:131], v[236:239]
s_add_u32 s67, s67, s33
ds_read_b128 a[44:47], v208 offset:23552
v_mul_f32 v194, 1069066811, v194
v_mfma_f32_16x16x32_bf16 v[144:147], a[16:19], a[200:203], v[144:147]
ds_read_b128 a[48:51], v208 offset:24576
buffer_store_dwordx4 v[80:83], v200, s[20:23], s94 offen sc1
v_mfma_f32_16x16x32_bf16 v[240:243], a[16:19], a[128:131], v[240:243]
s_add_u32 s94, s94, 184320
ds_read_b128 a[52:55], v208 offset:25600
v_exp_f32 v194, v194
s_nop 0
v_cvt_pk_bf16_f32 v194, v194, v194
v_mfma_f32_16x16x32_bf16 v[148:151], a[20:23], a[200:203], v[148:151]
ds_read_b128 a[56:59], v208 offset:26624
v_lshlrev_b32 v194, 16, v194
v_mfma_f32_16x16x32_bf16 v[244:247], a[20:23], a[128:131], v[244:247]
ds_read_b128 a[60:63], v208 offset:27648
v_mul_f32 v160, v194, v192
v_mfma_f32_16x16x32_bf16 v[152:155], a[24:27], a[200:203], v[152:155]
buffer_store_dwordx4 v[84:87], v200, s[20:23], s94 offen sc1
v_mul_f32 v161, v194, v193
v_mfma_f32_16x16x32_bf16 v[248:251], a[24:27], a[128:131], v[248:251]
s_add_u32 s94, s94, 184320
v_mul_f32 v160, 1069066811, v160
v_exp_f32 v160, v160
v_mfma_f32_16x16x32_bf16 v[156:159], a[28:31], a[200:203], v[156:159]
v_mul_f32 v161, 0.15915494, v161
v_rndne_f32 v162, v161
v_sub_f32 v161, v161, v162
v_mfma_f32_16x16x32_bf16 v[252:255], a[28:31], a[128:131], v[252:255]
s_waitcnt lgkmcnt(2)
v_cos_f32 v162, v161
v_sin_f32 v163, v161
v_mfma_f32_16x16x32_bf16 v[128:131], a[32:35], a[204:207], v[128:131]
v_mul_f32 v209, v160, v162
v_mul_f32 v210, v160, v163
v_mfma_f32_16x16x32_bf16 v[224:227], a[32:35], a[132:135], v[224:227]
v_mul_f32 v160, v192, v192
v_fmac_f32 v160, v193, v193
v_mfma_f32_16x16x32_bf16 v[132:135], a[36:39], a[204:207], v[132:135]
s_waitcnt vmcnt(21) lgkmcnt(0)
s_barrier
ds_read_b128 a[200:203], v205 offset:43008
v_mfma_f32_16x16x32_bf16 v[228:231], a[36:39], a[132:135], v[228:231]
s_add_u32 m0, s63, 143360
ds_read_b128 a[128:131], v201 offset:2048
v_rcp_f32 v160, v160
v_mfma_f32_16x16x32_bf16 v[136:139], a[40:43], a[204:207], v[136:139]
ds_read_b128 a[0:3], v204 offset:0
buffer_load_dwordx4 v200, s[20:23], s67 offen sc1 lds
v_add_f32 v161, -1.0, v209
v_mfma_f32_16x16x32_bf16 v[232:235], a[40:43], a[132:135], v[232:235]
ds_read_b128 a[4:7], v204 offset:1024
v_add_f32 v160, v160, v160
v_mfma_f32_16x16x32_bf16 v[140:143], a[44:47], a[204:207], v[140:143]
ds_read_b128 a[8:11], v204 offset:2048
buffer_load_dwordx4 v200, s[20:23], s67 offen offset:1024 sc1 lds
v_mfma_f32_16x16x32_bf16 v[236:239], a[44:47], a[132:135], v[236:239]
s_add_u32 s67, s67, s33
ds_read_b128 a[12:15], v204 offset:3072
v_mul_f32 v162, v161, v192
v_mfma_f32_16x16x32_bf16 v[144:147], a[48:51], a[204:207], v[144:147]
ds_read_b128 a[16:19], v204 offset:4096
buffer_store_dwordx4 v[88:91], v200, s[20:23], s94 offen sc1
v_mfma_f32_16x16x32_bf16 v[240:243], a[48:51], a[132:135], v[240:243]
s_add_u32 s94, s94, 184320
ds_read_b128 a[20:23], v204 offset:5120
v_fmac_f32 v162, v210, v193
v_mul_f32 v211, v162, v160
v_mfma_f32_16x16x32_bf16 v[148:151], a[52:55], a[204:207], v[148:151]
ds_read_b128 a[24:27], v204 offset:6144
v_mul_f32 v162, v210, v192
v_mfma_f32_16x16x32_bf16 v[244:247], a[52:55], a[132:135], v[244:247]
ds_read_b128 a[28:31], v204 offset:7168
v_fma_f32 v162, -v161, v193, v162
v_mfma_f32_16x16x32_bf16 v[152:155], a[56:59], a[204:207], v[152:155]
buffer_store_dwordx4 v[92:95], v200, s[20:23], s94 offen sc1
v_mul_f32 v212, v162, v160
v_mfma_f32_16x16x32_bf16 v[248:251], a[56:59], a[132:135], v[248:251]
s_add_u32 s94, s94, 184320
v_mov_b32 v160, v209
v_sub_f32 v161, 0, v210
v_mfma_f32_16x16x32_bf16 v[156:159], a[60:63], a[204:207], v[156:159]
v_mul_f32 v162, v161, v161
v_mul_f32 v163, v160, v161
v_fma_f32 v160, v160, v160, -v162
v_mfma_f32_16x16x32_bf16 v[252:255], a[60:63], a[132:135], v[252:255]
s_waitcnt lgkmcnt(2)
v_add_f32 v161, v163, v163
v_mul_f32 v162, v161, v161
v_mfma_f32_16x16x32_bf16 v[128:131], a[0:3], a[200:203], v[128:131]
v_mul_f32 v163, v160, v161
v_fma_f32 v160, v160, v160, -v162
v_mfma_f32_16x16x32_bf16 v[224:227], a[0:3], a[128:131], v[224:227]
v_add_f32 v161, v163, v163
v_mul_f32 v162, v161, v161
v_mfma_f32_16x16x32_bf16 v[132:135], a[4:7], a[200:203], v[132:135]
s_waitcnt vmcnt(21) lgkmcnt(0)
s_barrier
ds_read_b128 a[204:207], v206 offset:0
v_mfma_f32_16x16x32_bf16 v[228:231], a[4:7], a[128:131], v[228:231]
s_add_u32 m0, s63, 0
ds_read_b128 a[132:135], v201 offset:20480
v_mul_f32 v163, v160, v161
v_mfma_f32_16x16x32_bf16 v[136:139], a[8:11], a[200:203], v[136:139]
ds_read_b128 a[32:35], v204 offset:20480
buffer_load_dwordx4 v200, s[20:23], s67 offen sc1 lds
v_fma_f32 v160, v160, v160, -v162
v_mfma_f32_16x16x32_bf16 v[232:235], a[8:11], a[128:131], v[232:235]
ds_read_b128 a[36:39], v204 offset:21504
v_add_f32 v161, v163, v163
v_mfma_f32_16x16x32_bf16 v[140:143], a[12:15], a[200:203], v[140:143]
ds_read_b128 a[40:43], v204 offset:22528
buffer_load_dwordx4 v200, s[20:23], s67 offen offset:1024 sc1 lds
v_mfma_f32_16x16x32_bf16 v[236:239], a[12:15], a[128:131], v[236:239]
s_add_u32 s67, s67, s33
ds_read_b128 a[44:47], v204 offset:23552
v_mul_f32 v162, v161, v161
v_mfma_f32_16x16x32_bf16 v[144:147], a[16:19], a[200:203], v[144:147]
ds_read_b128 a[48:51], v204 offset:24576
v_mul_f32 v163, v160, v161
v_mfma_f32_16x16x32_bf16 v[240:243], a[16:19], a[128:131], v[240:243]
ds_read_b128 a[52:55], v204 offset:25600
v_fma_f32 v160, v160, v160, -v162
v_add_f32 v161, v163, v163
v_mfma_f32_16x16x32_bf16 v[148:151], a[20:23], a[200:203], v[148:151]
ds_read_b128 a[56:59], v204 offset:26624
v_mul_f32 v162, v161, v161
v_mfma_f32_16x16x32_bf16 v[244:247], a[20:23], a[128:131], v[244:247]
ds_read_b128 a[60:63], v204 offset:27648
v_mul_f32 v163, v160, v161
v_mfma_f32_16x16x32_bf16 v[152:155], a[24:27], a[200:203], v[152:155]
v_fma_f32 v160, v160, v160, -v162
v_add_f32 v161, v163, v163
v_mfma_f32_16x16x32_bf16 v[248:251], a[24:27], a[128:131], v[248:251]
v_mov_b32 v213, v160
v_mov_b32 v214, v161
v_mfma_f32_16x16x32_bf16 v[156:159], a[28:31], a[200:203], v[156:159]
v_mul_f32 v162, v161, v161
v_mul_f32 v163, v160, v161
T_d_2:
s_cbranch_execz T_r1
v_fma_f32 v160, v160, v160, -v162
v_mfma_f32_16x16x32_bf16 v[252:255], a[28:31], a[128:131], v[252:255]
s_waitcnt lgkmcnt(3)
v_add_f32 v161, v163, v163
v_mul_f32 v162, v161, v161
v_mfma_f32_16x16x32_bf16 v[128:131], a[32:35], a[204:207], v[128:131]
v_mul_f32 v163, v160, v161
v_fma_f32 v160, v160, v160, -v162
v_mfma_f32_16x16x32_bf16 v[224:227], a[32:35], a[132:135], v[224:227]
v_add_f32 v161, v163, v163
v_mov_b32 v215, v160
v_mfma_f32_16x16x32_bf16 v[132:135], a[36:39], a[204:207], v[132:135]
s_waitcnt vmcnt(18) lgkmcnt(0)
s_barrier
ds_read_b128 a[200:203], v206 offset:1024
v_mfma_f32_16x16x32_bf16 v[228:231], a[36:39], a[132:135], v[228:231]
s_add_u32 m0, s63, 20480
ds_read_b128 a[128:131], v201 offset:21504
v_mov_b32 v216, v161
v_mfma_f32_16x16x32_bf16 v[136:139], a[40:43], a[204:207], v[136:139]
ds_read_b128 a[0:3], v204 offset:40960
buffer_load_dwordx4 v200, s[20:23], s67 offen sc1 lds
v_mul_f32 v162, v161, v161
v_mfma_f32_16x16x32_bf16 v[232:235], a[40:43], a[132:135], v[232:235]
ds_read_b128 a[4:7], v204 offset:41984
v_mul_f32 v163, v160, v161
v_mfma_f32_16x16x32_bf16 v[140:143], a[44:47], a[204:207], v[140:143]
ds_read_b128 a[8:11], v204 offset:43008
buffer_load_dwordx4 v200, s[20:23], s67 offen offset:1024 sc1 lds
v_mfma_f32_16x16x32_bf16 v[236:239], a[44:47], a[132:135], v[236:239]
s_add_u32 s67, s67, s33
ds_read_b128 a[12:15], v204 offset:44032
v_fma_f32 v160, v160, v160, -v162
v_mfma_f32_16x16x32_bf16 v[144:147], a[48:51], a[204:207], v[144:147]
ds_read_b128 a[16:19], v204 offset:45056
v_add_f32 v161, v163, v163
v_mfma_f32_16x16x32_bf16 v[240:243], a[48:51], a[132:135], v[240:243]
ds_read_b128 a[20:23], v204 offset:46080
v_mul_f32 v162, v161, v161
v_mul_f32 v163, v160, v161
v_mfma_f32_16x16x32_bf16 v[148:151], a[52:55], a[204:207], v[148:151]
ds_read_b128 a[24:27], v204 offset:47104
v_fma_f32 v160, v160, v160, -v162
v_mfma_f32_16x16x32_bf16 v[244:247], a[52:55], a[132:135], v[244:247]
ds_read_b128 a[28:31], v204 offset:48128
v_add_f32 v161, v163, v163
v_mfma_f32_16x16x32_bf16 v[152:155], a[56:59], a[204:207], v[152:155]
v_mov_b32 v217, v160
v_mov_b32 v218, v161
v_mfma_f32_16x16x32_bf16 v[248:251], a[56:59], a[132:135], v[248:251]
s_lshl_b32 s37, s62, 12
s_add_u32 s37, s37, 4194304
s_lshl_b32 s36, s55, 8
v_mfma_f32_16x16x32_bf16 v[156:159], a[60:63], a[204:207], v[156:159]
s_add_u32 s36, s36, s37
s_sub_u32 s18, s55, 16
v_and_b32 v176, 0xf0, v200
v_lshrrev_b32 v177, 8, v200
v_mfma_f32_16x16x32_bf16 v[252:255], a[60:63], a[132:135], v[252:255]
s_waitcnt lgkmcnt(2)
v_lshl_add_u32 v178, v177, 28, v176
v_lshl_add_u32 v177, v177, 2, s18
v_mfma_f32_16x16x32_bf16 v[128:131], a[0:3], a[200:203], v[128:131]
v_mov_b32 v173, s96
v_mov_b32 v175, s96
v_mfma_f32_16x16x32_bf16 v[224:227], a[0:3], a[128:131], v[224:227]
v_add_u32 v179, 0, v177
v_and_b32 v179, 0xbfffff, v179
v_mfma_f32_16x16x32_bf16 v[132:135], a[4:7], a[200:203], v[132:135]
s_waitcnt vmcnt(14) lgkmcnt(0)
s_barrier
ds_read_b128 a[204:207], v206 offset:2048
v_mfma_f32_16x16x32_bf16 v[228:231], a[4:7], a[128:131], v[228:231]
ds_read_b128 a[132:135], v201 offset:22528
v_lshl_add_u32 v180, v179, 8, v176
v_mfma_f32_16x16x32_bf16 v[136:139], a[8:11], a[200:203], v[136:139]
ds_read_b128 a[32:35], v207 offset:0
v_add_u32 v179, 1, v177
v_and_b32 v179, 0xbfffff, v179
v_mfma_f32_16x16x32_bf16 v[232:235], a[8:11], a[128:131], v[232:235]
ds_read_b128 a[36:39], v207 offset:1024
v_lshl_add_u32 v181, v179, 8, v176
v_mfma_f32_16x16x32_bf16 v[140:143], a[12:15], a[200:203], v[140:143]
ds_read_b128 a[40:43], v207 offset:2048
v_add_u32 v179, 2, v177
v_mfma_f32_16x16x32_bf16 v[236:239], a[12:15], a[128:131], v[236:239]
ds_read_b128 a[44:47], v207 offset:3072
v_and_b32 v179, 0xbfffff, v179
v_mfma_f32_16x16x32_bf16 v[144:147], a[16:19], a[200:203], v[144:147]
ds_read_b128 a[48:51], v207 offset:4096
v_lshl_add_u32 v182, v179, 8, v176
v_mfma_f32_16x16x32_bf16 v[240:243], a[16:19], a[128:131], v[240:243]
ds_read_b128 a[52:55], v207 offset:5120
v_add_u32 v179, 3, v177
v_and_b32 v179, 0xbfffff, v179
v_mfma_f32_16x16x32_bf16 v[148:151], a[20:23], a[200:203], v[148:151]
ds_read_b128 a[56:59], v207 offset:6144
v_lshl_add_u32 v183, v179, 8, v176
v_mfma_f32_16x16x32_bf16 v[244:247], a[20:23], a[128:131], v[244:247]
s_mul_i32 s88, s55, 1474560
ds_read_b128 a[60:63], v207 offset:7168
s_add_u32 s88, s88, 10485760
v_mfma_f32_16x16x32_bf16 v[152:155], a[24:27], a[200:203], v[152:155]
s_lshl_b32 s46, s3, 13
s_add_u32 s46, s46, 40960
v_mfma_f32_16x16x32_bf16 v[248:251], a[24:27], a[128:131], v[248:251]
v_mfma_f32_16x16x32_bf16 v[156:159], a[28:31], a[200:203], v[156:159]
v_mfma_f32_16x16x32_bf16 v[252:255], a[28:31], a[128:131], v[252:255]
s_waitcnt lgkmcnt(4)
v_mfma_f32_16x16x32_bf16 v[128:131], a[32:35], a[204:207], v[128:131]
v_mfma_f32_16x16x32_bf16 v[224:227], a[32:35], a[132:135], v[224:227]
v_mfma_f32_16x16x32_bf16 v[132:135], a[36:39], a[204:207], v[132:135]
s_waitcnt lgkmcnt(0)
s_barrier
ds_read_b128 a[200:203], v206 offset:20480
v_mfma_f32_16x16x32_bf16 v[228:231], a[36:39], a[132:135], v[228:231]
ds_read_b128 a[128:131], v205 offset:0
v_mfma_f32_16x16x32_bf16 v[136:139], a[40:43], a[204:207], v[136:139]
ds_read_b128 a[0:3], v207 offset:20480
v_mfma_f32_16x16x32_bf16 v[232:235], a[40:43], a[132:135], v[232:235]
ds_read_b128 a[4:7], v207 offset:21504
v_mfma_f32_16x16x32_bf16 v[140:143], a[44:47], a[204:207], v[140:143]
ds_read_b128 a[8:11], v207 offset:22528
v_mfma_f32_16x16x32_bf16 v[236:239], a[44:47], a[132:135], v[236:239]
ds_read_b128 a[12:15], v207 offset:23552
v_mfma_f32_16x16x32_bf16 v[144:147], a[48:51], a[204:207], v[144:147]
ds_read_b128 a[16:19], v207 offset:24576
v_mfma_f32_16x16x32_bf16 v[240:243], a[48:51], a[132:135], v[240:243]
ds_read_b128 a[20:23], v207 offset:25600
v_mfma_f32_16x16x32_bf16 v[148:151], a[52:55], a[204:207], v[148:151]
ds_read_b128 a[24:27], v207 offset:26624
v_mfma_f32_16x16x32_bf16 v[244:247], a[52:55], a[132:135], v[244:247]
ds_read_b128 a[28:31], v207 offset:27648
v_mfma_f32_16x16x32_bf16 v[152:155], a[56:59], a[204:207], v[152:155]
v_mfma_f32_16x16x32_bf16 v[248:251], a[56:59], a[132:135], v[248:251]
v_mfma_f32_16x16x32_bf16 v[156:159], a[60:63], a[204:207], v[156:159]
v_mfma_f32_16x16x32_bf16 v[252:255], a[60:63], a[132:135], v[252:255]
s_waitcnt lgkmcnt(7)
v_mfma_f32_16x16x32_bf16 v[128:131], a[0:3], a[200:203], v[128:131]
v_mfma_f32_16x16x32_bf16 v[224:227], a[0:3], a[128:131], v[224:227]
s_waitcnt lgkmcnt(6)
v_mfma_f32_16x16x32_bf16 v[132:135], a[4:7], a[200:203], v[132:135]
s_waitcnt lgkmcnt(0)
s_barrier
ds_read_b128 a[204:207], v206 offset:21504
v_mfma_f32_16x16x32_bf16 v[228:231], a[4:7], a[128:131], v[228:231]
ds_read_b128 a[132:135], v205 offset:1024
v_mfma_f32_16x16x32_bf16 v[136:139], a[8:11], a[200:203], v[136:139]
ds_read_b128 a[32:35], v207 offset:40960
v_mfma_f32_16x16x32_bf16 v[232:235], a[8:11], a[128:131], v[232:235]
ds_read_b128 a[36:39], v207 offset:41984
v_mfma_f32_16x16x32_bf16 v[140:143], a[12:15], a[200:203], v[140:143]
ds_read_b128 a[40:43], v207 offset:43008
v_mfma_f32_16x16x32_bf16 v[236:239], a[12:15], a[128:131], v[236:239]
ds_read_b128 a[44:47], v207 offset:44032
v_mfma_f32_16x16x32_bf16 v[144:147], a[16:19], a[200:203], v[144:147]
ds_read_b128 a[48:51], v207 offset:45056
v_mfma_f32_16x16x32_bf16 v[240:243], a[16:19], a[128:131], v[240:243]
ds_read_b128 a[52:55], v207 offset:46080
v_mfma_f32_16x16x32_bf16 v[148:151], a[20:23], a[200:203], v[148:151]
ds_read_b128 a[56:59], v207 offset:47104
v_mfma_f32_16x16x32_bf16 v[244:247], a[20:23], a[128:131], v[244:247]
ds_read_b128 a[60:63], v207 offset:48128
v_mfma_f32_16x16x32_bf16 v[152:155], a[24:27], a[200:203], v[152:155]
v_mfma_f32_16x16x32_bf16 v[248:251], a[24:27], a[128:131], v[248:251]
v_mfma_f32_16x16x32_bf16 v[156:159], a[28:31], a[200:203], v[156:159]
v_mfma_f32_16x16x32_bf16 v[252:255], a[28:31], a[128:131], v[252:255]
s_waitcnt lgkmcnt(7)
v_mfma_f32_16x16x32_bf16 v[128:131], a[32:35], a[204:207], v[128:131]
v_mfma_f32_16x16x32_bf16 v[224:227], a[32:35], a[132:135], v[224:227]
s_waitcnt lgkmcnt(6)
v_mfma_f32_16x16x32_bf16 v[132:135], a[36:39], a[204:207], v[132:135]
s_waitcnt vmcnt(0) lgkmcnt(0)
s_barrier
ds_read_b128 a[200:203], v206 offset:22528
v_mfma_f32_16x16x32_bf16 v[228:231], a[36:39], a[132:135], v[228:231]
buffer_store_dword v223, v222, s[20:23], s45 offen offset:8 sc1
ds_read_b128 a[128:131], v205 offset:2048
v_mfma_f32_16x16x32_bf16 v[136:139], a[40:43], a[204:207], v[136:139]
ds_read_b128 a[0:3], v208 offset:0
v_mfma_f32_16x16x32_bf16 v[232:235], a[40:43], a[132:135], v[232:235]
ds_read_b128 a[4:7], v208 offset:1024
v_mfma_f32_16x16x32_bf16 v[140:143], a[44:47], a[204:207], v[140:143]
ds_read_b128 a[8:11], v208 offset:2048
v_mfma_f32_16x16x32_bf16 v[236:239], a[44:47], a[132:135], v[236:239]
ds_read_b128 a[12:15], v208 offset:3072
v_mfma_f32_16x16x32_bf16 v[144:147], a[48:51], a[204:207], v[144:147]
ds_read_b128 a[16:19], v208 offset:4096
v_mfma_f32_16x16x32_bf16 v[240:243], a[48:51], a[132:135], v[240:243]
ds_read_b128 a[20:23], v208 offset:5120
v_mfma_f32_16x16x32_bf16 v[148:151], a[52:55], a[204:207], v[148:151]
ds_read_b128 a[24:27], v208 offset:6144
v_mfma_f32_16x16x32_bf16 v[244:247], a[52:55], a[132:135], v[244:247]
ds_read_b128 a[28:31], v208 offset:7168
v_mfma_f32_16x16x32_bf16 v[152:155], a[56:59], a[204:207], v[152:155]
ds_read_b128 a[208:211], v206 offset:41984
v_mfma_f32_16x16x32_bf16 v[248:251], a[56:59], a[132:135], v[248:251]
ds_read_b128 a[212:215], v206 offset:43008
v_mfma_f32_16x16x32_bf16 v[156:159], a[60:63], a[204:207], v[156:159]
ds_read_b128 a[136:139], v205 offset:21504
v_mfma_f32_16x16x32_bf16 v[252:255], a[60:63], a[132:135], v[252:255]
s_waitcnt lgkmcnt(10)
ds_read_b128 a[140:143], v205 offset:22528
ds_read_b128 a[64:67], v204 offset:0
v_mfma_f32_16x16x32_bf16 v[128:131], a[0:3], a[200:203], v[128:131]
ds_read_b128 a[96:99], v204 offset:20480
ds_read_b128 a[204:207], v206 offset:40960
v_mfma_f32_16x16x32_bf16 v[224:227], a[0:3], a[128:131], v[224:227]
s_waitcnt lgkmcnt(2)
ds_read_b128 a[132:135], v205 offset:20480
v_mfma_f32_16x16x32_bf16 v[128:131], a[64:67], a[208:211], v[128:131]
ds_read_b128 a[32:35], v208 offset:20480
v_mfma_f32_16x16x32_bf16 v[224:227], a[64:67], a[136:139], v[224:227]
s_waitcnt lgkmcnt(3)
ds_read_b128 a[68:71], v204 offset:1024
v_mfma_f32_16x16x32_bf16 v[128:131], a[96:99], a[212:215], v[128:131]
ds_read_b128 a[100:103], v204 offset:21504
v_mfma_f32_16x16x32_bf16 v[224:227], a[96:99], a[140:143], v[224:227]
s_waitcnt lgkmcnt(2)
ds_read_b128 a[36:39], v208 offset:21504
v_mfma_f32_16x16x32_bf16 v[128:131], a[32:35], a[204:207], v[128:131]
ds_read_b128 a[72:75], v204 offset:2048
v_mfma_f32_16x16x32_bf16 v[224:227], a[32:35], a[132:135], v[224:227]
ds_read_b128 a[104:107], v204 offset:22528
v_mfma_f32_16x16x32_bf16 v[132:135], a[4:7], a[200:203], v[132:135]
ds_read_b128 a[40:43], v208 offset:22528
v_mfma_f32_16x16x32_bf16 v[228:231], a[4:7], a[128:131], v[228:231]
s_waitcnt lgkmcnt(5)
ds_read_b128 a[76:79], v204 offset:3072
v_fma_f32 v160, v209, v128, v129
v_mfma_f32_16x16x32_bf16 v[132:135], a[68:71], a[208:211], v[132:135]
ds_read_b128 a[108:111], v204 offset:23552
v_fma_f32 v161, v209, v224, v225
v_fma_f32 v160, -v210, v224, v160
v_mfma_f32_16x16x32_bf16 v[228:231], a[68:71], a[136:139], v[228:231]
s_waitcnt lgkmcnt(6)
ds_read_b128 a[44:47], v208 offset:23552
v_fma_f32 v161, v210, v128, v161
v_mfma_f32_16x16x32_bf16 v[132:135], a[100:103], a[212:215], v[132:135]
ds_read_b128 a[80:83], v204 offset:4096
v_fma_f32 v162, v209, v160, v130
v_fma_f32 v163, v209, v161, v226
v_mfma_f32_16x16x32_bf16 v[228:231], a[100:103], a[140:143], v[228:231]
s_waitcnt lgkmcnt(6)
ds_read_b128 a[112:115], v204 offset:24576
v_fma_f32 v162, -v210, v161, v162
v_mfma_f32_16x16x32_bf16 v[132:135], a[36:39], a[204:207], v[132:135]
ds_read_b128 a[48:51], v208 offset:24576
v_fma_f32 v163, v210, v160, v163
v_fma_f32 v160, v209, v162, v131
v_mfma_f32_16x16x32_bf16 v[228:231], a[36:39], a[132:135], v[228:231]
ds_read_b128 a[84:87], v204 offset:5120
v_fma_f32 v161, v209, v163, v227
v_mfma_f32_16x16x32_bf16 v[136:139], a[8:11], a[200:203], v[136:139]
ds_read_b128 a[116:119], v204 offset:25600
v_fma_f32 v160, -v210, v163, v160
v_fma_f32 v161, v210, v162, v161
v_mfma_f32_16x16x32_bf16 v[232:235], a[8:11], a[128:131], v[232:235]
ds_read_b128 a[52:55], v208 offset:25600
v_fma_f32 v162, v209, v160, v132
v_mfma_f32_16x16x32_bf16 v[136:139], a[72:75], a[208:211], v[136:139]
ds_read_b128 a[88:91], v204 offset:6144
v_fma_f32 v163, v209, v161, v228
v_fma_f32 v162, -v210, v161, v162
v_mfma_f32_16x16x32_bf16 v[232:235], a[72:75], a[136:139], v[232:235]
s_waitcnt lgkmcnt(5)
ds_read_b128 a[120:123], v204 offset:26624
v_fma_f32 v163, v210, v160, v163
v_mfma_f32_16x16x32_bf16 v[136:139], a[104:107], a[212:215], v[136:139]
ds_read_b128 a[56:59], v208 offset:26624
v_fma_f32 v160, v209, v162, v133
v_fma_f32 v161, v209, v163, v229
v_mfma_f32_16x16x32_bf16 v[232:235], a[104:107], a[140:143], v[232:235]
ds_read_b128 a[92:95], v204 offset:7168
v_fma_f32 v160, -v210, v163, v160
v_mfma_f32_16x16x32_bf16 v[136:139], a[40:43], a[204:207], v[136:139]
ds_read_b128 a[124:127], v204 offset:27648
v_fma_f32 v161, v210, v162, v161
v_fma_f32 v162, v209, v160, v134
v_mfma_f32_16x16x32_bf16 v[232:235], a[40:43], a[132:135], v[232:235]
ds_read_b128 a[60:63], v208 offset:27648
v_fma_f32 v163, v209, v161, v230
v_mfma_f32_16x16x32_bf16 v[140:143], a[12:15], a[200:203], v[140:143]
v_fma_f32 v162, -v210, v161, v162
v_fma_f32 v163, v210, v160, v163
v_fma_f32 v160, v209, v162, v135
v_mfma_f32_16x16x32_bf16 v[236:239], a[12:15], a[128:131], v[236:239]
v_fma_f32 v161, v209, v163, v231
v_fma_f32 v160, -v210, v163, v160
v_mfma_f32_16x16x32_bf16 v[140:143], a[76:79], a[208:211], v[140:143]
v_fma_f32 v161, v210, v162, v161
v_fma_f32 v162, v209, v160, v136
v_fma_f32 v163, v209, v161, v232
v_mfma_f32_16x16x32_bf16 v[236:239], a[76:79], a[136:139], v[236:239]
v_fma_f32 v162, -v210, v161, v162
v_fma_f32 v163, v210, v160, v163
v_mfma_f32_16x16x32_bf16 v[140:143], a[108:111], a[212:215], v[140:143]
v_fma_f32 v160, v209, v162, v137
v_fma_f32 v161, v209, v163, v233
v_fma_f32 v160, -v210, v163, v160
v_mfma_f32_16x16x32_bf16 v[236:239], a[108:111], a[140:143], v[236:239]
v_fma_f32 v161, v210, v162, v161
v_fma_f32 v162, v209, v160, v138
v_mfma_f32_16x16x32_bf16 v[140:143], a[44:47], a[204:207], v[140:143]
v_fma_f32 v163, v209, v161, v234
v_fma_f32 v162, -v210, v161, v162
v_fma_f32 v163, v210, v160, v163
v_mfma_f32_16x16x32_bf16 v[236:239], a[44:47], a[132:135], v[236:239]
v_fma_f32 v160, v209, v162, v139
v_fma_f32 v161, v209, v163, v235
v_mfma_f32_16x16x32_bf16 v[144:147], a[16:19], a[200:203], v[144:147]
v_fma_f32 v160, -v210, v163, v160
v_fma_f32 v161, v210, v162, v161
v_mfma_f32_16x16x32_bf16 v[240:243], a[16:19], a[128:131], v[240:243]
v_fma_f32 v162, v209, v160, v140
s_nop 0
v_fma_f32 v163, v209, v161, v236
v_mfma_f32_16x16x32_bf16 v[144:147], a[80:83], a[208:211], v[144:147]
v_fma_f32 v162, -v210, v161, v162
v_fma_f32 v163, v210, v160, v163
v_fma_f32 v160, v209, v162, v141
v_mfma_f32_16x16x32_bf16 v[240:243], a[80:83], a[136:139], v[240:243]
v_fma_f32 v161, v209, v163, v237
v_fma_f32 v160, -v210, v163, v160
v_mfma_f32_16x16x32_bf16 v[144:147], a[112:115], a[212:215], v[144:147]
v_fma_f32 v161, v210, v162, v161
v_fma_f32 v162, v209, v160, v142
v_fma_f32 v163, v209, v161, v238
v_mfma_f32_16x16x32_bf16 v[240:243], a[112:115], a[140:143], v[240:243]
s_waitcnt lgkmcnt(0)
v_fma_f32 v162, -v210, v161, v162
v_fma_f32 v163, v210, v160, v163
v_mfma_f32_16x16x32_bf16 v[144:147], a[48:51], a[204:207], v[144:147]
v_fma_f32 v160, v209, v162, v143
v_fma_f32 v161, v209, v163, v239
v_fma_f32 v160, -v210, v163, v160
v_mfma_f32_16x16x32_bf16 v[240:243], a[48:51], a[132:135], v[240:243]
v_fma_f32 v161, v210, v162, v161
v_mfma_f32_16x16x32_bf16 v[148:151], a[20:23], a[200:203], v[148:151]
v_mfma_f32_16x16x32_bf16 v[244:247], a[20:23], a[128:131], v[244:247]
s_nop 0
v_fma_f32 v162, v209, v160, v144
s_nop 2
v_fma_f32 v163, v209, v161, v240
v_mfma_f32_16x16x32_bf16 v[148:151], a[84:87], a[208:211], v[148:151]
v_fma_f32 v162, -v210, v161, v162
v_fma_f32 v163, v210, v160, v163
v_mfma_f32_16x16x32_bf16 v[244:247], a[84:87], a[136:139], v[244:247]
v_fma_f32 v160, v209, v162, v145
v_fma_f32 v161, v209, v163, v241
v_fma_f32 v160, -v210, v163, v160
v_mfma_f32_16x16x32_bf16 v[148:151], a[116:119], a[212:215], v[148:151]
v_fma_f32 v161, v210, v162, v161
v_fma_f32 v162, v209, v160, v146
v_mfma_f32_16x16x32_bf16 v[244:247], a[116:119], a[140:143], v[244:247]
v_fma_f32 v163, v209, v161, v242
v_fma_f32 v162, -v210, v161, v162
v_fma_f32 v163, v210, v160, v163
v_mfma_f32_16x16x32_bf16 v[148:151], a[52:55], a[204:207], v[148:151]
v_fma_f32 v160, v209, v162, v147
v_fma_f32 v161, v209, v163, v243
v_mfma_f32_16x16x32_bf16 v[244:247], a[52:55], a[132:135], v[244:247]
v_fma_f32 v160, -v210, v163, v160
v_fma_f32 v161, v210, v162, v161
v_mfma_f32_16x16x32_bf16 v[152:155], a[24:27], a[200:203], v[152:155]
v_mfma_f32_16x16x32_bf16 v[248:251], a[24:27], a[128:131], v[248:251]
s_nop 0
v_fma_f32 v162, v209, v160, v148
v_mfma_f32_16x16x32_bf16 v[152:155], a[88:91], a[208:211], v[152:155]
s_nop 0
v_fma_f32 v163, v209, v161, v244
v_fma_f32 v162, -v210, v161, v162
v_mfma_f32_16x16x32_bf16 v[248:251], a[88:91], a[136:139], v[248:251]
v_fma_f32 v163, v210, v160, v163
v_fma_f32 v160, v209, v162, v149
v_mfma_f32_16x16x32_bf16 v[152:155], a[120:123], a[212:215], v[152:155]
v_fma_f32 v161, v209, v163, v245
v_fma_f32 v160, -v210, v163, v160
v_fma_f32 v161, v210, v162, v161
v_mfma_f32_16x16x32_bf16 v[248:251], a[120:123], a[140:143], v[248:251]
v_fma_f32 v162, v209, v160, v150
v_fma_f32 v163, v209, v161, v246
v_mfma_f32_16x16x32_bf16 v[152:155], a[56:59], a[204:207], v[152:155]
v_fma_f32 v162, -v210, v161, v162
v_fma_f32 v163, v210, v160, v163
v_fma_f32 v160, v209, v162, v151
v_mfma_f32_16x16x32_bf16 v[248:251], a[56:59], a[132:135], v[248:251]
v_fma_f32 v161, v209, v163, v247
v_fma_f32 v160, -v210, v163, v160
v_mfma_f32_16x16x32_bf16 v[156:159], a[28:31], a[200:203], v[156:159]
v_fma_f32 v161, v210, v162, v161
v_mfma_f32_16x16x32_bf16 v[252:255], a[28:31], a[128:131], v[252:255]
v_fma_f32 v162, v209, v160, v152
s_nop 1
v_fma_f32 v163, v209, v161, v248
v_mfma_f32_16x16x32_bf16 v[156:159], a[92:95], a[208:211], v[156:159]
v_fma_f32 v162, -v210, v161, v162
v_fma_f32 v163, v210, v160, v163
v_fma_f32 v160, v209, v162, v153
v_mfma_f32_16x16x32_bf16 v[252:255], a[92:95], a[136:139], v[252:255]
v_fma_f32 v161, v209, v163, v249
v_fma_f32 v160, -v210, v163, v160
v_mfma_f32_16x16x32_bf16 v[156:159], a[124:127], a[212:215], v[156:159]
v_fma_f32 v161, v210, v162, v161
v_fma_f32 v162, v209, v160, v154
v_fma_f32 v163, v209, v161, v250
v_mfma_f32_16x16x32_bf16 v[252:255], a[124:127], a[140:143], v[252:255]
v_fma_f32 v162, -v210, v161, v162
v_fma_f32 v163, v210, v160, v163
v_mfma_f32_16x16x32_bf16 v[156:159], a[60:63], a[204:207], v[156:159]
v_fma_f32 v160, v209, v162, v155
v_fma_f32 v161, v209, v163, v251
v_fma_f32 v160, -v210, v163, v160
v_mfma_f32_16x16x32_bf16 v[252:255], a[60:63], a[132:135], v[252:255]
v_fma_f32 v161, v210, v162, v161
s_nop 2
v_fma_f32 v162, v209, v160, v156
s_nop 2
v_fma_f32 v163, v209, v161, v252
v_fma_f32 v162, -v210, v161, v162
v_fma_f32 v163, v210, v160, v163
v_fma_f32 v160, v209, v162, v157
v_fma_f32 v161, v209, v163, v253
v_fma_f32 v160, -v210, v163, v160
v_fma_f32 v161, v210, v162, v161
v_fma_f32 v162, v209, v160, v158
v_fma_f32 v163, v209, v161, v254
v_fma_f32 v162, -v210, v161, v162
v_fma_f32 v163, v210, v160, v163
v_fma_f32 v160, v209, v162, v159
v_fma_f32 v161, v209, v163, v255
v_fma_f32 v160, -v210, v163, v160
v_fma_f32 v161, v210, v162, v161
v_mul_f32 v164, v211, v160
v_mul_f32 v168, v211, v161
v_fma_f32 v164, -v212, v161, v164
v_fma_f32 v168, -v212, v160, -v168
v_mov_b32 v166, v164
v_mov_b32 v170, v168
s_nop 0
v_permlane32_swap_b32 v164, v166
v_permlane32_swap_b32 v168, v170
v_mov_b32 v165, v164
v_mov_b32 v167, v166
v_mov_b32 v169, v168
v_mov_b32 v171, v170
v_permlane16_swap_b32 v164, v165
v_permlane16_swap_b32 v166, v167
v_permlane16_swap_b32 v168, v169
v_permlane16_swap_b32 v170, v171
v_fma_f32 v160, v213, v164, v165
v_fma_f32 v161, v213, v168, v169
v_fma_f32 v160, -v214, v168, v160
v_fma_f32 v161, v214, v164, v161
v_fma_f32 v162, v213, v160, v166
v_fma_f32 v163, v213, v161, v170
v_fma_f32 v162, -v214, v161, v162
v_fma_f32 v163, v214, v160, v163
v_fma_f32 v172, v213, v162, v167
v_fma_f32 v174, v213, v163, v171
v_fma_f32 v172, -v214, v163, v172
v_fma_f32 v174, v214, v162, v174
buffer_store_dwordx4 v[172:175], v178, s[20:23], s36 offen sc1
buffer_load_dwordx4 v[184:187], v180, s[20:23], s37 offen sc1
buffer_load_dwordx4 v[188:191], v181, s[20:23], s37 offen sc1
buffer_load_dwordx4 v[192:195], v182, s[20:23], s37 offen sc1
buffer_load_dwordx4 v[196:199], v183, s[20:23], s37 offen sc1
v_mul_f32 v160, v211, v128
v_mul_f32 v161, v212, v128
v_fma_f32 v128, -v212, v224, v160
v_fma_f32 v224, -v211, v224, -v161
v_mul_f32 v162, v211, v129
v_mul_f32 v163, v212, v129
v_fma_f32 v129, -v212, v225, v162
v_fma_f32 v225, -v211, v225, -v163
v_mul_f32 v160, v211, v130
v_mul_f32 v161, v212, v130
v_fma_f32 v130, -v212, v226, v160
v_fma_f32 v226, -v211, v226, -v161
v_mul_f32 v162, v211, v131
v_mul_f32 v163, v212, v131
v_fma_f32 v131, -v212, v227, v162
v_fma_f32 v227, -v211, v227, -v163
v_mul_f32 v160, v211, v132
v_mul_f32 v161, v212, v132
v_fma_f32 v132, -v212, v228, v160
v_fma_f32 v228, -v211, v228, -v161
v_mul_f32 v162, v211, v133
v_mul_f32 v163, v212, v133
v_fma_f32 v133, -v212, v229, v162
v_fma_f32 v229, -v211, v229, -v163
v_mul_f32 v160, v211, v134
v_mul_f32 v161, v212, v134
v_fma_f32 v134, -v212, v230, v160
v_fma_f32 v230, -v211, v230, -v161
v_mul_f32 v162, v211, v135
v_mul_f32 v163, v212, v135
v_fma_f32 v135, -v212, v231, v162
v_fma_f32 v231, -v211, v231, -v163
v_mul_f32 v160, v211, v136
v_mul_f32 v161, v212, v136
v_fma_f32 v136, -v212, v232, v160
v_fma_f32 v232, -v211, v232, -v161
v_mul_f32 v162, v211, v137
v_mul_f32 v163, v212, v137
v_fma_f32 v137, -v212, v233, v162
v_fma_f32 v233, -v211, v233, -v163
v_mul_f32 v160, v211, v138
v_mul_f32 v161, v212, v138
v_fma_f32 v138, -v212, v234, v160
v_fma_f32 v234, -v211, v234, -v161
v_mul_f32 v162, v211, v139
v_mul_f32 v163, v212, v139
v_fma_f32 v139, -v212, v235, v162
v_fma_f32 v235, -v211, v235, -v163
v_mul_f32 v160, v211, v140
v_mul_f32 v161, v212, v140
v_fma_f32 v140, -v212, v236, v160
v_fma_f32 v236, -v211, v236, -v161
v_mul_f32 v162, v211, v141
v_mul_f32 v163, v212, v141
v_fma_f32 v141, -v212, v237, v162
v_fma_f32 v237, -v211, v237, -v163
v_mul_f32 v160, v211, v142
v_mul_f32 v161, v212, v142
v_fma_f32 v142, -v212, v238, v160
v_fma_f32 v238, -v211, v238, -v161
v_mul_f32 v162, v211, v143
v_mul_f32 v163, v212, v143
v_fma_f32 v143, -v212, v239, v162
v_fma_f32 v239, -v211, v239, -v163
v_mul_f32 v160, v211, v144
v_mul_f32 v161, v212, v144
v_fma_f32 v144, -v212, v240, v160
v_fma_f32 v240, -v211, v240, -v161
v_mul_f32 v162, v211, v145
v_mul_f32 v163, v212, v145
v_fma_f32 v145, -v212, v241, v162
v_fma_f32 v241, -v211, v241, -v163
v_mul_f32 v160, v211, v146
v_mul_f32 v161, v212, v146
v_fma_f32 v146, -v212, v242, v160
v_fma_f32 v242, -v211, v242, -v161
v_mul_f32 v162, v211, v147
v_mul_f32 v163, v212, v147
v_fma_f32 v147, -v212, v243, v162
v_fma_f32 v243, -v211, v243, -v163
v_mul_f32 v160, v211, v148
v_mul_f32 v161, v212, v148
v_fma_f32 v148, -v212, v244, v160
v_fma_f32 v244, -v211, v244, -v161
v_mul_f32 v162, v211, v149
v_mul_f32 v163, v212, v149
v_fma_f32 v149, -v212, v245, v162
v_fma_f32 v245, -v211, v245, -v163
v_mul_f32 v160, v211, v150
v_mul_f32 v161, v212, v150
v_fma_f32 v150, -v212, v246, v160
v_fma_f32 v246, -v211, v246, -v161
v_mul_f32 v162, v211, v151
v_mul_f32 v163, v212, v151
v_fma_f32 v151, -v212, v247, v162
v_fma_f32 v247, -v211, v247, -v163
v_mul_f32 v160, v211, v152
v_mul_f32 v161, v212, v152
v_fma_f32 v152, -v212, v248, v160
v_fma_f32 v248, -v211, v248, -v161
v_mul_f32 v162, v211, v153
v_mul_f32 v163, v212, v153
v_fma_f32 v153, -v212, v249, v162
v_fma_f32 v249, -v211, v249, -v163
v_mul_f32 v160, v211, v154
v_mul_f32 v161, v212, v154
v_fma_f32 v154, -v212, v250, v160
v_fma_f32 v250, -v211, v250, -v161
v_mul_f32 v162, v211, v155
v_mul_f32 v163, v212, v155
v_fma_f32 v155, -v212, v251, v162
T_d_3:
s_cbranch_execz T_r1
v_fma_f32 v251, -v211, v251, -v163
v_mul_f32 v160, v211, v156
v_mul_f32 v161, v212, v156
v_fma_f32 v156, -v212, v252, v160
v_fma_f32 v252, -v211, v252, -v161
v_mul_f32 v162, v211, v157
v_mul_f32 v163, v212, v157
v_fma_f32 v157, -v212, v253, v162
v_fma_f32 v253, -v211, v253, -v163
v_mul_f32 v160, v211, v158
v_mul_f32 v161, v212, v158
v_fma_f32 v158, -v212, v254, v160
v_fma_f32 v254, -v211, v254, -v161
v_mul_f32 v162, v211, v159
v_mul_f32 v163, v212, v159
v_fma_f32 v159, -v212, v255, v162
v_fma_f32 v255, -v211, v255, -v163
v_ashrrev_i32 v172, 31, v180
v_bfi_b32 v172, v172, 0, s96
v_ashrrev_i32 v173, 31, v181
v_bfi_b32 v173, v173, 0, s96
v_ashrrev_i32 v174, 31, v182
v_bfi_b32 v174, v174, 0, s96
v_ashrrev_i32 v175, 31, v183
v_bfi_b32 v175, v175, 0, s96
v_lshrrev_b32 v176, 8, v200
v_lshlrev_b32 v177, 11, v176
v_bfe_u32 v178, v200, 4, 4
v_lshl_add_u32 v177, v178, 2, v177
v_add_u32 v177, s46, v177
v_lshrrev_b32 v179, 2, v178
v_lshlrev_b32 v179, 11, v179
v_and_b32 v178, 3, v178
v_lshl_add_u32 v178, v178, 6, v179
v_lshl_add_u32 v178, v176, 4, v178
v_add_u32 v178, s46, v178
v_add_u32 v179, 1024, v177
s_add_u32 s36, s62, 144
s_lshl_b32 s36, s36, 10
s_add_u32 s36, s36, s88
s_waitcnt vmcnt(0)
v_xor_b32 v160, v185, v172
v_xor_b32 v161, v187, v172
v_or_b32 v160, v160, v161
v_xor_b32 v161, v189, v173
v_xor_b32 v162, v191, v173
v_or3_b32 v160, v160, v161, v162
v_xor_b32 v161, v193, v174
v_xor_b32 v162, v195, v174
v_or3_b32 v160, v160, v161, v162
v_xor_b32 v161, v197, v175
v_xor_b32 v162, v199, v175
v_or3_b32 v160, v160, v161, v162
v_cmp_ne_u32 vcc, 0, v160
s_cbranch_vccnz lb_20
lb_20_r:
v_fma_f32 v160, v215, v184, v188
v_fma_f32 v161, v215, v186, v190
v_fma_f32 v160, -v216, v186, v160
v_fma_f32 v161, v216, v184, v161
v_fma_f32 v162, v215, v160, v192
v_fma_f32 v163, v215, v161, v194
v_fma_f32 v162, -v216, v161, v162
v_fma_f32 v163, v216, v160, v163
v_fma_f32 v172, v215, v162, v196
v_fma_f32 v180, v215, v163, v198
v_fma_f32 v172, -v216, v163, v172
v_fma_f32 v180, v216, v162, v180
v_mov_b32 v174, v172
v_mov_b32 v182, v180
s_nop 0
v_permlane32_swap_b32 v172, v174
v_permlane32_swap_b32 v180, v182
v_mov_b32 v173, v172
v_mov_b32 v175, v174
v_mov_b32 v181, v180
v_mov_b32 v183, v182
v_permlane16_swap_b32 v172, v173
v_permlane16_swap_b32 v174, v175
v_permlane16_swap_b32 v180, v181
v_permlane16_swap_b32 v182, v183
v_fma_f32 v160, v217, v172, v173
v_fma_f32 v161, v217, v180, v181
v_fma_f32 v160, -v218, v180, v160
v_fma_f32 v161, v218, v172, v161
v_fma_f32 v162, v217, v160, v174
v_fma_f32 v163, v217, v161, v182
v_fma_f32 v162, -v218, v161, v162
v_fma_f32 v163, v218, v160, v163
v_fma_f32 v184, v217, v162, v175
v_fma_f32 v185, v217, v163, v183
v_fma_f32 v184, -v218, v163, v184
v_fma_f32 v185, v218, v162, v185
v_mov_b32 v160, v184
v_mov_b32 v161, v185
v_cmp_eq_u32 vcc, 1, v176
v_fma_f32 v186, v213, v184, v164
v_fma_f32 v187, v213, v185, v168
v_fma_f32 v186, -v214, v185, v186
v_fma_f32 v187, v214, v184, v187
v_cndmask_b32 v160, v160, v186, vcc
v_cndmask_b32 v161, v161, v187, vcc
v_cmp_eq_u32 vcc, 2, v176
v_fma_f32 v188, v213, v186, v165
v_fma_f32 v189, v213, v187, v169
v_fma_f32 v188, -v214, v187, v188
v_fma_f32 v189, v214, v186, v189
v_cndmask_b32 v160, v160, v188, vcc
v_cndmask_b32 v161, v161, v189, vcc
v_cmp_eq_u32 vcc, 3, v176
v_fma_f32 v190, v213, v188, v166
v_fma_f32 v191, v213, v189, v170
v_fma_f32 v190, -v214, v189, v190
v_fma_f32 v191, v214, v188, v191
v_cndmask_b32 v160, v160, v190, vcc
v_cndmask_b32 v161, v161, v191, vcc
v_fmac_f32 v128, v209, v160
v_fmac_f32 v224, v209, v161
v_fmac_f32 v128, v210, v161
v_fma_f32 v224, -v210, v160, v224
v_cvt_pk_bf16_f32 v162, v128, v224
v_fmac_f32 v129, v209, v128
v_fmac_f32 v225, v209, v224
v_fmac_f32 v129, v210, v224
v_fma_f32 v225, -v210, v128, v225
v_cvt_pk_bf16_f32 v163, v129, v225
v_fmac_f32 v130, v209, v129
v_fmac_f32 v226, v209, v225
v_fmac_f32 v130, v210, v225
ds_write2_b32 v177, v162, v163 offset0:0 offset1:16
v_fma_f32 v226, -v210, v129, v226
v_cvt_pk_bf16_f32 v164, v130, v226
v_fmac_f32 v131, v209, v130
v_fmac_f32 v227, v209, v226
v_fmac_f32 v131, v210, v226
v_fma_f32 v227, -v210, v130, v227
v_cvt_pk_bf16_f32 v165, v131, v227
v_fmac_f32 v132, v209, v131
v_fmac_f32 v228, v209, v227
v_fmac_f32 v132, v210, v227
ds_write2_b32 v177, v164, v165 offset0:32 offset1:48
v_fma_f32 v228, -v210, v131, v228
v_cvt_pk_bf16_f32 v166, v132, v228
v_fmac_f32 v133, v209, v132
v_fmac_f32 v229, v209, v228
v_fmac_f32 v133, v210, v228
v_fma_f32 v229, -v210, v132, v229
v_cvt_pk_bf16_f32 v167, v133, v229
ds_read_b128 v[128:131], v178 offset:0
v_fmac_f32 v134, v209, v133
v_fmac_f32 v230, v209, v229
v_fmac_f32 v134, v210, v229
ds_write2_b32 v177, v166, v167 offset0:64 offset1:80
v_fma_f32 v230, -v210, v133, v230
v_cvt_pk_bf16_f32 v168, v134, v230
v_fmac_f32 v135, v209, v134
v_fmac_f32 v231, v209, v230
v_fmac_f32 v135, v210, v230
v_fma_f32 v231, -v210, v134, v231
v_cvt_pk_bf16_f32 v169, v135, v231
v_fmac_f32 v136, v209, v135
v_fmac_f32 v232, v209, v231
v_fmac_f32 v136, v210, v231
ds_write2_b32 v177, v168, v169 offset0:96 offset1:112
v_fma_f32 v232, -v210, v135, v232
v_cvt_pk_bf16_f32 v162, v136, v232
v_fmac_f32 v137, v209, v136
v_fmac_f32 v233, v209, v232
v_fmac_f32 v137, v210, v232
v_fma_f32 v233, -v210, v136, v233
v_cvt_pk_bf16_f32 v163, v137, v233
ds_read_b128 v[132:135], v178 offset:256
s_waitcnt lgkmcnt(3)
buffer_store_dwordx4 v[128:131], v200, s[20:23], s36 offen sc1
s_add_u32 s36, s36, 184320
v_fmac_f32 v138, v209, v137
v_fmac_f32 v234, v209, v233
v_fmac_f32 v138, v210, v233
ds_write2_b32 v177, v162, v163 offset0:128 offset1:144
v_fma_f32 v234, -v210, v137, v234
v_cvt_pk_bf16_f32 v164, v138, v234
v_fmac_f32 v139, v209, v138
v_fmac_f32 v235, v209, v234
v_fmac_f32 v139, v210, v234
v_fma_f32 v235, -v210, v138, v235
v_cvt_pk_bf16_f32 v165, v139, v235
v_fmac_f32 v140, v209, v139
v_fmac_f32 v236, v209, v235
v_fmac_f32 v140, v210, v235
ds_write2_b32 v177, v164, v165 offset0:160 offset1:176
v_fma_f32 v236, -v210, v139, v236
v_cvt_pk_bf16_f32 v166, v140, v236
v_fmac_f32 v141, v209, v140
v_fmac_f32 v237, v209, v236
v_fmac_f32 v141, v210, v236
v_fma_f32 v237, -v210, v140, v237
v_cvt_pk_bf16_f32 v167, v141, v237
ds_read_b128 v[136:139], v178 offset:512
s_waitcnt lgkmcnt(3)
buffer_store_dwordx4 v[132:135], v200, s[20:23], s36 offen sc1
s_add_u32 s36, s36, 184320
v_fmac_f32 v142, v209, v141
v_fmac_f32 v238, v209, v237
v_fmac_f32 v142, v210, v237
ds_write2_b32 v177, v166, v167 offset0:192 offset1:208
v_fma_f32 v238, -v210, v141, v238
v_cvt_pk_bf16_f32 v168, v142, v238
v_fmac_f32 v143, v209, v142
v_fmac_f32 v239, v209, v238
v_fmac_f32 v143, v210, v238
v_fma_f32 v239, -v210, v142, v239
v_cvt_pk_bf16_f32 v169, v143, v239
v_fmac_f32 v144, v209, v143
v_fmac_f32 v240, v209, v239
v_fmac_f32 v144, v210, v239
ds_write2_b32 v177, v168, v169 offset0:224 offset1:240
v_fma_f32 v240, -v210, v143, v240
v_cvt_pk_bf16_f32 v162, v144, v240
v_fmac_f32 v145, v209, v144
v_fmac_f32 v241, v209, v240
v_fmac_f32 v145, v210, v240
v_fma_f32 v241, -v210, v144, v241
v_cvt_pk_bf16_f32 v163, v145, v241
ds_read_b128 v[140:143], v178 offset:768
s_waitcnt lgkmcnt(3)
buffer_store_dwordx4 v[136:139], v200, s[20:23], s36 offen sc1
s_add_u32 s36, s36, 184320
v_fmac_f32 v146, v209, v145
v_fmac_f32 v242, v209, v241
v_fmac_f32 v146, v210, v241
ds_write2_b32 v179, v162, v163 offset0:0 offset1:16
v_fma_f32 v242, -v210, v145, v242
v_cvt_pk_bf16_f32 v164, v146, v242
v_fmac_f32 v147, v209, v146
v_fmac_f32 v243, v209, v242
v_fmac_f32 v147, v210, v242
v_fma_f32 v243, -v210, v146, v243
v_cvt_pk_bf16_f32 v165, v147, v243
v_fmac_f32 v148, v209, v147
v_fmac_f32 v244, v209, v243
v_fmac_f32 v148, v210, v243
ds_write2_b32 v179, v164, v165 offset0:32 offset1:48
v_fma_f32 v244, -v210, v147, v244
v_cvt_pk_bf16_f32 v166, v148, v244
v_fmac_f32 v149, v209, v148
v_fmac_f32 v245, v209, v244
v_fmac_f32 v149, v210, v244
v_fma_f32 v245, -v210, v148, v245
v_cvt_pk_bf16_f32 v167, v149, v245
ds_read_b128 v[144:147], v178 offset:1024
s_waitcnt lgkmcnt(3)
buffer_store_dwordx4 v[140:143], v200, s[20:23], s36 offen sc1
s_add_u32 s36, s36, 184320
v_fmac_f32 v150, v209, v149
v_fmac_f32 v246, v209, v245
v_fmac_f32 v150, v210, v245
ds_write2_b32 v179, v166, v167 offset0:64 offset1:80
v_fma_f32 v246, -v210, v149, v246
v_cvt_pk_bf16_f32 v168, v150, v246
v_fmac_f32 v151, v209, v150
v_fmac_f32 v247, v209, v246
v_fmac_f32 v151, v210, v246
v_fma_f32 v247, -v210, v150, v247
v_cvt_pk_bf16_f32 v169, v151, v247
v_fmac_f32 v152, v209, v151
v_fmac_f32 v248, v209, v247
v_fmac_f32 v152, v210, v247
ds_write2_b32 v179, v168, v169 offset0:96 offset1:112
v_fma_f32 v248, -v210, v151, v248
v_cvt_pk_bf16_f32 v162, v152, v248
v_fmac_f32 v153, v209, v152
v_fmac_f32 v249, v209, v248
v_fmac_f32 v153, v210, v248
v_fma_f32 v249, -v210, v152, v249
v_cvt_pk_bf16_f32 v163, v153, v249
ds_read_b128 v[148:151], v178 offset:1280
s_waitcnt lgkmcnt(3)
buffer_store_dwordx4 v[144:147], v200, s[20:23], s36 offen sc1
s_add_u32 s36, s36, 184320
v_fmac_f32 v154, v209, v153
v_fmac_f32 v250, v209, v249
v_fmac_f32 v154, v210, v249
ds_write2_b32 v179, v162, v163 offset0:128 offset1:144
v_fma_f32 v250, -v210, v153, v250
v_cvt_pk_bf16_f32 v164, v154, v250
v_fmac_f32 v155, v209, v154
v_fmac_f32 v251, v209, v250
v_fmac_f32 v155, v210, v250
v_fma_f32 v251, -v210, v154, v251
v_cvt_pk_bf16_f32 v165, v155, v251
v_fmac_f32 v156, v209, v155
v_fmac_f32 v252, v209, v251
v_fmac_f32 v156, v210, v251
ds_write2_b32 v179, v164, v165 offset0:160 offset1:176
v_fma_f32 v252, -v210, v155, v252
v_cvt_pk_bf16_f32 v166, v156, v252
v_fmac_f32 v157, v209, v156
v_fmac_f32 v253, v209, v252
v_fmac_f32 v157, v210, v252
v_fma_f32 v253, -v210, v156, v253
v_cvt_pk_bf16_f32 v167, v157, v253
ds_read_b128 v[152:155], v178 offset:1536
s_waitcnt lgkmcnt(3)
buffer_store_dwordx4 v[148:151], v200, s[20:23], s36 offen sc1
s_add_u32 s36, s36, 184320
v_fmac_f32 v158, v209, v157
v_fmac_f32 v254, v209, v253
v_fmac_f32 v158, v210, v253
ds_write2_b32 v179, v166, v167 offset0:192 offset1:208
v_fma_f32 v254, -v210, v157, v254
v_cvt_pk_bf16_f32 v168, v158, v254
v_fmac_f32 v159, v209, v158
v_fmac_f32 v255, v209, v254
v_fmac_f32 v159, v210, v254
v_fma_f32 v255, -v210, v158, v255
v_cvt_pk_bf16_f32 v169, v159, v255
ds_write2_b32 v179, v168, v169 offset0:224 offset1:240
ds_read_b128 v[156:159], v178 offset:1792
s_waitcnt lgkmcnt(3)
buffer_store_dwordx4 v[152:155], v200, s[20:23], s36 offen sc1
s_add_u32 s36, s36, 184320
s_waitcnt lgkmcnt(0)
buffer_store_dwordx4 v[156:159], v200, s[20:23], s36 offen sc1
s_add_u32 s36, s36, 184320
s_waitcnt vmcnt(0)
v_mov_b32 v184, 0
v_mov_b32 v185, s96
s_mov_b64 exec, 1
buffer_store_dword v185, v184, s[20:23], s90 offen sc1
s_mov_b64 exec, -1
s_endpgm
lb_20:
s_mov_b32 s97, 0
spoll_21:
buffer_load_dwordx4 v[184:187], v180, s[20:23], s37 offen sc1
buffer_load_dwordx4 v[188:191], v181, s[20:23], s37 offen sc1
buffer_load_dwordx4 v[192:195], v182, s[20:23], s37 offen sc1
buffer_load_dwordx4 v[196:199], v183, s[20:23], s37 offen sc1
s_waitcnt vmcnt(0)
v_xor_b32 v160, v185, v172
v_xor_b32 v161, v187, v172
v_or_b32 v160, v160, v161
v_xor_b32 v161, v189, v173
v_xor_b32 v162, v191, v173
v_or3_b32 v160, v160, v161, v162
v_xor_b32 v161, v193, v174
v_xor_b32 v162, v195, v174
v_or3_b32 v160, v160, v161, v162
v_xor_b32 v161, v197, v175
v_xor_b32 v162, v199, v175
v_or3_b32 v160, v160, v161, v162
v_cmp_ne_u32 vcc, 0, v160
s_add_u32 s97, s97, 1
s_cmp_ge_u32 s97, 32768
s_cbranch_scc1 spoll_21_x
s_cbranch_vccnz spoll_21
spoll_21_x:
s_branch lb_20_r
L_end:
s_endpgm
.section .rodata,"a"
.p2align 6
.amdhsa_kernel recurrent_scan__ssm_conv_s5__glu_gated_bilinear__prompt_kernel
.amdhsa_next_free_vgpr 512
.amdhsa_next_free_sgpr 102
.amdhsa_accum_offset 256
.amdhsa_group_segment_fixed_size 0
.amdhsa_kernarg_size 128
.amdhsa_user_sgpr_count 2
.amdhsa_user_sgpr_kernarg_segment_ptr 1
.amdhsa_system_sgpr_workgroup_id_x 1
.end_amdhsa_kernel
```
